```python
import torch

def _softmax(x, axis=-1):
    return torch.softmax(x, dim=axis)
def _gelu(x):
    return torch.nn.functional.gelu(x, approximate="tanh")
def _silu(x):
    return torch.nn.functional.silu(x)
def _sigmoid(x):
    return torch.sigmoid(x)
def _layernorm(x, axis=-1, eps=1e-5):
    m = x.mean(dim=axis, keepdim=True)
    v = x.var(dim=axis, keepdim=True, unbiased=False)
    return (x - m) / torch.sqrt(v + eps)
def _scatter_add(tgt, idx, src, axis=0):
    return tgt.clone().index_add_(axis, idx, src)
def _segment_sum(src, seg, n):
    out = torch.zeros((n,) + src.shape[1:], dtype=src.dtype)
    return out.index_add_(0, seg, src)
def _pad(x, pw):
    flat = tuple(v for pair in reversed(pw) for v in pair)
    return torch.nn.functional.pad(x, flat)

kernel_name = 'parallel_sum__sliding_block__glu_gated_reglu__prompt'

def setup_inputs():

    _w = (lambda a: (lambda t: t.to(torch.bfloat16) if t.is_floating_point() else t)(torch.as_tensor(a)))
    def _A_setup():
        B, S, D = 1, 2048, 640
        return {
            "x": _w((lambda *s: torch.randn(*s, dtype=torch.bfloat16) * 0.05)(B, S, D)),
            "wqkv": _w((lambda *s: torch.randn(*s, dtype=torch.bfloat16) * 0.05)(D, 3 * D)),
            "wo": _w((lambda *s: torch.randn(*s, dtype=torch.bfloat16) * 0.05)(D, D)),
        }
    _A_in = _A_setup()

    def _B_setup():
        B, S, D, F = 1, 2048, 640, 1728
        return {
            "x": _w((lambda *s: torch.randn(*s, dtype=torch.bfloat16) * 0.05)(B, S, D)),
            "W_gate": _w((lambda *s: torch.randn(*s, dtype=torch.bfloat16) * 0.8)(D, F) * (2.0 / D) ** 0.5),
            "W_up": _w((lambda *s: torch.randn(*s, dtype=torch.bfloat16) * 0.8)(D, F) * (2.0 / D) ** 0.5),
            "W_down": _w((lambda *s: torch.randn(*s, dtype=torch.bfloat16) * 0.8)(F, D) * (1.0 / F) ** 0.5),
        }
    _B_in = _B_setup()

    return {
        "A_x": _A_in["x"],
        "A_wqkv": _A_in["wqkv"],
        "A_wo": _A_in["wo"],
        "B_x": _B_in["x"],
        "B_W_gate": _B_in["W_gate"],
        "B_W_up": _B_in["W_up"],
        "B_W_down": _B_in["W_down"],
    }

def reference(A_x, A_wqkv, A_wo, B_x, B_W_gate, B_W_up, B_W_down):
    def _A_ref(x, wqkv, wo):
        B, S, D = x.shape
        H = 32; Dh = D // H; W = 256
        qkv = (lambda x, *d: x.permute(*d))((x @ wqkv).reshape(B, S, 3, H, Dh), 2, 0, 3, 1, 4)
        q, k, v = qkv[0], qkv[1], qkv[2]
        scores = torch.einsum("bhqd,bhkd->bhqk", q, k) * (Dh ** -0.5)
        idx = torch.arange(S)
        mask = (idx[:, None] - idx[None, :] >= 0) & (idx[:, None] - idx[None, :] < W)
        scores = torch.where(mask[None, None], scores, -1e9)
        p = _softmax(scores, axis=-1)
        o = torch.einsum("bhqk,bhkd->bhqd", p, v)
        return (lambda x, *d: x.permute(*d))(o, 0, 2, 1, 3).reshape(B, S, D) @ wo

    def _B_ref(x, W_gate, W_up, W_down):
        gate = torch.einsum("bsd,df->bsf", x, W_gate)
        up = torch.einsum("bsd,df->bsf", x, W_up)
        gate = gate * (lambda x, dt: x.to(dt))(gate > 0, gate.dtype)
        h = gate * up
        return torch.einsum("bsf,fd->bsd", h, W_down)

    x = A_x
    xn = _layernorm(x, axis=-1)
    return x + _A_ref(xn, A_wqkv, A_wo) + _B_ref(xn, B_W_gate, B_W_up, B_W_down)
```

```asm
; @launch grid=(256,1,1) block=(512,1,1) lds=163840
.amdgcn_target "amdgcn-amd-amdhsa--gfx950"
.text
.globl parallel_sum__sliding_block__glu_gated_reglu__prompt_kernel
.p2align 8
.type parallel_sum__sliding_block__glu_gated_reglu__prompt_kernel,@function
parallel_sum__sliding_block__glu_gated_reglu__prompt_kernel:
s_cmp_ge_u32 s2, 256
s_cbranch_scc1 F_exit
s_load_dwordx16 s[4:19], s[0:1], 0
s_load_dwordx4 s[20:23], s[0:1], 64
s_memrealtime s[46:47]
v_lshrrev_b32 v1, 6, v0
v_and_b32 v2, 63, v0
v_readfirstlane_b32 s3, v1
s_waitcnt lgkmcnt(0)
s_mov_b32 s28, s4
s_and_b32 s29, s5, 0xffff
s_mov_b32 s30, 2621440
s_mov_b32 s31, 0x20000
s_cmp_ge_u32 s3, 4
s_cbranch_scc1 F_nx
s_lshl_b32 s40, s2, 2
s_add_u32 s40, s40, s3
s_mul_i32 s40, s40, 2560
v_lshrrev_b32 v9, 5, v2
v_and_b32 v3, 31, v2
v_lshlrev_b32 v3, 3, v3
v_mul_u32_u24 v8, 1280, v9
v_add_u32 v8, v8, v3
buffer_load_dwordx2 v[10:11], v8, s[28:31], s40 offen offset:0
buffer_load_dwordx2 v[12:13], v8, s[28:31], s40 offen offset:256
buffer_load_dwordx2 v[14:15], v8, s[28:31], s40 offen offset:512
buffer_load_dwordx2 v[16:17], v8, s[28:31], s40 offen offset:768
buffer_load_dwordx2 v[18:19], v8, s[28:31], s40 offen offset:1024
F_nx:
s_mov_b32 s24, s22
s_and_b32 s25, s23, 0xffff
s_mov_b32 s26, 268435456
s_mov_b32 s27, 0x20000
s_mov_b32 s36, s20
s_and_b32 s37, s21, 0xffff
s_mov_b32 s38, 256
s_mov_b32 s39, 0x20000
s_cmp_lg_u32 s3, 3
s_cbranch_scc1 F_n0
s_cmp_lg_u32 s2, 0
s_cbranch_scc1 F_n0
s_or_b32 s46, s46, 1
v_mov_b32 v4, s46
v_mov_b32 v5, 0
s_mov_b64 exec, 1
buffer_store_dword v4, v5, s[36:39], 0 offen sc1
s_mov_b64 exec, -1
F_n0:
s_and_b32 s40, s2, 7
s_lshr_b32 s41, s2, 3
s_lshr_b32 s42, s40, 2
s_lshl_b32 s42, s42, 3
s_and_b32 s43, s41, 7
s_add_u32 s60, s42, s43
s_and_b32 s42, s40, 3
s_lshr_b32 s43, s41, 3
s_lshl_b32 s43, s43, 2
s_add_u32 s61, s42, s43
s_cmp_ge_u32 s3, 4
s_cbranch_scc1 F_ldr0
s_cmp_lg_u32 s3, 0
s_cbranch_scc1 F_c0
v_mov_b32 v4, 0
v_lshlrev_b32 v5, 2, v2
s_mov_b64 exec, -2
ds_write_b32 v5, v4
s_mov_b64 exec, -1
F_c0:
s_waitcnt vmcnt(0)
v_lshlrev_b32 v30, 16, v10
v_and_b32 v31, 0xffff0000, v10
v_lshlrev_b32 v32, 16, v11
v_and_b32 v33, 0xffff0000, v11
v_lshlrev_b32 v34, 16, v12
v_and_b32 v35, 0xffff0000, v12
v_lshlrev_b32 v36, 16, v13
v_and_b32 v37, 0xffff0000, v13
v_lshlrev_b32 v38, 16, v14
v_and_b32 v39, 0xffff0000, v14
v_lshlrev_b32 v40, 16, v15
v_and_b32 v41, 0xffff0000, v15
v_lshlrev_b32 v42, 16, v16
v_and_b32 v43, 0xffff0000, v16
v_lshlrev_b32 v44, 16, v17
v_and_b32 v45, 0xffff0000, v17
v_lshlrev_b32 v46, 16, v18
v_and_b32 v47, 0xffff0000, v18
v_lshlrev_b32 v48, 16, v19
v_and_b32 v49, 0xffff0000, v19
v_pk_add_f32 v[50:51], v[30:31], v[32:33]
v_pk_add_f32 v[52:53], v[34:35], v[36:37]
v_pk_add_f32 v[50:51], v[50:51], v[38:39]
v_pk_add_f32 v[52:53], v[52:53], v[40:41]
v_pk_add_f32 v[50:51], v[50:51], v[42:43]
v_pk_add_f32 v[52:53], v[52:53], v[44:45]
v_pk_add_f32 v[50:51], v[50:51], v[46:47]
v_pk_add_f32 v[52:53], v[52:53], v[48:49]
v_pk_add_f32 v[50:51], v[50:51], v[52:53]
s_nop 0
v_add_f32 v54, v50, v51
s_nop 1
v_add_f32_dpp v54, v54, v54 quad_perm:[1,0,3,2] row_mask:0xf bank_mask:0xf
s_nop 1
v_add_f32_dpp v54, v54, v54 quad_perm:[2,3,0,1] row_mask:0xf bank_mask:0xf
s_nop 1
v_add_f32_dpp v54, v54, v54 row_half_mirror row_mask:0xf bank_mask:0xf
s_nop 1
v_add_f32_dpp v54, v54, v54 row_mirror row_mask:0xf bank_mask:0xf
s_nop 0
v_mov_b32 v55, v54
s_nop 1
v_permlane16_swap_b32 v54, v55
s_nop 0
v_add_f32 v54, v54, v55
v_mul_f32 v54, 0x3acccccd, v54
v_pk_add_f32 v[60:61], v[30:31], v[54:55] op_sel_hi:[1,0] neg_lo:[0,1] neg_hi:[0,1]
v_pk_mul_f32 v[50:51], v[60:61], v[60:61]
v_pk_add_f32 v[62:63], v[32:33], v[54:55] op_sel_hi:[1,0] neg_lo:[0,1] neg_hi:[0,1]
v_pk_mul_f32 v[52:53], v[62:63], v[62:63]
v_pk_add_f32 v[64:65], v[34:35], v[54:55] op_sel_hi:[1,0] neg_lo:[0,1] neg_hi:[0,1]
v_pk_fma_f32 v[50:51], v[64:65], v[64:65], v[50:51]
v_pk_add_f32 v[66:67], v[36:37], v[54:55] op_sel_hi:[1,0] neg_lo:[0,1] neg_hi:[0,1]
v_pk_fma_f32 v[52:53], v[66:67], v[66:67], v[52:53]
v_pk_add_f32 v[60:61], v[38:39], v[54:55] op_sel_hi:[1,0] neg_lo:[0,1] neg_hi:[0,1]
v_pk_fma_f32 v[50:51], v[60:61], v[60:61], v[50:51]
v_pk_add_f32 v[62:63], v[40:41], v[54:55] op_sel_hi:[1,0] neg_lo:[0,1] neg_hi:[0,1]
v_pk_fma_f32 v[52:53], v[62:63], v[62:63], v[52:53]
v_pk_add_f32 v[64:65], v[42:43], v[54:55] op_sel_hi:[1,0] neg_lo:[0,1] neg_hi:[0,1]
v_pk_fma_f32 v[50:51], v[64:65], v[64:65], v[50:51]
v_pk_add_f32 v[66:67], v[44:45], v[54:55] op_sel_hi:[1,0] neg_lo:[0,1] neg_hi:[0,1]
v_pk_fma_f32 v[52:53], v[66:67], v[66:67], v[52:53]
v_pk_add_f32 v[60:61], v[46:47], v[54:55] op_sel_hi:[1,0] neg_lo:[0,1] neg_hi:[0,1]
v_pk_fma_f32 v[50:51], v[60:61], v[60:61], v[50:51]
v_pk_add_f32 v[62:63], v[48:49], v[54:55] op_sel_hi:[1,0] neg_lo:[0,1] neg_hi:[0,1]
v_pk_fma_f32 v[52:53], v[62:63], v[62:63], v[52:53]
v_pk_add_f32 v[50:51], v[50:51], v[52:53]
s_nop 0
v_add_f32 v56, v50, v51
s_nop 1
v_add_f32_dpp v56, v56, v56 quad_perm:[1,0,3,2] row_mask:0xf bank_mask:0xf
s_nop 1
v_add_f32_dpp v56, v56, v56 quad_perm:[2,3,0,1] row_mask:0xf bank_mask:0xf
s_nop 1
v_add_f32_dpp v56, v56, v56 row_half_mirror row_mask:0xf bank_mask:0xf
s_nop 1
v_add_f32_dpp v56, v56, v56 row_mirror row_mask:0xf bank_mask:0xf
s_nop 0
v_mov_b32 v57, v56
s_nop 1
v_permlane16_swap_b32 v56, v57
s_nop 0
v_add_f32 v56, v56, v57
v_mul_f32 v56, 0x3acccccd, v56
v_cvt_pk_bf16_f32 v54, v54, v54
v_lshlrev_b32 v54, 16, v54
v_cvt_pk_bf16_f32 v56, v56, v56
v_lshlrev_b32 v56, 16, v56
v_add_f32 v56, 0x3727c5ac, v56
v_cvt_pk_bf16_f32 v56, v56, v56
v_lshlrev_b32 v56, 16, v56
v_sqrt_f32 v56, v56
s_nop 0
v_cvt_pk_bf16_f32 v56, v56, v56
v_lshlrev_b32 v56, 16, v56
v_rcp_f32 v58, v56
s_nop 0
v_pk_add_f32 v[30:31], v[30:31], v[54:55] op_sel_hi:[1,0] neg_lo:[0,1] neg_hi:[0,1]
v_pk_add_f32 v[32:33], v[32:33], v[54:55] op_sel_hi:[1,0] neg_lo:[0,1] neg_hi:[0,1]
v_pk_add_f32 v[34:35], v[34:35], v[54:55] op_sel_hi:[1,0] neg_lo:[0,1] neg_hi:[0,1]
v_pk_add_f32 v[36:37], v[36:37], v[54:55] op_sel_hi:[1,0] neg_lo:[0,1] neg_hi:[0,1]
v_pk_add_f32 v[38:39], v[38:39], v[54:55] op_sel_hi:[1,0] neg_lo:[0,1] neg_hi:[0,1]
v_pk_add_f32 v[40:41], v[40:41], v[54:55] op_sel_hi:[1,0] neg_lo:[0,1] neg_hi:[0,1]
v_pk_add_f32 v[42:43], v[42:43], v[54:55] op_sel_hi:[1,0] neg_lo:[0,1] neg_hi:[0,1]
v_pk_add_f32 v[44:45], v[44:45], v[54:55] op_sel_hi:[1,0] neg_lo:[0,1] neg_hi:[0,1]
v_pk_add_f32 v[46:47], v[46:47], v[54:55] op_sel_hi:[1,0] neg_lo:[0,1] neg_hi:[0,1]
v_pk_add_f32 v[48:49], v[48:49], v[54:55] op_sel_hi:[1,0] neg_lo:[0,1] neg_hi:[0,1]
v_cvt_pk_bf16_f32 v10, v30, v31
v_cvt_pk_bf16_f32 v11, v32, v33
v_cvt_pk_bf16_f32 v12, v34, v35
v_cvt_pk_bf16_f32 v13, v36, v37
v_cvt_pk_bf16_f32 v14, v38, v39
v_cvt_pk_bf16_f32 v15, v40, v41
v_cvt_pk_bf16_f32 v16, v42, v43
v_cvt_pk_bf16_f32 v17, v44, v45
v_cvt_pk_bf16_f32 v18, v46, v47
v_cvt_pk_bf16_f32 v19, v48, v49
v_lshlrev_b32 v30, 16, v10
v_and_b32 v31, 0xffff0000, v10
v_lshlrev_b32 v32, 16, v11
v_and_b32 v33, 0xffff0000, v11
v_lshlrev_b32 v34, 16, v12
v_and_b32 v35, 0xffff0000, v12
v_lshlrev_b32 v36, 16, v13
v_and_b32 v37, 0xffff0000, v13
v_lshlrev_b32 v38, 16, v14
v_and_b32 v39, 0xffff0000, v14
v_lshlrev_b32 v40, 16, v15
v_and_b32 v41, 0xffff0000, v15
v_lshlrev_b32 v42, 16, v16
v_and_b32 v43, 0xffff0000, v16
v_lshlrev_b32 v44, 16, v17
v_and_b32 v45, 0xffff0000, v17
v_lshlrev_b32 v46, 16, v18
v_and_b32 v47, 0xffff0000, v18
v_lshlrev_b32 v48, 16, v19
v_and_b32 v49, 0xffff0000, v19
v_pk_mul_f32 v[60:61], v[30:31], v[58:59] op_sel_hi:[1,0]
v_pk_mul_f32 v[62:63], v[32:33], v[58:59] op_sel_hi:[1,0]
v_pk_mul_f32 v[64:65], v[34:35], v[58:59] op_sel_hi:[1,0]
v_pk_mul_f32 v[66:67], v[36:37], v[58:59] op_sel_hi:[1,0]
v_pk_fma_f32 v[30:31], v[60:61], v[56:57], v[30:31] op_sel_hi:[1,0,1] neg_lo:[1,0,0] neg_hi:[1,0,0]
v_pk_fma_f32 v[32:33], v[62:63], v[56:57], v[32:33] op_sel_hi:[1,0,1] neg_lo:[1,0,0] neg_hi:[1,0,0]
v_pk_fma_f32 v[34:35], v[64:65], v[56:57], v[34:35] op_sel_hi:[1,0,1] neg_lo:[1,0,0] neg_hi:[1,0,0]
v_pk_fma_f32 v[36:37], v[66:67], v[56:57], v[36:37] op_sel_hi:[1,0,1] neg_lo:[1,0,0] neg_hi:[1,0,0]
v_pk_fma_f32 v[30:31], v[30:31], v[58:59], v[60:61] op_sel_hi:[1,0,1]
v_pk_fma_f32 v[32:33], v[32:33], v[58:59], v[62:63] op_sel_hi:[1,0,1]
v_pk_fma_f32 v[34:35], v[34:35], v[58:59], v[64:65] op_sel_hi:[1,0,1]
v_pk_fma_f32 v[36:37], v[36:37], v[58:59], v[66:67] op_sel_hi:[1,0,1]
v_pk_mul_f32 v[60:61], v[38:39], v[58:59] op_sel_hi:[1,0]
v_pk_mul_f32 v[62:63], v[40:41], v[58:59] op_sel_hi:[1,0]
v_pk_mul_f32 v[64:65], v[42:43], v[58:59] op_sel_hi:[1,0]
v_pk_mul_f32 v[66:67], v[44:45], v[58:59] op_sel_hi:[1,0]
v_pk_fma_f32 v[38:39], v[60:61], v[56:57], v[38:39] op_sel_hi:[1,0,1] neg_lo:[1,0,0] neg_hi:[1,0,0]
v_pk_fma_f32 v[40:41], v[62:63], v[56:57], v[40:41] op_sel_hi:[1,0,1] neg_lo:[1,0,0] neg_hi:[1,0,0]
v_pk_fma_f32 v[42:43], v[64:65], v[56:57], v[42:43] op_sel_hi:[1,0,1] neg_lo:[1,0,0] neg_hi:[1,0,0]
v_pk_fma_f32 v[44:45], v[66:67], v[56:57], v[44:45] op_sel_hi:[1,0,1] neg_lo:[1,0,0] neg_hi:[1,0,0]
v_pk_fma_f32 v[38:39], v[38:39], v[58:59], v[60:61] op_sel_hi:[1,0,1]
v_pk_fma_f32 v[40:41], v[40:41], v[58:59], v[62:63] op_sel_hi:[1,0,1]
v_pk_fma_f32 v[42:43], v[42:43], v[58:59], v[64:65] op_sel_hi:[1,0,1]
v_pk_fma_f32 v[44:45], v[44:45], v[58:59], v[66:67] op_sel_hi:[1,0,1]
v_pk_mul_f32 v[60:61], v[46:47], v[58:59] op_sel_hi:[1,0]
v_pk_mul_f32 v[62:63], v[48:49], v[58:59] op_sel_hi:[1,0]
v_pk_fma_f32 v[46:47], v[60:61], v[56:57], v[46:47] op_sel_hi:[1,0,1] neg_lo:[1,0,0] neg_hi:[1,0,0]
v_pk_fma_f32 v[48:49], v[62:63], v[56:57], v[48:49] op_sel_hi:[1,0,1] neg_lo:[1,0,0] neg_hi:[1,0,0]
v_pk_fma_f32 v[46:47], v[46:47], v[58:59], v[60:61] op_sel_hi:[1,0,1]
v_pk_fma_f32 v[48:49], v[48:49], v[58:59], v[62:63] op_sel_hi:[1,0,1]
v_cvt_pk_bf16_f32 v10, v30, v31
v_cvt_pk_bf16_f32 v11, v32, v33
v_cvt_pk_bf16_f32 v12, v34, v35
v_cvt_pk_bf16_f32 v13, v36, v37
v_cvt_pk_bf16_f32 v14, v38, v39
v_cvt_pk_bf16_f32 v15, v40, v41
v_cvt_pk_bf16_f32 v16, v42, v43
v_cvt_pk_bf16_f32 v17, v44, v45
v_cvt_pk_bf16_f32 v18, v46, v47
v_cvt_pk_bf16_f32 v19, v48, v49
s_mul_i32 s57, s3, 2592
s_add_u32 s57, s57, 1024
v_mul_u32_u24 v9, 1296, v9
v_add3_u32 v9, v9, v3, s57
ds_write_b64 v9, v[10:11] offset:0
ds_write_b64 v9, v[12:13] offset:256
ds_write_b64 v9, v[14:15] offset:512
ds_write_b64 v9, v[16:17] offset:768
ds_write_b64 v9, v[18:19] offset:1024
s_waitcnt lgkmcnt(0)
s_barrier
v_mov_b32 v5, 0
buffer_load_dword v46, v5, s[36:39], 0 offen sc1
v_lshrrev_b32 v47, 3, v0
v_and_b32 v48, 7, v0
v_mul_u32_u24 v49, 1296, v48
v_lshl_add_u32 v49, v47, 4, v49
v_add_u32 v49, 1024, v49
v_lshlrev_b32 v50, 9, v47
v_lshl_add_u32 v50, v48, 4, v50
s_lshr_b32 s57, s2, 2
s_mul_i32 s57, s57, 40960
s_and_b32 s58, s2, 3
s_lshl_b32 s58, s58, 7
s_add_u32 s57, s57, s58
s_add_u32 s57, s57, 4194304
ds_read_b128 v[52:55], v49
ds_read_b128 v[56:59], v49 offset:512
s_cmp_ge_u32 s3, 2
s_cbranch_scc1 XN_no3
ds_read_b128 v[60:63], v49 offset:1024
XN_no3:
s_add_u32 s58, s57, 16384
s_add_u32 s59, s57, 32768
s_waitcnt lgkmcnt(0)
buffer_store_dwordx4 v[52:55], v50, s[24:27], s57 offen sc1
buffer_store_dwordx4 v[56:59], v50, s[24:27], s58 offen sc1
s_cmp_ge_u32 s3, 2
s_cbranch_scc1 XN_no3b
buffer_store_dwordx4 v[60:63], v50, s[24:27], s59 offen sc1
XN_no3b:
s_barrier
v_cmp_eq_u32 vcc, 0, v2
v_mov_b32 v3, 0x80000000
s_lshl_b32 s41, s2, 5
s_add_u32 s41, s41, s3
s_lshl_b32 s41, s41, 2
s_add_u32 s41, s41, 0
v_cndmask_b32 v3, v3, 0, vcc
s_waitcnt vmcnt(0)
v_mov_b32 v4, v46
v_readfirstlane_b32 s40, v46
s_cmp_lg_u32 s40, 0
s_cbranch_scc1 F_np1
s_mov_b32 s1, 20000
v_mov_b32 v5, 0
F_np:
buffer_load_dword v4, v5, s[36:39], 0 offen sc1
s_waitcnt vmcnt(0)
v_readfirstlane_b32 s40, v4
s_cmp_lg_u32 s40, 0
s_cbranch_scc1 F_np1
s_sub_u32 s1, s1, 1
s_cmp_lg_u32 s1, 0
s_cbranch_scc1 F_np
F_np1:
v_mov_b32 v0, v4
s_mov_b32 s0, s40
buffer_store_dword v0, v3, s[24:27], s41 offen offset:0 sc1
s_cmp_lg_u32 s3, 3
s_cbranch_scc1 F_c1
v_mov_b32 v5, 0
ds_write_b32 v5, v4
s_waitcnt lgkmcnt(0)
F_c1:
s_cmp_ge_u32 s61, 11
s_cbranch_scc1 F_cC
s_cmp_ge_u32 s61, 8
s_cbranch_scc1 F_cB
F_cA:
s_mov_b32 s44, s61
s_and_b32 s45, s61, 3
s_add_u32 s45, s45, 8
s_mov_b32 s46, 0
s_lshl_b32 s47, s61, 1
s_add_u32 s48, s47, 1
s_lshr_b32 s49, s61, 2
s_mov_b32 s53, 1051011932
s_lshl_b32 s63, s60, 2
s_add_u32 s63, s63, s3
v_lshrrev_b32 v13, 5, v2
v_lshlrev_b32 v13, 3, v13
v_bfe_u32 v14, v2, 2, 2
v_add_u32 v13, v13, v14
v_lshlrev_b32 v13, 7, v13
v_bfe_u32 v14, v2, 3, 1
v_lshl_add_u32 v13, v14, 6, v13
v_bfe_u32 v14, v2, 4, 1
v_lshl_add_u32 v13, v14, 5, v13
v_and_b32 v14, 3, v2
v_lshl_add_u32 v4, v14, 3, v13
v_add_u32 v5, 0x10000, v4
v_xor_b32 v6, 64, v4
v_xor_b32 v7, 64, v5
s_lshl_b32 s50, s49, 6
v_xor_b32 v8, s50, v4
v_xor_b32 v9, s50, v5
v_lshlrev_b32 v10, 3, v2
v_lshlrev_b32 v12, 4, v2
v_lshrrev_b32 v13, 5, v2
v_mul_u32_u24 v13, 10368, v13
v_and_b32 v14, 31, v2
v_lshl_add_u32 v11, v14, 4, v13
s_mov_b32 s52, 8388608
s_cmp_ge_u32 s44, 10
s_cselect_b32 s50, 12541952, s52
s_lshl_b32 s51, s44, 12
s_add_u32 s50, s50, s51
s_mul_i32 s51, s63, 40960
s_add_u32 s64, s50, s51
s_cmp_ge_u32 s44, 10
s_cselect_b32 s56, 1.0, s53
s_mov_b32 s52, 8388608
s_cmp_ge_u32 s45, 10
s_cselect_b32 s50, 12541952, s52
s_lshl_b32 s51, s45, 12
s_add_u32 s50, s50, s51
s_mul_i32 s51, s63, 40960
s_add_u32 s65, s50, s51
s_cmp_ge_u32 s45, 10
s_cselect_b32 s57, 1.0, s53
s_lshl_b32 s50, s49, 11
s_add_u32 s65, s65, s50
s_lshl_b32 s50, s47, 12
s_mul_i32 s51, s63, 110592
s_add_u32 s50, s50, s51
s_add_u32 s70, s50, 20971520
s_lshl_b32 s50, s48, 12
s_mul_i32 s51, s63, 110592
s_add_u32 s50, s50, s51
s_add_u32 s71, s50, 20971520
v_add_u32 v4, 32768, v4
v_add_u32 v5, 32768, v5
v_add_u32 v6, 32768, v6
v_add_u32 v7, 32768, v7
v_add_u32 v8, 32768, v8
v_add_u32 v9, 32768, v9
s_lshl_b32 s58, s63, 4
s_add_u32 s58, s58, s61
s_lshl_b32 s58, s58, 9
s_add_u32 s58, s58, 524288
s_lshl_b32 s40, s3, 2
s_add_u32 s40, s40, 16
v_mov_b32 v13, s40
v_mov_b32 v14, 1
s_lshl_b32 s43, s63, 9
s_add_u32 s43, s43, 0
v_lshrrev_b32 v16, 2, v2
v_lshlrev_b32 v16, 7, v16
v_and_b32 v17, 3, v2
v_lshl_add_u32 v16, v17, 2, v16
s_mov_b32 s1, 20000
s_mov_b32 exec_lo, 65535
s_mov_b32 exec_hi, 0
FXpA:
buffer_load_dword v17, v16, s[24:27], s43 offen offset:0 sc1
s_waitcnt vmcnt(0)
v_cmp_eq_u32 vcc, s0, v17
s_nop 0
s_cmp_eq_u64 vcc, exec
s_cbranch_scc1 FXpA_ok
s_sub_u32 s1, s1, 1
s_cmp_lg_u32 s1, 0
s_cbranch_scc1 FXpA
FXpA_ok:
s_mov_b64 exec, -1
s_mul_i32 s50, s63, 40960
s_add_u32 s50, s50, 4194304
buffer_load_dwordx4 v[96:99], v12, s[24:27], s50 offen offset:0 sc1
buffer_load_dwordx4 v[100:103], v12, s[24:27], s50 offen offset:1024 sc1
buffer_load_dwordx4 v[104:107], v12, s[24:27], s50 offen offset:2048 sc1
buffer_load_dwordx4 v[108:111], v12, s[24:27], s50 offen offset:3072 sc1
s_add_u32 s50, s50, 4096
buffer_load_dwordx4 v[112:115], v12, s[24:27], s50 offen offset:0 sc1
buffer_load_dwordx4 v[116:119], v12, s[24:27], s50 offen offset:1024 sc1
buffer_load_dwordx4 v[120:123], v12, s[24:27], s50 offen offset:2048 sc1
buffer_load_dwordx4 v[124:127], v12, s[24:27], s50 offen offset:3072 sc1
s_add_u32 s50, s50, 4096
buffer_load_dwordx4 v[128:131], v12, s[24:27], s50 offen offset:0 sc1
buffer_load_dwordx4 v[132:135], v12, s[24:27], s50 offen offset:1024 sc1
buffer_load_dwordx4 v[136:139], v12, s[24:27], s50 offen offset:2048 sc1
buffer_load_dwordx4 v[140:143], v12, s[24:27], s50 offen offset:3072 sc1
s_add_u32 s50, s50, 4096
buffer_load_dwordx4 v[144:147], v12, s[24:27], s50 offen offset:0 sc1
buffer_load_dwordx4 v[148:151], v12, s[24:27], s50 offen offset:1024 sc1
buffer_load_dwordx4 v[152:155], v12, s[24:27], s50 offen offset:2048 sc1
buffer_load_dwordx4 v[156:159], v12, s[24:27], s50 offen offset:3072 sc1
s_barrier
ds_read_b64_tr_b16 v[16:17], v4 offset:32768
ds_read_b64_tr_b16 v[18:19], v4 offset:33280
ds_read_b64_tr_b16 v[20:21], v4 offset:40960
ds_read_b64_tr_b16 v[22:23], v4 offset:41472
ds_read_b64_tr_b16 v[24:25], v4 offset:34816
ds_read_b64_tr_b16 v[26:27], v4 offset:35328
ds_read_b64_tr_b16 v[28:29], v4 offset:43008
ds_read_b64_tr_b16 v[30:31], v4 offset:43520
s_waitcnt vmcnt(15) lgkmcnt(6)
v_mfma_f32_32x32x16_bf16 v[32:47], v[16:19], v[96:99], 0
ds_read_b64_tr_b16 v[16:17], v4 offset:36864
ds_read_b64_tr_b16 v[18:19], v4 offset:37376
s_waitcnt lgkmcnt(6)
v_mfma_f32_32x32x16_bf16 v[48:63], v[20:23], v[96:99], 0
ds_read_b64_tr_b16 v[20:21], v4 offset:45056
ds_read_b64_tr_b16 v[22:23], v4 offset:45568
s_waitcnt vmcnt(14) lgkmcnt(6)
v_mfma_f32_32x32x16_bf16 v[32:47], v[24:27], v[100:103], v[32:47]
ds_read_b64_tr_b16 v[24:25], v4 offset:38912
ds_read_b64_tr_b16 v[26:27], v4 offset:39424
s_waitcnt lgkmcnt(6)
v_mfma_f32_32x32x16_bf16 v[48:63], v[28:31], v[100:103], v[48:63]
ds_read_b64_tr_b16 v[28:29], v4 offset:47104
ds_read_b64_tr_b16 v[30:31], v4 offset:47616
s_add_u32 s50, s50, 4096
buffer_load_dwordx4 v[160:163], v12, s[24:27], s50 offen offset:0 sc1
s_waitcnt vmcnt(14) lgkmcnt(6)
v_mfma_f32_32x32x16_bf16 v[32:47], v[16:19], v[104:107], v[32:47]
ds_read_b64_tr_b16 v[16:17], v6 offset:32768
ds_read_b64_tr_b16 v[18:19], v6 offset:33280
s_waitcnt lgkmcnt(6)
v_mfma_f32_32x32x16_bf16 v[48:63], v[20:23], v[104:107], v[48:63]
ds_read_b64_tr_b16 v[20:21], v6 offset:40960
ds_read_b64_tr_b16 v[22:23], v6 offset:41472
s_waitcnt vmcnt(13) lgkmcnt(6)
v_mfma_f32_32x32x16_bf16 v[32:47], v[24:27], v[108:111], v[32:47]
ds_read_b64_tr_b16 v[24:25], v6 offset:34816
ds_read_b64_tr_b16 v[26:27], v6 offset:35328
s_waitcnt lgkmcnt(6)
v_mfma_f32_32x32x16_bf16 v[48:63], v[28:31], v[108:111], v[48:63]
ds_read_b64_tr_b16 v[28:29], v6 offset:43008
ds_read_b64_tr_b16 v[30:31], v6 offset:43520
buffer_load_dwordx4 v[164:167], v12, s[24:27], s50 offen offset:1024 sc1
s_waitcnt lgkmcnt(6)
v_mfma_f32_32x32x16_bf16 v[64:79], v[16:19], v[96:99], 0
ds_read_b64_tr_b16 v[16:17], v6 offset:36864
ds_read_b64_tr_b16 v[18:19], v6 offset:37376
s_waitcnt lgkmcnt(6)
v_mfma_f32_32x32x16_bf16 v[80:95], v[20:23], v[96:99], 0
ds_read_b64_tr_b16 v[20:21], v6 offset:45056
ds_read_b64_tr_b16 v[22:23], v6 offset:45568
s_waitcnt lgkmcnt(6)
v_mfma_f32_32x32x16_bf16 v[64:79], v[24:27], v[100:103], v[64:79]
ds_read_b64_tr_b16 v[24:25], v6 offset:38912
ds_read_b64_tr_b16 v[26:27], v6 offset:39424
s_waitcnt lgkmcnt(6)
v_mfma_f32_32x32x16_bf16 v[80:95], v[28:31], v[100:103], v[80:95]
s_barrier
ds_read_b64_tr_b16 v[28:29], v6 offset:47104
ds_read_b64_tr_b16 v[30:31], v6 offset:47616
buffer_load_dwordx4 v[168:171], v12, s[24:27], s50 offen offset:2048 sc1
s_waitcnt lgkmcnt(6)
v_mfma_f32_32x32x16_bf16 v[64:79], v[16:19], v[104:107], v[64:79]
ds_read_b64_tr_b16 v[16:17], v4 offset:49152
ds_read_b64_tr_b16 v[18:19], v4 offset:49664
s_waitcnt lgkmcnt(6)
v_mfma_f32_32x32x16_bf16 v[80:95], v[20:23], v[104:107], v[80:95]
ds_read_b64_tr_b16 v[20:21], v4 offset:57344
ds_read_b64_tr_b16 v[22:23], v4 offset:57856
s_waitcnt lgkmcnt(6)
v_mfma_f32_32x32x16_bf16 v[64:79], v[24:27], v[108:111], v[64:79]
ds_read_b64_tr_b16 v[24:25], v4 offset:51200
ds_read_b64_tr_b16 v[26:27], v4 offset:51712
s_waitcnt lgkmcnt(6)
v_mfma_f32_32x32x16_bf16 v[80:95], v[28:31], v[108:111], v[80:95]
ds_read_b64_tr_b16 v[28:29], v4 offset:59392
ds_read_b64_tr_b16 v[30:31], v4 offset:59904
buffer_load_dwordx4 v[172:175], v12, s[24:27], s50 offen offset:3072 sc1
s_waitcnt vmcnt(15) lgkmcnt(6)
v_mfma_f32_32x32x16_bf16 v[32:47], v[16:19], v[112:115], v[32:47]
ds_read_b64_tr_b16 v[16:17], v4 offset:53248
ds_read_b64_tr_b16 v[18:19], v4 offset:53760
s_waitcnt lgkmcnt(6)
v_mfma_f32_32x32x16_bf16 v[48:63], v[20:23], v[112:115], v[48:63]
ds_read_b64_tr_b16 v[20:21], v4 offset:61440
ds_read_b64_tr_b16 v[22:23], v4 offset:61952
s_waitcnt vmcnt(14) lgkmcnt(6)
v_mfma_f32_32x32x16_bf16 v[32:47], v[24:27], v[116:119], v[32:47]
ds_read_b64_tr_b16 v[24:25], v4 offset:55296
ds_read_b64_tr_b16 v[26:27], v4 offset:55808
s_waitcnt lgkmcnt(6)
v_mfma_f32_32x32x16_bf16 v[48:63], v[28:31], v[116:119], v[48:63]
ds_read_b64_tr_b16 v[28:29], v4 offset:63488
ds_read_b64_tr_b16 v[30:31], v4 offset:64000
s_add_u32 s50, s50, 4096
buffer_load_dwordx4 v[176:179], v12, s[24:27], s50 offen offset:0 sc1
s_waitcnt vmcnt(14) lgkmcnt(6)
v_mfma_f32_32x32x16_bf16 v[32:47], v[16:19], v[120:123], v[32:47]
ds_read_b64_tr_b16 v[16:17], v6 offset:49152
ds_read_b64_tr_b16 v[18:19], v6 offset:49664
s_waitcnt lgkmcnt(6)
v_mfma_f32_32x32x16_bf16 v[48:63], v[20:23], v[120:123], v[48:63]
ds_read_b64_tr_b16 v[20:21], v6 offset:57344
ds_read_b64_tr_b16 v[22:23], v6 offset:57856
s_waitcnt vmcnt(13) lgkmcnt(6)
v_mfma_f32_32x32x16_bf16 v[32:47], v[24:27], v[124:127], v[32:47]
ds_read_b64_tr_b16 v[24:25], v6 offset:51200
ds_read_b64_tr_b16 v[26:27], v6 offset:51712
s_waitcnt lgkmcnt(6)
v_mfma_f32_32x32x16_bf16 v[48:63], v[28:31], v[124:127], v[48:63]
ds_read_b64_tr_b16 v[28:29], v6 offset:59392
ds_read_b64_tr_b16 v[30:31], v6 offset:59904
buffer_load_dwordx4 v[180:183], v12, s[24:27], s50 offen offset:1024 sc1
s_waitcnt lgkmcnt(6)
v_mfma_f32_32x32x16_bf16 v[64:79], v[16:19], v[112:115], v[64:79]
ds_read_b64_tr_b16 v[16:17], v6 offset:53248
ds_read_b64_tr_b16 v[18:19], v6 offset:53760
s_waitcnt lgkmcnt(6)
v_mfma_f32_32x32x16_bf16 v[80:95], v[20:23], v[112:115], v[80:95]
ds_read_b64_tr_b16 v[20:21], v6 offset:61440
ds_read_b64_tr_b16 v[22:23], v6 offset:61952
s_waitcnt lgkmcnt(6)
v_mfma_f32_32x32x16_bf16 v[64:79], v[24:27], v[116:119], v[64:79]
ds_read_b64_tr_b16 v[24:25], v6 offset:55296
ds_read_b64_tr_b16 v[26:27], v6 offset:55808
s_waitcnt lgkmcnt(6)
v_mfma_f32_32x32x16_bf16 v[80:95], v[28:31], v[116:119], v[80:95]
s_barrier
ds_read_b64_tr_b16 v[28:29], v6 offset:63488
ds_read_b64_tr_b16 v[30:31], v6 offset:64000
buffer_load_dwordx4 v[184:187], v12, s[24:27], s50 offen offset:2048 sc1
s_waitcnt lgkmcnt(6)
v_mfma_f32_32x32x16_bf16 v[64:79], v[16:19], v[120:123], v[64:79]
ds_read_b64_tr_b16 v[16:17], v5 offset:0
ds_read_b64_tr_b16 v[18:19], v5 offset:512
s_waitcnt lgkmcnt(6)
v_mfma_f32_32x32x16_bf16 v[80:95], v[20:23], v[120:123], v[80:95]
ds_read_b64_tr_b16 v[20:21], v5 offset:8192
ds_read_b64_tr_b16 v[22:23], v5 offset:8704
s_waitcnt lgkmcnt(6)
v_mfma_f32_32x32x16_bf16 v[64:79], v[24:27], v[124:127], v[64:79]
ds_read_b64_tr_b16 v[24:25], v5 offset:2048
ds_read_b64_tr_b16 v[26:27], v5 offset:2560
s_waitcnt lgkmcnt(6)
v_mfma_f32_32x32x16_bf16 v[80:95], v[28:31], v[124:127], v[80:95]
ds_read_b64_tr_b16 v[28:29], v5 offset:10240
ds_read_b64_tr_b16 v[30:31], v5 offset:10752
buffer_load_dwordx4 v[188:191], v12, s[24:27], s50 offen offset:3072 sc1
s_waitcnt vmcnt(15) lgkmcnt(6)
v_mfma_f32_32x32x16_bf16 v[32:47], v[16:19], v[128:131], v[32:47]
ds_read_b64_tr_b16 v[16:17], v5 offset:4096
ds_read_b64_tr_b16 v[18:19], v5 offset:4608
s_waitcnt lgkmcnt(6)
v_mfma_f32_32x32x16_bf16 v[48:63], v[20:23], v[128:131], v[48:63]
ds_read_b64_tr_b16 v[20:21], v5 offset:12288
ds_read_b64_tr_b16 v[22:23], v5 offset:12800
s_waitcnt vmcnt(14) lgkmcnt(6)
v_mfma_f32_32x32x16_bf16 v[32:47], v[24:27], v[132:135], v[32:47]
ds_read_b64_tr_b16 v[24:25], v5 offset:6144
ds_read_b64_tr_b16 v[26:27], v5 offset:6656
s_waitcnt lgkmcnt(6)
v_mfma_f32_32x32x16_bf16 v[48:63], v[28:31], v[132:135], v[48:63]
ds_read_b64_tr_b16 v[28:29], v5 offset:14336
ds_read_b64_tr_b16 v[30:31], v5 offset:14848
s_add_u32 s50, s50, 4096
buffer_load_dwordx4 v[192:195], v12, s[24:27], s50 offen offset:0 sc1
s_waitcnt vmcnt(14) lgkmcnt(6)
v_mfma_f32_32x32x16_bf16 v[32:47], v[16:19], v[136:139], v[32:47]
ds_read_b64_tr_b16 v[16:17], v7 offset:0
ds_read_b64_tr_b16 v[18:19], v7 offset:512
s_waitcnt lgkmcnt(6)
v_mfma_f32_32x32x16_bf16 v[48:63], v[20:23], v[136:139], v[48:63]
ds_read_b64_tr_b16 v[20:21], v7 offset:8192
ds_read_b64_tr_b16 v[22:23], v7 offset:8704
s_waitcnt vmcnt(13) lgkmcnt(6)
v_mfma_f32_32x32x16_bf16 v[32:47], v[24:27], v[140:143], v[32:47]
ds_read_b64_tr_b16 v[24:25], v7 offset:2048
ds_read_b64_tr_b16 v[26:27], v7 offset:2560
s_waitcnt lgkmcnt(6)
v_mfma_f32_32x32x16_bf16 v[48:63], v[28:31], v[140:143], v[48:63]
ds_read_b64_tr_b16 v[28:29], v7 offset:10240
ds_read_b64_tr_b16 v[30:31], v7 offset:10752
buffer_load_dwordx4 v[196:199], v12, s[24:27], s50 offen offset:1024 sc1
s_waitcnt lgkmcnt(6)
v_mfma_f32_32x32x16_bf16 v[64:79], v[16:19], v[128:131], v[64:79]
ds_read_b64_tr_b16 v[16:17], v7 offset:4096
ds_read_b64_tr_b16 v[18:19], v7 offset:4608
s_waitcnt lgkmcnt(6)
v_mfma_f32_32x32x16_bf16 v[80:95], v[20:23], v[128:131], v[80:95]
ds_read_b64_tr_b16 v[20:21], v7 offset:12288
ds_read_b64_tr_b16 v[22:23], v7 offset:12800
s_waitcnt lgkmcnt(6)
v_mfma_f32_32x32x16_bf16 v[64:79], v[24:27], v[132:135], v[64:79]
ds_read_b64_tr_b16 v[24:25], v7 offset:6144
ds_read_b64_tr_b16 v[26:27], v7 offset:6656
s_waitcnt lgkmcnt(6)
v_mfma_f32_32x32x16_bf16 v[80:95], v[28:31], v[132:135], v[80:95]
s_barrier
ds_read_b64_tr_b16 v[28:29], v7 offset:14336
ds_read_b64_tr_b16 v[30:31], v7 offset:14848
buffer_load_dwordx4 v[200:203], v12, s[24:27], s50 offen offset:2048 sc1
s_waitcnt lgkmcnt(6)
v_mfma_f32_32x32x16_bf16 v[64:79], v[16:19], v[136:139], v[64:79]
ds_read_b64_tr_b16 v[16:17], v5 offset:16384
ds_read_b64_tr_b16 v[18:19], v5 offset:16896
s_waitcnt lgkmcnt(6)
v_mfma_f32_32x32x16_bf16 v[80:95], v[20:23], v[136:139], v[80:95]
ds_read_b64_tr_b16 v[20:21], v5 offset:24576
ds_read_b64_tr_b16 v[22:23], v5 offset:25088
s_waitcnt lgkmcnt(6)
v_mfma_f32_32x32x16_bf16 v[64:79], v[24:27], v[140:143], v[64:79]
ds_read_b64_tr_b16 v[24:25], v5 offset:18432
ds_read_b64_tr_b16 v[26:27], v5 offset:18944
s_waitcnt lgkmcnt(6)
v_mfma_f32_32x32x16_bf16 v[80:95], v[28:31], v[140:143], v[80:95]
ds_read_b64_tr_b16 v[28:29], v5 offset:26624
ds_read_b64_tr_b16 v[30:31], v5 offset:27136
buffer_load_dwordx4 v[204:207], v12, s[24:27], s50 offen offset:3072 sc1
s_waitcnt vmcnt(15) lgkmcnt(6)
v_mfma_f32_32x32x16_bf16 v[32:47], v[16:19], v[144:147], v[32:47]
ds_read_b64_tr_b16 v[16:17], v5 offset:20480
ds_read_b64_tr_b16 v[18:19], v5 offset:20992
s_waitcnt lgkmcnt(6)
v_mfma_f32_32x32x16_bf16 v[48:63], v[20:23], v[144:147], v[48:63]
ds_read_b64_tr_b16 v[20:21], v5 offset:28672
ds_read_b64_tr_b16 v[22:23], v5 offset:29184
s_waitcnt vmcnt(14) lgkmcnt(6)
v_mfma_f32_32x32x16_bf16 v[32:47], v[24:27], v[148:151], v[32:47]
ds_read_b64_tr_b16 v[24:25], v5 offset:22528
ds_read_b64_tr_b16 v[26:27], v5 offset:23040
s_waitcnt lgkmcnt(6)
v_mfma_f32_32x32x16_bf16 v[48:63], v[28:31], v[148:151], v[48:63]
ds_read_b64_tr_b16 v[28:29], v5 offset:30720
ds_read_b64_tr_b16 v[30:31], v5 offset:31232
s_add_u32 s50, s50, 4096
buffer_load_dwordx4 v[208:211], v12, s[24:27], s50 offen offset:0 sc1
s_waitcnt vmcnt(14) lgkmcnt(6)
v_mfma_f32_32x32x16_bf16 v[32:47], v[16:19], v[152:155], v[32:47]
ds_read_b64_tr_b16 v[16:17], v7 offset:16384
ds_read_b64_tr_b16 v[18:19], v7 offset:16896
s_waitcnt lgkmcnt(6)
v_mfma_f32_32x32x16_bf16 v[48:63], v[20:23], v[152:155], v[48:63]
ds_read_b64_tr_b16 v[20:21], v7 offset:24576
ds_read_b64_tr_b16 v[22:23], v7 offset:25088
s_waitcnt vmcnt(13) lgkmcnt(6)
v_mfma_f32_32x32x16_bf16 v[32:47], v[24:27], v[156:159], v[32:47]
ds_read_b64_tr_b16 v[24:25], v7 offset:18432
ds_read_b64_tr_b16 v[26:27], v7 offset:18944
s_waitcnt lgkmcnt(6)
v_mfma_f32_32x32x16_bf16 v[48:63], v[28:31], v[156:159], v[48:63]
ds_read_b64_tr_b16 v[28:29], v7 offset:26624
ds_read_b64_tr_b16 v[30:31], v7 offset:27136
buffer_load_dwordx4 v[212:215], v12, s[24:27], s50 offen offset:1024 sc1
s_waitcnt lgkmcnt(6)
v_mfma_f32_32x32x16_bf16 v[64:79], v[16:19], v[144:147], v[64:79]
ds_read_b64_tr_b16 v[16:17], v7 offset:20480
ds_read_b64_tr_b16 v[18:19], v7 offset:20992
s_waitcnt lgkmcnt(6)
v_mfma_f32_32x32x16_bf16 v[80:95], v[20:23], v[144:147], v[80:95]
ds_read_b64_tr_b16 v[20:21], v7 offset:28672
ds_read_b64_tr_b16 v[22:23], v7 offset:29184
s_waitcnt lgkmcnt(6)
v_mfma_f32_32x32x16_bf16 v[64:79], v[24:27], v[148:151], v[64:79]
ds_read_b64_tr_b16 v[24:25], v7 offset:22528
ds_read_b64_tr_b16 v[26:27], v7 offset:23040
s_waitcnt lgkmcnt(6)
v_mfma_f32_32x32x16_bf16 v[80:95], v[28:31], v[148:151], v[80:95]
s_barrier
ds_read_b64_tr_b16 v[28:29], v7 offset:30720
ds_read_b64_tr_b16 v[30:31], v7 offset:31232
buffer_load_dwordx4 v[216:219], v12, s[24:27], s50 offen offset:2048 sc1
s_waitcnt lgkmcnt(6)
v_mfma_f32_32x32x16_bf16 v[64:79], v[16:19], v[152:155], v[64:79]
ds_read_b64_tr_b16 v[16:17], v5 offset:32768
ds_read_b64_tr_b16 v[18:19], v5 offset:33280
s_waitcnt lgkmcnt(6)
v_mfma_f32_32x32x16_bf16 v[80:95], v[20:23], v[152:155], v[80:95]
ds_read_b64_tr_b16 v[20:21], v5 offset:40960
ds_read_b64_tr_b16 v[22:23], v5 offset:41472
s_waitcnt lgkmcnt(6)
v_mfma_f32_32x32x16_bf16 v[64:79], v[24:27], v[156:159], v[64:79]
ds_read_b64_tr_b16 v[24:25], v5 offset:34816
ds_read_b64_tr_b16 v[26:27], v5 offset:35328
s_waitcnt lgkmcnt(6)
v_mfma_f32_32x32x16_bf16 v[80:95], v[28:31], v[156:159], v[80:95]
ds_read_b64_tr_b16 v[28:29], v5 offset:43008
ds_read_b64_tr_b16 v[30:31], v5 offset:43520
buffer_load_dwordx4 v[220:223], v12, s[24:27], s50 offen offset:3072 sc1
s_waitcnt vmcnt(15) lgkmcnt(6)
v_mfma_f32_32x32x16_bf16 v[32:47], v[16:19], v[160:163], v[32:47]
ds_read_b64_tr_b16 v[16:17], v5 offset:36864
ds_read_b64_tr_b16 v[18:19], v5 offset:37376
s_waitcnt lgkmcnt(6)
v_mfma_f32_32x32x16_bf16 v[48:63], v[20:23], v[160:163], v[48:63]
ds_read_b64_tr_b16 v[20:21], v5 offset:45056
ds_read_b64_tr_b16 v[22:23], v5 offset:45568
s_waitcnt vmcnt(14) lgkmcnt(6)
v_mfma_f32_32x32x16_bf16 v[32:47], v[24:27], v[164:167], v[32:47]
ds_read_b64_tr_b16 v[24:25], v5 offset:38912
ds_read_b64_tr_b16 v[26:27], v5 offset:39424
s_waitcnt lgkmcnt(6)
v_mfma_f32_32x32x16_bf16 v[48:63], v[28:31], v[164:167], v[48:63]
ds_read_b64_tr_b16 v[28:29], v5 offset:47104
ds_read_b64_tr_b16 v[30:31], v5 offset:47616
s_add_u32 s50, s50, 4096
buffer_load_dwordx4 v[224:227], v12, s[24:27], s50 offen offset:0 sc1
s_waitcnt vmcnt(14) lgkmcnt(6)
v_mfma_f32_32x32x16_bf16 v[32:47], v[16:19], v[168:171], v[32:47]
ds_read_b64_tr_b16 v[16:17], v7 offset:32768
ds_read_b64_tr_b16 v[18:19], v7 offset:33280
s_waitcnt lgkmcnt(6)
v_mfma_f32_32x32x16_bf16 v[48:63], v[20:23], v[168:171], v[48:63]
ds_read_b64_tr_b16 v[20:21], v7 offset:40960
ds_read_b64_tr_b16 v[22:23], v7 offset:41472
s_waitcnt vmcnt(13) lgkmcnt(6)
v_mfma_f32_32x32x16_bf16 v[32:47], v[24:27], v[172:175], v[32:47]
ds_read_b64_tr_b16 v[24:25], v7 offset:34816
ds_read_b64_tr_b16 v[26:27], v7 offset:35328
s_waitcnt lgkmcnt(6)
v_mfma_f32_32x32x16_bf16 v[48:63], v[28:31], v[172:175], v[48:63]
ds_read_b64_tr_b16 v[28:29], v7 offset:43008
ds_read_b64_tr_b16 v[30:31], v7 offset:43520
buffer_load_dwordx4 v[228:231], v12, s[24:27], s50 offen offset:1024 sc1
s_waitcnt lgkmcnt(6)
v_mfma_f32_32x32x16_bf16 v[64:79], v[16:19], v[160:163], v[64:79]
ds_read_b64_tr_b16 v[16:17], v7 offset:36864
ds_read_b64_tr_b16 v[18:19], v7 offset:37376
s_waitcnt lgkmcnt(6)
v_mfma_f32_32x32x16_bf16 v[80:95], v[20:23], v[160:163], v[80:95]
ds_read_b64_tr_b16 v[20:21], v7 offset:45056
ds_read_b64_tr_b16 v[22:23], v7 offset:45568
s_waitcnt lgkmcnt(6)
v_mfma_f32_32x32x16_bf16 v[64:79], v[24:27], v[164:167], v[64:79]
ds_read_b64_tr_b16 v[24:25], v7 offset:38912
ds_read_b64_tr_b16 v[26:27], v7 offset:39424
s_waitcnt lgkmcnt(6)
v_mfma_f32_32x32x16_bf16 v[80:95], v[28:31], v[164:167], v[80:95]
s_barrier
ds_read_b64_tr_b16 v[28:29], v7 offset:47104
ds_read_b64_tr_b16 v[30:31], v7 offset:47616
buffer_load_dwordx4 v[232:235], v12, s[24:27], s50 offen offset:2048 sc1
s_waitcnt lgkmcnt(6)
v_mfma_f32_32x32x16_bf16 v[64:79], v[16:19], v[168:171], v[64:79]
ds_read_b64_tr_b16 v[16:17], v5 offset:49152
ds_read_b64_tr_b16 v[18:19], v5 offset:49664
s_waitcnt lgkmcnt(6)
v_mfma_f32_32x32x16_bf16 v[80:95], v[20:23], v[168:171], v[80:95]
ds_read_b64_tr_b16 v[20:21], v5 offset:57344
ds_read_b64_tr_b16 v[22:23], v5 offset:57856
s_waitcnt lgkmcnt(6)
v_mfma_f32_32x32x16_bf16 v[64:79], v[24:27], v[172:175], v[64:79]
ds_read_b64_tr_b16 v[24:25], v5 offset:51200
ds_read_b64_tr_b16 v[26:27], v5 offset:51712
s_waitcnt lgkmcnt(6)
v_mfma_f32_32x32x16_bf16 v[80:95], v[28:31], v[172:175], v[80:95]
ds_read_b64_tr_b16 v[28:29], v5 offset:59392
ds_read_b64_tr_b16 v[30:31], v5 offset:59904
buffer_load_dwordx4 v[236:239], v12, s[24:27], s50 offen offset:3072 sc1
s_waitcnt vmcnt(15) lgkmcnt(6)
v_mfma_f32_32x32x16_bf16 v[32:47], v[16:19], v[176:179], v[32:47]
ds_read_b64_tr_b16 v[16:17], v5 offset:53248
ds_read_b64_tr_b16 v[18:19], v5 offset:53760
s_waitcnt lgkmcnt(6)
v_mfma_f32_32x32x16_bf16 v[48:63], v[20:23], v[176:179], v[48:63]
ds_read_b64_tr_b16 v[20:21], v5 offset:61440
ds_read_b64_tr_b16 v[22:23], v5 offset:61952
s_waitcnt vmcnt(14) lgkmcnt(6)
v_mfma_f32_32x32x16_bf16 v[32:47], v[24:27], v[180:183], v[32:47]
ds_read_b64_tr_b16 v[24:25], v5 offset:55296
ds_read_b64_tr_b16 v[26:27], v5 offset:55808
s_waitcnt lgkmcnt(6)
v_mfma_f32_32x32x16_bf16 v[48:63], v[28:31], v[180:183], v[48:63]
ds_read_b64_tr_b16 v[28:29], v5 offset:63488
ds_read_b64_tr_b16 v[30:31], v5 offset:64000
s_add_u32 s50, s50, 4096
buffer_load_dwordx4 v[240:243], v12, s[24:27], s50 offen offset:0 sc1
s_waitcnt vmcnt(14) lgkmcnt(6)
v_mfma_f32_32x32x16_bf16 v[32:47], v[16:19], v[184:187], v[32:47]
ds_read_b64_tr_b16 v[16:17], v7 offset:49152
ds_read_b64_tr_b16 v[18:19], v7 offset:49664
s_waitcnt lgkmcnt(6)
v_mfma_f32_32x32x16_bf16 v[48:63], v[20:23], v[184:187], v[48:63]
ds_read_b64_tr_b16 v[20:21], v7 offset:57344
ds_read_b64_tr_b16 v[22:23], v7 offset:57856
s_waitcnt vmcnt(13) lgkmcnt(6)
v_mfma_f32_32x32x16_bf16 v[32:47], v[24:27], v[188:191], v[32:47]
ds_read_b64_tr_b16 v[24:25], v7 offset:51200
ds_read_b64_tr_b16 v[26:27], v7 offset:51712
s_waitcnt lgkmcnt(6)
v_mfma_f32_32x32x16_bf16 v[48:63], v[28:31], v[188:191], v[48:63]
ds_read_b64_tr_b16 v[28:29], v7 offset:59392
ds_read_b64_tr_b16 v[30:31], v7 offset:59904
buffer_load_dwordx4 v[244:247], v12, s[24:27], s50 offen offset:1024 sc1
s_waitcnt lgkmcnt(6)
v_mfma_f32_32x32x16_bf16 v[64:79], v[16:19], v[176:179], v[64:79]
ds_read_b64_tr_b16 v[16:17], v7 offset:53248
ds_read_b64_tr_b16 v[18:19], v7 offset:53760
s_waitcnt lgkmcnt(6)
v_mfma_f32_32x32x16_bf16 v[80:95], v[20:23], v[176:179], v[80:95]
ds_read_b64_tr_b16 v[20:21], v7 offset:61440
ds_read_b64_tr_b16 v[22:23], v7 offset:61952
s_waitcnt lgkmcnt(6)
v_mfma_f32_32x32x16_bf16 v[64:79], v[24:27], v[180:183], v[64:79]
ds_read_b64_tr_b16 v[24:25], v7 offset:55296
ds_read_b64_tr_b16 v[26:27], v7 offset:55808
s_waitcnt lgkmcnt(6)
v_mfma_f32_32x32x16_bf16 v[80:95], v[28:31], v[180:183], v[80:95]
s_barrier
ds_read_b64_tr_b16 v[28:29], v7 offset:63488
ds_read_b64_tr_b16 v[30:31], v7 offset:64000
buffer_load_dwordx4 v[248:251], v12, s[24:27], s50 offen offset:2048 sc1
s_waitcnt lgkmcnt(6)
v_mfma_f32_32x32x16_bf16 v[64:79], v[16:19], v[184:187], v[64:79]
ds_read_b64_tr_b16 v[16:17], v4 offset:0
ds_read_b64_tr_b16 v[18:19], v4 offset:512
s_waitcnt lgkmcnt(6)
v_mfma_f32_32x32x16_bf16 v[80:95], v[20:23], v[184:187], v[80:95]
ds_read_b64_tr_b16 v[20:21], v4 offset:8192
ds_read_b64_tr_b16 v[22:23], v4 offset:8704
s_waitcnt lgkmcnt(6)
v_mfma_f32_32x32x16_bf16 v[64:79], v[24:27], v[188:191], v[64:79]
ds_read_b64_tr_b16 v[24:25], v4 offset:2048
ds_read_b64_tr_b16 v[26:27], v4 offset:2560
s_waitcnt lgkmcnt(6)
v_mfma_f32_32x32x16_bf16 v[80:95], v[28:31], v[188:191], v[80:95]
ds_read_b64_tr_b16 v[28:29], v4 offset:10240
ds_read_b64_tr_b16 v[30:31], v4 offset:10752
buffer_load_dwordx4 v[252:255], v12, s[24:27], s50 offen offset:3072 sc1
s_waitcnt vmcnt(15) lgkmcnt(6)
v_mfma_f32_32x32x16_bf16 v[32:47], v[16:19], v[192:195], v[32:47]
ds_read_b64_tr_b16 v[16:17], v4 offset:4096
ds_read_b64_tr_b16 v[18:19], v4 offset:4608
s_waitcnt lgkmcnt(6)
v_mfma_f32_32x32x16_bf16 v[48:63], v[20:23], v[192:195], v[48:63]
ds_read_b64_tr_b16 v[20:21], v4 offset:12288
ds_read_b64_tr_b16 v[22:23], v4 offset:12800
s_waitcnt vmcnt(14) lgkmcnt(6)
v_mfma_f32_32x32x16_bf16 v[32:47], v[24:27], v[196:199], v[32:47]
ds_read_b64_tr_b16 v[24:25], v4 offset:6144
ds_read_b64_tr_b16 v[26:27], v4 offset:6656
s_waitcnt lgkmcnt(6)
v_mfma_f32_32x32x16_bf16 v[48:63], v[28:31], v[196:199], v[48:63]
ds_read_b64_tr_b16 v[28:29], v4 offset:14336
ds_read_b64_tr_b16 v[30:31], v4 offset:14848
s_waitcnt vmcnt(13) lgkmcnt(6)
v_mfma_f32_32x32x16_bf16 v[32:47], v[16:19], v[200:203], v[32:47]
ds_read_b64_tr_b16 v[16:17], v6 offset:0
ds_read_b64_tr_b16 v[18:19], v6 offset:512
s_waitcnt lgkmcnt(6)
v_mfma_f32_32x32x16_bf16 v[48:63], v[20:23], v[200:203], v[48:63]
ds_read_b64_tr_b16 v[20:21], v6 offset:8192
ds_read_b64_tr_b16 v[22:23], v6 offset:8704
s_waitcnt vmcnt(12) lgkmcnt(6)
v_mfma_f32_32x32x16_bf16 v[32:47], v[24:27], v[204:207], v[32:47]
ds_read_b64_tr_b16 v[24:25], v6 offset:2048
ds_read_b64_tr_b16 v[26:27], v6 offset:2560
s_waitcnt lgkmcnt(6)
v_mfma_f32_32x32x16_bf16 v[48:63], v[28:31], v[204:207], v[48:63]
ds_read_b64_tr_b16 v[28:29], v6 offset:10240
ds_read_b64_tr_b16 v[30:31], v6 offset:10752
s_waitcnt lgkmcnt(6)
v_mfma_f32_32x32x16_bf16 v[64:79], v[16:19], v[192:195], v[64:79]
ds_read_b64_tr_b16 v[16:17], v6 offset:4096
ds_read_b64_tr_b16 v[18:19], v6 offset:4608
s_waitcnt lgkmcnt(6)
v_mfma_f32_32x32x16_bf16 v[80:95], v[20:23], v[192:195], v[80:95]
ds_read_b64_tr_b16 v[20:21], v6 offset:12288
ds_read_b64_tr_b16 v[22:23], v6 offset:12800
s_waitcnt lgkmcnt(6)
v_mfma_f32_32x32x16_bf16 v[64:79], v[24:27], v[196:199], v[64:79]
ds_read_b64_tr_b16 v[24:25], v6 offset:6144
ds_read_b64_tr_b16 v[26:27], v6 offset:6656
s_waitcnt lgkmcnt(6)
v_mfma_f32_32x32x16_bf16 v[80:95], v[28:31], v[196:199], v[80:95]
s_barrier
ds_read_b64_tr_b16 v[28:29], v6 offset:14336
ds_read_b64_tr_b16 v[30:31], v6 offset:14848
s_waitcnt lgkmcnt(6)
v_mfma_f32_32x32x16_bf16 v[64:79], v[16:19], v[200:203], v[64:79]
ds_read_b64_tr_b16 v[16:17], v4 offset:16384
ds_read_b64_tr_b16 v[18:19], v4 offset:16896
s_waitcnt lgkmcnt(6)
v_mfma_f32_32x32x16_bf16 v[80:95], v[20:23], v[200:203], v[80:95]
ds_read_b64_tr_b16 v[20:21], v4 offset:24576
ds_read_b64_tr_b16 v[22:23], v4 offset:25088
s_waitcnt lgkmcnt(6)
v_mfma_f32_32x32x16_bf16 v[64:79], v[24:27], v[204:207], v[64:79]
ds_read_b64_tr_b16 v[24:25], v4 offset:18432
ds_read_b64_tr_b16 v[26:27], v4 offset:18944
s_waitcnt lgkmcnt(6)
v_mfma_f32_32x32x16_bf16 v[80:95], v[28:31], v[204:207], v[80:95]
ds_read_b64_tr_b16 v[28:29], v4 offset:26624
ds_read_b64_tr_b16 v[30:31], v4 offset:27136
s_waitcnt vmcnt(11) lgkmcnt(6)
v_mfma_f32_32x32x16_bf16 v[32:47], v[16:19], v[208:211], v[32:47]
ds_read_b64_tr_b16 v[16:17], v4 offset:20480
ds_read_b64_tr_b16 v[18:19], v4 offset:20992
s_waitcnt lgkmcnt(6)
v_mfma_f32_32x32x16_bf16 v[48:63], v[20:23], v[208:211], v[48:63]
ds_read_b64_tr_b16 v[20:21], v4 offset:28672
ds_read_b64_tr_b16 v[22:23], v4 offset:29184
s_waitcnt vmcnt(10) lgkmcnt(6)
v_mfma_f32_32x32x16_bf16 v[32:47], v[24:27], v[212:215], v[32:47]
ds_read_b64_tr_b16 v[24:25], v4 offset:22528
ds_read_b64_tr_b16 v[26:27], v4 offset:23040
s_waitcnt lgkmcnt(6)
v_mfma_f32_32x32x16_bf16 v[48:63], v[28:31], v[212:215], v[48:63]
ds_read_b64_tr_b16 v[28:29], v4 offset:30720
ds_read_b64_tr_b16 v[30:31], v4 offset:31232
s_waitcnt vmcnt(9) lgkmcnt(6)
v_mfma_f32_32x32x16_bf16 v[32:47], v[16:19], v[216:219], v[32:47]
ds_read_b64_tr_b16 v[16:17], v4 offset:32768
ds_read_b64_tr_b16 v[18:19], v4 offset:33280
s_waitcnt lgkmcnt(6)
v_mfma_f32_32x32x16_bf16 v[48:63], v[20:23], v[216:219], v[48:63]
ds_read_b64_tr_b16 v[20:21], v4 offset:40960
ds_read_b64_tr_b16 v[22:23], v4 offset:41472
s_waitcnt vmcnt(8) lgkmcnt(6)
v_mfma_f32_32x32x16_bf16 v[32:47], v[24:27], v[220:223], v[32:47]
ds_read_b64_tr_b16 v[24:25], v4 offset:34816
ds_read_b64_tr_b16 v[26:27], v4 offset:35328
s_waitcnt lgkmcnt(6)
v_mfma_f32_32x32x16_bf16 v[48:63], v[28:31], v[220:223], v[48:63]
ds_read_b64_tr_b16 v[28:29], v4 offset:43008
ds_read_b64_tr_b16 v[30:31], v4 offset:43520
s_waitcnt vmcnt(7) lgkmcnt(6)
v_mfma_f32_32x32x16_bf16 v[32:47], v[16:19], v[224:227], v[32:47]
ds_read_b64_tr_b16 v[16:17], v4 offset:36864
ds_read_b64_tr_b16 v[18:19], v4 offset:37376
s_waitcnt lgkmcnt(6)
v_mfma_f32_32x32x16_bf16 v[48:63], v[20:23], v[224:227], v[48:63]
ds_read_b64_tr_b16 v[20:21], v4 offset:45056
ds_read_b64_tr_b16 v[22:23], v4 offset:45568
s_waitcnt vmcnt(6) lgkmcnt(6)
v_mfma_f32_32x32x16_bf16 v[32:47], v[24:27], v[228:231], v[32:47]
ds_read_b64_tr_b16 v[24:25], v4 offset:38912
ds_read_b64_tr_b16 v[26:27], v4 offset:39424
s_waitcnt lgkmcnt(6)
v_mfma_f32_32x32x16_bf16 v[48:63], v[28:31], v[228:231], v[48:63]
s_barrier
ds_read_b64_tr_b16 v[28:29], v4 offset:47104
ds_read_b64_tr_b16 v[30:31], v4 offset:47616
s_waitcnt vmcnt(5) lgkmcnt(6)
v_mfma_f32_32x32x16_bf16 v[32:47], v[16:19], v[232:235], v[32:47]
ds_read_b64_tr_b16 v[16:17], v4 offset:49152
ds_read_b64_tr_b16 v[18:19], v4 offset:49664
s_waitcnt lgkmcnt(6)
v_mfma_f32_32x32x16_bf16 v[48:63], v[20:23], v[232:235], v[48:63]
ds_read_b64_tr_b16 v[20:21], v4 offset:57344
ds_read_b64_tr_b16 v[22:23], v4 offset:57856
s_waitcnt vmcnt(4) lgkmcnt(6)
v_mfma_f32_32x32x16_bf16 v[32:47], v[24:27], v[236:239], v[32:47]
ds_read_b64_tr_b16 v[24:25], v4 offset:51200
ds_read_b64_tr_b16 v[26:27], v4 offset:51712
s_waitcnt lgkmcnt(6)
v_mfma_f32_32x32x16_bf16 v[48:63], v[28:31], v[236:239], v[48:63]
ds_read_b64_tr_b16 v[28:29], v4 offset:59392
ds_read_b64_tr_b16 v[30:31], v4 offset:59904
s_waitcnt vmcnt(3) lgkmcnt(6)
v_mfma_f32_32x32x16_bf16 v[32:47], v[16:19], v[240:243], v[32:47]
ds_read_b64_tr_b16 v[16:17], v4 offset:53248
ds_read_b64_tr_b16 v[18:19], v4 offset:53760
s_waitcnt lgkmcnt(6)
v_mfma_f32_32x32x16_bf16 v[48:63], v[20:23], v[240:243], v[48:63]
ds_read_b64_tr_b16 v[20:21], v4 offset:61440
ds_read_b64_tr_b16 v[22:23], v4 offset:61952
s_waitcnt vmcnt(2) lgkmcnt(6)
v_mfma_f32_32x32x16_bf16 v[32:47], v[24:27], v[244:247], v[32:47]
ds_read_b64_tr_b16 v[24:25], v4 offset:55296
ds_read_b64_tr_b16 v[26:27], v4 offset:55808
s_waitcnt lgkmcnt(6)
v_mfma_f32_32x32x16_bf16 v[48:63], v[28:31], v[244:247], v[48:63]
ds_read_b64_tr_b16 v[28:29], v4 offset:63488
ds_read_b64_tr_b16 v[30:31], v4 offset:64000
s_waitcnt vmcnt(1) lgkmcnt(6)
v_mfma_f32_32x32x16_bf16 v[32:47], v[16:19], v[248:251], v[32:47]
ds_read_b64_tr_b16 v[16:17], v6 offset:16384
ds_read_b64_tr_b16 v[18:19], v6 offset:16896
s_waitcnt lgkmcnt(6)
v_mfma_f32_32x32x16_bf16 v[48:63], v[20:23], v[248:251], v[48:63]
ds_read_b64_tr_b16 v[20:21], v6 offset:24576
ds_read_b64_tr_b16 v[22:23], v6 offset:25088
s_waitcnt vmcnt(0) lgkmcnt(6)
v_mfma_f32_32x32x16_bf16 v[32:47], v[24:27], v[252:255], v[32:47]
ds_read_b64_tr_b16 v[24:25], v6 offset:18432
ds_read_b64_tr_b16 v[26:27], v6 offset:18944
s_waitcnt lgkmcnt(6)
v_mfma_f32_32x32x16_bf16 v[48:63], v[28:31], v[252:255], v[48:63]
ds_read_b64_tr_b16 v[28:29], v6 offset:26624
ds_read_b64_tr_b16 v[30:31], v6 offset:27136
s_waitcnt lgkmcnt(6)
v_mfma_f32_32x32x16_bf16 v[64:79], v[16:19], v[208:211], v[64:79]
ds_read_b64_tr_b16 v[16:17], v6 offset:20480
ds_read_b64_tr_b16 v[18:19], v6 offset:20992
s_waitcnt lgkmcnt(6)
v_mfma_f32_32x32x16_bf16 v[80:95], v[20:23], v[208:211], v[80:95]
ds_read_b64_tr_b16 v[20:21], v6 offset:28672
ds_read_b64_tr_b16 v[22:23], v6 offset:29184
s_waitcnt lgkmcnt(6)
v_mfma_f32_32x32x16_bf16 v[64:79], v[24:27], v[212:215], v[64:79]
ds_read_b64_tr_b16 v[24:25], v6 offset:22528
ds_read_b64_tr_b16 v[26:27], v6 offset:23040
s_waitcnt lgkmcnt(6)
v_mfma_f32_32x32x16_bf16 v[80:95], v[28:31], v[212:215], v[80:95]
s_barrier
ds_read_b64_tr_b16 v[28:29], v6 offset:30720
ds_read_b64_tr_b16 v[30:31], v6 offset:31232
v_max_f32 v32, 0, v32
v_mul_f32 v32, v32, v48
v_max_f32 v33, 0, v33
s_waitcnt lgkmcnt(6)
v_mfma_f32_32x32x16_bf16 v[64:79], v[16:19], v[216:219], v[64:79]
ds_read_b64_tr_b16 v[16:17], v6 offset:32768
ds_read_b64_tr_b16 v[18:19], v6 offset:33280
v_mul_f32 v33, v33, v49
v_max_f32 v34, 0, v34
v_mul_f32 v34, v34, v50
s_waitcnt lgkmcnt(6)
v_mfma_f32_32x32x16_bf16 v[80:95], v[20:23], v[216:219], v[80:95]
ds_read_b64_tr_b16 v[20:21], v6 offset:40960
ds_read_b64_tr_b16 v[22:23], v6 offset:41472
v_max_f32 v35, 0, v35
v_mul_f32 v35, v35, v51
v_max_f32 v36, 0, v36
s_waitcnt lgkmcnt(6)
v_mfma_f32_32x32x16_bf16 v[64:79], v[24:27], v[220:223], v[64:79]
ds_read_b64_tr_b16 v[24:25], v6 offset:34816
ds_read_b64_tr_b16 v[26:27], v6 offset:35328
v_mul_f32 v36, v36, v52
v_max_f32 v37, 0, v37
v_mul_f32 v37, v37, v53
s_waitcnt lgkmcnt(6)
v_mfma_f32_32x32x16_bf16 v[80:95], v[28:31], v[220:223], v[80:95]
ds_read_b64_tr_b16 v[28:29], v6 offset:43008
ds_read_b64_tr_b16 v[30:31], v6 offset:43520
v_max_f32 v38, 0, v38
v_mul_f32 v38, v38, v54
v_max_f32 v39, 0, v39
s_waitcnt lgkmcnt(6)
v_mfma_f32_32x32x16_bf16 v[64:79], v[16:19], v[224:227], v[64:79]
ds_read_b64_tr_b16 v[16:17], v6 offset:36864
ds_read_b64_tr_b16 v[18:19], v6 offset:37376
v_mul_f32 v39, v39, v55
v_cvt_pk_bf16_f32 v32, v32, v33
v_cvt_pk_bf16_f32 v33, v34, v35
s_waitcnt lgkmcnt(6)
v_mfma_f32_32x32x16_bf16 v[80:95], v[20:23], v[224:227], v[80:95]
ds_read_b64_tr_b16 v[20:21], v6 offset:45056
ds_read_b64_tr_b16 v[22:23], v6 offset:45568
v_cvt_pk_bf16_f32 v34, v36, v37
v_cvt_pk_bf16_f32 v35, v38, v39
buffer_store_dwordx4 v[32:35], v12, s[24:27], s70 offen offset:0 sc1
s_waitcnt lgkmcnt(6)
v_mfma_f32_32x32x16_bf16 v[64:79], v[24:27], v[228:231], v[64:79]
ds_read_b64_tr_b16 v[24:25], v6 offset:38912
ds_read_b64_tr_b16 v[26:27], v6 offset:39424
v_max_f32 v40, 0, v40
v_mul_f32 v40, v40, v56
v_max_f32 v41, 0, v41
s_waitcnt lgkmcnt(6)
v_mfma_f32_32x32x16_bf16 v[80:95], v[28:31], v[228:231], v[80:95]
ds_read_b64_tr_b16 v[28:29], v6 offset:47104
ds_read_b64_tr_b16 v[30:31], v6 offset:47616
v_mul_f32 v41, v41, v57
v_max_f32 v42, 0, v42
v_mul_f32 v42, v42, v58
s_waitcnt lgkmcnt(6)
v_mfma_f32_32x32x16_bf16 v[64:79], v[16:19], v[232:235], v[64:79]
ds_read_b64_tr_b16 v[16:17], v6 offset:49152
ds_read_b64_tr_b16 v[18:19], v6 offset:49664
v_max_f32 v43, 0, v43
v_mul_f32 v43, v43, v59
v_max_f32 v44, 0, v44
s_waitcnt lgkmcnt(6)
v_mfma_f32_32x32x16_bf16 v[80:95], v[20:23], v[232:235], v[80:95]
ds_read_b64_tr_b16 v[20:21], v6 offset:57344
ds_read_b64_tr_b16 v[22:23], v6 offset:57856
v_mul_f32 v44, v44, v60
v_max_f32 v45, 0, v45
v_mul_f32 v45, v45, v61
s_waitcnt lgkmcnt(6)
v_mfma_f32_32x32x16_bf16 v[64:79], v[24:27], v[236:239], v[64:79]
ds_read_b64_tr_b16 v[24:25], v6 offset:51200
ds_read_b64_tr_b16 v[26:27], v6 offset:51712
v_max_f32 v46, 0, v46
v_mul_f32 v46, v46, v62
v_max_f32 v47, 0, v47
s_waitcnt lgkmcnt(6)
v_mfma_f32_32x32x16_bf16 v[80:95], v[28:31], v[236:239], v[80:95]
ds_read_b64_tr_b16 v[28:29], v6 offset:59392
ds_read_b64_tr_b16 v[30:31], v6 offset:59904
v_mul_f32 v47, v47, v63
v_cvt_pk_bf16_f32 v40, v40, v41
v_cvt_pk_bf16_f32 v41, v42, v43
s_waitcnt lgkmcnt(6)
v_mfma_f32_32x32x16_bf16 v[64:79], v[16:19], v[240:243], v[64:79]
ds_read_b64_tr_b16 v[16:17], v6 offset:53248
ds_read_b64_tr_b16 v[18:19], v6 offset:53760
v_cvt_pk_bf16_f32 v42, v44, v45
v_cvt_pk_bf16_f32 v43, v46, v47
buffer_store_dwordx4 v[40:43], v12, s[24:27], s70 offen offset:1024 sc1
s_waitcnt lgkmcnt(6)
v_mfma_f32_32x32x16_bf16 v[80:95], v[20:23], v[240:243], v[80:95]
ds_read_b64_tr_b16 v[20:21], v6 offset:61440
ds_read_b64_tr_b16 v[22:23], v6 offset:61952
s_waitcnt lgkmcnt(6)
v_mfma_f32_32x32x16_bf16 v[64:79], v[24:27], v[244:247], v[64:79]
ds_read_b64_tr_b16 v[24:25], v6 offset:55296
ds_read_b64_tr_b16 v[26:27], v6 offset:55808
s_waitcnt lgkmcnt(6)
v_mfma_f32_32x32x16_bf16 v[80:95], v[28:31], v[244:247], v[80:95]
s_barrier
ds_read_b64_tr_b16 v[28:29], v6 offset:63488
ds_read_b64_tr_b16 v[30:31], v6 offset:64000
s_waitcnt lgkmcnt(6)
v_mfma_f32_32x32x16_bf16 v[64:79], v[16:19], v[248:251], v[64:79]
ds_read_b64_tr_b16 v[16:17], v5 offset:0
ds_read_b64_tr_b16 v[18:19], v5 offset:512
s_waitcnt lgkmcnt(6)
v_mfma_f32_32x32x16_bf16 v[80:95], v[20:23], v[248:251], v[80:95]
ds_read_b64_tr_b16 v[20:21], v7 offset:0
ds_read_b64_tr_b16 v[22:23], v7 offset:512
s_waitcnt lgkmcnt(6)
v_mfma_f32_32x32x16_bf16 v[64:79], v[24:27], v[252:255], v[64:79]
ds_read_b64_tr_b16 v[24:25], v5 offset:2048
ds_read_b64_tr_b16 v[26:27], v5 offset:2560
s_waitcnt lgkmcnt(6)
v_mfma_f32_32x32x16_bf16 v[80:95], v[28:31], v[252:255], v[80:95]
ds_read_b64_tr_b16 v[28:29], v7 offset:2048
ds_read_b64_tr_b16 v[30:31], v7 offset:2560
s_waitcnt lgkmcnt(6)
v_mfma_f32_32x32x16_bf16 v[32:47], v[16:19], v[96:99], 0
ds_read_b64_tr_b16 v[16:17], v5 offset:4096
ds_read_b64_tr_b16 v[18:19], v5 offset:4608
s_waitcnt lgkmcnt(6)
v_mfma_f32_32x32x16_bf16 v[48:63], v[20:23], v[96:99], 0
ds_read_b64_tr_b16 v[20:21], v7 offset:4096
ds_read_b64_tr_b16 v[22:23], v7 offset:4608
s_waitcnt lgkmcnt(6)
v_mfma_f32_32x32x16_bf16 v[32:47], v[24:27], v[100:103], v[32:47]
ds_read_b64_tr_b16 v[24:25], v5 offset:6144
ds_read_b64_tr_b16 v[26:27], v5 offset:6656
s_waitcnt lgkmcnt(6)
v_mfma_f32_32x32x16_bf16 v[48:63], v[28:31], v[100:103], v[48:63]
ds_read_b64_tr_b16 v[28:29], v7 offset:6144
ds_read_b64_tr_b16 v[30:31], v7 offset:6656
v_max_f32 v64, 0, v64
v_mul_f32 v64, v64, v80
v_max_f32 v65, 0, v65
s_waitcnt lgkmcnt(6)
v_mfma_f32_32x32x16_bf16 v[32:47], v[16:19], v[104:107], v[32:47]
ds_read_b64_tr_b16 v[16:17], v5 offset:8192
ds_read_b64_tr_b16 v[18:19], v5 offset:8704
v_mul_f32 v65, v65, v81
v_max_f32 v66, 0, v66
v_mul_f32 v66, v66, v82
s_waitcnt lgkmcnt(6)
v_mfma_f32_32x32x16_bf16 v[48:63], v[20:23], v[104:107], v[48:63]
ds_read_b64_tr_b16 v[20:21], v7 offset:8192
ds_read_b64_tr_b16 v[22:23], v7 offset:8704
v_max_f32 v67, 0, v67
v_mul_f32 v67, v67, v83
v_max_f32 v68, 0, v68
s_waitcnt lgkmcnt(6)
v_mfma_f32_32x32x16_bf16 v[32:47], v[24:27], v[108:111], v[32:47]
ds_read_b64_tr_b16 v[24:25], v5 offset:10240
ds_read_b64_tr_b16 v[26:27], v5 offset:10752
v_mul_f32 v68, v68, v84
v_max_f32 v69, 0, v69
v_mul_f32 v69, v69, v85
s_waitcnt lgkmcnt(6)
v_mfma_f32_32x32x16_bf16 v[48:63], v[28:31], v[108:111], v[48:63]
ds_read_b64_tr_b16 v[28:29], v7 offset:10240
ds_read_b64_tr_b16 v[30:31], v7 offset:10752
v_max_f32 v70, 0, v70
v_mul_f32 v70, v70, v86
v_max_f32 v71, 0, v71
s_waitcnt lgkmcnt(6)
v_mfma_f32_32x32x16_bf16 v[32:47], v[16:19], v[112:115], v[32:47]
ds_read_b64_tr_b16 v[16:17], v5 offset:12288
ds_read_b64_tr_b16 v[18:19], v5 offset:12800
v_mul_f32 v71, v71, v87
v_cvt_pk_bf16_f32 v64, v64, v65
v_cvt_pk_bf16_f32 v65, v66, v67
s_waitcnt lgkmcnt(6)
v_mfma_f32_32x32x16_bf16 v[48:63], v[20:23], v[112:115], v[48:63]
ds_read_b64_tr_b16 v[20:21], v7 offset:12288
ds_read_b64_tr_b16 v[22:23], v7 offset:12800
v_cvt_pk_bf16_f32 v66, v68, v69
v_cvt_pk_bf16_f32 v67, v70, v71
buffer_store_dwordx4 v[64:67], v12, s[24:27], s70 offen offset:2048 sc1
s_waitcnt lgkmcnt(6)
v_mfma_f32_32x32x16_bf16 v[32:47], v[24:27], v[116:119], v[32:47]
ds_read_b64_tr_b16 v[24:25], v5 offset:14336
ds_read_b64_tr_b16 v[26:27], v5 offset:14848
v_max_f32 v72, 0, v72
v_mul_f32 v72, v72, v88
v_max_f32 v73, 0, v73
s_waitcnt lgkmcnt(6)
v_mfma_f32_32x32x16_bf16 v[48:63], v[28:31], v[116:119], v[48:63]
s_barrier
ds_read_b64_tr_b16 v[28:29], v7 offset:14336
ds_read_b64_tr_b16 v[30:31], v7 offset:14848
v_mul_f32 v73, v73, v89
v_max_f32 v74, 0, v74
v_mul_f32 v74, v74, v90
s_waitcnt lgkmcnt(6)
v_mfma_f32_32x32x16_bf16 v[32:47], v[16:19], v[120:123], v[32:47]
ds_read_b64_tr_b16 v[16:17], v5 offset:16384
ds_read_b64_tr_b16 v[18:19], v5 offset:16896
v_max_f32 v75, 0, v75
v_mul_f32 v75, v75, v91
v_max_f32 v76, 0, v76
s_waitcnt lgkmcnt(6)
v_mfma_f32_32x32x16_bf16 v[48:63], v[20:23], v[120:123], v[48:63]
ds_read_b64_tr_b16 v[20:21], v7 offset:16384
ds_read_b64_tr_b16 v[22:23], v7 offset:16896
v_mul_f32 v76, v76, v92
v_max_f32 v77, 0, v77
v_mul_f32 v77, v77, v93
s_waitcnt lgkmcnt(6)
v_mfma_f32_32x32x16_bf16 v[32:47], v[24:27], v[124:127], v[32:47]
ds_read_b64_tr_b16 v[24:25], v5 offset:18432
ds_read_b64_tr_b16 v[26:27], v5 offset:18944
v_max_f32 v78, 0, v78
v_mul_f32 v78, v78, v94
v_max_f32 v79, 0, v79
s_waitcnt lgkmcnt(6)
v_mfma_f32_32x32x16_bf16 v[48:63], v[28:31], v[124:127], v[48:63]
ds_read_b64_tr_b16 v[28:29], v7 offset:18432
ds_read_b64_tr_b16 v[30:31], v7 offset:18944
v_mul_f32 v79, v79, v95
v_cvt_pk_bf16_f32 v72, v72, v73
v_cvt_pk_bf16_f32 v73, v74, v75
s_waitcnt lgkmcnt(6)
v_mfma_f32_32x32x16_bf16 v[32:47], v[16:19], v[128:131], v[32:47]
ds_read_b64_tr_b16 v[16:17], v5 offset:20480
ds_read_b64_tr_b16 v[18:19], v5 offset:20992
v_cvt_pk_bf16_f32 v74, v76, v77
v_cvt_pk_bf16_f32 v75, v78, v79
buffer_store_dwordx4 v[72:75], v12, s[24:27], s70 offen offset:3072 sc1
s_waitcnt lgkmcnt(6)
v_mfma_f32_32x32x16_bf16 v[48:63], v[20:23], v[128:131], v[48:63]
ds_read_b64_tr_b16 v[20:21], v7 offset:20480
ds_read_b64_tr_b16 v[22:23], v7 offset:20992
s_waitcnt lgkmcnt(6)
v_mfma_f32_32x32x16_bf16 v[32:47], v[24:27], v[132:135], v[32:47]
ds_read_b64_tr_b16 v[24:25], v5 offset:22528
ds_read_b64_tr_b16 v[26:27], v5 offset:23040
s_waitcnt lgkmcnt(6)
v_mfma_f32_32x32x16_bf16 v[48:63], v[28:31], v[132:135], v[48:63]
ds_read_b64_tr_b16 v[28:29], v7 offset:22528
ds_read_b64_tr_b16 v[30:31], v7 offset:23040
s_waitcnt lgkmcnt(6)
v_mfma_f32_32x32x16_bf16 v[32:47], v[16:19], v[136:139], v[32:47]
ds_read_b64_tr_b16 v[16:17], v5 offset:24576
ds_read_b64_tr_b16 v[18:19], v5 offset:25088
s_waitcnt lgkmcnt(6)
v_mfma_f32_32x32x16_bf16 v[48:63], v[20:23], v[136:139], v[48:63]
ds_read_b64_tr_b16 v[20:21], v7 offset:24576
ds_read_b64_tr_b16 v[22:23], v7 offset:25088
s_waitcnt lgkmcnt(6)
v_mfma_f32_32x32x16_bf16 v[32:47], v[24:27], v[140:143], v[32:47]
ds_read_b64_tr_b16 v[24:25], v5 offset:26624
ds_read_b64_tr_b16 v[26:27], v5 offset:27136
s_waitcnt lgkmcnt(6)
v_mfma_f32_32x32x16_bf16 v[48:63], v[28:31], v[140:143], v[48:63]
ds_read_b64_tr_b16 v[28:29], v7 offset:26624
ds_read_b64_tr_b16 v[30:31], v7 offset:27136
s_waitcnt lgkmcnt(6)
v_mfma_f32_32x32x16_bf16 v[32:47], v[16:19], v[144:147], v[32:47]
ds_read_b64_tr_b16 v[16:17], v5 offset:28672
ds_read_b64_tr_b16 v[18:19], v5 offset:29184
s_waitcnt lgkmcnt(6)
v_mfma_f32_32x32x16_bf16 v[48:63], v[20:23], v[144:147], v[48:63]
ds_read_b64_tr_b16 v[20:21], v7 offset:28672
ds_read_b64_tr_b16 v[22:23], v7 offset:29184
s_waitcnt lgkmcnt(6)
v_mfma_f32_32x32x16_bf16 v[32:47], v[24:27], v[148:151], v[32:47]
ds_read_b64_tr_b16 v[24:25], v5 offset:30720
ds_read_b64_tr_b16 v[26:27], v5 offset:31232
s_waitcnt lgkmcnt(6)
v_mfma_f32_32x32x16_bf16 v[48:63], v[28:31], v[148:151], v[48:63]
s_barrier
ds_read_b64_tr_b16 v[28:29], v7 offset:30720
ds_read_b64_tr_b16 v[30:31], v7 offset:31232
s_waitcnt lgkmcnt(6)
v_mfma_f32_32x32x16_bf16 v[32:47], v[16:19], v[152:155], v[32:47]
ds_read_b64_tr_b16 v[16:17], v5 offset:32768
ds_read_b64_tr_b16 v[18:19], v5 offset:33280
s_waitcnt lgkmcnt(6)
v_mfma_f32_32x32x16_bf16 v[48:63], v[20:23], v[152:155], v[48:63]
ds_read_b64_tr_b16 v[20:21], v7 offset:32768
ds_read_b64_tr_b16 v[22:23], v7 offset:33280
s_waitcnt lgkmcnt(6)
v_mfma_f32_32x32x16_bf16 v[32:47], v[24:27], v[156:159], v[32:47]
ds_read_b64_tr_b16 v[24:25], v5 offset:34816
ds_read_b64_tr_b16 v[26:27], v5 offset:35328
s_waitcnt lgkmcnt(6)
v_mfma_f32_32x32x16_bf16 v[48:63], v[28:31], v[156:159], v[48:63]
ds_read_b64_tr_b16 v[28:29], v7 offset:34816
ds_read_b64_tr_b16 v[30:31], v7 offset:35328
s_waitcnt lgkmcnt(6)
v_mfma_f32_32x32x16_bf16 v[32:47], v[16:19], v[160:163], v[32:47]
ds_read_b64_tr_b16 v[16:17], v5 offset:36864
ds_read_b64_tr_b16 v[18:19], v5 offset:37376
s_waitcnt lgkmcnt(6)
v_mfma_f32_32x32x16_bf16 v[48:63], v[20:23], v[160:163], v[48:63]
ds_read_b64_tr_b16 v[20:21], v7 offset:36864
ds_read_b64_tr_b16 v[22:23], v7 offset:37376
s_waitcnt lgkmcnt(6)
v_mfma_f32_32x32x16_bf16 v[32:47], v[24:27], v[164:167], v[32:47]
ds_read_b64_tr_b16 v[24:25], v5 offset:38912
ds_read_b64_tr_b16 v[26:27], v5 offset:39424
s_waitcnt lgkmcnt(6)
v_mfma_f32_32x32x16_bf16 v[48:63], v[28:31], v[164:167], v[48:63]
ds_read_b64_tr_b16 v[28:29], v7 offset:38912
ds_read_b64_tr_b16 v[30:31], v7 offset:39424
s_waitcnt lgkmcnt(6)
v_mfma_f32_32x32x16_bf16 v[32:47], v[16:19], v[168:171], v[32:47]
ds_read_b64_tr_b16 v[16:17], v5 offset:40960
ds_read_b64_tr_b16 v[18:19], v5 offset:41472
s_waitcnt lgkmcnt(6)
v_mfma_f32_32x32x16_bf16 v[48:63], v[20:23], v[168:171], v[48:63]
ds_read_b64_tr_b16 v[20:21], v7 offset:40960
ds_read_b64_tr_b16 v[22:23], v7 offset:41472
s_waitcnt lgkmcnt(6)
v_mfma_f32_32x32x16_bf16 v[32:47], v[24:27], v[172:175], v[32:47]
ds_read_b64_tr_b16 v[24:25], v5 offset:43008
ds_read_b64_tr_b16 v[26:27], v5 offset:43520
s_waitcnt lgkmcnt(6)
v_mfma_f32_32x32x16_bf16 v[48:63], v[28:31], v[172:175], v[48:63]
ds_read_b64_tr_b16 v[28:29], v7 offset:43008
ds_read_b64_tr_b16 v[30:31], v7 offset:43520
s_waitcnt lgkmcnt(6)
v_mfma_f32_32x32x16_bf16 v[32:47], v[16:19], v[176:179], v[32:47]
ds_read_b64_tr_b16 v[16:17], v5 offset:45056
ds_read_b64_tr_b16 v[18:19], v5 offset:45568
s_waitcnt lgkmcnt(6)
v_mfma_f32_32x32x16_bf16 v[48:63], v[20:23], v[176:179], v[48:63]
ds_read_b64_tr_b16 v[20:21], v7 offset:45056
ds_read_b64_tr_b16 v[22:23], v7 offset:45568
s_waitcnt lgkmcnt(6)
v_mfma_f32_32x32x16_bf16 v[32:47], v[24:27], v[180:183], v[32:47]
ds_read_b64_tr_b16 v[24:25], v5 offset:47104
ds_read_b64_tr_b16 v[26:27], v5 offset:47616
s_waitcnt lgkmcnt(6)
v_mfma_f32_32x32x16_bf16 v[48:63], v[28:31], v[180:183], v[48:63]
s_barrier
ds_read_b64_tr_b16 v[28:29], v7 offset:47104
ds_read_b64_tr_b16 v[30:31], v7 offset:47616
s_waitcnt lgkmcnt(6)
v_mfma_f32_32x32x16_bf16 v[32:47], v[16:19], v[184:187], v[32:47]
ds_read_b64_tr_b16 v[16:17], v5 offset:49152
ds_read_b64_tr_b16 v[18:19], v5 offset:49664
s_waitcnt lgkmcnt(6)
v_mfma_f32_32x32x16_bf16 v[48:63], v[20:23], v[184:187], v[48:63]
ds_read_b64_tr_b16 v[20:21], v7 offset:49152
ds_read_b64_tr_b16 v[22:23], v7 offset:49664
s_waitcnt lgkmcnt(6)
v_mfma_f32_32x32x16_bf16 v[32:47], v[24:27], v[188:191], v[32:47]
ds_read_b64_tr_b16 v[24:25], v5 offset:51200
ds_read_b64_tr_b16 v[26:27], v5 offset:51712
s_waitcnt lgkmcnt(6)
v_mfma_f32_32x32x16_bf16 v[48:63], v[28:31], v[188:191], v[48:63]
ds_read_b64_tr_b16 v[28:29], v7 offset:51200
ds_read_b64_tr_b16 v[30:31], v7 offset:51712
s_waitcnt lgkmcnt(6)
v_mfma_f32_32x32x16_bf16 v[32:47], v[16:19], v[192:195], v[32:47]
ds_read_b64_tr_b16 v[16:17], v5 offset:53248
ds_read_b64_tr_b16 v[18:19], v5 offset:53760
s_waitcnt lgkmcnt(6)
v_mfma_f32_32x32x16_bf16 v[48:63], v[20:23], v[192:195], v[48:63]
ds_read_b64_tr_b16 v[20:21], v7 offset:53248
ds_read_b64_tr_b16 v[22:23], v7 offset:53760
s_waitcnt lgkmcnt(6)
v_mfma_f32_32x32x16_bf16 v[32:47], v[24:27], v[196:199], v[32:47]
ds_read_b64_tr_b16 v[24:25], v5 offset:55296
ds_read_b64_tr_b16 v[26:27], v5 offset:55808
s_waitcnt lgkmcnt(6)
v_mfma_f32_32x32x16_bf16 v[48:63], v[28:31], v[196:199], v[48:63]
ds_read_b64_tr_b16 v[28:29], v7 offset:55296
ds_read_b64_tr_b16 v[30:31], v7 offset:55808
s_waitcnt lgkmcnt(6)
v_mfma_f32_32x32x16_bf16 v[32:47], v[16:19], v[200:203], v[32:47]
ds_read_b64_tr_b16 v[16:17], v5 offset:57344
ds_read_b64_tr_b16 v[18:19], v5 offset:57856
s_waitcnt lgkmcnt(6)
v_mfma_f32_32x32x16_bf16 v[48:63], v[20:23], v[200:203], v[48:63]
ds_read_b64_tr_b16 v[20:21], v7 offset:57344
ds_read_b64_tr_b16 v[22:23], v7 offset:57856
s_waitcnt lgkmcnt(6)
v_mfma_f32_32x32x16_bf16 v[32:47], v[24:27], v[204:207], v[32:47]
ds_read_b64_tr_b16 v[24:25], v5 offset:59392
ds_read_b64_tr_b16 v[26:27], v5 offset:59904
s_waitcnt lgkmcnt(6)
v_mfma_f32_32x32x16_bf16 v[48:63], v[28:31], v[204:207], v[48:63]
ds_read_b64_tr_b16 v[28:29], v7 offset:59392
ds_read_b64_tr_b16 v[30:31], v7 offset:59904
s_waitcnt lgkmcnt(6)
v_mfma_f32_32x32x16_bf16 v[32:47], v[16:19], v[208:211], v[32:47]
ds_read_b64_tr_b16 v[16:17], v5 offset:61440
ds_read_b64_tr_b16 v[18:19], v5 offset:61952
s_waitcnt lgkmcnt(6)
v_mfma_f32_32x32x16_bf16 v[48:63], v[20:23], v[208:211], v[48:63]
ds_read_b64_tr_b16 v[20:21], v7 offset:61440
ds_read_b64_tr_b16 v[22:23], v7 offset:61952
s_waitcnt lgkmcnt(6)
v_mfma_f32_32x32x16_bf16 v[32:47], v[24:27], v[212:215], v[32:47]
ds_read_b64_tr_b16 v[24:25], v5 offset:63488
ds_read_b64_tr_b16 v[26:27], v5 offset:64000
s_waitcnt lgkmcnt(6)
v_mfma_f32_32x32x16_bf16 v[48:63], v[28:31], v[212:215], v[48:63]
s_barrier
ds_read_b64_tr_b16 v[28:29], v7 offset:63488
ds_read_b64_tr_b16 v[30:31], v7 offset:64000
s_waitcnt lgkmcnt(6)
v_mfma_f32_32x32x16_bf16 v[32:47], v[16:19], v[216:219], v[32:47]
ds_read_b64_tr_b16 v[16:17], v4 offset:0
ds_read_b64_tr_b16 v[18:19], v4 offset:512
s_waitcnt lgkmcnt(6)
v_mfma_f32_32x32x16_bf16 v[48:63], v[20:23], v[216:219], v[48:63]
ds_read_b64_tr_b16 v[20:21], v6 offset:0
ds_read_b64_tr_b16 v[22:23], v6 offset:512
s_waitcnt lgkmcnt(6)
v_mfma_f32_32x32x16_bf16 v[32:47], v[24:27], v[220:223], v[32:47]
ds_read_b64_tr_b16 v[24:25], v4 offset:2048
ds_read_b64_tr_b16 v[26:27], v4 offset:2560
s_waitcnt lgkmcnt(6)
v_mfma_f32_32x32x16_bf16 v[48:63], v[28:31], v[220:223], v[48:63]
ds_read_b64_tr_b16 v[28:29], v6 offset:2048
ds_read_b64_tr_b16 v[30:31], v6 offset:2560
s_waitcnt lgkmcnt(6)
v_mfma_f32_32x32x16_bf16 v[32:47], v[16:19], v[224:227], v[32:47]
ds_read_b64_tr_b16 v[16:17], v4 offset:4096
ds_read_b64_tr_b16 v[18:19], v4 offset:4608
s_waitcnt vmcnt(0)
buffer_store_dword v0, v3, s[24:27], s58 offen offset:256 sc1
s_waitcnt lgkmcnt(6)
v_mfma_f32_32x32x16_bf16 v[48:63], v[20:23], v[224:227], v[48:63]
ds_read_b64_tr_b16 v[20:21], v6 offset:4096
ds_read_b64_tr_b16 v[22:23], v6 offset:4608
s_waitcnt lgkmcnt(6)
v_mfma_f32_32x32x16_bf16 v[32:47], v[24:27], v[228:231], v[32:47]
ds_read_b64_tr_b16 v[24:25], v4 offset:6144
ds_read_b64_tr_b16 v[26:27], v4 offset:6656
s_waitcnt lgkmcnt(6)
v_mfma_f32_32x32x16_bf16 v[48:63], v[28:31], v[228:231], v[48:63]
ds_read_b64_tr_b16 v[28:29], v6 offset:6144
ds_read_b64_tr_b16 v[30:31], v6 offset:6656
s_waitcnt lgkmcnt(6)
v_mfma_f32_32x32x16_bf16 v[32:47], v[16:19], v[232:235], v[32:47]
ds_read_b64_tr_b16 v[16:17], v4 offset:8192
ds_read_b64_tr_b16 v[18:19], v4 offset:8704
s_waitcnt lgkmcnt(6)
v_mfma_f32_32x32x16_bf16 v[48:63], v[20:23], v[232:235], v[48:63]
ds_read_b64_tr_b16 v[20:21], v6 offset:8192
ds_read_b64_tr_b16 v[22:23], v6 offset:8704
s_waitcnt lgkmcnt(6)
v_mfma_f32_32x32x16_bf16 v[32:47], v[24:27], v[236:239], v[32:47]
ds_read_b64_tr_b16 v[24:25], v4 offset:10240
ds_read_b64_tr_b16 v[26:27], v4 offset:10752
s_waitcnt lgkmcnt(6)
v_mfma_f32_32x32x16_bf16 v[48:63], v[28:31], v[236:239], v[48:63]
ds_read_b64_tr_b16 v[28:29], v6 offset:10240
ds_read_b64_tr_b16 v[30:31], v6 offset:10752
s_waitcnt lgkmcnt(6)
v_mfma_f32_32x32x16_bf16 v[32:47], v[16:19], v[240:243], v[32:47]
ds_read_b64_tr_b16 v[16:17], v4 offset:12288
ds_read_b64_tr_b16 v[18:19], v4 offset:12800
s_waitcnt lgkmcnt(6)
v_mfma_f32_32x32x16_bf16 v[48:63], v[20:23], v[240:243], v[48:63]
ds_read_b64_tr_b16 v[20:21], v6 offset:12288
ds_read_b64_tr_b16 v[22:23], v6 offset:12800
s_waitcnt lgkmcnt(6)
v_mfma_f32_32x32x16_bf16 v[32:47], v[24:27], v[244:247], v[32:47]
ds_read_b64_tr_b16 v[24:25], v4 offset:14336
ds_read_b64_tr_b16 v[26:27], v4 offset:14848
s_waitcnt lgkmcnt(6)
v_mfma_f32_32x32x16_bf16 v[48:63], v[28:31], v[244:247], v[48:63]
s_barrier
ds_read_b64_tr_b16 v[28:29], v6 offset:14336
ds_read_b64_tr_b16 v[30:31], v6 offset:14848
s_waitcnt lgkmcnt(6)
v_mfma_f32_32x32x16_bf16 v[32:47], v[16:19], v[248:251], v[32:47]
ds_read_b64_tr_b16 v[16:17], v8 offset:16384
ds_read_b64_tr_b16 v[18:19], v8 offset:16896
s_waitcnt lgkmcnt(6)
v_mfma_f32_32x32x16_bf16 v[48:63], v[20:23], v[248:251], v[48:63]
ds_read_b64_tr_b16 v[20:21], v8 offset:18432
ds_read_b64_tr_b16 v[22:23], v8 offset:18944
s_waitcnt lgkmcnt(6)
v_mfma_f32_32x32x16_bf16 v[32:47], v[24:27], v[252:255], v[32:47]
ds_read_b64_tr_b16 v[24:25], v8 offset:20480
ds_read_b64_tr_b16 v[26:27], v8 offset:20992
s_waitcnt lgkmcnt(6)
v_mfma_f32_32x32x16_bf16 v[48:63], v[28:31], v[252:255], v[48:63]
ds_read_b64_tr_b16 v[28:29], v8 offset:22528
ds_read_b64_tr_b16 v[30:31], v8 offset:23040
s_waitcnt lgkmcnt(6)
v_mfma_f32_32x32x16_bf16 v[64:79], v[16:19], v[96:99], 0
ds_read_b64_tr_b16 v[16:17], v8 offset:24576
ds_read_b64_tr_b16 v[18:19], v8 offset:25088
s_waitcnt lgkmcnt(6)
v_mfma_f32_32x32x16_bf16 v[64:79], v[20:23], v[100:103], v[64:79]
ds_read_b64_tr_b16 v[20:21], v8 offset:26624
ds_read_b64_tr_b16 v[22:23], v8 offset:27136
s_waitcnt lgkmcnt(6)
v_mfma_f32_32x32x16_bf16 v[64:79], v[24:27], v[104:107], v[64:79]
ds_read_b64_tr_b16 v[24:25], v8 offset:28672
ds_read_b64_tr_b16 v[26:27], v8 offset:29184
v_mul_f32 v32, s56, v32
v_mul_f32 v33, s56, v33
v_mul_f32 v34, s56, v34
s_waitcnt lgkmcnt(6)
v_mfma_f32_32x32x16_bf16 v[64:79], v[28:31], v[108:111], v[64:79]
s_barrier
ds_read_b64_tr_b16 v[28:29], v8 offset:30720
ds_read_b64_tr_b16 v[30:31], v8 offset:31232
v_mul_f32 v35, s56, v35
v_cvt_pk_bf16_f32 v32, v32, v33
v_cvt_pk_bf16_f32 v33, v34, v35
s_waitcnt lgkmcnt(6)
v_mfma_f32_32x32x16_bf16 v[64:79], v[16:19], v[112:115], v[64:79]
ds_read_b64_tr_b16 v[16:17], v8 offset:32768
ds_read_b64_tr_b16 v[18:19], v8 offset:33280
buffer_store_dwordx2 v[32:33], v10, s[24:27], s64 offen offset:0 sc1
v_mul_f32 v36, s56, v36
v_mul_f32 v37, s56, v37
s_waitcnt lgkmcnt(6)
v_mfma_f32_32x32x16_bf16 v[64:79], v[20:23], v[116:119], v[64:79]
ds_read_b64_tr_b16 v[20:21], v8 offset:34816
ds_read_b64_tr_b16 v[22:23], v8 offset:35328
v_mul_f32 v38, s56, v38
v_mul_f32 v39, s56, v39
v_cvt_pk_bf16_f32 v36, v36, v37
s_waitcnt lgkmcnt(6)
v_mfma_f32_32x32x16_bf16 v[64:79], v[24:27], v[120:123], v[64:79]
ds_read_b64_tr_b16 v[24:25], v8 offset:36864
ds_read_b64_tr_b16 v[26:27], v8 offset:37376
v_cvt_pk_bf16_f32 v37, v38, v39
buffer_store_dwordx2 v[36:37], v10, s[24:27], s64 offen offset:512 sc1
v_mul_f32 v40, s56, v40
s_waitcnt lgkmcnt(6)
v_mfma_f32_32x32x16_bf16 v[64:79], v[28:31], v[124:127], v[64:79]
ds_read_b64_tr_b16 v[28:29], v8 offset:38912
ds_read_b64_tr_b16 v[30:31], v8 offset:39424
v_mul_f32 v41, s56, v41
v_mul_f32 v42, s56, v42
v_mul_f32 v43, s56, v43
s_waitcnt lgkmcnt(6)
v_mfma_f32_32x32x16_bf16 v[64:79], v[16:19], v[128:131], v[64:79]
ds_read_b64_tr_b16 v[16:17], v8 offset:40960
ds_read_b64_tr_b16 v[18:19], v8 offset:41472
v_cvt_pk_bf16_f32 v40, v40, v41
v_cvt_pk_bf16_f32 v41, v42, v43
buffer_store_dwordx2 v[40:41], v10, s[24:27], s64 offen offset:1024 sc1
s_waitcnt lgkmcnt(6)
v_mfma_f32_32x32x16_bf16 v[64:79], v[20:23], v[132:135], v[64:79]
ds_read_b64_tr_b16 v[20:21], v8 offset:43008
ds_read_b64_tr_b16 v[22:23], v8 offset:43520
v_mul_f32 v44, s56, v44
v_mul_f32 v45, s56, v45
v_mul_f32 v46, s56, v46
s_waitcnt lgkmcnt(6)
v_mfma_f32_32x32x16_bf16 v[64:79], v[24:27], v[136:139], v[64:79]
ds_read_b64_tr_b16 v[24:25], v8 offset:45056
ds_read_b64_tr_b16 v[26:27], v8 offset:45568
v_mul_f32 v47, s56, v47
v_cvt_pk_bf16_f32 v44, v44, v45
v_cvt_pk_bf16_f32 v45, v46, v47
s_waitcnt lgkmcnt(6)
v_mfma_f32_32x32x16_bf16 v[64:79], v[28:31], v[140:143], v[64:79]
s_barrier
ds_read_b64_tr_b16 v[28:29], v8 offset:47104
ds_read_b64_tr_b16 v[30:31], v8 offset:47616
buffer_store_dwordx2 v[44:45], v10, s[24:27], s64 offen offset:1536 sc1
s_waitcnt lgkmcnt(6)
v_mfma_f32_32x32x16_bf16 v[64:79], v[16:19], v[144:147], v[64:79]
ds_read_b64_tr_b16 v[16:17], v8 offset:49152
ds_read_b64_tr_b16 v[18:19], v8 offset:49664
v_mul_f32 v48, s56, v48
v_mul_f32 v49, s56, v49
v_mul_f32 v50, s56, v50
s_waitcnt lgkmcnt(6)
v_mfma_f32_32x32x16_bf16 v[64:79], v[20:23], v[148:151], v[64:79]
ds_read_b64_tr_b16 v[20:21], v8 offset:51200
ds_read_b64_tr_b16 v[22:23], v8 offset:51712
v_mul_f32 v51, s56, v51
v_cvt_pk_bf16_f32 v48, v48, v49
v_cvt_pk_bf16_f32 v49, v50, v51
s_waitcnt lgkmcnt(6)
v_mfma_f32_32x32x16_bf16 v[64:79], v[24:27], v[152:155], v[64:79]
ds_read_b64_tr_b16 v[24:25], v8 offset:53248
ds_read_b64_tr_b16 v[26:27], v8 offset:53760
buffer_store_dwordx2 v[48:49], v10, s[24:27], s64 offen offset:2048 sc1
v_mul_f32 v52, s56, v52
v_mul_f32 v53, s56, v53
s_waitcnt lgkmcnt(6)
v_mfma_f32_32x32x16_bf16 v[64:79], v[28:31], v[156:159], v[64:79]
ds_read_b64_tr_b16 v[28:29], v8 offset:55296
ds_read_b64_tr_b16 v[30:31], v8 offset:55808
v_mul_f32 v54, s56, v54
v_mul_f32 v55, s56, v55
v_cvt_pk_bf16_f32 v52, v52, v53
s_waitcnt lgkmcnt(6)
v_mfma_f32_32x32x16_bf16 v[64:79], v[16:19], v[160:163], v[64:79]
ds_read_b64_tr_b16 v[16:17], v8 offset:57344
ds_read_b64_tr_b16 v[18:19], v8 offset:57856
v_cvt_pk_bf16_f32 v53, v54, v55
buffer_store_dwordx2 v[52:53], v10, s[24:27], s64 offen offset:2560 sc1
v_mul_f32 v56, s56, v56
s_waitcnt lgkmcnt(6)
v_mfma_f32_32x32x16_bf16 v[64:79], v[20:23], v[164:167], v[64:79]
ds_read_b64_tr_b16 v[20:21], v8 offset:59392
ds_read_b64_tr_b16 v[22:23], v8 offset:59904
v_mul_f32 v57, s56, v57
v_mul_f32 v58, s56, v58
v_mul_f32 v59, s56, v59
s_waitcnt lgkmcnt(6)
v_mfma_f32_32x32x16_bf16 v[64:79], v[24:27], v[168:171], v[64:79]
ds_read_b64_tr_b16 v[24:25], v8 offset:61440
ds_read_b64_tr_b16 v[26:27], v8 offset:61952
v_cvt_pk_bf16_f32 v56, v56, v57
v_cvt_pk_bf16_f32 v57, v58, v59
buffer_store_dwordx2 v[56:57], v10, s[24:27], s64 offen offset:3072 sc1
s_waitcnt lgkmcnt(6)
v_mfma_f32_32x32x16_bf16 v[64:79], v[28:31], v[172:175], v[64:79]
s_barrier
ds_read_b64_tr_b16 v[28:29], v8 offset:63488
ds_read_b64_tr_b16 v[30:31], v8 offset:64000
v_mul_f32 v60, s56, v60
v_mul_f32 v61, s56, v61
v_mul_f32 v62, s56, v62
s_waitcnt lgkmcnt(6)
v_mfma_f32_32x32x16_bf16 v[64:79], v[16:19], v[176:179], v[64:79]
ds_read_b64_tr_b16 v[16:17], v9 offset:0
ds_read_b64_tr_b16 v[18:19], v9 offset:512
v_mul_f32 v63, s56, v63
v_cvt_pk_bf16_f32 v60, v60, v61
v_cvt_pk_bf16_f32 v61, v62, v63
s_waitcnt lgkmcnt(6)
v_mfma_f32_32x32x16_bf16 v[64:79], v[20:23], v[180:183], v[64:79]
ds_read_b64_tr_b16 v[20:21], v9 offset:2048
ds_read_b64_tr_b16 v[22:23], v9 offset:2560
buffer_store_dwordx2 v[60:61], v10, s[24:27], s64 offen offset:3584 sc1
s_waitcnt lgkmcnt(6)
v_mfma_f32_32x32x16_bf16 v[64:79], v[24:27], v[184:187], v[64:79]
ds_read_b64_tr_b16 v[24:25], v9 offset:4096
ds_read_b64_tr_b16 v[26:27], v9 offset:4608
s_waitcnt lgkmcnt(6)
v_mfma_f32_32x32x16_bf16 v[64:79], v[28:31], v[188:191], v[64:79]
ds_read_b64_tr_b16 v[28:29], v9 offset:6144
ds_read_b64_tr_b16 v[30:31], v9 offset:6656
s_waitcnt lgkmcnt(6)
v_mfma_f32_32x32x16_bf16 v[64:79], v[16:19], v[192:195], v[64:79]
ds_read_b64_tr_b16 v[16:17], v9 offset:8192
ds_read_b64_tr_b16 v[18:19], v9 offset:8704
s_waitcnt lgkmcnt(6)
v_mfma_f32_32x32x16_bf16 v[64:79], v[20:23], v[196:199], v[64:79]
ds_read_b64_tr_b16 v[20:21], v9 offset:10240
ds_read_b64_tr_b16 v[22:23], v9 offset:10752
s_waitcnt lgkmcnt(6)
v_mfma_f32_32x32x16_bf16 v[64:79], v[24:27], v[200:203], v[64:79]
ds_read_b64_tr_b16 v[24:25], v9 offset:12288
ds_read_b64_tr_b16 v[26:27], v9 offset:12800
s_waitcnt lgkmcnt(6)
v_mfma_f32_32x32x16_bf16 v[64:79], v[28:31], v[204:207], v[64:79]
s_barrier
ds_read_b64_tr_b16 v[28:29], v9 offset:14336
ds_read_b64_tr_b16 v[30:31], v9 offset:14848
s_waitcnt lgkmcnt(6)
v_mfma_f32_32x32x16_bf16 v[64:79], v[16:19], v[208:211], v[64:79]
ds_read_b64_tr_b16 v[16:17], v9 offset:16384
ds_read_b64_tr_b16 v[18:19], v9 offset:16896
s_waitcnt lgkmcnt(6)
v_mfma_f32_32x32x16_bf16 v[64:79], v[20:23], v[212:215], v[64:79]
ds_read_b64_tr_b16 v[20:21], v9 offset:18432
ds_read_b64_tr_b16 v[22:23], v9 offset:18944
s_waitcnt lgkmcnt(6)
v_mfma_f32_32x32x16_bf16 v[64:79], v[24:27], v[216:219], v[64:79]
ds_read_b64_tr_b16 v[24:25], v9 offset:20480
ds_read_b64_tr_b16 v[26:27], v9 offset:20992
s_waitcnt lgkmcnt(6)
v_mfma_f32_32x32x16_bf16 v[64:79], v[28:31], v[220:223], v[64:79]
ds_read_b64_tr_b16 v[28:29], v9 offset:22528
ds_read_b64_tr_b16 v[30:31], v9 offset:23040
s_waitcnt lgkmcnt(6)
v_mfma_f32_32x32x16_bf16 v[64:79], v[16:19], v[224:227], v[64:79]
ds_read_b64_tr_b16 v[16:17], v9 offset:24576
ds_read_b64_tr_b16 v[18:19], v9 offset:25088
s_waitcnt lgkmcnt(6)
v_mfma_f32_32x32x16_bf16 v[64:79], v[20:23], v[228:231], v[64:79]
ds_read_b64_tr_b16 v[20:21], v9 offset:26624
ds_read_b64_tr_b16 v[22:23], v9 offset:27136
s_waitcnt lgkmcnt(6)
v_mfma_f32_32x32x16_bf16 v[64:79], v[24:27], v[232:235], v[64:79]
ds_read_b64_tr_b16 v[24:25], v9 offset:28672
ds_read_b64_tr_b16 v[26:27], v9 offset:29184
s_waitcnt lgkmcnt(6)
v_mfma_f32_32x32x16_bf16 v[64:79], v[28:31], v[236:239], v[64:79]
s_barrier
ds_read_b64_tr_b16 v[28:29], v9 offset:30720
ds_read_b64_tr_b16 v[30:31], v9 offset:31232
s_waitcnt lgkmcnt(6)
v_mfma_f32_32x32x16_bf16 v[64:79], v[16:19], v[240:243], v[64:79]
ds_read_b64_tr_b16 v[16:17], v5 offset:32768
ds_read_b64_tr_b16 v[18:19], v5 offset:33280
s_waitcnt lgkmcnt(6)
v_mfma_f32_32x32x16_bf16 v[64:79], v[20:23], v[244:247], v[64:79]
ds_read_b64_tr_b16 v[20:21], v5 offset:40960
ds_read_b64_tr_b16 v[22:23], v5 offset:41472
s_waitcnt lgkmcnt(6)
v_mfma_f32_32x32x16_bf16 v[64:79], v[24:27], v[248:251], v[64:79]
ds_read_b64_tr_b16 v[24:25], v5 offset:34816
ds_read_b64_tr_b16 v[26:27], v5 offset:35328
s_waitcnt lgkmcnt(6)
v_mfma_f32_32x32x16_bf16 v[64:79], v[28:31], v[252:255], v[64:79]
ds_read_b64_tr_b16 v[28:29], v5 offset:43008
ds_read_b64_tr_b16 v[30:31], v5 offset:43520
s_waitcnt lgkmcnt(6)
v_mfma_f32_32x32x16_bf16 v[32:47], v[16:19], v[96:99], 0
ds_read_b64_tr_b16 v[16:17], v5 offset:36864
ds_read_b64_tr_b16 v[18:19], v5 offset:37376
s_waitcnt lgkmcnt(6)
v_mfma_f32_32x32x16_bf16 v[48:63], v[20:23], v[96:99], 0
ds_read_b64_tr_b16 v[20:21], v5 offset:45056
ds_read_b64_tr_b16 v[22:23], v5 offset:45568
s_waitcnt lgkmcnt(6)
v_mfma_f32_32x32x16_bf16 v[32:47], v[24:27], v[100:103], v[32:47]
ds_read_b64_tr_b16 v[24:25], v5 offset:38912
ds_read_b64_tr_b16 v[26:27], v5 offset:39424
s_waitcnt lgkmcnt(6)
v_mfma_f32_32x32x16_bf16 v[48:63], v[28:31], v[100:103], v[48:63]
ds_read_b64_tr_b16 v[28:29], v5 offset:47104
ds_read_b64_tr_b16 v[30:31], v5 offset:47616
v_mul_f32 v64, s57, v64
v_mul_f32 v65, s57, v65
v_mul_f32 v66, s57, v66
s_waitcnt lgkmcnt(6)
v_mfma_f32_32x32x16_bf16 v[32:47], v[16:19], v[104:107], v[32:47]
ds_read_b64_tr_b16 v[16:17], v5 offset:49152
ds_read_b64_tr_b16 v[18:19], v5 offset:49664
v_mul_f32 v67, s57, v67
v_cvt_pk_bf16_f32 v64, v64, v65
v_cvt_pk_bf16_f32 v65, v66, v67
s_waitcnt lgkmcnt(6)
v_mfma_f32_32x32x16_bf16 v[48:63], v[20:23], v[104:107], v[48:63]
ds_read_b64_tr_b16 v[20:21], v5 offset:57344
ds_read_b64_tr_b16 v[22:23], v5 offset:57856
buffer_store_dwordx2 v[64:65], v10, s[24:27], s65 offen offset:0 sc1
v_mul_f32 v68, s57, v68
v_mul_f32 v69, s57, v69
s_waitcnt lgkmcnt(6)
v_mfma_f32_32x32x16_bf16 v[32:47], v[24:27], v[108:111], v[32:47]
ds_read_b64_tr_b16 v[24:25], v5 offset:51200
ds_read_b64_tr_b16 v[26:27], v5 offset:51712
v_mul_f32 v70, s57, v70
v_mul_f32 v71, s57, v71
v_cvt_pk_bf16_f32 v68, v68, v69
s_waitcnt lgkmcnt(6)
v_mfma_f32_32x32x16_bf16 v[48:63], v[28:31], v[108:111], v[48:63]
ds_read_b64_tr_b16 v[28:29], v5 offset:59392
ds_read_b64_tr_b16 v[30:31], v5 offset:59904
v_cvt_pk_bf16_f32 v69, v70, v71
buffer_store_dwordx2 v[68:69], v10, s[24:27], s65 offen offset:512 sc1
v_mul_f32 v72, s57, v72
s_waitcnt lgkmcnt(6)
v_mfma_f32_32x32x16_bf16 v[32:47], v[16:19], v[112:115], v[32:47]
ds_read_b64_tr_b16 v[16:17], v5 offset:53248
ds_read_b64_tr_b16 v[18:19], v5 offset:53760
v_mul_f32 v73, s57, v73
v_mul_f32 v74, s57, v74
v_mul_f32 v75, s57, v75
s_waitcnt lgkmcnt(6)
v_mfma_f32_32x32x16_bf16 v[48:63], v[20:23], v[112:115], v[48:63]
ds_read_b64_tr_b16 v[20:21], v5 offset:61440
ds_read_b64_tr_b16 v[22:23], v5 offset:61952
v_cvt_pk_bf16_f32 v72, v72, v73
v_cvt_pk_bf16_f32 v73, v74, v75
buffer_store_dwordx2 v[72:73], v10, s[24:27], s65 offen offset:1024 sc1
s_waitcnt lgkmcnt(6)
v_mfma_f32_32x32x16_bf16 v[32:47], v[24:27], v[116:119], v[32:47]
ds_read_b64_tr_b16 v[24:25], v5 offset:55296
ds_read_b64_tr_b16 v[26:27], v5 offset:55808
v_mul_f32 v76, s57, v76
v_mul_f32 v77, s57, v77
v_mul_f32 v78, s57, v78
s_waitcnt lgkmcnt(6)
v_mfma_f32_32x32x16_bf16 v[48:63], v[28:31], v[116:119], v[48:63]
s_barrier
ds_read_b64_tr_b16 v[28:29], v5 offset:63488
ds_read_b64_tr_b16 v[30:31], v5 offset:64000
v_mul_f32 v79, s57, v79
v_cvt_pk_bf16_f32 v76, v76, v77
v_cvt_pk_bf16_f32 v77, v78, v79
s_waitcnt lgkmcnt(6)
v_mfma_f32_32x32x16_bf16 v[32:47], v[16:19], v[120:123], v[32:47]
ds_read_b64_tr_b16 v[16:17], v4 offset:0
ds_read_b64_tr_b16 v[18:19], v4 offset:512
buffer_store_dwordx2 v[76:77], v10, s[24:27], s65 offen offset:1536 sc1
s_waitcnt lgkmcnt(6)
v_mfma_f32_32x32x16_bf16 v[48:63], v[20:23], v[120:123], v[48:63]
ds_read_b64_tr_b16 v[20:21], v4 offset:8192
ds_read_b64_tr_b16 v[22:23], v4 offset:8704
s_waitcnt lgkmcnt(6)
v_mfma_f32_32x32x16_bf16 v[32:47], v[24:27], v[124:127], v[32:47]
ds_read_b64_tr_b16 v[24:25], v4 offset:2048
ds_read_b64_tr_b16 v[26:27], v4 offset:2560
s_waitcnt lgkmcnt(6)
v_mfma_f32_32x32x16_bf16 v[48:63], v[28:31], v[124:127], v[48:63]
ds_read_b64_tr_b16 v[28:29], v4 offset:10240
ds_read_b64_tr_b16 v[30:31], v4 offset:10752
s_waitcnt lgkmcnt(6)
v_mfma_f32_32x32x16_bf16 v[32:47], v[16:19], v[128:131], v[32:47]
ds_read_b64_tr_b16 v[16:17], v4 offset:4096
ds_read_b64_tr_b16 v[18:19], v4 offset:4608
s_waitcnt lgkmcnt(6)
v_mfma_f32_32x32x16_bf16 v[48:63], v[20:23], v[128:131], v[48:63]
ds_read_b64_tr_b16 v[20:21], v4 offset:12288
ds_read_b64_tr_b16 v[22:23], v4 offset:12800
s_waitcnt lgkmcnt(6)
v_mfma_f32_32x32x16_bf16 v[32:47], v[24:27], v[132:135], v[32:47]
ds_read_b64_tr_b16 v[24:25], v4 offset:6144
ds_read_b64_tr_b16 v[26:27], v4 offset:6656
s_waitcnt lgkmcnt(6)
v_mfma_f32_32x32x16_bf16 v[48:63], v[28:31], v[132:135], v[48:63]
ds_read_b64_tr_b16 v[28:29], v4 offset:14336
ds_read_b64_tr_b16 v[30:31], v4 offset:14848
s_waitcnt lgkmcnt(6)
v_mfma_f32_32x32x16_bf16 v[32:47], v[16:19], v[136:139], v[32:47]
ds_read_b64_tr_b16 v[16:17], v7 offset:32768
ds_read_b64_tr_b16 v[18:19], v7 offset:33280
s_waitcnt lgkmcnt(6)
v_mfma_f32_32x32x16_bf16 v[48:63], v[20:23], v[136:139], v[48:63]
ds_read_b64_tr_b16 v[20:21], v7 offset:40960
ds_read_b64_tr_b16 v[22:23], v7 offset:41472
s_waitcnt lgkmcnt(6)
v_mfma_f32_32x32x16_bf16 v[32:47], v[24:27], v[140:143], v[32:47]
ds_read_b64_tr_b16 v[24:25], v7 offset:34816
ds_read_b64_tr_b16 v[26:27], v7 offset:35328
s_waitcnt lgkmcnt(6)
v_mfma_f32_32x32x16_bf16 v[48:63], v[28:31], v[140:143], v[48:63]
ds_read_b64_tr_b16 v[28:29], v7 offset:43008
ds_read_b64_tr_b16 v[30:31], v7 offset:43520
s_waitcnt lgkmcnt(6)
v_mfma_f32_32x32x16_bf16 v[64:79], v[16:19], v[96:99], 0
ds_read_b64_tr_b16 v[16:17], v7 offset:36864
ds_read_b64_tr_b16 v[18:19], v7 offset:37376
s_waitcnt lgkmcnt(6)
v_mfma_f32_32x32x16_bf16 v[80:95], v[20:23], v[96:99], 0
ds_read_b64_tr_b16 v[20:21], v7 offset:45056
ds_read_b64_tr_b16 v[22:23], v7 offset:45568
s_waitcnt lgkmcnt(6)
v_mfma_f32_32x32x16_bf16 v[64:79], v[24:27], v[100:103], v[64:79]
ds_read_b64_tr_b16 v[24:25], v7 offset:38912
ds_read_b64_tr_b16 v[26:27], v7 offset:39424
s_waitcnt lgkmcnt(6)
v_mfma_f32_32x32x16_bf16 v[80:95], v[28:31], v[100:103], v[80:95]
s_barrier
ds_read_b64_tr_b16 v[28:29], v7 offset:47104
ds_read_b64_tr_b16 v[30:31], v7 offset:47616
s_waitcnt lgkmcnt(6)
v_mfma_f32_32x32x16_bf16 v[64:79], v[16:19], v[104:107], v[64:79]
ds_read_b64_tr_b16 v[16:17], v7 offset:49152
ds_read_b64_tr_b16 v[18:19], v7 offset:49664
s_waitcnt lgkmcnt(6)
v_mfma_f32_32x32x16_bf16 v[80:95], v[20:23], v[104:107], v[80:95]
ds_read_b64_tr_b16 v[20:21], v7 offset:57344
ds_read_b64_tr_b16 v[22:23], v7 offset:57856
s_waitcnt lgkmcnt(6)
v_mfma_f32_32x32x16_bf16 v[64:79], v[24:27], v[108:111], v[64:79]
ds_read_b64_tr_b16 v[24:25], v7 offset:51200
ds_read_b64_tr_b16 v[26:27], v7 offset:51712
s_waitcnt lgkmcnt(6)
v_mfma_f32_32x32x16_bf16 v[80:95], v[28:31], v[108:111], v[80:95]
ds_read_b64_tr_b16 v[28:29], v7 offset:59392
ds_read_b64_tr_b16 v[30:31], v7 offset:59904
s_waitcnt lgkmcnt(6)
v_mfma_f32_32x32x16_bf16 v[64:79], v[16:19], v[112:115], v[64:79]
ds_read_b64_tr_b16 v[16:17], v7 offset:53248
ds_read_b64_tr_b16 v[18:19], v7 offset:53760
s_waitcnt lgkmcnt(6)
v_mfma_f32_32x32x16_bf16 v[80:95], v[20:23], v[112:115], v[80:95]
ds_read_b64_tr_b16 v[20:21], v7 offset:61440
ds_read_b64_tr_b16 v[22:23], v7 offset:61952
s_waitcnt lgkmcnt(6)
v_mfma_f32_32x32x16_bf16 v[64:79], v[24:27], v[116:119], v[64:79]
ds_read_b64_tr_b16 v[24:25], v7 offset:55296
ds_read_b64_tr_b16 v[26:27], v7 offset:55808
s_waitcnt lgkmcnt(6)
v_mfma_f32_32x32x16_bf16 v[80:95], v[28:31], v[116:119], v[80:95]
ds_read_b64_tr_b16 v[28:29], v7 offset:63488
ds_read_b64_tr_b16 v[30:31], v7 offset:64000
s_waitcnt lgkmcnt(6)
v_mfma_f32_32x32x16_bf16 v[64:79], v[16:19], v[120:123], v[64:79]
ds_read_b64_tr_b16 v[16:17], v6 offset:0
ds_read_b64_tr_b16 v[18:19], v6 offset:512
s_waitcnt vmcnt(0)
buffer_store_dword v0, v3, s[24:27], s58 offen offset:0 sc1
s_waitcnt lgkmcnt(6)
v_mfma_f32_32x32x16_bf16 v[80:95], v[20:23], v[120:123], v[80:95]
ds_read_b64_tr_b16 v[20:21], v6 offset:8192
ds_read_b64_tr_b16 v[22:23], v6 offset:8704
s_waitcnt lgkmcnt(6)
v_mfma_f32_32x32x16_bf16 v[64:79], v[24:27], v[124:127], v[64:79]
ds_read_b64_tr_b16 v[24:25], v6 offset:2048
ds_read_b64_tr_b16 v[26:27], v6 offset:2560
s_waitcnt lgkmcnt(6)
v_mfma_f32_32x32x16_bf16 v[80:95], v[28:31], v[124:127], v[80:95]
ds_read_b64_tr_b16 v[28:29], v6 offset:10240
ds_read_b64_tr_b16 v[30:31], v6 offset:10752
s_waitcnt lgkmcnt(6)
v_mfma_f32_32x32x16_bf16 v[64:79], v[16:19], v[128:131], v[64:79]
ds_read_b64_tr_b16 v[16:17], v6 offset:4096
ds_read_b64_tr_b16 v[18:19], v6 offset:4608
s_waitcnt lgkmcnt(6)
v_mfma_f32_32x32x16_bf16 v[80:95], v[20:23], v[128:131], v[80:95]
ds_read_b64_tr_b16 v[20:21], v6 offset:12288
ds_read_b64_tr_b16 v[22:23], v6 offset:12800
s_waitcnt lgkmcnt(6)
v_mfma_f32_32x32x16_bf16 v[64:79], v[24:27], v[132:135], v[64:79]
ds_read_b64_tr_b16 v[24:25], v6 offset:6144
ds_read_b64_tr_b16 v[26:27], v6 offset:6656
s_waitcnt lgkmcnt(6)
v_mfma_f32_32x32x16_bf16 v[80:95], v[28:31], v[132:135], v[80:95]
s_barrier
ds_read_b64_tr_b16 v[28:29], v6 offset:14336
ds_read_b64_tr_b16 v[30:31], v6 offset:14848
s_waitcnt lgkmcnt(6)
v_mfma_f32_32x32x16_bf16 v[64:79], v[16:19], v[136:139], v[64:79]
ds_read_b64_tr_b16 v[16:17], v4 offset:16384
ds_read_b64_tr_b16 v[18:19], v4 offset:16896
s_waitcnt lgkmcnt(6)
v_mfma_f32_32x32x16_bf16 v[80:95], v[20:23], v[136:139], v[80:95]
ds_read_b64_tr_b16 v[20:21], v4 offset:24576
ds_read_b64_tr_b16 v[22:23], v4 offset:25088
s_waitcnt lgkmcnt(6)
v_mfma_f32_32x32x16_bf16 v[64:79], v[24:27], v[140:143], v[64:79]
ds_read_b64_tr_b16 v[24:25], v4 offset:18432
ds_read_b64_tr_b16 v[26:27], v4 offset:18944
s_waitcnt lgkmcnt(6)
v_mfma_f32_32x32x16_bf16 v[80:95], v[28:31], v[140:143], v[80:95]
ds_read_b64_tr_b16 v[28:29], v4 offset:26624
ds_read_b64_tr_b16 v[30:31], v4 offset:27136
s_waitcnt lgkmcnt(6)
v_mfma_f32_32x32x16_bf16 v[32:47], v[16:19], v[144:147], v[32:47]
ds_read_b64_tr_b16 v[16:17], v4 offset:20480
ds_read_b64_tr_b16 v[18:19], v4 offset:20992
s_waitcnt lgkmcnt(6)
v_mfma_f32_32x32x16_bf16 v[48:63], v[20:23], v[144:147], v[48:63]
ds_read_b64_tr_b16 v[20:21], v4 offset:28672
ds_read_b64_tr_b16 v[22:23], v4 offset:29184
s_waitcnt lgkmcnt(6)
v_mfma_f32_32x32x16_bf16 v[32:47], v[24:27], v[148:151], v[32:47]
ds_read_b64_tr_b16 v[24:25], v4 offset:22528
ds_read_b64_tr_b16 v[26:27], v4 offset:23040
s_waitcnt lgkmcnt(6)
v_mfma_f32_32x32x16_bf16 v[48:63], v[28:31], v[148:151], v[48:63]
ds_read_b64_tr_b16 v[28:29], v4 offset:30720
ds_read_b64_tr_b16 v[30:31], v4 offset:31232
s_waitcnt lgkmcnt(6)
v_mfma_f32_32x32x16_bf16 v[32:47], v[16:19], v[152:155], v[32:47]
ds_read_b64_tr_b16 v[16:17], v6 offset:16384
ds_read_b64_tr_b16 v[18:19], v6 offset:16896
s_waitcnt lgkmcnt(6)
v_mfma_f32_32x32x16_bf16 v[48:63], v[20:23], v[152:155], v[48:63]
ds_read_b64_tr_b16 v[20:21], v6 offset:24576
ds_read_b64_tr_b16 v[22:23], v6 offset:25088
s_waitcnt lgkmcnt(6)
v_mfma_f32_32x32x16_bf16 v[32:47], v[24:27], v[156:159], v[32:47]
ds_read_b64_tr_b16 v[24:25], v6 offset:18432
ds_read_b64_tr_b16 v[26:27], v6 offset:18944
s_waitcnt lgkmcnt(6)
v_mfma_f32_32x32x16_bf16 v[48:63], v[28:31], v[156:159], v[48:63]
ds_read_b64_tr_b16 v[28:29], v6 offset:26624
ds_read_b64_tr_b16 v[30:31], v6 offset:27136
s_waitcnt lgkmcnt(6)
v_mfma_f32_32x32x16_bf16 v[64:79], v[16:19], v[144:147], v[64:79]
ds_read_b64_tr_b16 v[16:17], v6 offset:20480
ds_read_b64_tr_b16 v[18:19], v6 offset:20992
s_waitcnt lgkmcnt(6)
v_mfma_f32_32x32x16_bf16 v[80:95], v[20:23], v[144:147], v[80:95]
ds_read_b64_tr_b16 v[20:21], v6 offset:28672
ds_read_b64_tr_b16 v[22:23], v6 offset:29184
s_waitcnt lgkmcnt(6)
v_mfma_f32_32x32x16_bf16 v[64:79], v[24:27], v[148:151], v[64:79]
ds_read_b64_tr_b16 v[24:25], v6 offset:22528
ds_read_b64_tr_b16 v[26:27], v6 offset:23040
s_waitcnt lgkmcnt(6)
v_mfma_f32_32x32x16_bf16 v[80:95], v[28:31], v[148:151], v[80:95]
s_barrier
ds_read_b64_tr_b16 v[28:29], v6 offset:30720
ds_read_b64_tr_b16 v[30:31], v6 offset:31232
s_waitcnt lgkmcnt(6)
v_mfma_f32_32x32x16_bf16 v[64:79], v[16:19], v[152:155], v[64:79]
ds_read_b64_tr_b16 v[16:17], v4 offset:32768
ds_read_b64_tr_b16 v[18:19], v4 offset:33280
s_waitcnt lgkmcnt(6)
v_mfma_f32_32x32x16_bf16 v[80:95], v[20:23], v[152:155], v[80:95]
ds_read_b64_tr_b16 v[20:21], v4 offset:40960
ds_read_b64_tr_b16 v[22:23], v4 offset:41472
s_waitcnt lgkmcnt(6)
v_mfma_f32_32x32x16_bf16 v[64:79], v[24:27], v[156:159], v[64:79]
ds_read_b64_tr_b16 v[24:25], v4 offset:34816
ds_read_b64_tr_b16 v[26:27], v4 offset:35328
s_waitcnt lgkmcnt(6)
v_mfma_f32_32x32x16_bf16 v[80:95], v[28:31], v[156:159], v[80:95]
ds_read_b64_tr_b16 v[28:29], v4 offset:43008
ds_read_b64_tr_b16 v[30:31], v4 offset:43520
s_waitcnt lgkmcnt(6)
v_mfma_f32_32x32x16_bf16 v[32:47], v[16:19], v[160:163], v[32:47]
ds_read_b64_tr_b16 v[16:17], v4 offset:36864
ds_read_b64_tr_b16 v[18:19], v4 offset:37376
s_waitcnt lgkmcnt(6)
v_mfma_f32_32x32x16_bf16 v[48:63], v[20:23], v[160:163], v[48:63]
ds_read_b64_tr_b16 v[20:21], v4 offset:45056
ds_read_b64_tr_b16 v[22:23], v4 offset:45568
s_waitcnt lgkmcnt(6)
v_mfma_f32_32x32x16_bf16 v[32:47], v[24:27], v[164:167], v[32:47]
ds_read_b64_tr_b16 v[24:25], v4 offset:38912
ds_read_b64_tr_b16 v[26:27], v4 offset:39424
s_waitcnt lgkmcnt(6)
v_mfma_f32_32x32x16_bf16 v[48:63], v[28:31], v[164:167], v[48:63]
ds_read_b64_tr_b16 v[28:29], v4 offset:47104
ds_read_b64_tr_b16 v[30:31], v4 offset:47616
s_waitcnt lgkmcnt(6)
v_mfma_f32_32x32x16_bf16 v[32:47], v[16:19], v[168:171], v[32:47]
ds_read_b64_tr_b16 v[16:17], v6 offset:32768
ds_read_b64_tr_b16 v[18:19], v6 offset:33280
s_waitcnt lgkmcnt(6)
v_mfma_f32_32x32x16_bf16 v[48:63], v[20:23], v[168:171], v[48:63]
ds_read_b64_tr_b16 v[20:21], v6 offset:40960
ds_read_b64_tr_b16 v[22:23], v6 offset:41472
s_waitcnt lgkmcnt(6)
v_mfma_f32_32x32x16_bf16 v[32:47], v[24:27], v[172:175], v[32:47]
ds_read_b64_tr_b16 v[24:25], v6 offset:34816
ds_read_b64_tr_b16 v[26:27], v6 offset:35328
s_waitcnt lgkmcnt(6)
v_mfma_f32_32x32x16_bf16 v[48:63], v[28:31], v[172:175], v[48:63]
ds_read_b64_tr_b16 v[28:29], v6 offset:43008
ds_read_b64_tr_b16 v[30:31], v6 offset:43520
s_waitcnt lgkmcnt(6)
v_mfma_f32_32x32x16_bf16 v[64:79], v[16:19], v[160:163], v[64:79]
ds_read_b64_tr_b16 v[16:17], v6 offset:36864
ds_read_b64_tr_b16 v[18:19], v6 offset:37376
s_waitcnt lgkmcnt(6)
v_mfma_f32_32x32x16_bf16 v[80:95], v[20:23], v[160:163], v[80:95]
ds_read_b64_tr_b16 v[20:21], v6 offset:45056
ds_read_b64_tr_b16 v[22:23], v6 offset:45568
s_waitcnt lgkmcnt(6)
v_mfma_f32_32x32x16_bf16 v[64:79], v[24:27], v[164:167], v[64:79]
ds_read_b64_tr_b16 v[24:25], v6 offset:38912
ds_read_b64_tr_b16 v[26:27], v6 offset:39424
s_waitcnt lgkmcnt(6)
v_mfma_f32_32x32x16_bf16 v[80:95], v[28:31], v[164:167], v[80:95]
s_barrier
ds_read_b64_tr_b16 v[28:29], v6 offset:47104
ds_read_b64_tr_b16 v[30:31], v6 offset:47616
s_waitcnt lgkmcnt(6)
v_mfma_f32_32x32x16_bf16 v[64:79], v[16:19], v[168:171], v[64:79]
ds_read_b64_tr_b16 v[16:17], v4 offset:49152
ds_read_b64_tr_b16 v[18:19], v4 offset:49664
s_waitcnt lgkmcnt(6)
v_mfma_f32_32x32x16_bf16 v[80:95], v[20:23], v[168:171], v[80:95]
ds_read_b64_tr_b16 v[20:21], v4 offset:57344
ds_read_b64_tr_b16 v[22:23], v4 offset:57856
s_waitcnt lgkmcnt(6)
v_mfma_f32_32x32x16_bf16 v[64:79], v[24:27], v[172:175], v[64:79]
ds_read_b64_tr_b16 v[24:25], v4 offset:51200
ds_read_b64_tr_b16 v[26:27], v4 offset:51712
s_waitcnt lgkmcnt(6)
v_mfma_f32_32x32x16_bf16 v[80:95], v[28:31], v[172:175], v[80:95]
ds_read_b64_tr_b16 v[28:29], v4 offset:59392
ds_read_b64_tr_b16 v[30:31], v4 offset:59904
s_waitcnt lgkmcnt(6)
v_mfma_f32_32x32x16_bf16 v[32:47], v[16:19], v[176:179], v[32:47]
ds_read_b64_tr_b16 v[16:17], v4 offset:53248
ds_read_b64_tr_b16 v[18:19], v4 offset:53760
s_waitcnt lgkmcnt(6)
v_mfma_f32_32x32x16_bf16 v[48:63], v[20:23], v[176:179], v[48:63]
ds_read_b64_tr_b16 v[20:21], v4 offset:61440
ds_read_b64_tr_b16 v[22:23], v4 offset:61952
s_waitcnt lgkmcnt(6)
v_mfma_f32_32x32x16_bf16 v[32:47], v[24:27], v[180:183], v[32:47]
ds_read_b64_tr_b16 v[24:25], v4 offset:55296
ds_read_b64_tr_b16 v[26:27], v4 offset:55808
s_waitcnt lgkmcnt(6)
v_mfma_f32_32x32x16_bf16 v[48:63], v[28:31], v[180:183], v[48:63]
ds_read_b64_tr_b16 v[28:29], v4 offset:63488
ds_read_b64_tr_b16 v[30:31], v4 offset:64000
s_waitcnt lgkmcnt(6)
v_mfma_f32_32x32x16_bf16 v[32:47], v[16:19], v[184:187], v[32:47]
ds_read_b64_tr_b16 v[16:17], v6 offset:49152
ds_read_b64_tr_b16 v[18:19], v6 offset:49664
s_waitcnt lgkmcnt(6)
v_mfma_f32_32x32x16_bf16 v[48:63], v[20:23], v[184:187], v[48:63]
ds_read_b64_tr_b16 v[20:21], v6 offset:57344
ds_read_b64_tr_b16 v[22:23], v6 offset:57856
s_waitcnt lgkmcnt(6)
v_mfma_f32_32x32x16_bf16 v[32:47], v[24:27], v[188:191], v[32:47]
ds_read_b64_tr_b16 v[24:25], v6 offset:51200
ds_read_b64_tr_b16 v[26:27], v6 offset:51712
s_waitcnt lgkmcnt(6)
v_mfma_f32_32x32x16_bf16 v[48:63], v[28:31], v[188:191], v[48:63]
ds_read_b64_tr_b16 v[28:29], v6 offset:59392
ds_read_b64_tr_b16 v[30:31], v6 offset:59904
s_waitcnt lgkmcnt(6)
v_mfma_f32_32x32x16_bf16 v[64:79], v[16:19], v[176:179], v[64:79]
ds_read_b64_tr_b16 v[16:17], v6 offset:53248
ds_read_b64_tr_b16 v[18:19], v6 offset:53760
s_waitcnt lgkmcnt(6)
v_mfma_f32_32x32x16_bf16 v[80:95], v[20:23], v[176:179], v[80:95]
ds_read_b64_tr_b16 v[20:21], v6 offset:61440
ds_read_b64_tr_b16 v[22:23], v6 offset:61952
s_waitcnt lgkmcnt(6)
v_mfma_f32_32x32x16_bf16 v[64:79], v[24:27], v[180:183], v[64:79]
ds_read_b64_tr_b16 v[24:25], v6 offset:55296
ds_read_b64_tr_b16 v[26:27], v6 offset:55808
s_waitcnt lgkmcnt(6)
v_mfma_f32_32x32x16_bf16 v[80:95], v[28:31], v[180:183], v[80:95]
s_barrier
ds_read_b64_tr_b16 v[28:29], v6 offset:63488
ds_read_b64_tr_b16 v[30:31], v6 offset:64000
s_waitcnt lgkmcnt(6)
v_mfma_f32_32x32x16_bf16 v[64:79], v[16:19], v[184:187], v[64:79]
ds_read_b64_tr_b16 v[16:17], v5 offset:0
ds_read_b64_tr_b16 v[18:19], v5 offset:512
s_waitcnt lgkmcnt(6)
v_mfma_f32_32x32x16_bf16 v[80:95], v[20:23], v[184:187], v[80:95]
ds_read_b64_tr_b16 v[20:21], v5 offset:8192
ds_read_b64_tr_b16 v[22:23], v5 offset:8704
s_waitcnt lgkmcnt(6)
v_mfma_f32_32x32x16_bf16 v[64:79], v[24:27], v[188:191], v[64:79]
ds_read_b64_tr_b16 v[24:25], v5 offset:2048
ds_read_b64_tr_b16 v[26:27], v5 offset:2560
s_waitcnt lgkmcnt(6)
v_mfma_f32_32x32x16_bf16 v[80:95], v[28:31], v[188:191], v[80:95]
ds_read_b64_tr_b16 v[28:29], v5 offset:10240
ds_read_b64_tr_b16 v[30:31], v5 offset:10752
s_waitcnt lgkmcnt(6)
v_mfma_f32_32x32x16_bf16 v[32:47], v[16:19], v[192:195], v[32:47]
ds_read_b64_tr_b16 v[16:17], v5 offset:4096
ds_read_b64_tr_b16 v[18:19], v5 offset:4608
s_waitcnt lgkmcnt(6)
v_mfma_f32_32x32x16_bf16 v[48:63], v[20:23], v[192:195], v[48:63]
ds_read_b64_tr_b16 v[20:21], v5 offset:12288
ds_read_b64_tr_b16 v[22:23], v5 offset:12800
s_waitcnt lgkmcnt(6)
v_mfma_f32_32x32x16_bf16 v[32:47], v[24:27], v[196:199], v[32:47]
ds_read_b64_tr_b16 v[24:25], v5 offset:6144
ds_read_b64_tr_b16 v[26:27], v5 offset:6656
s_waitcnt lgkmcnt(6)
v_mfma_f32_32x32x16_bf16 v[48:63], v[28:31], v[196:199], v[48:63]
ds_read_b64_tr_b16 v[28:29], v5 offset:14336
ds_read_b64_tr_b16 v[30:31], v5 offset:14848
s_waitcnt lgkmcnt(6)
v_mfma_f32_32x32x16_bf16 v[32:47], v[16:19], v[200:203], v[32:47]
ds_read_b64_tr_b16 v[16:17], v7 offset:0
ds_read_b64_tr_b16 v[18:19], v7 offset:512
s_waitcnt lgkmcnt(6)
v_mfma_f32_32x32x16_bf16 v[48:63], v[20:23], v[200:203], v[48:63]
ds_read_b64_tr_b16 v[20:21], v7 offset:8192
ds_read_b64_tr_b16 v[22:23], v7 offset:8704
s_waitcnt lgkmcnt(6)
v_mfma_f32_32x32x16_bf16 v[32:47], v[24:27], v[204:207], v[32:47]
ds_read_b64_tr_b16 v[24:25], v7 offset:2048
ds_read_b64_tr_b16 v[26:27], v7 offset:2560
s_waitcnt lgkmcnt(6)
v_mfma_f32_32x32x16_bf16 v[48:63], v[28:31], v[204:207], v[48:63]
ds_read_b64_tr_b16 v[28:29], v7 offset:10240
ds_read_b64_tr_b16 v[30:31], v7 offset:10752
s_waitcnt lgkmcnt(6)
v_mfma_f32_32x32x16_bf16 v[64:79], v[16:19], v[192:195], v[64:79]
ds_read_b64_tr_b16 v[16:17], v7 offset:4096
ds_read_b64_tr_b16 v[18:19], v7 offset:4608
s_waitcnt lgkmcnt(6)
v_mfma_f32_32x32x16_bf16 v[80:95], v[20:23], v[192:195], v[80:95]
ds_read_b64_tr_b16 v[20:21], v7 offset:12288
ds_read_b64_tr_b16 v[22:23], v7 offset:12800
s_waitcnt lgkmcnt(6)
v_mfma_f32_32x32x16_bf16 v[64:79], v[24:27], v[196:199], v[64:79]
ds_read_b64_tr_b16 v[24:25], v7 offset:6144
ds_read_b64_tr_b16 v[26:27], v7 offset:6656
s_waitcnt lgkmcnt(6)
v_mfma_f32_32x32x16_bf16 v[80:95], v[28:31], v[196:199], v[80:95]
ds_read_b64_tr_b16 v[28:29], v7 offset:14336
ds_read_b64_tr_b16 v[30:31], v7 offset:14848
s_waitcnt lgkmcnt(6)
v_mfma_f32_32x32x16_bf16 v[64:79], v[16:19], v[200:203], v[64:79]
ds_read_b64_tr_b16 v[16:17], v5 offset:16384
ds_read_b64_tr_b16 v[18:19], v5 offset:16896
s_waitcnt lgkmcnt(6)
v_mfma_f32_32x32x16_bf16 v[80:95], v[20:23], v[200:203], v[80:95]
ds_read_b64_tr_b16 v[20:21], v5 offset:24576
ds_read_b64_tr_b16 v[22:23], v5 offset:25088
s_waitcnt lgkmcnt(6)
v_mfma_f32_32x32x16_bf16 v[64:79], v[24:27], v[204:207], v[64:79]
ds_read_b64_tr_b16 v[24:25], v5 offset:18432
ds_read_b64_tr_b16 v[26:27], v5 offset:18944
s_waitcnt lgkmcnt(6)
v_mfma_f32_32x32x16_bf16 v[80:95], v[28:31], v[204:207], v[80:95]
ds_read_b64_tr_b16 v[28:29], v5 offset:26624
ds_read_b64_tr_b16 v[30:31], v5 offset:27136
ds_write_b32 v13, v14
s_waitcnt lgkmcnt(7)
v_mfma_f32_32x32x16_bf16 v[32:47], v[16:19], v[208:211], v[32:47]
ds_read_b64_tr_b16 v[16:17], v5 offset:20480
ds_read_b64_tr_b16 v[18:19], v5 offset:20992
s_waitcnt lgkmcnt(7)
v_mfma_f32_32x32x16_bf16 v[48:63], v[20:23], v[208:211], v[48:63]
ds_read_b64_tr_b16 v[20:21], v5 offset:28672
ds_read_b64_tr_b16 v[22:23], v5 offset:29184
s_waitcnt lgkmcnt(7)
v_mfma_f32_32x32x16_bf16 v[32:47], v[24:27], v[212:215], v[32:47]
ds_read_b64_tr_b16 v[24:25], v5 offset:22528
ds_read_b64_tr_b16 v[26:27], v5 offset:23040
s_waitcnt lgkmcnt(7)
v_mfma_f32_32x32x16_bf16 v[48:63], v[28:31], v[212:215], v[48:63]
ds_read_b64_tr_b16 v[28:29], v5 offset:30720
ds_read_b64_tr_b16 v[30:31], v5 offset:31232
s_waitcnt lgkmcnt(6)
v_mfma_f32_32x32x16_bf16 v[32:47], v[16:19], v[216:219], v[32:47]
ds_read_b64_tr_b16 v[16:17], v5 offset:32768
ds_read_b64_tr_b16 v[18:19], v5 offset:33280
s_waitcnt lgkmcnt(6)
v_mfma_f32_32x32x16_bf16 v[48:63], v[20:23], v[216:219], v[48:63]
ds_read_b64_tr_b16 v[20:21], v5 offset:40960
ds_read_b64_tr_b16 v[22:23], v5 offset:41472
s_waitcnt lgkmcnt(6)
v_mfma_f32_32x32x16_bf16 v[32:47], v[24:27], v[220:223], v[32:47]
ds_read_b64_tr_b16 v[24:25], v5 offset:34816
ds_read_b64_tr_b16 v[26:27], v5 offset:35328
s_waitcnt lgkmcnt(6)
v_mfma_f32_32x32x16_bf16 v[48:63], v[28:31], v[220:223], v[48:63]
ds_read_b64_tr_b16 v[28:29], v5 offset:43008
ds_read_b64_tr_b16 v[30:31], v5 offset:43520
s_waitcnt lgkmcnt(6)
v_mfma_f32_32x32x16_bf16 v[32:47], v[16:19], v[224:227], v[32:47]
ds_read_b64_tr_b16 v[16:17], v5 offset:36864
ds_read_b64_tr_b16 v[18:19], v5 offset:37376
s_waitcnt lgkmcnt(6)
v_mfma_f32_32x32x16_bf16 v[48:63], v[20:23], v[224:227], v[48:63]
ds_read_b64_tr_b16 v[20:21], v5 offset:45056
ds_read_b64_tr_b16 v[22:23], v5 offset:45568
s_waitcnt lgkmcnt(6)
v_mfma_f32_32x32x16_bf16 v[32:47], v[24:27], v[228:231], v[32:47]
ds_read_b64_tr_b16 v[24:25], v5 offset:38912
ds_read_b64_tr_b16 v[26:27], v5 offset:39424
s_waitcnt lgkmcnt(6)
v_mfma_f32_32x32x16_bf16 v[48:63], v[28:31], v[228:231], v[48:63]
ds_read_b64_tr_b16 v[28:29], v5 offset:47104
ds_read_b64_tr_b16 v[30:31], v5 offset:47616
s_waitcnt lgkmcnt(6)
v_mfma_f32_32x32x16_bf16 v[32:47], v[16:19], v[232:235], v[32:47]
ds_read_b64_tr_b16 v[16:17], v5 offset:49152
ds_read_b64_tr_b16 v[18:19], v5 offset:49664
s_waitcnt lgkmcnt(6)
v_mfma_f32_32x32x16_bf16 v[48:63], v[20:23], v[232:235], v[48:63]
ds_read_b64_tr_b16 v[20:21], v5 offset:57344
ds_read_b64_tr_b16 v[22:23], v5 offset:57856
s_waitcnt lgkmcnt(6)
v_mfma_f32_32x32x16_bf16 v[32:47], v[24:27], v[236:239], v[32:47]
ds_read_b64_tr_b16 v[24:25], v5 offset:51200
ds_read_b64_tr_b16 v[26:27], v5 offset:51712
s_waitcnt lgkmcnt(6)
v_mfma_f32_32x32x16_bf16 v[48:63], v[28:31], v[236:239], v[48:63]
ds_read_b64_tr_b16 v[28:29], v5 offset:59392
ds_read_b64_tr_b16 v[30:31], v5 offset:59904
s_waitcnt lgkmcnt(6)
v_mfma_f32_32x32x16_bf16 v[32:47], v[16:19], v[240:243], v[32:47]
ds_read_b64_tr_b16 v[16:17], v5 offset:53248
ds_read_b64_tr_b16 v[18:19], v5 offset:53760
s_waitcnt lgkmcnt(6)
v_mfma_f32_32x32x16_bf16 v[48:63], v[20:23], v[240:243], v[48:63]
ds_read_b64_tr_b16 v[20:21], v5 offset:61440
ds_read_b64_tr_b16 v[22:23], v5 offset:61952
s_waitcnt lgkmcnt(6)
v_mfma_f32_32x32x16_bf16 v[32:47], v[24:27], v[244:247], v[32:47]
ds_read_b64_tr_b16 v[24:25], v5 offset:55296
ds_read_b64_tr_b16 v[26:27], v5 offset:55808
s_waitcnt lgkmcnt(6)
v_mfma_f32_32x32x16_bf16 v[48:63], v[28:31], v[244:247], v[48:63]
ds_read_b64_tr_b16 v[28:29], v5 offset:63488
ds_read_b64_tr_b16 v[30:31], v5 offset:64000
s_waitcnt lgkmcnt(6)
v_mfma_f32_32x32x16_bf16 v[32:47], v[16:19], v[248:251], v[32:47]
ds_read_b64_tr_b16 v[16:17], v7 offset:16384
ds_read_b64_tr_b16 v[18:19], v7 offset:16896
s_waitcnt lgkmcnt(6)
v_mfma_f32_32x32x16_bf16 v[48:63], v[20:23], v[248:251], v[48:63]
ds_read_b64_tr_b16 v[20:21], v7 offset:24576
ds_read_b64_tr_b16 v[22:23], v7 offset:25088
s_waitcnt lgkmcnt(6)
v_mfma_f32_32x32x16_bf16 v[32:47], v[24:27], v[252:255], v[32:47]
ds_read_b64_tr_b16 v[24:25], v7 offset:18432
ds_read_b64_tr_b16 v[26:27], v7 offset:18944
s_waitcnt lgkmcnt(6)
v_mfma_f32_32x32x16_bf16 v[48:63], v[28:31], v[252:255], v[48:63]
ds_read_b64_tr_b16 v[28:29], v7 offset:26624
ds_read_b64_tr_b16 v[30:31], v7 offset:27136
s_waitcnt lgkmcnt(6)
v_mfma_f32_32x32x16_bf16 v[64:79], v[16:19], v[208:211], v[64:79]
ds_read_b64_tr_b16 v[16:17], v7 offset:20480
ds_read_b64_tr_b16 v[18:19], v7 offset:20992
s_waitcnt lgkmcnt(6)
v_mfma_f32_32x32x16_bf16 v[80:95], v[20:23], v[208:211], v[80:95]
ds_read_b64_tr_b16 v[20:21], v7 offset:28672
ds_read_b64_tr_b16 v[22:23], v7 offset:29184
s_waitcnt lgkmcnt(6)
v_mfma_f32_32x32x16_bf16 v[64:79], v[24:27], v[212:215], v[64:79]
ds_read_b64_tr_b16 v[24:25], v7 offset:22528
ds_read_b64_tr_b16 v[26:27], v7 offset:23040
s_waitcnt lgkmcnt(6)
v_mfma_f32_32x32x16_bf16 v[80:95], v[28:31], v[212:215], v[80:95]
ds_read_b64_tr_b16 v[28:29], v7 offset:30720
ds_read_b64_tr_b16 v[30:31], v7 offset:31232
v_max_f32 v32, 0, v32
v_mul_f32 v32, v32, v48
v_max_f32 v33, 0, v33
s_waitcnt lgkmcnt(6)
v_mfma_f32_32x32x16_bf16 v[64:79], v[16:19], v[216:219], v[64:79]
ds_read_b64_tr_b16 v[16:17], v7 offset:32768
ds_read_b64_tr_b16 v[18:19], v7 offset:33280
v_mul_f32 v33, v33, v49
v_max_f32 v34, 0, v34
v_mul_f32 v34, v34, v50
s_waitcnt lgkmcnt(6)
v_mfma_f32_32x32x16_bf16 v[80:95], v[20:23], v[216:219], v[80:95]
ds_read_b64_tr_b16 v[20:21], v7 offset:40960
ds_read_b64_tr_b16 v[22:23], v7 offset:41472
v_max_f32 v35, 0, v35
v_mul_f32 v35, v35, v51
v_max_f32 v36, 0, v36
s_waitcnt lgkmcnt(6)
v_mfma_f32_32x32x16_bf16 v[64:79], v[24:27], v[220:223], v[64:79]
ds_read_b64_tr_b16 v[24:25], v7 offset:34816
ds_read_b64_tr_b16 v[26:27], v7 offset:35328
v_mul_f32 v36, v36, v52
v_max_f32 v37, 0, v37
v_mul_f32 v37, v37, v53
s_waitcnt lgkmcnt(6)
v_mfma_f32_32x32x16_bf16 v[80:95], v[28:31], v[220:223], v[80:95]
ds_read_b64_tr_b16 v[28:29], v7 offset:43008
ds_read_b64_tr_b16 v[30:31], v7 offset:43520
v_max_f32 v38, 0, v38
v_mul_f32 v38, v38, v54
v_max_f32 v39, 0, v39
s_waitcnt lgkmcnt(6)
v_mfma_f32_32x32x16_bf16 v[64:79], v[16:19], v[224:227], v[64:79]
ds_read_b64_tr_b16 v[16:17], v7 offset:36864
ds_read_b64_tr_b16 v[18:19], v7 offset:37376
v_mul_f32 v39, v39, v55
v_cvt_pk_bf16_f32 v32, v32, v33
v_cvt_pk_bf16_f32 v33, v34, v35
s_waitcnt lgkmcnt(6)
v_mfma_f32_32x32x16_bf16 v[80:95], v[20:23], v[224:227], v[80:95]
ds_read_b64_tr_b16 v[20:21], v7 offset:45056
ds_read_b64_tr_b16 v[22:23], v7 offset:45568
v_cvt_pk_bf16_f32 v34, v36, v37
v_cvt_pk_bf16_f32 v35, v38, v39
buffer_store_dwordx4 v[32:35], v12, s[24:27], s71 offen offset:0 sc1
s_waitcnt lgkmcnt(6)
v_mfma_f32_32x32x16_bf16 v[64:79], v[24:27], v[228:231], v[64:79]
ds_read_b64_tr_b16 v[24:25], v7 offset:38912
ds_read_b64_tr_b16 v[26:27], v7 offset:39424
v_max_f32 v40, 0, v40
v_mul_f32 v40, v40, v56
v_max_f32 v41, 0, v41
s_waitcnt lgkmcnt(6)
v_mfma_f32_32x32x16_bf16 v[80:95], v[28:31], v[228:231], v[80:95]
ds_read_b64_tr_b16 v[28:29], v7 offset:47104
ds_read_b64_tr_b16 v[30:31], v7 offset:47616
v_mul_f32 v41, v41, v57
v_max_f32 v42, 0, v42
v_mul_f32 v42, v42, v58
s_waitcnt lgkmcnt(6)
v_mfma_f32_32x32x16_bf16 v[64:79], v[16:19], v[232:235], v[64:79]
ds_read_b64_tr_b16 v[16:17], v7 offset:49152
ds_read_b64_tr_b16 v[18:19], v7 offset:49664
v_max_f32 v43, 0, v43
v_mul_f32 v43, v43, v59
v_max_f32 v44, 0, v44
s_waitcnt lgkmcnt(6)
v_mfma_f32_32x32x16_bf16 v[80:95], v[20:23], v[232:235], v[80:95]
ds_read_b64_tr_b16 v[20:21], v7 offset:57344
ds_read_b64_tr_b16 v[22:23], v7 offset:57856
v_mul_f32 v44, v44, v60
v_max_f32 v45, 0, v45
v_mul_f32 v45, v45, v61
s_waitcnt lgkmcnt(6)
v_mfma_f32_32x32x16_bf16 v[64:79], v[24:27], v[236:239], v[64:79]
ds_read_b64_tr_b16 v[24:25], v7 offset:51200
ds_read_b64_tr_b16 v[26:27], v7 offset:51712
v_max_f32 v46, 0, v46
v_mul_f32 v46, v46, v62
v_max_f32 v47, 0, v47
s_waitcnt lgkmcnt(6)
v_mfma_f32_32x32x16_bf16 v[80:95], v[28:31], v[236:239], v[80:95]
ds_read_b64_tr_b16 v[28:29], v7 offset:59392
ds_read_b64_tr_b16 v[30:31], v7 offset:59904
v_mul_f32 v47, v47, v63
v_cvt_pk_bf16_f32 v40, v40, v41
v_cvt_pk_bf16_f32 v41, v42, v43
s_waitcnt lgkmcnt(6)
v_mfma_f32_32x32x16_bf16 v[64:79], v[16:19], v[240:243], v[64:79]
ds_read_b64_tr_b16 v[16:17], v7 offset:53248
ds_read_b64_tr_b16 v[18:19], v7 offset:53760
v_cvt_pk_bf16_f32 v42, v44, v45
v_cvt_pk_bf16_f32 v43, v46, v47
buffer_store_dwordx4 v[40:43], v12, s[24:27], s71 offen offset:1024 sc1
s_waitcnt lgkmcnt(6)
v_mfma_f32_32x32x16_bf16 v[80:95], v[20:23], v[240:243], v[80:95]
ds_read_b64_tr_b16 v[20:21], v7 offset:61440
ds_read_b64_tr_b16 v[22:23], v7 offset:61952
s_waitcnt lgkmcnt(6)
v_mfma_f32_32x32x16_bf16 v[64:79], v[24:27], v[244:247], v[64:79]
ds_read_b64_tr_b16 v[24:25], v7 offset:55296
ds_read_b64_tr_b16 v[26:27], v7 offset:55808
s_waitcnt lgkmcnt(6)
v_mfma_f32_32x32x16_bf16 v[80:95], v[28:31], v[244:247], v[80:95]
ds_read_b64_tr_b16 v[28:29], v7 offset:63488
ds_read_b64_tr_b16 v[30:31], v7 offset:64000
s_waitcnt lgkmcnt(6)
v_mfma_f32_32x32x16_bf16 v[64:79], v[16:19], v[248:251], v[64:79]
s_waitcnt lgkmcnt(4)
v_mfma_f32_32x32x16_bf16 v[80:95], v[20:23], v[248:251], v[80:95]
s_waitcnt lgkmcnt(2)
v_mfma_f32_32x32x16_bf16 v[64:79], v[24:27], v[252:255], v[64:79]
s_waitcnt lgkmcnt(0)
v_mfma_f32_32x32x16_bf16 v[80:95], v[28:31], v[252:255], v[80:95]
s_nop 7
s_nop 3
v_max_f32 v64, 0, v64
v_mul_f32 v64, v64, v80
v_max_f32 v65, 0, v65
v_mul_f32 v65, v65, v81
v_max_f32 v66, 0, v66
v_mul_f32 v66, v66, v82
v_max_f32 v67, 0, v67
v_mul_f32 v67, v67, v83
v_max_f32 v68, 0, v68
v_mul_f32 v68, v68, v84
v_max_f32 v69, 0, v69
v_mul_f32 v69, v69, v85
v_max_f32 v70, 0, v70
v_mul_f32 v70, v70, v86
v_max_f32 v71, 0, v71
v_mul_f32 v71, v71, v87
v_cvt_pk_bf16_f32 v64, v64, v65
v_cvt_pk_bf16_f32 v65, v66, v67
v_cvt_pk_bf16_f32 v66, v68, v69
v_cvt_pk_bf16_f32 v67, v70, v71
buffer_store_dwordx4 v[64:67], v12, s[24:27], s71 offen offset:2048 sc1
v_max_f32 v72, 0, v72
v_mul_f32 v72, v72, v88
v_max_f32 v73, 0, v73
v_mul_f32 v73, v73, v89
v_max_f32 v74, 0, v74
v_mul_f32 v74, v74, v90
v_max_f32 v75, 0, v75
v_mul_f32 v75, v75, v91
v_max_f32 v76, 0, v76
v_mul_f32 v76, v76, v92
v_max_f32 v77, 0, v77
v_mul_f32 v77, v77, v93
v_max_f32 v78, 0, v78
v_mul_f32 v78, v78, v94
v_max_f32 v79, 0, v79
v_mul_f32 v79, v79, v95
v_cvt_pk_bf16_f32 v72, v72, v73
v_cvt_pk_bf16_f32 v73, v74, v75
v_cvt_pk_bf16_f32 v74, v76, v77
v_cvt_pk_bf16_f32 v75, v78, v79
buffer_store_dwordx4 v[72:75], v12, s[24:27], s71 offen offset:3072 sc1
s_branch F_att
F_cB:
s_add_u32 s44, s61, 4
s_mov_b32 s45, 0
s_mov_b32 s46, 0
s_lshl_b32 s47, s61, 1
s_add_u32 s48, s47, 1
s_mov_b32 s49, 0
s_mov_b32 s53, 1051011932
s_lshl_b32 s63, s60, 2
s_add_u32 s63, s63, s3
v_lshrrev_b32 v13, 5, v2
v_lshlrev_b32 v13, 3, v13
v_bfe_u32 v14, v2, 2, 2
v_add_u32 v13, v13, v14
v_lshlrev_b32 v13, 7, v13
v_bfe_u32 v14, v2, 3, 1
v_lshl_add_u32 v13, v14, 6, v13
v_bfe_u32 v14, v2, 4, 1
v_lshl_add_u32 v13, v14, 5, v13
v_and_b32 v14, 3, v2
v_lshl_add_u32 v4, v14, 3, v13
v_add_u32 v5, 0x10000, v4
v_xor_b32 v6, 64, v4
v_xor_b32 v7, 64, v5
s_lshl_b32 s50, s49, 6
v_xor_b32 v8, s50, v4
v_xor_b32 v9, s50, v5
v_lshlrev_b32 v10, 3, v2
v_lshlrev_b32 v12, 4, v2
v_lshrrev_b32 v13, 5, v2
v_mul_u32_u24 v13, 10368, v13
v_and_b32 v14, 31, v2
v_lshl_add_u32 v11, v14, 4, v13
s_mov_b32 s52, 8388608
s_cmp_ge_u32 s44, 10
s_cselect_b32 s50, 12541952, s52
s_lshl_b32 s51, s44, 12
s_add_u32 s50, s50, s51
s_mul_i32 s51, s63, 40960
s_add_u32 s64, s50, s51
s_cmp_ge_u32 s44, 10
s_cselect_b32 s56, 1.0, s53
s_lshl_b32 s50, s47, 12
s_mul_i32 s51, s63, 110592
s_add_u32 s50, s50, s51
s_add_u32 s70, s50, 20971520
s_lshl_b32 s50, s48, 12
s_mul_i32 s51, s63, 110592
s_add_u32 s50, s50, s51
s_add_u32 s71, s50, 20971520
v_add_u32 v4, 32768, v4
v_add_u32 v5, 32768, v5
v_add_u32 v6, 32768, v6
v_add_u32 v7, 32768, v7
v_add_u32 v8, 32768, v8
v_add_u32 v9, 32768, v9
s_lshl_b32 s58, s63, 4
s_add_u32 s58, s58, s61
s_lshl_b32 s58, s58, 9
s_add_u32 s58, s58, 524288
s_lshl_b32 s40, s3, 2
s_add_u32 s40, s40, 16
v_mov_b32 v13, s40
v_mov_b32 v14, 1
s_lshl_b32 s43, s63, 9
s_add_u32 s43, s43, 0
v_lshrrev_b32 v16, 2, v2
v_lshlrev_b32 v16, 7, v16
v_and_b32 v17, 3, v2
v_lshl_add_u32 v16, v17, 2, v16
s_mov_b32 s1, 20000
s_mov_b32 exec_lo, 65535
s_mov_b32 exec_hi, 0
FXpB:
buffer_load_dword v17, v16, s[24:27], s43 offen offset:0 sc1
s_waitcnt vmcnt(0)
v_cmp_eq_u32 vcc, s0, v17
s_nop 0
s_cmp_eq_u64 vcc, exec
s_cbranch_scc1 FXpB_ok
s_sub_u32 s1, s1, 1
s_cmp_lg_u32 s1, 0
s_cbranch_scc1 FXpB
FXpB_ok:
s_mov_b64 exec, -1
s_mul_i32 s50, s63, 40960
s_add_u32 s50, s50, 4194304
buffer_load_dwordx4 v[96:99], v12, s[24:27], s50 offen offset:0 sc1
buffer_load_dwordx4 v[100:103], v12, s[24:27], s50 offen offset:1024 sc1
buffer_load_dwordx4 v[104:107], v12, s[24:27], s50 offen offset:2048 sc1
buffer_load_dwordx4 v[108:111], v12, s[24:27], s50 offen offset:3072 sc1
s_add_u32 s50, s50, 4096
buffer_load_dwordx4 v[112:115], v12, s[24:27], s50 offen offset:0 sc1
buffer_load_dwordx4 v[116:119], v12, s[24:27], s50 offen offset:1024 sc1
buffer_load_dwordx4 v[120:123], v12, s[24:27], s50 offen offset:2048 sc1
buffer_load_dwordx4 v[124:127], v12, s[24:27], s50 offen offset:3072 sc1
s_add_u32 s50, s50, 4096
buffer_load_dwordx4 v[128:131], v12, s[24:27], s50 offen offset:0 sc1
buffer_load_dwordx4 v[132:135], v12, s[24:27], s50 offen offset:1024 sc1
buffer_load_dwordx4 v[136:139], v12, s[24:27], s50 offen offset:2048 sc1
buffer_load_dwordx4 v[140:143], v12, s[24:27], s50 offen offset:3072 sc1
s_add_u32 s50, s50, 4096
buffer_load_dwordx4 v[144:147], v12, s[24:27], s50 offen offset:0 sc1
buffer_load_dwordx4 v[148:151], v12, s[24:27], s50 offen offset:1024 sc1
buffer_load_dwordx4 v[152:155], v12, s[24:27], s50 offen offset:2048 sc1
buffer_load_dwordx4 v[156:159], v12, s[24:27], s50 offen offset:3072 sc1
s_barrier
ds_read_b64_tr_b16 v[16:17], v5 offset:49152
ds_read_b64_tr_b16 v[18:19], v5 offset:49664
ds_read_b64_tr_b16 v[20:21], v5 offset:57344
ds_read_b64_tr_b16 v[22:23], v5 offset:57856
ds_read_b64_tr_b16 v[24:25], v5 offset:51200
ds_read_b64_tr_b16 v[26:27], v5 offset:51712
ds_read_b64_tr_b16 v[28:29], v5 offset:59392
ds_read_b64_tr_b16 v[30:31], v5 offset:59904
s_waitcnt vmcnt(15) lgkmcnt(6)
v_mfma_f32_32x32x16_bf16 v[32:47], v[16:19], v[96:99], 0
ds_read_b64_tr_b16 v[16:17], v5 offset:53248
ds_read_b64_tr_b16 v[18:19], v5 offset:53760
s_waitcnt lgkmcnt(6)
v_mfma_f32_32x32x16_bf16 v[48:63], v[20:23], v[96:99], 0
ds_read_b64_tr_b16 v[20:21], v5 offset:61440
ds_read_b64_tr_b16 v[22:23], v5 offset:61952
s_waitcnt vmcnt(14) lgkmcnt(6)
v_mfma_f32_32x32x16_bf16 v[32:47], v[24:27], v[100:103], v[32:47]
ds_read_b64_tr_b16 v[24:25], v5 offset:55296
ds_read_b64_tr_b16 v[26:27], v5 offset:55808
s_waitcnt lgkmcnt(6)
v_mfma_f32_32x32x16_bf16 v[48:63], v[28:31], v[100:103], v[48:63]
ds_read_b64_tr_b16 v[28:29], v5 offset:63488
ds_read_b64_tr_b16 v[30:31], v5 offset:64000
s_add_u32 s50, s50, 4096
buffer_load_dwordx4 v[160:163], v12, s[24:27], s50 offen offset:0 sc1
s_waitcnt vmcnt(14) lgkmcnt(6)
v_mfma_f32_32x32x16_bf16 v[32:47], v[16:19], v[104:107], v[32:47]
ds_read_b64_tr_b16 v[16:17], v7 offset:49152
ds_read_b64_tr_b16 v[18:19], v7 offset:49664
s_waitcnt lgkmcnt(6)
v_mfma_f32_32x32x16_bf16 v[48:63], v[20:23], v[104:107], v[48:63]
ds_read_b64_tr_b16 v[20:21], v7 offset:57344
ds_read_b64_tr_b16 v[22:23], v7 offset:57856
s_waitcnt vmcnt(13) lgkmcnt(6)
v_mfma_f32_32x32x16_bf16 v[32:47], v[24:27], v[108:111], v[32:47]
ds_read_b64_tr_b16 v[24:25], v7 offset:51200
ds_read_b64_tr_b16 v[26:27], v7 offset:51712
s_waitcnt lgkmcnt(6)
v_mfma_f32_32x32x16_bf16 v[48:63], v[28:31], v[108:111], v[48:63]
ds_read_b64_tr_b16 v[28:29], v7 offset:59392
ds_read_b64_tr_b16 v[30:31], v7 offset:59904
buffer_load_dwordx4 v[164:167], v12, s[24:27], s50 offen offset:1024 sc1
s_waitcnt lgkmcnt(6)
v_mfma_f32_32x32x16_bf16 v[64:79], v[16:19], v[96:99], 0
ds_read_b64_tr_b16 v[16:17], v7 offset:53248
ds_read_b64_tr_b16 v[18:19], v7 offset:53760
s_waitcnt lgkmcnt(6)
v_mfma_f32_32x32x16_bf16 v[80:95], v[20:23], v[96:99], 0
ds_read_b64_tr_b16 v[20:21], v7 offset:61440
ds_read_b64_tr_b16 v[22:23], v7 offset:61952
s_waitcnt lgkmcnt(6)
v_mfma_f32_32x32x16_bf16 v[64:79], v[24:27], v[100:103], v[64:79]
ds_read_b64_tr_b16 v[24:25], v7 offset:55296
ds_read_b64_tr_b16 v[26:27], v7 offset:55808
s_waitcnt lgkmcnt(6)
v_mfma_f32_32x32x16_bf16 v[80:95], v[28:31], v[100:103], v[80:95]
s_barrier
ds_read_b64_tr_b16 v[28:29], v7 offset:63488
ds_read_b64_tr_b16 v[30:31], v7 offset:64000
buffer_load_dwordx4 v[168:171], v12, s[24:27], s50 offen offset:2048 sc1
s_waitcnt lgkmcnt(6)
v_mfma_f32_32x32x16_bf16 v[64:79], v[16:19], v[104:107], v[64:79]
ds_read_b64_tr_b16 v[16:17], v4 offset:0
ds_read_b64_tr_b16 v[18:19], v4 offset:512
s_waitcnt lgkmcnt(6)
v_mfma_f32_32x32x16_bf16 v[80:95], v[20:23], v[104:107], v[80:95]
ds_read_b64_tr_b16 v[20:21], v4 offset:8192
ds_read_b64_tr_b16 v[22:23], v4 offset:8704
s_waitcnt lgkmcnt(6)
v_mfma_f32_32x32x16_bf16 v[64:79], v[24:27], v[108:111], v[64:79]
ds_read_b64_tr_b16 v[24:25], v4 offset:2048
ds_read_b64_tr_b16 v[26:27], v4 offset:2560
s_waitcnt lgkmcnt(6)
v_mfma_f32_32x32x16_bf16 v[80:95], v[28:31], v[108:111], v[80:95]
ds_read_b64_tr_b16 v[28:29], v4 offset:10240
ds_read_b64_tr_b16 v[30:31], v4 offset:10752
buffer_load_dwordx4 v[172:175], v12, s[24:27], s50 offen offset:3072 sc1
s_waitcnt vmcnt(15) lgkmcnt(6)
v_mfma_f32_32x32x16_bf16 v[32:47], v[16:19], v[112:115], v[32:47]
ds_read_b64_tr_b16 v[16:17], v4 offset:4096
ds_read_b64_tr_b16 v[18:19], v4 offset:4608
s_waitcnt lgkmcnt(6)
v_mfma_f32_32x32x16_bf16 v[48:63], v[20:23], v[112:115], v[48:63]
ds_read_b64_tr_b16 v[20:21], v4 offset:12288
ds_read_b64_tr_b16 v[22:23], v4 offset:12800
s_waitcnt vmcnt(14) lgkmcnt(6)
v_mfma_f32_32x32x16_bf16 v[32:47], v[24:27], v[116:119], v[32:47]
ds_read_b64_tr_b16 v[24:25], v4 offset:6144
ds_read_b64_tr_b16 v[26:27], v4 offset:6656
s_waitcnt lgkmcnt(6)
v_mfma_f32_32x32x16_bf16 v[48:63], v[28:31], v[116:119], v[48:63]
ds_read_b64_tr_b16 v[28:29], v4 offset:14336
ds_read_b64_tr_b16 v[30:31], v4 offset:14848
s_add_u32 s50, s50, 4096
buffer_load_dwordx4 v[176:179], v12, s[24:27], s50 offen offset:0 sc1
s_waitcnt vmcnt(14) lgkmcnt(6)
v_mfma_f32_32x32x16_bf16 v[32:47], v[16:19], v[120:123], v[32:47]
ds_read_b64_tr_b16 v[16:17], v6 offset:0
ds_read_b64_tr_b16 v[18:19], v6 offset:512
s_waitcnt lgkmcnt(6)
v_mfma_f32_32x32x16_bf16 v[48:63], v[20:23], v[120:123], v[48:63]
ds_read_b64_tr_b16 v[20:21], v6 offset:8192
ds_read_b64_tr_b16 v[22:23], v6 offset:8704
s_waitcnt vmcnt(13) lgkmcnt(6)
v_mfma_f32_32x32x16_bf16 v[32:47], v[24:27], v[124:127], v[32:47]
ds_read_b64_tr_b16 v[24:25], v6 offset:2048
ds_read_b64_tr_b16 v[26:27], v6 offset:2560
s_waitcnt lgkmcnt(6)
v_mfma_f32_32x32x16_bf16 v[48:63], v[28:31], v[124:127], v[48:63]
ds_read_b64_tr_b16 v[28:29], v6 offset:10240
ds_read_b64_tr_b16 v[30:31], v6 offset:10752
buffer_load_dwordx4 v[180:183], v12, s[24:27], s50 offen offset:1024 sc1
s_waitcnt lgkmcnt(6)
v_mfma_f32_32x32x16_bf16 v[64:79], v[16:19], v[112:115], v[64:79]
ds_read_b64_tr_b16 v[16:17], v6 offset:4096
ds_read_b64_tr_b16 v[18:19], v6 offset:4608
s_waitcnt lgkmcnt(6)
v_mfma_f32_32x32x16_bf16 v[80:95], v[20:23], v[112:115], v[80:95]
ds_read_b64_tr_b16 v[20:21], v6 offset:12288
ds_read_b64_tr_b16 v[22:23], v6 offset:12800
s_waitcnt lgkmcnt(6)
v_mfma_f32_32x32x16_bf16 v[64:79], v[24:27], v[116:119], v[64:79]
ds_read_b64_tr_b16 v[24:25], v6 offset:6144
ds_read_b64_tr_b16 v[26:27], v6 offset:6656
s_waitcnt lgkmcnt(6)
v_mfma_f32_32x32x16_bf16 v[80:95], v[28:31], v[116:119], v[80:95]
s_barrier
ds_read_b64_tr_b16 v[28:29], v6 offset:14336
ds_read_b64_tr_b16 v[30:31], v6 offset:14848
buffer_load_dwordx4 v[184:187], v12, s[24:27], s50 offen offset:2048 sc1
s_waitcnt lgkmcnt(6)
v_mfma_f32_32x32x16_bf16 v[64:79], v[16:19], v[120:123], v[64:79]
ds_read_b64_tr_b16 v[16:17], v4 offset:16384
ds_read_b64_tr_b16 v[18:19], v4 offset:16896
s_waitcnt lgkmcnt(6)
v_mfma_f32_32x32x16_bf16 v[80:95], v[20:23], v[120:123], v[80:95]
ds_read_b64_tr_b16 v[20:21], v4 offset:24576
ds_read_b64_tr_b16 v[22:23], v4 offset:25088
s_waitcnt lgkmcnt(6)
v_mfma_f32_32x32x16_bf16 v[64:79], v[24:27], v[124:127], v[64:79]
ds_read_b64_tr_b16 v[24:25], v4 offset:18432
ds_read_b64_tr_b16 v[26:27], v4 offset:18944
s_waitcnt lgkmcnt(6)
v_mfma_f32_32x32x16_bf16 v[80:95], v[28:31], v[124:127], v[80:95]
ds_read_b64_tr_b16 v[28:29], v4 offset:26624
ds_read_b64_tr_b16 v[30:31], v4 offset:27136
buffer_load_dwordx4 v[188:191], v12, s[24:27], s50 offen offset:3072 sc1
s_waitcnt vmcnt(15) lgkmcnt(6)
v_mfma_f32_32x32x16_bf16 v[32:47], v[16:19], v[128:131], v[32:47]
ds_read_b64_tr_b16 v[16:17], v4 offset:20480
ds_read_b64_tr_b16 v[18:19], v4 offset:20992
s_waitcnt lgkmcnt(6)
v_mfma_f32_32x32x16_bf16 v[48:63], v[20:23], v[128:131], v[48:63]
ds_read_b64_tr_b16 v[20:21], v4 offset:28672
ds_read_b64_tr_b16 v[22:23], v4 offset:29184
s_waitcnt vmcnt(14) lgkmcnt(6)
v_mfma_f32_32x32x16_bf16 v[32:47], v[24:27], v[132:135], v[32:47]
ds_read_b64_tr_b16 v[24:25], v4 offset:22528
ds_read_b64_tr_b16 v[26:27], v4 offset:23040
s_waitcnt lgkmcnt(6)
v_mfma_f32_32x32x16_bf16 v[48:63], v[28:31], v[132:135], v[48:63]
ds_read_b64_tr_b16 v[28:29], v4 offset:30720
ds_read_b64_tr_b16 v[30:31], v4 offset:31232
s_add_u32 s50, s50, 4096
buffer_load_dwordx4 v[192:195], v12, s[24:27], s50 offen offset:0 sc1
s_waitcnt vmcnt(14) lgkmcnt(6)
v_mfma_f32_32x32x16_bf16 v[32:47], v[16:19], v[136:139], v[32:47]
ds_read_b64_tr_b16 v[16:17], v6 offset:16384
ds_read_b64_tr_b16 v[18:19], v6 offset:16896
s_waitcnt lgkmcnt(6)
v_mfma_f32_32x32x16_bf16 v[48:63], v[20:23], v[136:139], v[48:63]
ds_read_b64_tr_b16 v[20:21], v6 offset:24576
ds_read_b64_tr_b16 v[22:23], v6 offset:25088
s_waitcnt vmcnt(13) lgkmcnt(6)
v_mfma_f32_32x32x16_bf16 v[32:47], v[24:27], v[140:143], v[32:47]
ds_read_b64_tr_b16 v[24:25], v6 offset:18432
ds_read_b64_tr_b16 v[26:27], v6 offset:18944
s_waitcnt lgkmcnt(6)
v_mfma_f32_32x32x16_bf16 v[48:63], v[28:31], v[140:143], v[48:63]
ds_read_b64_tr_b16 v[28:29], v6 offset:26624
ds_read_b64_tr_b16 v[30:31], v6 offset:27136
buffer_load_dwordx4 v[196:199], v12, s[24:27], s50 offen offset:1024 sc1
s_waitcnt lgkmcnt(6)
v_mfma_f32_32x32x16_bf16 v[64:79], v[16:19], v[128:131], v[64:79]
ds_read_b64_tr_b16 v[16:17], v6 offset:20480
ds_read_b64_tr_b16 v[18:19], v6 offset:20992
s_waitcnt lgkmcnt(6)
v_mfma_f32_32x32x16_bf16 v[80:95], v[20:23], v[128:131], v[80:95]
ds_read_b64_tr_b16 v[20:21], v6 offset:28672
ds_read_b64_tr_b16 v[22:23], v6 offset:29184
s_waitcnt lgkmcnt(6)
v_mfma_f32_32x32x16_bf16 v[64:79], v[24:27], v[132:135], v[64:79]
ds_read_b64_tr_b16 v[24:25], v6 offset:22528
ds_read_b64_tr_b16 v[26:27], v6 offset:23040
s_waitcnt lgkmcnt(6)
v_mfma_f32_32x32x16_bf16 v[80:95], v[28:31], v[132:135], v[80:95]
s_barrier
ds_read_b64_tr_b16 v[28:29], v6 offset:30720
ds_read_b64_tr_b16 v[30:31], v6 offset:31232
buffer_load_dwordx4 v[200:203], v12, s[24:27], s50 offen offset:2048 sc1
s_waitcnt lgkmcnt(6)
v_mfma_f32_32x32x16_bf16 v[64:79], v[16:19], v[136:139], v[64:79]
ds_read_b64_tr_b16 v[16:17], v4 offset:32768
ds_read_b64_tr_b16 v[18:19], v4 offset:33280
s_waitcnt lgkmcnt(6)
v_mfma_f32_32x32x16_bf16 v[80:95], v[20:23], v[136:139], v[80:95]
ds_read_b64_tr_b16 v[20:21], v4 offset:40960
ds_read_b64_tr_b16 v[22:23], v4 offset:41472
s_waitcnt lgkmcnt(6)
v_mfma_f32_32x32x16_bf16 v[64:79], v[24:27], v[140:143], v[64:79]
ds_read_b64_tr_b16 v[24:25], v4 offset:34816
ds_read_b64_tr_b16 v[26:27], v4 offset:35328
s_waitcnt lgkmcnt(6)
v_mfma_f32_32x32x16_bf16 v[80:95], v[28:31], v[140:143], v[80:95]
ds_read_b64_tr_b16 v[28:29], v4 offset:43008
ds_read_b64_tr_b16 v[30:31], v4 offset:43520
buffer_load_dwordx4 v[204:207], v12, s[24:27], s50 offen offset:3072 sc1
s_waitcnt vmcnt(15) lgkmcnt(6)
v_mfma_f32_32x32x16_bf16 v[32:47], v[16:19], v[144:147], v[32:47]
ds_read_b64_tr_b16 v[16:17], v4 offset:36864
ds_read_b64_tr_b16 v[18:19], v4 offset:37376
s_waitcnt lgkmcnt(6)
v_mfma_f32_32x32x16_bf16 v[48:63], v[20:23], v[144:147], v[48:63]
ds_read_b64_tr_b16 v[20:21], v4 offset:45056
ds_read_b64_tr_b16 v[22:23], v4 offset:45568
s_waitcnt vmcnt(14) lgkmcnt(6)
v_mfma_f32_32x32x16_bf16 v[32:47], v[24:27], v[148:151], v[32:47]
ds_read_b64_tr_b16 v[24:25], v4 offset:38912
ds_read_b64_tr_b16 v[26:27], v4 offset:39424
s_waitcnt lgkmcnt(6)
v_mfma_f32_32x32x16_bf16 v[48:63], v[28:31], v[148:151], v[48:63]
ds_read_b64_tr_b16 v[28:29], v4 offset:47104
ds_read_b64_tr_b16 v[30:31], v4 offset:47616
s_add_u32 s50, s50, 4096
buffer_load_dwordx4 v[208:211], v12, s[24:27], s50 offen offset:0 sc1
s_waitcnt vmcnt(14) lgkmcnt(6)
v_mfma_f32_32x32x16_bf16 v[32:47], v[16:19], v[152:155], v[32:47]
ds_read_b64_tr_b16 v[16:17], v6 offset:32768
ds_read_b64_tr_b16 v[18:19], v6 offset:33280
s_waitcnt lgkmcnt(6)
v_mfma_f32_32x32x16_bf16 v[48:63], v[20:23], v[152:155], v[48:63]
ds_read_b64_tr_b16 v[20:21], v6 offset:40960
ds_read_b64_tr_b16 v[22:23], v6 offset:41472
s_waitcnt vmcnt(13) lgkmcnt(6)
v_mfma_f32_32x32x16_bf16 v[32:47], v[24:27], v[156:159], v[32:47]
ds_read_b64_tr_b16 v[24:25], v6 offset:34816
ds_read_b64_tr_b16 v[26:27], v6 offset:35328
s_waitcnt lgkmcnt(6)
v_mfma_f32_32x32x16_bf16 v[48:63], v[28:31], v[156:159], v[48:63]
ds_read_b64_tr_b16 v[28:29], v6 offset:43008
ds_read_b64_tr_b16 v[30:31], v6 offset:43520
buffer_load_dwordx4 v[212:215], v12, s[24:27], s50 offen offset:1024 sc1
s_waitcnt lgkmcnt(6)
v_mfma_f32_32x32x16_bf16 v[64:79], v[16:19], v[144:147], v[64:79]
ds_read_b64_tr_b16 v[16:17], v6 offset:36864
ds_read_b64_tr_b16 v[18:19], v6 offset:37376
s_waitcnt lgkmcnt(6)
v_mfma_f32_32x32x16_bf16 v[80:95], v[20:23], v[144:147], v[80:95]
ds_read_b64_tr_b16 v[20:21], v6 offset:45056
ds_read_b64_tr_b16 v[22:23], v6 offset:45568
s_waitcnt lgkmcnt(6)
v_mfma_f32_32x32x16_bf16 v[64:79], v[24:27], v[148:151], v[64:79]
ds_read_b64_tr_b16 v[24:25], v6 offset:38912
ds_read_b64_tr_b16 v[26:27], v6 offset:39424
s_waitcnt lgkmcnt(6)
v_mfma_f32_32x32x16_bf16 v[80:95], v[28:31], v[148:151], v[80:95]
s_barrier
ds_read_b64_tr_b16 v[28:29], v6 offset:47104
ds_read_b64_tr_b16 v[30:31], v6 offset:47616
buffer_load_dwordx4 v[216:219], v12, s[24:27], s50 offen offset:2048 sc1
s_waitcnt lgkmcnt(6)
v_mfma_f32_32x32x16_bf16 v[64:79], v[16:19], v[152:155], v[64:79]
ds_read_b64_tr_b16 v[16:17], v4 offset:49152
ds_read_b64_tr_b16 v[18:19], v4 offset:49664
s_waitcnt lgkmcnt(6)
v_mfma_f32_32x32x16_bf16 v[80:95], v[20:23], v[152:155], v[80:95]
ds_read_b64_tr_b16 v[20:21], v4 offset:57344
ds_read_b64_tr_b16 v[22:23], v4 offset:57856
s_waitcnt lgkmcnt(6)
v_mfma_f32_32x32x16_bf16 v[64:79], v[24:27], v[156:159], v[64:79]
ds_read_b64_tr_b16 v[24:25], v4 offset:51200
ds_read_b64_tr_b16 v[26:27], v4 offset:51712
s_waitcnt lgkmcnt(6)
v_mfma_f32_32x32x16_bf16 v[80:95], v[28:31], v[156:159], v[80:95]
ds_read_b64_tr_b16 v[28:29], v4 offset:59392
ds_read_b64_tr_b16 v[30:31], v4 offset:59904
buffer_load_dwordx4 v[220:223], v12, s[24:27], s50 offen offset:3072 sc1
s_waitcnt vmcnt(15) lgkmcnt(6)
v_mfma_f32_32x32x16_bf16 v[32:47], v[16:19], v[160:163], v[32:47]
ds_read_b64_tr_b16 v[16:17], v4 offset:53248
ds_read_b64_tr_b16 v[18:19], v4 offset:53760
s_waitcnt lgkmcnt(6)
v_mfma_f32_32x32x16_bf16 v[48:63], v[20:23], v[160:163], v[48:63]
ds_read_b64_tr_b16 v[20:21], v4 offset:61440
ds_read_b64_tr_b16 v[22:23], v4 offset:61952
s_waitcnt vmcnt(14) lgkmcnt(6)
v_mfma_f32_32x32x16_bf16 v[32:47], v[24:27], v[164:167], v[32:47]
ds_read_b64_tr_b16 v[24:25], v4 offset:55296
ds_read_b64_tr_b16 v[26:27], v4 offset:55808
s_waitcnt lgkmcnt(6)
v_mfma_f32_32x32x16_bf16 v[48:63], v[28:31], v[164:167], v[48:63]
ds_read_b64_tr_b16 v[28:29], v4 offset:63488
ds_read_b64_tr_b16 v[30:31], v4 offset:64000
s_add_u32 s50, s50, 4096
buffer_load_dwordx4 v[224:227], v12, s[24:27], s50 offen offset:0 sc1
s_waitcnt vmcnt(14) lgkmcnt(6)
v_mfma_f32_32x32x16_bf16 v[32:47], v[16:19], v[168:171], v[32:47]
ds_read_b64_tr_b16 v[16:17], v6 offset:49152
ds_read_b64_tr_b16 v[18:19], v6 offset:49664
s_waitcnt lgkmcnt(6)
v_mfma_f32_32x32x16_bf16 v[48:63], v[20:23], v[168:171], v[48:63]
ds_read_b64_tr_b16 v[20:21], v6 offset:57344
ds_read_b64_tr_b16 v[22:23], v6 offset:57856
s_waitcnt vmcnt(13) lgkmcnt(6)
v_mfma_f32_32x32x16_bf16 v[32:47], v[24:27], v[172:175], v[32:47]
ds_read_b64_tr_b16 v[24:25], v6 offset:51200
ds_read_b64_tr_b16 v[26:27], v6 offset:51712
s_waitcnt lgkmcnt(6)
v_mfma_f32_32x32x16_bf16 v[48:63], v[28:31], v[172:175], v[48:63]
ds_read_b64_tr_b16 v[28:29], v6 offset:59392
ds_read_b64_tr_b16 v[30:31], v6 offset:59904
buffer_load_dwordx4 v[228:231], v12, s[24:27], s50 offen offset:1024 sc1
s_waitcnt lgkmcnt(6)
v_mfma_f32_32x32x16_bf16 v[64:79], v[16:19], v[160:163], v[64:79]
ds_read_b64_tr_b16 v[16:17], v6 offset:53248
ds_read_b64_tr_b16 v[18:19], v6 offset:53760
s_waitcnt lgkmcnt(6)
v_mfma_f32_32x32x16_bf16 v[80:95], v[20:23], v[160:163], v[80:95]
ds_read_b64_tr_b16 v[20:21], v6 offset:61440
ds_read_b64_tr_b16 v[22:23], v6 offset:61952
s_waitcnt lgkmcnt(6)
v_mfma_f32_32x32x16_bf16 v[64:79], v[24:27], v[164:167], v[64:79]
ds_read_b64_tr_b16 v[24:25], v6 offset:55296
ds_read_b64_tr_b16 v[26:27], v6 offset:55808
s_waitcnt lgkmcnt(6)
v_mfma_f32_32x32x16_bf16 v[80:95], v[28:31], v[164:167], v[80:95]
s_barrier
ds_read_b64_tr_b16 v[28:29], v6 offset:63488
ds_read_b64_tr_b16 v[30:31], v6 offset:64000
buffer_load_dwordx4 v[232:235], v12, s[24:27], s50 offen offset:2048 sc1
s_waitcnt lgkmcnt(6)
v_mfma_f32_32x32x16_bf16 v[64:79], v[16:19], v[168:171], v[64:79]
ds_read_b64_tr_b16 v[16:17], v5 offset:0
ds_read_b64_tr_b16 v[18:19], v5 offset:512
s_waitcnt lgkmcnt(6)
v_mfma_f32_32x32x16_bf16 v[80:95], v[20:23], v[168:171], v[80:95]
ds_read_b64_tr_b16 v[20:21], v5 offset:8192
ds_read_b64_tr_b16 v[22:23], v5 offset:8704
s_waitcnt lgkmcnt(6)
v_mfma_f32_32x32x16_bf16 v[64:79], v[24:27], v[172:175], v[64:79]
ds_read_b64_tr_b16 v[24:25], v5 offset:2048
ds_read_b64_tr_b16 v[26:27], v5 offset:2560
s_waitcnt lgkmcnt(6)
v_mfma_f32_32x32x16_bf16 v[80:95], v[28:31], v[172:175], v[80:95]
ds_read_b64_tr_b16 v[28:29], v5 offset:10240
ds_read_b64_tr_b16 v[30:31], v5 offset:10752
buffer_load_dwordx4 v[236:239], v12, s[24:27], s50 offen offset:3072 sc1
s_waitcnt vmcnt(15) lgkmcnt(6)
v_mfma_f32_32x32x16_bf16 v[32:47], v[16:19], v[176:179], v[32:47]
ds_read_b64_tr_b16 v[16:17], v5 offset:4096
ds_read_b64_tr_b16 v[18:19], v5 offset:4608
s_waitcnt lgkmcnt(6)
v_mfma_f32_32x32x16_bf16 v[48:63], v[20:23], v[176:179], v[48:63]
ds_read_b64_tr_b16 v[20:21], v5 offset:12288
ds_read_b64_tr_b16 v[22:23], v5 offset:12800
s_waitcnt vmcnt(14) lgkmcnt(6)
v_mfma_f32_32x32x16_bf16 v[32:47], v[24:27], v[180:183], v[32:47]
ds_read_b64_tr_b16 v[24:25], v5 offset:6144
ds_read_b64_tr_b16 v[26:27], v5 offset:6656
s_waitcnt lgkmcnt(6)
v_mfma_f32_32x32x16_bf16 v[48:63], v[28:31], v[180:183], v[48:63]
ds_read_b64_tr_b16 v[28:29], v5 offset:14336
ds_read_b64_tr_b16 v[30:31], v5 offset:14848
s_add_u32 s50, s50, 4096
buffer_load_dwordx4 v[240:243], v12, s[24:27], s50 offen offset:0 sc1
s_waitcnt vmcnt(14) lgkmcnt(6)
v_mfma_f32_32x32x16_bf16 v[32:47], v[16:19], v[184:187], v[32:47]
ds_read_b64_tr_b16 v[16:17], v7 offset:0
ds_read_b64_tr_b16 v[18:19], v7 offset:512
s_waitcnt lgkmcnt(6)
v_mfma_f32_32x32x16_bf16 v[48:63], v[20:23], v[184:187], v[48:63]
ds_read_b64_tr_b16 v[20:21], v7 offset:8192
ds_read_b64_tr_b16 v[22:23], v7 offset:8704
s_waitcnt vmcnt(13) lgkmcnt(6)
v_mfma_f32_32x32x16_bf16 v[32:47], v[24:27], v[188:191], v[32:47]
ds_read_b64_tr_b16 v[24:25], v7 offset:2048
ds_read_b64_tr_b16 v[26:27], v7 offset:2560
s_waitcnt lgkmcnt(6)
v_mfma_f32_32x32x16_bf16 v[48:63], v[28:31], v[188:191], v[48:63]
ds_read_b64_tr_b16 v[28:29], v7 offset:10240
ds_read_b64_tr_b16 v[30:31], v7 offset:10752
buffer_load_dwordx4 v[244:247], v12, s[24:27], s50 offen offset:1024 sc1
s_waitcnt lgkmcnt(6)
v_mfma_f32_32x32x16_bf16 v[64:79], v[16:19], v[176:179], v[64:79]
ds_read_b64_tr_b16 v[16:17], v7 offset:4096
ds_read_b64_tr_b16 v[18:19], v7 offset:4608
s_waitcnt lgkmcnt(6)
v_mfma_f32_32x32x16_bf16 v[80:95], v[20:23], v[176:179], v[80:95]
ds_read_b64_tr_b16 v[20:21], v7 offset:12288
ds_read_b64_tr_b16 v[22:23], v7 offset:12800
s_waitcnt lgkmcnt(6)
v_mfma_f32_32x32x16_bf16 v[64:79], v[24:27], v[180:183], v[64:79]
ds_read_b64_tr_b16 v[24:25], v7 offset:6144
ds_read_b64_tr_b16 v[26:27], v7 offset:6656
s_waitcnt lgkmcnt(6)
v_mfma_f32_32x32x16_bf16 v[80:95], v[28:31], v[180:183], v[80:95]
s_barrier
ds_read_b64_tr_b16 v[28:29], v7 offset:14336
ds_read_b64_tr_b16 v[30:31], v7 offset:14848
buffer_load_dwordx4 v[248:251], v12, s[24:27], s50 offen offset:2048 sc1
s_waitcnt lgkmcnt(6)
v_mfma_f32_32x32x16_bf16 v[64:79], v[16:19], v[184:187], v[64:79]
ds_read_b64_tr_b16 v[16:17], v5 offset:16384
ds_read_b64_tr_b16 v[18:19], v5 offset:16896
s_waitcnt lgkmcnt(6)
v_mfma_f32_32x32x16_bf16 v[80:95], v[20:23], v[184:187], v[80:95]
ds_read_b64_tr_b16 v[20:21], v5 offset:24576
ds_read_b64_tr_b16 v[22:23], v5 offset:25088
s_waitcnt lgkmcnt(6)
v_mfma_f32_32x32x16_bf16 v[64:79], v[24:27], v[188:191], v[64:79]
ds_read_b64_tr_b16 v[24:25], v5 offset:18432
ds_read_b64_tr_b16 v[26:27], v5 offset:18944
s_waitcnt lgkmcnt(6)
v_mfma_f32_32x32x16_bf16 v[80:95], v[28:31], v[188:191], v[80:95]
ds_read_b64_tr_b16 v[28:29], v5 offset:26624
ds_read_b64_tr_b16 v[30:31], v5 offset:27136
buffer_load_dwordx4 v[252:255], v12, s[24:27], s50 offen offset:3072 sc1
s_waitcnt vmcnt(15) lgkmcnt(6)
v_mfma_f32_32x32x16_bf16 v[32:47], v[16:19], v[192:195], v[32:47]
ds_read_b64_tr_b16 v[16:17], v5 offset:20480
ds_read_b64_tr_b16 v[18:19], v5 offset:20992
s_waitcnt lgkmcnt(6)
v_mfma_f32_32x32x16_bf16 v[48:63], v[20:23], v[192:195], v[48:63]
ds_read_b64_tr_b16 v[20:21], v5 offset:28672
ds_read_b64_tr_b16 v[22:23], v5 offset:29184
s_waitcnt vmcnt(14) lgkmcnt(6)
v_mfma_f32_32x32x16_bf16 v[32:47], v[24:27], v[196:199], v[32:47]
ds_read_b64_tr_b16 v[24:25], v5 offset:22528
ds_read_b64_tr_b16 v[26:27], v5 offset:23040
s_waitcnt lgkmcnt(6)
v_mfma_f32_32x32x16_bf16 v[48:63], v[28:31], v[196:199], v[48:63]
ds_read_b64_tr_b16 v[28:29], v5 offset:30720
ds_read_b64_tr_b16 v[30:31], v5 offset:31232
s_waitcnt vmcnt(13) lgkmcnt(6)
v_mfma_f32_32x32x16_bf16 v[32:47], v[16:19], v[200:203], v[32:47]
ds_read_b64_tr_b16 v[16:17], v7 offset:16384
ds_read_b64_tr_b16 v[18:19], v7 offset:16896
s_waitcnt lgkmcnt(6)
v_mfma_f32_32x32x16_bf16 v[48:63], v[20:23], v[200:203], v[48:63]
ds_read_b64_tr_b16 v[20:21], v7 offset:24576
ds_read_b64_tr_b16 v[22:23], v7 offset:25088
s_waitcnt vmcnt(12) lgkmcnt(6)
v_mfma_f32_32x32x16_bf16 v[32:47], v[24:27], v[204:207], v[32:47]
ds_read_b64_tr_b16 v[24:25], v7 offset:18432
ds_read_b64_tr_b16 v[26:27], v7 offset:18944
s_waitcnt lgkmcnt(6)
v_mfma_f32_32x32x16_bf16 v[48:63], v[28:31], v[204:207], v[48:63]
ds_read_b64_tr_b16 v[28:29], v7 offset:26624
ds_read_b64_tr_b16 v[30:31], v7 offset:27136
s_waitcnt lgkmcnt(6)
v_mfma_f32_32x32x16_bf16 v[64:79], v[16:19], v[192:195], v[64:79]
ds_read_b64_tr_b16 v[16:17], v7 offset:20480
ds_read_b64_tr_b16 v[18:19], v7 offset:20992
s_waitcnt lgkmcnt(6)
v_mfma_f32_32x32x16_bf16 v[80:95], v[20:23], v[192:195], v[80:95]
ds_read_b64_tr_b16 v[20:21], v7 offset:28672
ds_read_b64_tr_b16 v[22:23], v7 offset:29184
s_waitcnt lgkmcnt(6)
v_mfma_f32_32x32x16_bf16 v[64:79], v[24:27], v[196:199], v[64:79]
ds_read_b64_tr_b16 v[24:25], v7 offset:22528
ds_read_b64_tr_b16 v[26:27], v7 offset:23040
s_waitcnt lgkmcnt(6)
v_mfma_f32_32x32x16_bf16 v[80:95], v[28:31], v[196:199], v[80:95]
s_barrier
ds_read_b64_tr_b16 v[28:29], v7 offset:30720
ds_read_b64_tr_b16 v[30:31], v7 offset:31232
s_waitcnt lgkmcnt(6)
v_mfma_f32_32x32x16_bf16 v[64:79], v[16:19], v[200:203], v[64:79]
ds_read_b64_tr_b16 v[16:17], v5 offset:32768
ds_read_b64_tr_b16 v[18:19], v5 offset:33280
s_waitcnt lgkmcnt(6)
v_mfma_f32_32x32x16_bf16 v[80:95], v[20:23], v[200:203], v[80:95]
ds_read_b64_tr_b16 v[20:21], v5 offset:40960
ds_read_b64_tr_b16 v[22:23], v5 offset:41472
s_waitcnt lgkmcnt(6)
v_mfma_f32_32x32x16_bf16 v[64:79], v[24:27], v[204:207], v[64:79]
ds_read_b64_tr_b16 v[24:25], v5 offset:34816
ds_read_b64_tr_b16 v[26:27], v5 offset:35328
s_waitcnt lgkmcnt(6)
v_mfma_f32_32x32x16_bf16 v[80:95], v[28:31], v[204:207], v[80:95]
ds_read_b64_tr_b16 v[28:29], v5 offset:43008
ds_read_b64_tr_b16 v[30:31], v5 offset:43520
s_waitcnt vmcnt(11) lgkmcnt(6)
v_mfma_f32_32x32x16_bf16 v[32:47], v[16:19], v[208:211], v[32:47]
ds_read_b64_tr_b16 v[16:17], v5 offset:36864
ds_read_b64_tr_b16 v[18:19], v5 offset:37376
s_waitcnt lgkmcnt(6)
v_mfma_f32_32x32x16_bf16 v[48:63], v[20:23], v[208:211], v[48:63]
ds_read_b64_tr_b16 v[20:21], v5 offset:45056
ds_read_b64_tr_b16 v[22:23], v5 offset:45568
s_waitcnt vmcnt(10) lgkmcnt(6)
v_mfma_f32_32x32x16_bf16 v[32:47], v[24:27], v[212:215], v[32:47]
ds_read_b64_tr_b16 v[24:25], v5 offset:38912
ds_read_b64_tr_b16 v[26:27], v5 offset:39424
s_waitcnt lgkmcnt(6)
v_mfma_f32_32x32x16_bf16 v[48:63], v[28:31], v[212:215], v[48:63]
ds_read_b64_tr_b16 v[28:29], v5 offset:47104
ds_read_b64_tr_b16 v[30:31], v5 offset:47616
s_waitcnt vmcnt(9) lgkmcnt(6)
v_mfma_f32_32x32x16_bf16 v[32:47], v[16:19], v[216:219], v[32:47]
ds_read_b64_tr_b16 v[16:17], v5 offset:49152
ds_read_b64_tr_b16 v[18:19], v5 offset:49664
s_waitcnt lgkmcnt(6)
v_mfma_f32_32x32x16_bf16 v[48:63], v[20:23], v[216:219], v[48:63]
ds_read_b64_tr_b16 v[20:21], v5 offset:57344
ds_read_b64_tr_b16 v[22:23], v5 offset:57856
s_waitcnt vmcnt(8) lgkmcnt(6)
v_mfma_f32_32x32x16_bf16 v[32:47], v[24:27], v[220:223], v[32:47]
ds_read_b64_tr_b16 v[24:25], v5 offset:51200
ds_read_b64_tr_b16 v[26:27], v5 offset:51712
s_waitcnt lgkmcnt(6)
v_mfma_f32_32x32x16_bf16 v[48:63], v[28:31], v[220:223], v[48:63]
ds_read_b64_tr_b16 v[28:29], v5 offset:59392
ds_read_b64_tr_b16 v[30:31], v5 offset:59904
s_waitcnt vmcnt(7) lgkmcnt(6)
v_mfma_f32_32x32x16_bf16 v[32:47], v[16:19], v[224:227], v[32:47]
ds_read_b64_tr_b16 v[16:17], v5 offset:53248
ds_read_b64_tr_b16 v[18:19], v5 offset:53760
s_waitcnt lgkmcnt(6)
v_mfma_f32_32x32x16_bf16 v[48:63], v[20:23], v[224:227], v[48:63]
ds_read_b64_tr_b16 v[20:21], v5 offset:61440
ds_read_b64_tr_b16 v[22:23], v5 offset:61952
s_waitcnt vmcnt(6) lgkmcnt(6)
v_mfma_f32_32x32x16_bf16 v[32:47], v[24:27], v[228:231], v[32:47]
ds_read_b64_tr_b16 v[24:25], v5 offset:55296
ds_read_b64_tr_b16 v[26:27], v5 offset:55808
s_waitcnt lgkmcnt(6)
v_mfma_f32_32x32x16_bf16 v[48:63], v[28:31], v[228:231], v[48:63]
s_barrier
ds_read_b64_tr_b16 v[28:29], v5 offset:63488
ds_read_b64_tr_b16 v[30:31], v5 offset:64000
s_waitcnt vmcnt(5) lgkmcnt(6)
v_mfma_f32_32x32x16_bf16 v[32:47], v[16:19], v[232:235], v[32:47]
ds_read_b64_tr_b16 v[16:17], v4 offset:0
ds_read_b64_tr_b16 v[18:19], v4 offset:512
s_waitcnt lgkmcnt(6)
v_mfma_f32_32x32x16_bf16 v[48:63], v[20:23], v[232:235], v[48:63]
ds_read_b64_tr_b16 v[20:21], v4 offset:8192
ds_read_b64_tr_b16 v[22:23], v4 offset:8704
s_waitcnt vmcnt(4) lgkmcnt(6)
v_mfma_f32_32x32x16_bf16 v[32:47], v[24:27], v[236:239], v[32:47]
ds_read_b64_tr_b16 v[24:25], v4 offset:2048
ds_read_b64_tr_b16 v[26:27], v4 offset:2560
s_waitcnt lgkmcnt(6)
v_mfma_f32_32x32x16_bf16 v[48:63], v[28:31], v[236:239], v[48:63]
ds_read_b64_tr_b16 v[28:29], v4 offset:10240
ds_read_b64_tr_b16 v[30:31], v4 offset:10752
s_waitcnt vmcnt(3) lgkmcnt(6)
v_mfma_f32_32x32x16_bf16 v[32:47], v[16:19], v[240:243], v[32:47]
ds_read_b64_tr_b16 v[16:17], v4 offset:4096
ds_read_b64_tr_b16 v[18:19], v4 offset:4608
s_waitcnt lgkmcnt(6)
v_mfma_f32_32x32x16_bf16 v[48:63], v[20:23], v[240:243], v[48:63]
ds_read_b64_tr_b16 v[20:21], v4 offset:12288
ds_read_b64_tr_b16 v[22:23], v4 offset:12800
s_waitcnt vmcnt(2) lgkmcnt(6)
v_mfma_f32_32x32x16_bf16 v[32:47], v[24:27], v[244:247], v[32:47]
ds_read_b64_tr_b16 v[24:25], v4 offset:6144
ds_read_b64_tr_b16 v[26:27], v4 offset:6656
s_waitcnt lgkmcnt(6)
v_mfma_f32_32x32x16_bf16 v[48:63], v[28:31], v[244:247], v[48:63]
ds_read_b64_tr_b16 v[28:29], v4 offset:14336
ds_read_b64_tr_b16 v[30:31], v4 offset:14848
s_waitcnt vmcnt(1) lgkmcnt(6)
v_mfma_f32_32x32x16_bf16 v[32:47], v[16:19], v[248:251], v[32:47]
ds_read_b64_tr_b16 v[16:17], v7 offset:32768
ds_read_b64_tr_b16 v[18:19], v7 offset:33280
s_waitcnt lgkmcnt(6)
v_mfma_f32_32x32x16_bf16 v[48:63], v[20:23], v[248:251], v[48:63]
ds_read_b64_tr_b16 v[20:21], v7 offset:40960
ds_read_b64_tr_b16 v[22:23], v7 offset:41472
s_waitcnt vmcnt(0) lgkmcnt(6)
v_mfma_f32_32x32x16_bf16 v[32:47], v[24:27], v[252:255], v[32:47]
ds_read_b64_tr_b16 v[24:25], v7 offset:34816
ds_read_b64_tr_b16 v[26:27], v7 offset:35328
s_waitcnt lgkmcnt(6)
v_mfma_f32_32x32x16_bf16 v[48:63], v[28:31], v[252:255], v[48:63]
ds_read_b64_tr_b16 v[28:29], v7 offset:43008
ds_read_b64_tr_b16 v[30:31], v7 offset:43520
s_waitcnt lgkmcnt(6)
v_mfma_f32_32x32x16_bf16 v[64:79], v[16:19], v[208:211], v[64:79]
ds_read_b64_tr_b16 v[16:17], v7 offset:36864
ds_read_b64_tr_b16 v[18:19], v7 offset:37376
s_waitcnt lgkmcnt(6)
v_mfma_f32_32x32x16_bf16 v[80:95], v[20:23], v[208:211], v[80:95]
ds_read_b64_tr_b16 v[20:21], v7 offset:45056
ds_read_b64_tr_b16 v[22:23], v7 offset:45568
s_waitcnt lgkmcnt(6)
v_mfma_f32_32x32x16_bf16 v[64:79], v[24:27], v[212:215], v[64:79]
ds_read_b64_tr_b16 v[24:25], v7 offset:38912
ds_read_b64_tr_b16 v[26:27], v7 offset:39424
s_waitcnt lgkmcnt(6)
v_mfma_f32_32x32x16_bf16 v[80:95], v[28:31], v[212:215], v[80:95]
s_barrier
ds_read_b64_tr_b16 v[28:29], v7 offset:47104
ds_read_b64_tr_b16 v[30:31], v7 offset:47616
v_max_f32 v32, 0, v32
v_mul_f32 v32, v32, v48
v_max_f32 v33, 0, v33
s_waitcnt lgkmcnt(6)
v_mfma_f32_32x32x16_bf16 v[64:79], v[16:19], v[216:219], v[64:79]
ds_read_b64_tr_b16 v[16:17], v7 offset:49152
ds_read_b64_tr_b16 v[18:19], v7 offset:49664
v_mul_f32 v33, v33, v49
v_max_f32 v34, 0, v34
v_mul_f32 v34, v34, v50
s_waitcnt lgkmcnt(6)
v_mfma_f32_32x32x16_bf16 v[80:95], v[20:23], v[216:219], v[80:95]
ds_read_b64_tr_b16 v[20:21], v7 offset:57344
ds_read_b64_tr_b16 v[22:23], v7 offset:57856
v_max_f32 v35, 0, v35
v_mul_f32 v35, v35, v51
v_max_f32 v36, 0, v36
s_waitcnt lgkmcnt(6)
v_mfma_f32_32x32x16_bf16 v[64:79], v[24:27], v[220:223], v[64:79]
ds_read_b64_tr_b16 v[24:25], v7 offset:51200
ds_read_b64_tr_b16 v[26:27], v7 offset:51712
v_mul_f32 v36, v36, v52
v_max_f32 v37, 0, v37
v_mul_f32 v37, v37, v53
s_waitcnt lgkmcnt(6)
v_mfma_f32_32x32x16_bf16 v[80:95], v[28:31], v[220:223], v[80:95]
ds_read_b64_tr_b16 v[28:29], v7 offset:59392
ds_read_b64_tr_b16 v[30:31], v7 offset:59904
v_max_f32 v38, 0, v38
v_mul_f32 v38, v38, v54
v_max_f32 v39, 0, v39
s_waitcnt lgkmcnt(6)
v_mfma_f32_32x32x16_bf16 v[64:79], v[16:19], v[224:227], v[64:79]
ds_read_b64_tr_b16 v[16:17], v7 offset:53248
ds_read_b64_tr_b16 v[18:19], v7 offset:53760
v_mul_f32 v39, v39, v55
v_cvt_pk_bf16_f32 v32, v32, v33
v_cvt_pk_bf16_f32 v33, v34, v35
s_waitcnt lgkmcnt(6)
v_mfma_f32_32x32x16_bf16 v[80:95], v[20:23], v[224:227], v[80:95]
ds_read_b64_tr_b16 v[20:21], v7 offset:61440
ds_read_b64_tr_b16 v[22:23], v7 offset:61952
v_cvt_pk_bf16_f32 v34, v36, v37
v_cvt_pk_bf16_f32 v35, v38, v39
buffer_store_dwordx4 v[32:35], v12, s[24:27], s70 offen offset:0 sc1
s_waitcnt lgkmcnt(6)
v_mfma_f32_32x32x16_bf16 v[64:79], v[24:27], v[228:231], v[64:79]
ds_read_b64_tr_b16 v[24:25], v7 offset:55296
ds_read_b64_tr_b16 v[26:27], v7 offset:55808
v_max_f32 v40, 0, v40
v_mul_f32 v40, v40, v56
v_max_f32 v41, 0, v41
s_waitcnt lgkmcnt(6)
v_mfma_f32_32x32x16_bf16 v[80:95], v[28:31], v[228:231], v[80:95]
ds_read_b64_tr_b16 v[28:29], v7 offset:63488
ds_read_b64_tr_b16 v[30:31], v7 offset:64000
v_mul_f32 v41, v41, v57
v_max_f32 v42, 0, v42
v_mul_f32 v42, v42, v58
s_waitcnt lgkmcnt(6)
v_mfma_f32_32x32x16_bf16 v[64:79], v[16:19], v[232:235], v[64:79]
ds_read_b64_tr_b16 v[16:17], v6 offset:0
ds_read_b64_tr_b16 v[18:19], v6 offset:512
v_max_f32 v43, 0, v43
v_mul_f32 v43, v43, v59
v_max_f32 v44, 0, v44
s_waitcnt lgkmcnt(6)
v_mfma_f32_32x32x16_bf16 v[80:95], v[20:23], v[232:235], v[80:95]
ds_read_b64_tr_b16 v[20:21], v6 offset:8192
ds_read_b64_tr_b16 v[22:23], v6 offset:8704
v_mul_f32 v44, v44, v60
v_max_f32 v45, 0, v45
v_mul_f32 v45, v45, v61
s_waitcnt lgkmcnt(6)
v_mfma_f32_32x32x16_bf16 v[64:79], v[24:27], v[236:239], v[64:79]
ds_read_b64_tr_b16 v[24:25], v6 offset:2048
ds_read_b64_tr_b16 v[26:27], v6 offset:2560
v_max_f32 v46, 0, v46
v_mul_f32 v46, v46, v62
v_max_f32 v47, 0, v47
s_waitcnt lgkmcnt(6)
v_mfma_f32_32x32x16_bf16 v[80:95], v[28:31], v[236:239], v[80:95]
ds_read_b64_tr_b16 v[28:29], v6 offset:10240
ds_read_b64_tr_b16 v[30:31], v6 offset:10752
v_mul_f32 v47, v47, v63
v_cvt_pk_bf16_f32 v40, v40, v41
v_cvt_pk_bf16_f32 v41, v42, v43
s_waitcnt lgkmcnt(6)
v_mfma_f32_32x32x16_bf16 v[64:79], v[16:19], v[240:243], v[64:79]
ds_read_b64_tr_b16 v[16:17], v6 offset:4096
ds_read_b64_tr_b16 v[18:19], v6 offset:4608
v_cvt_pk_bf16_f32 v42, v44, v45
v_cvt_pk_bf16_f32 v43, v46, v47
buffer_store_dwordx4 v[40:43], v12, s[24:27], s70 offen offset:1024 sc1
s_waitcnt lgkmcnt(6)
v_mfma_f32_32x32x16_bf16 v[80:95], v[20:23], v[240:243], v[80:95]
ds_read_b64_tr_b16 v[20:21], v6 offset:12288
ds_read_b64_tr_b16 v[22:23], v6 offset:12800
s_waitcnt lgkmcnt(6)
v_mfma_f32_32x32x16_bf16 v[64:79], v[24:27], v[244:247], v[64:79]
ds_read_b64_tr_b16 v[24:25], v6 offset:6144
ds_read_b64_tr_b16 v[26:27], v6 offset:6656
s_waitcnt lgkmcnt(6)
v_mfma_f32_32x32x16_bf16 v[80:95], v[28:31], v[244:247], v[80:95]
s_barrier
ds_read_b64_tr_b16 v[28:29], v6 offset:14336
ds_read_b64_tr_b16 v[30:31], v6 offset:14848
s_waitcnt lgkmcnt(6)
v_mfma_f32_32x32x16_bf16 v[64:79], v[16:19], v[248:251], v[64:79]
ds_read_b64_tr_b16 v[16:17], v4 offset:16384
ds_read_b64_tr_b16 v[18:19], v4 offset:16896
s_waitcnt lgkmcnt(6)
v_mfma_f32_32x32x16_bf16 v[80:95], v[20:23], v[248:251], v[80:95]
ds_read_b64_tr_b16 v[20:21], v6 offset:16384
ds_read_b64_tr_b16 v[22:23], v6 offset:16896
s_waitcnt lgkmcnt(6)
v_mfma_f32_32x32x16_bf16 v[64:79], v[24:27], v[252:255], v[64:79]
ds_read_b64_tr_b16 v[24:25], v4 offset:18432
ds_read_b64_tr_b16 v[26:27], v4 offset:18944
s_waitcnt lgkmcnt(6)
v_mfma_f32_32x32x16_bf16 v[80:95], v[28:31], v[252:255], v[80:95]
ds_read_b64_tr_b16 v[28:29], v6 offset:18432
ds_read_b64_tr_b16 v[30:31], v6 offset:18944
s_waitcnt lgkmcnt(6)
v_mfma_f32_32x32x16_bf16 v[32:47], v[16:19], v[96:99], 0
ds_read_b64_tr_b16 v[16:17], v4 offset:20480
ds_read_b64_tr_b16 v[18:19], v4 offset:20992
s_waitcnt lgkmcnt(6)
v_mfma_f32_32x32x16_bf16 v[48:63], v[20:23], v[96:99], 0
ds_read_b64_tr_b16 v[20:21], v6 offset:20480
ds_read_b64_tr_b16 v[22:23], v6 offset:20992
s_waitcnt lgkmcnt(6)
v_mfma_f32_32x32x16_bf16 v[32:47], v[24:27], v[100:103], v[32:47]
ds_read_b64_tr_b16 v[24:25], v4 offset:22528
ds_read_b64_tr_b16 v[26:27], v4 offset:23040
s_waitcnt lgkmcnt(6)
v_mfma_f32_32x32x16_bf16 v[48:63], v[28:31], v[100:103], v[48:63]
ds_read_b64_tr_b16 v[28:29], v6 offset:22528
ds_read_b64_tr_b16 v[30:31], v6 offset:23040
v_max_f32 v64, 0, v64
v_mul_f32 v64, v64, v80
v_max_f32 v65, 0, v65
s_waitcnt lgkmcnt(6)
v_mfma_f32_32x32x16_bf16 v[32:47], v[16:19], v[104:107], v[32:47]
ds_read_b64_tr_b16 v[16:17], v4 offset:24576
ds_read_b64_tr_b16 v[18:19], v4 offset:25088
v_mul_f32 v65, v65, v81
v_max_f32 v66, 0, v66
v_mul_f32 v66, v66, v82
s_waitcnt lgkmcnt(6)
v_mfma_f32_32x32x16_bf16 v[48:63], v[20:23], v[104:107], v[48:63]
ds_read_b64_tr_b16 v[20:21], v6 offset:24576
ds_read_b64_tr_b16 v[22:23], v6 offset:25088
v_max_f32 v67, 0, v67
v_mul_f32 v67, v67, v83
v_max_f32 v68, 0, v68
s_waitcnt lgkmcnt(6)
v_mfma_f32_32x32x16_bf16 v[32:47], v[24:27], v[108:111], v[32:47]
ds_read_b64_tr_b16 v[24:25], v4 offset:26624
ds_read_b64_tr_b16 v[26:27], v4 offset:27136
v_mul_f32 v68, v68, v84
v_max_f32 v69, 0, v69
v_mul_f32 v69, v69, v85
s_waitcnt lgkmcnt(6)
v_mfma_f32_32x32x16_bf16 v[48:63], v[28:31], v[108:111], v[48:63]
ds_read_b64_tr_b16 v[28:29], v6 offset:26624
ds_read_b64_tr_b16 v[30:31], v6 offset:27136
v_max_f32 v70, 0, v70
v_mul_f32 v70, v70, v86
v_max_f32 v71, 0, v71
s_waitcnt lgkmcnt(6)
v_mfma_f32_32x32x16_bf16 v[32:47], v[16:19], v[112:115], v[32:47]
ds_read_b64_tr_b16 v[16:17], v4 offset:28672
ds_read_b64_tr_b16 v[18:19], v4 offset:29184
v_mul_f32 v71, v71, v87
v_cvt_pk_bf16_f32 v64, v64, v65
v_cvt_pk_bf16_f32 v65, v66, v67
s_waitcnt lgkmcnt(6)
v_mfma_f32_32x32x16_bf16 v[48:63], v[20:23], v[112:115], v[48:63]
ds_read_b64_tr_b16 v[20:21], v6 offset:28672
ds_read_b64_tr_b16 v[22:23], v6 offset:29184
v_cvt_pk_bf16_f32 v66, v68, v69
v_cvt_pk_bf16_f32 v67, v70, v71
buffer_store_dwordx4 v[64:67], v12, s[24:27], s70 offen offset:2048 sc1
s_waitcnt lgkmcnt(6)
v_mfma_f32_32x32x16_bf16 v[32:47], v[24:27], v[116:119], v[32:47]
ds_read_b64_tr_b16 v[24:25], v4 offset:30720
ds_read_b64_tr_b16 v[26:27], v4 offset:31232
v_max_f32 v72, 0, v72
v_mul_f32 v72, v72, v88
v_max_f32 v73, 0, v73
s_waitcnt lgkmcnt(6)
v_mfma_f32_32x32x16_bf16 v[48:63], v[28:31], v[116:119], v[48:63]
s_barrier
ds_read_b64_tr_b16 v[28:29], v6 offset:30720
ds_read_b64_tr_b16 v[30:31], v6 offset:31232
v_mul_f32 v73, v73, v89
v_max_f32 v74, 0, v74
v_mul_f32 v74, v74, v90
s_waitcnt lgkmcnt(6)
v_mfma_f32_32x32x16_bf16 v[32:47], v[16:19], v[120:123], v[32:47]
ds_read_b64_tr_b16 v[16:17], v4 offset:32768
ds_read_b64_tr_b16 v[18:19], v4 offset:33280
v_max_f32 v75, 0, v75
v_mul_f32 v75, v75, v91
v_max_f32 v76, 0, v76
s_waitcnt lgkmcnt(6)
v_mfma_f32_32x32x16_bf16 v[48:63], v[20:23], v[120:123], v[48:63]
ds_read_b64_tr_b16 v[20:21], v6 offset:32768
ds_read_b64_tr_b16 v[22:23], v6 offset:33280
v_mul_f32 v76, v76, v92
v_max_f32 v77, 0, v77
v_mul_f32 v77, v77, v93
s_waitcnt lgkmcnt(6)
v_mfma_f32_32x32x16_bf16 v[32:47], v[24:27], v[124:127], v[32:47]
ds_read_b64_tr_b16 v[24:25], v4 offset:34816
ds_read_b64_tr_b16 v[26:27], v4 offset:35328
v_max_f32 v78, 0, v78
v_mul_f32 v78, v78, v94
v_max_f32 v79, 0, v79
s_waitcnt lgkmcnt(6)
v_mfma_f32_32x32x16_bf16 v[48:63], v[28:31], v[124:127], v[48:63]
ds_read_b64_tr_b16 v[28:29], v6 offset:34816
ds_read_b64_tr_b16 v[30:31], v6 offset:35328
v_mul_f32 v79, v79, v95
v_cvt_pk_bf16_f32 v72, v72, v73
v_cvt_pk_bf16_f32 v73, v74, v75
s_waitcnt lgkmcnt(6)
v_mfma_f32_32x32x16_bf16 v[32:47], v[16:19], v[128:131], v[32:47]
ds_read_b64_tr_b16 v[16:17], v4 offset:36864
ds_read_b64_tr_b16 v[18:19], v4 offset:37376
v_cvt_pk_bf16_f32 v74, v76, v77
v_cvt_pk_bf16_f32 v75, v78, v79
buffer_store_dwordx4 v[72:75], v12, s[24:27], s70 offen offset:3072 sc1
s_waitcnt lgkmcnt(6)
v_mfma_f32_32x32x16_bf16 v[48:63], v[20:23], v[128:131], v[48:63]
ds_read_b64_tr_b16 v[20:21], v6 offset:36864
ds_read_b64_tr_b16 v[22:23], v6 offset:37376
s_waitcnt lgkmcnt(6)
v_mfma_f32_32x32x16_bf16 v[32:47], v[24:27], v[132:135], v[32:47]
ds_read_b64_tr_b16 v[24:25], v4 offset:38912
ds_read_b64_tr_b16 v[26:27], v4 offset:39424
s_waitcnt lgkmcnt(6)
v_mfma_f32_32x32x16_bf16 v[48:63], v[28:31], v[132:135], v[48:63]
ds_read_b64_tr_b16 v[28:29], v6 offset:38912
ds_read_b64_tr_b16 v[30:31], v6 offset:39424
s_waitcnt lgkmcnt(6)
v_mfma_f32_32x32x16_bf16 v[32:47], v[16:19], v[136:139], v[32:47]
ds_read_b64_tr_b16 v[16:17], v4 offset:40960
ds_read_b64_tr_b16 v[18:19], v4 offset:41472
s_waitcnt lgkmcnt(6)
v_mfma_f32_32x32x16_bf16 v[48:63], v[20:23], v[136:139], v[48:63]
ds_read_b64_tr_b16 v[20:21], v6 offset:40960
ds_read_b64_tr_b16 v[22:23], v6 offset:41472
s_waitcnt lgkmcnt(6)
v_mfma_f32_32x32x16_bf16 v[32:47], v[24:27], v[140:143], v[32:47]
ds_read_b64_tr_b16 v[24:25], v4 offset:43008
ds_read_b64_tr_b16 v[26:27], v4 offset:43520
s_waitcnt lgkmcnt(6)
v_mfma_f32_32x32x16_bf16 v[48:63], v[28:31], v[140:143], v[48:63]
ds_read_b64_tr_b16 v[28:29], v6 offset:43008
ds_read_b64_tr_b16 v[30:31], v6 offset:43520
s_waitcnt lgkmcnt(6)
v_mfma_f32_32x32x16_bf16 v[32:47], v[16:19], v[144:147], v[32:47]
ds_read_b64_tr_b16 v[16:17], v4 offset:45056
ds_read_b64_tr_b16 v[18:19], v4 offset:45568
s_waitcnt lgkmcnt(6)
v_mfma_f32_32x32x16_bf16 v[48:63], v[20:23], v[144:147], v[48:63]
ds_read_b64_tr_b16 v[20:21], v6 offset:45056
ds_read_b64_tr_b16 v[22:23], v6 offset:45568
s_waitcnt lgkmcnt(6)
v_mfma_f32_32x32x16_bf16 v[32:47], v[24:27], v[148:151], v[32:47]
ds_read_b64_tr_b16 v[24:25], v4 offset:47104
ds_read_b64_tr_b16 v[26:27], v4 offset:47616
s_waitcnt lgkmcnt(6)
v_mfma_f32_32x32x16_bf16 v[48:63], v[28:31], v[148:151], v[48:63]
s_barrier
ds_read_b64_tr_b16 v[28:29], v6 offset:47104
ds_read_b64_tr_b16 v[30:31], v6 offset:47616
s_waitcnt lgkmcnt(6)
v_mfma_f32_32x32x16_bf16 v[32:47], v[16:19], v[152:155], v[32:47]
ds_read_b64_tr_b16 v[16:17], v4 offset:49152
ds_read_b64_tr_b16 v[18:19], v4 offset:49664
s_waitcnt lgkmcnt(6)
v_mfma_f32_32x32x16_bf16 v[48:63], v[20:23], v[152:155], v[48:63]
ds_read_b64_tr_b16 v[20:21], v6 offset:49152
ds_read_b64_tr_b16 v[22:23], v6 offset:49664
s_waitcnt lgkmcnt(6)
v_mfma_f32_32x32x16_bf16 v[32:47], v[24:27], v[156:159], v[32:47]
ds_read_b64_tr_b16 v[24:25], v4 offset:51200
ds_read_b64_tr_b16 v[26:27], v4 offset:51712
s_waitcnt lgkmcnt(6)
v_mfma_f32_32x32x16_bf16 v[48:63], v[28:31], v[156:159], v[48:63]
ds_read_b64_tr_b16 v[28:29], v6 offset:51200
ds_read_b64_tr_b16 v[30:31], v6 offset:51712
s_waitcnt lgkmcnt(6)
v_mfma_f32_32x32x16_bf16 v[32:47], v[16:19], v[160:163], v[32:47]
ds_read_b64_tr_b16 v[16:17], v4 offset:53248
ds_read_b64_tr_b16 v[18:19], v4 offset:53760
s_waitcnt lgkmcnt(6)
v_mfma_f32_32x32x16_bf16 v[48:63], v[20:23], v[160:163], v[48:63]
ds_read_b64_tr_b16 v[20:21], v6 offset:53248
ds_read_b64_tr_b16 v[22:23], v6 offset:53760
s_waitcnt lgkmcnt(6)
v_mfma_f32_32x32x16_bf16 v[32:47], v[24:27], v[164:167], v[32:47]
ds_read_b64_tr_b16 v[24:25], v4 offset:55296
ds_read_b64_tr_b16 v[26:27], v4 offset:55808
s_waitcnt lgkmcnt(6)
v_mfma_f32_32x32x16_bf16 v[48:63], v[28:31], v[164:167], v[48:63]
ds_read_b64_tr_b16 v[28:29], v6 offset:55296
ds_read_b64_tr_b16 v[30:31], v6 offset:55808
s_waitcnt lgkmcnt(6)
v_mfma_f32_32x32x16_bf16 v[32:47], v[16:19], v[168:171], v[32:47]
ds_read_b64_tr_b16 v[16:17], v4 offset:57344
ds_read_b64_tr_b16 v[18:19], v4 offset:57856
s_waitcnt lgkmcnt(6)
v_mfma_f32_32x32x16_bf16 v[48:63], v[20:23], v[168:171], v[48:63]
ds_read_b64_tr_b16 v[20:21], v6 offset:57344
ds_read_b64_tr_b16 v[22:23], v6 offset:57856
s_waitcnt lgkmcnt(6)
v_mfma_f32_32x32x16_bf16 v[32:47], v[24:27], v[172:175], v[32:47]
ds_read_b64_tr_b16 v[24:25], v4 offset:59392
ds_read_b64_tr_b16 v[26:27], v4 offset:59904
s_waitcnt lgkmcnt(6)
v_mfma_f32_32x32x16_bf16 v[48:63], v[28:31], v[172:175], v[48:63]
ds_read_b64_tr_b16 v[28:29], v6 offset:59392
ds_read_b64_tr_b16 v[30:31], v6 offset:59904
s_waitcnt lgkmcnt(6)
v_mfma_f32_32x32x16_bf16 v[32:47], v[16:19], v[176:179], v[32:47]
ds_read_b64_tr_b16 v[16:17], v4 offset:61440
ds_read_b64_tr_b16 v[18:19], v4 offset:61952
s_waitcnt lgkmcnt(6)
v_mfma_f32_32x32x16_bf16 v[48:63], v[20:23], v[176:179], v[48:63]
ds_read_b64_tr_b16 v[20:21], v6 offset:61440
ds_read_b64_tr_b16 v[22:23], v6 offset:61952
s_waitcnt lgkmcnt(6)
v_mfma_f32_32x32x16_bf16 v[32:47], v[24:27], v[180:183], v[32:47]
ds_read_b64_tr_b16 v[24:25], v4 offset:63488
ds_read_b64_tr_b16 v[26:27], v4 offset:64000
s_waitcnt lgkmcnt(6)
v_mfma_f32_32x32x16_bf16 v[48:63], v[28:31], v[180:183], v[48:63]
s_barrier
ds_read_b64_tr_b16 v[28:29], v6 offset:63488
ds_read_b64_tr_b16 v[30:31], v6 offset:64000
s_waitcnt lgkmcnt(6)
v_mfma_f32_32x32x16_bf16 v[32:47], v[16:19], v[184:187], v[32:47]
ds_read_b64_tr_b16 v[16:17], v5 offset:0
ds_read_b64_tr_b16 v[18:19], v5 offset:512
s_waitcnt lgkmcnt(6)
v_mfma_f32_32x32x16_bf16 v[48:63], v[20:23], v[184:187], v[48:63]
ds_read_b64_tr_b16 v[20:21], v7 offset:0
ds_read_b64_tr_b16 v[22:23], v7 offset:512
s_waitcnt lgkmcnt(6)
v_mfma_f32_32x32x16_bf16 v[32:47], v[24:27], v[188:191], v[32:47]
ds_read_b64_tr_b16 v[24:25], v5 offset:2048
ds_read_b64_tr_b16 v[26:27], v5 offset:2560
s_waitcnt lgkmcnt(6)
v_mfma_f32_32x32x16_bf16 v[48:63], v[28:31], v[188:191], v[48:63]
ds_read_b64_tr_b16 v[28:29], v7 offset:2048
ds_read_b64_tr_b16 v[30:31], v7 offset:2560
s_waitcnt lgkmcnt(6)
v_mfma_f32_32x32x16_bf16 v[32:47], v[16:19], v[192:195], v[32:47]
ds_read_b64_tr_b16 v[16:17], v5 offset:4096
ds_read_b64_tr_b16 v[18:19], v5 offset:4608
s_waitcnt lgkmcnt(6)
v_mfma_f32_32x32x16_bf16 v[48:63], v[20:23], v[192:195], v[48:63]
ds_read_b64_tr_b16 v[20:21], v7 offset:4096
ds_read_b64_tr_b16 v[22:23], v7 offset:4608
s_waitcnt lgkmcnt(6)
v_mfma_f32_32x32x16_bf16 v[32:47], v[24:27], v[196:199], v[32:47]
ds_read_b64_tr_b16 v[24:25], v5 offset:6144
ds_read_b64_tr_b16 v[26:27], v5 offset:6656
s_waitcnt lgkmcnt(6)
v_mfma_f32_32x32x16_bf16 v[48:63], v[28:31], v[196:199], v[48:63]
ds_read_b64_tr_b16 v[28:29], v7 offset:6144
ds_read_b64_tr_b16 v[30:31], v7 offset:6656
s_waitcnt lgkmcnt(6)
v_mfma_f32_32x32x16_bf16 v[32:47], v[16:19], v[200:203], v[32:47]
ds_read_b64_tr_b16 v[16:17], v5 offset:8192
ds_read_b64_tr_b16 v[18:19], v5 offset:8704
s_waitcnt lgkmcnt(6)
v_mfma_f32_32x32x16_bf16 v[48:63], v[20:23], v[200:203], v[48:63]
ds_read_b64_tr_b16 v[20:21], v7 offset:8192
ds_read_b64_tr_b16 v[22:23], v7 offset:8704
s_waitcnt lgkmcnt(6)
v_mfma_f32_32x32x16_bf16 v[32:47], v[24:27], v[204:207], v[32:47]
ds_read_b64_tr_b16 v[24:25], v5 offset:10240
ds_read_b64_tr_b16 v[26:27], v5 offset:10752
s_waitcnt lgkmcnt(6)
v_mfma_f32_32x32x16_bf16 v[48:63], v[28:31], v[204:207], v[48:63]
ds_read_b64_tr_b16 v[28:29], v7 offset:10240
ds_read_b64_tr_b16 v[30:31], v7 offset:10752
s_waitcnt lgkmcnt(6)
v_mfma_f32_32x32x16_bf16 v[32:47], v[16:19], v[208:211], v[32:47]
ds_read_b64_tr_b16 v[16:17], v5 offset:12288
ds_read_b64_tr_b16 v[18:19], v5 offset:12800
s_waitcnt lgkmcnt(6)
v_mfma_f32_32x32x16_bf16 v[48:63], v[20:23], v[208:211], v[48:63]
ds_read_b64_tr_b16 v[20:21], v7 offset:12288
ds_read_b64_tr_b16 v[22:23], v7 offset:12800
s_waitcnt lgkmcnt(6)
v_mfma_f32_32x32x16_bf16 v[32:47], v[24:27], v[212:215], v[32:47]
ds_read_b64_tr_b16 v[24:25], v5 offset:14336
ds_read_b64_tr_b16 v[26:27], v5 offset:14848
s_waitcnt lgkmcnt(6)
v_mfma_f32_32x32x16_bf16 v[48:63], v[28:31], v[212:215], v[48:63]
s_barrier
ds_read_b64_tr_b16 v[28:29], v7 offset:14336
ds_read_b64_tr_b16 v[30:31], v7 offset:14848
s_waitcnt lgkmcnt(6)
v_mfma_f32_32x32x16_bf16 v[32:47], v[16:19], v[216:219], v[32:47]
ds_read_b64_tr_b16 v[16:17], v5 offset:16384
ds_read_b64_tr_b16 v[18:19], v5 offset:16896
s_waitcnt lgkmcnt(6)
v_mfma_f32_32x32x16_bf16 v[48:63], v[20:23], v[216:219], v[48:63]
ds_read_b64_tr_b16 v[20:21], v7 offset:16384
ds_read_b64_tr_b16 v[22:23], v7 offset:16896
s_waitcnt lgkmcnt(6)
v_mfma_f32_32x32x16_bf16 v[32:47], v[24:27], v[220:223], v[32:47]
ds_read_b64_tr_b16 v[24:25], v5 offset:18432
ds_read_b64_tr_b16 v[26:27], v5 offset:18944
s_waitcnt lgkmcnt(6)
v_mfma_f32_32x32x16_bf16 v[48:63], v[28:31], v[220:223], v[48:63]
ds_read_b64_tr_b16 v[28:29], v7 offset:18432
ds_read_b64_tr_b16 v[30:31], v7 offset:18944
s_waitcnt lgkmcnt(6)
v_mfma_f32_32x32x16_bf16 v[32:47], v[16:19], v[224:227], v[32:47]
ds_read_b64_tr_b16 v[16:17], v5 offset:20480
ds_read_b64_tr_b16 v[18:19], v5 offset:20992
s_waitcnt vmcnt(0)
buffer_store_dword v0, v3, s[24:27], s58 offen offset:256 sc1
s_waitcnt lgkmcnt(6)
v_mfma_f32_32x32x16_bf16 v[48:63], v[20:23], v[224:227], v[48:63]
ds_read_b64_tr_b16 v[20:21], v7 offset:20480
ds_read_b64_tr_b16 v[22:23], v7 offset:20992
s_waitcnt lgkmcnt(6)
v_mfma_f32_32x32x16_bf16 v[32:47], v[24:27], v[228:231], v[32:47]
ds_read_b64_tr_b16 v[24:25], v5 offset:22528
ds_read_b64_tr_b16 v[26:27], v5 offset:23040
s_waitcnt lgkmcnt(6)
v_mfma_f32_32x32x16_bf16 v[48:63], v[28:31], v[228:231], v[48:63]
ds_read_b64_tr_b16 v[28:29], v7 offset:22528
ds_read_b64_tr_b16 v[30:31], v7 offset:23040
s_waitcnt lgkmcnt(6)
v_mfma_f32_32x32x16_bf16 v[32:47], v[16:19], v[232:235], v[32:47]
ds_read_b64_tr_b16 v[16:17], v5 offset:24576
ds_read_b64_tr_b16 v[18:19], v5 offset:25088
s_waitcnt lgkmcnt(6)
v_mfma_f32_32x32x16_bf16 v[48:63], v[20:23], v[232:235], v[48:63]
ds_read_b64_tr_b16 v[20:21], v7 offset:24576
ds_read_b64_tr_b16 v[22:23], v7 offset:25088
s_waitcnt lgkmcnt(6)
v_mfma_f32_32x32x16_bf16 v[32:47], v[24:27], v[236:239], v[32:47]
ds_read_b64_tr_b16 v[24:25], v5 offset:26624
ds_read_b64_tr_b16 v[26:27], v5 offset:27136
s_waitcnt lgkmcnt(6)
v_mfma_f32_32x32x16_bf16 v[48:63], v[28:31], v[236:239], v[48:63]
ds_read_b64_tr_b16 v[28:29], v7 offset:26624
ds_read_b64_tr_b16 v[30:31], v7 offset:27136
s_waitcnt lgkmcnt(6)
v_mfma_f32_32x32x16_bf16 v[32:47], v[16:19], v[240:243], v[32:47]
ds_read_b64_tr_b16 v[16:17], v5 offset:28672
ds_read_b64_tr_b16 v[18:19], v5 offset:29184
s_waitcnt lgkmcnt(6)
v_mfma_f32_32x32x16_bf16 v[48:63], v[20:23], v[240:243], v[48:63]
ds_read_b64_tr_b16 v[20:21], v7 offset:28672
ds_read_b64_tr_b16 v[22:23], v7 offset:29184
s_waitcnt lgkmcnt(6)
v_mfma_f32_32x32x16_bf16 v[32:47], v[24:27], v[244:247], v[32:47]
ds_read_b64_tr_b16 v[24:25], v5 offset:30720
ds_read_b64_tr_b16 v[26:27], v5 offset:31232
s_waitcnt lgkmcnt(6)
v_mfma_f32_32x32x16_bf16 v[48:63], v[28:31], v[244:247], v[48:63]
s_barrier
ds_read_b64_tr_b16 v[28:29], v7 offset:30720
ds_read_b64_tr_b16 v[30:31], v7 offset:31232
s_waitcnt lgkmcnt(6)
v_mfma_f32_32x32x16_bf16 v[32:47], v[16:19], v[248:251], v[32:47]
ds_read_b64_tr_b16 v[16:17], v5 offset:32768
ds_read_b64_tr_b16 v[18:19], v5 offset:33280
s_waitcnt lgkmcnt(6)
v_mfma_f32_32x32x16_bf16 v[48:63], v[20:23], v[248:251], v[48:63]
ds_read_b64_tr_b16 v[20:21], v5 offset:40960
ds_read_b64_tr_b16 v[22:23], v5 offset:41472
s_waitcnt lgkmcnt(6)
v_mfma_f32_32x32x16_bf16 v[32:47], v[24:27], v[252:255], v[32:47]
ds_read_b64_tr_b16 v[24:25], v5 offset:34816
ds_read_b64_tr_b16 v[26:27], v5 offset:35328
s_waitcnt lgkmcnt(6)
v_mfma_f32_32x32x16_bf16 v[48:63], v[28:31], v[252:255], v[48:63]
ds_read_b64_tr_b16 v[28:29], v5 offset:43008
ds_read_b64_tr_b16 v[30:31], v5 offset:43520
s_waitcnt lgkmcnt(6)
v_mfma_f32_32x32x16_bf16 v[64:79], v[16:19], v[96:99], 0
ds_read_b64_tr_b16 v[16:17], v5 offset:36864
ds_read_b64_tr_b16 v[18:19], v5 offset:37376
s_waitcnt lgkmcnt(6)
v_mfma_f32_32x32x16_bf16 v[80:95], v[20:23], v[96:99], 0
ds_read_b64_tr_b16 v[20:21], v5 offset:45056
ds_read_b64_tr_b16 v[22:23], v5 offset:45568
s_waitcnt lgkmcnt(6)
v_mfma_f32_32x32x16_bf16 v[64:79], v[24:27], v[100:103], v[64:79]
ds_read_b64_tr_b16 v[24:25], v5 offset:38912
ds_read_b64_tr_b16 v[26:27], v5 offset:39424
v_mul_f32 v32, s56, v32
v_mul_f32 v33, s56, v33
v_mul_f32 v34, s56, v34
s_waitcnt lgkmcnt(6)
v_mfma_f32_32x32x16_bf16 v[80:95], v[28:31], v[100:103], v[80:95]
ds_read_b64_tr_b16 v[28:29], v5 offset:47104
ds_read_b64_tr_b16 v[30:31], v5 offset:47616
v_mul_f32 v35, s56, v35
v_cvt_pk_bf16_f32 v32, v32, v33
v_cvt_pk_bf16_f32 v33, v34, v35
s_waitcnt lgkmcnt(6)
v_mfma_f32_32x32x16_bf16 v[64:79], v[16:19], v[104:107], v[64:79]
ds_read_b64_tr_b16 v[16:17], v5 offset:49152
ds_read_b64_tr_b16 v[18:19], v5 offset:49664
buffer_store_dwordx2 v[32:33], v10, s[24:27], s64 offen offset:0 sc1
v_mul_f32 v36, s56, v36
v_mul_f32 v37, s56, v37
s_waitcnt lgkmcnt(6)
v_mfma_f32_32x32x16_bf16 v[80:95], v[20:23], v[104:107], v[80:95]
ds_read_b64_tr_b16 v[20:21], v5 offset:57344
ds_read_b64_tr_b16 v[22:23], v5 offset:57856
v_mul_f32 v38, s56, v38
v_mul_f32 v39, s56, v39
v_cvt_pk_bf16_f32 v36, v36, v37
s_waitcnt lgkmcnt(6)
v_mfma_f32_32x32x16_bf16 v[64:79], v[24:27], v[108:111], v[64:79]
ds_read_b64_tr_b16 v[24:25], v5 offset:51200
ds_read_b64_tr_b16 v[26:27], v5 offset:51712
v_cvt_pk_bf16_f32 v37, v38, v39
buffer_store_dwordx2 v[36:37], v10, s[24:27], s64 offen offset:512 sc1
v_mul_f32 v40, s56, v40
s_waitcnt lgkmcnt(6)
v_mfma_f32_32x32x16_bf16 v[80:95], v[28:31], v[108:111], v[80:95]
ds_read_b64_tr_b16 v[28:29], v5 offset:59392
ds_read_b64_tr_b16 v[30:31], v5 offset:59904
v_mul_f32 v41, s56, v41
v_mul_f32 v42, s56, v42
v_mul_f32 v43, s56, v43
s_waitcnt lgkmcnt(6)
v_mfma_f32_32x32x16_bf16 v[64:79], v[16:19], v[112:115], v[64:79]
ds_read_b64_tr_b16 v[16:17], v5 offset:53248
ds_read_b64_tr_b16 v[18:19], v5 offset:53760
v_cvt_pk_bf16_f32 v40, v40, v41
v_cvt_pk_bf16_f32 v41, v42, v43
buffer_store_dwordx2 v[40:41], v10, s[24:27], s64 offen offset:1024 sc1
s_waitcnt lgkmcnt(6)
v_mfma_f32_32x32x16_bf16 v[80:95], v[20:23], v[112:115], v[80:95]
ds_read_b64_tr_b16 v[20:21], v5 offset:61440
ds_read_b64_tr_b16 v[22:23], v5 offset:61952
v_mul_f32 v44, s56, v44
v_mul_f32 v45, s56, v45
v_mul_f32 v46, s56, v46
s_waitcnt lgkmcnt(6)
v_mfma_f32_32x32x16_bf16 v[64:79], v[24:27], v[116:119], v[64:79]
ds_read_b64_tr_b16 v[24:25], v5 offset:55296
ds_read_b64_tr_b16 v[26:27], v5 offset:55808
v_mul_f32 v47, s56, v47
v_cvt_pk_bf16_f32 v44, v44, v45
v_cvt_pk_bf16_f32 v45, v46, v47
s_waitcnt lgkmcnt(6)
v_mfma_f32_32x32x16_bf16 v[80:95], v[28:31], v[116:119], v[80:95]
s_barrier
ds_read_b64_tr_b16 v[28:29], v5 offset:63488
ds_read_b64_tr_b16 v[30:31], v5 offset:64000
buffer_store_dwordx2 v[44:45], v10, s[24:27], s64 offen offset:1536 sc1
s_waitcnt lgkmcnt(6)
v_mfma_f32_32x32x16_bf16 v[64:79], v[16:19], v[120:123], v[64:79]
ds_read_b64_tr_b16 v[16:17], v4 offset:0
ds_read_b64_tr_b16 v[18:19], v4 offset:512
v_mul_f32 v48, s56, v48
v_mul_f32 v49, s56, v49
v_mul_f32 v50, s56, v50
s_waitcnt lgkmcnt(6)
v_mfma_f32_32x32x16_bf16 v[80:95], v[20:23], v[120:123], v[80:95]
ds_read_b64_tr_b16 v[20:21], v4 offset:8192
ds_read_b64_tr_b16 v[22:23], v4 offset:8704
v_mul_f32 v51, s56, v51
v_cvt_pk_bf16_f32 v48, v48, v49
v_cvt_pk_bf16_f32 v49, v50, v51
s_waitcnt lgkmcnt(6)
v_mfma_f32_32x32x16_bf16 v[64:79], v[24:27], v[124:127], v[64:79]
ds_read_b64_tr_b16 v[24:25], v4 offset:2048
ds_read_b64_tr_b16 v[26:27], v4 offset:2560
buffer_store_dwordx2 v[48:49], v10, s[24:27], s64 offen offset:2048 sc1
v_mul_f32 v52, s56, v52
v_mul_f32 v53, s56, v53
s_waitcnt lgkmcnt(6)
v_mfma_f32_32x32x16_bf16 v[80:95], v[28:31], v[124:127], v[80:95]
ds_read_b64_tr_b16 v[28:29], v4 offset:10240
ds_read_b64_tr_b16 v[30:31], v4 offset:10752
v_mul_f32 v54, s56, v54
v_mul_f32 v55, s56, v55
v_cvt_pk_bf16_f32 v52, v52, v53
s_waitcnt lgkmcnt(6)
v_mfma_f32_32x32x16_bf16 v[64:79], v[16:19], v[128:131], v[64:79]
ds_read_b64_tr_b16 v[16:17], v4 offset:4096
ds_read_b64_tr_b16 v[18:19], v4 offset:4608
v_cvt_pk_bf16_f32 v53, v54, v55
buffer_store_dwordx2 v[52:53], v10, s[24:27], s64 offen offset:2560 sc1
v_mul_f32 v56, s56, v56
s_waitcnt lgkmcnt(6)
v_mfma_f32_32x32x16_bf16 v[80:95], v[20:23], v[128:131], v[80:95]
ds_read_b64_tr_b16 v[20:21], v4 offset:12288
ds_read_b64_tr_b16 v[22:23], v4 offset:12800
v_mul_f32 v57, s56, v57
v_mul_f32 v58, s56, v58
v_mul_f32 v59, s56, v59
s_waitcnt lgkmcnt(6)
v_mfma_f32_32x32x16_bf16 v[64:79], v[24:27], v[132:135], v[64:79]
ds_read_b64_tr_b16 v[24:25], v4 offset:6144
ds_read_b64_tr_b16 v[26:27], v4 offset:6656
v_cvt_pk_bf16_f32 v56, v56, v57
v_cvt_pk_bf16_f32 v57, v58, v59
buffer_store_dwordx2 v[56:57], v10, s[24:27], s64 offen offset:3072 sc1
s_waitcnt lgkmcnt(6)
v_mfma_f32_32x32x16_bf16 v[80:95], v[28:31], v[132:135], v[80:95]
ds_read_b64_tr_b16 v[28:29], v4 offset:14336
ds_read_b64_tr_b16 v[30:31], v4 offset:14848
v_mul_f32 v60, s56, v60
v_mul_f32 v61, s56, v61
v_mul_f32 v62, s56, v62
s_waitcnt lgkmcnt(6)
v_mfma_f32_32x32x16_bf16 v[64:79], v[16:19], v[136:139], v[64:79]
ds_read_b64_tr_b16 v[16:17], v7 offset:32768
ds_read_b64_tr_b16 v[18:19], v7 offset:33280
v_mul_f32 v63, s56, v63
v_cvt_pk_bf16_f32 v60, v60, v61
v_cvt_pk_bf16_f32 v61, v62, v63
s_waitcnt lgkmcnt(6)
v_mfma_f32_32x32x16_bf16 v[80:95], v[20:23], v[136:139], v[80:95]
ds_read_b64_tr_b16 v[20:21], v7 offset:40960
ds_read_b64_tr_b16 v[22:23], v7 offset:41472
buffer_store_dwordx2 v[60:61], v10, s[24:27], s64 offen offset:3584 sc1
s_waitcnt lgkmcnt(6)
v_mfma_f32_32x32x16_bf16 v[64:79], v[24:27], v[140:143], v[64:79]
ds_read_b64_tr_b16 v[24:25], v7 offset:34816
ds_read_b64_tr_b16 v[26:27], v7 offset:35328
s_waitcnt lgkmcnt(6)
v_mfma_f32_32x32x16_bf16 v[80:95], v[28:31], v[140:143], v[80:95]
ds_read_b64_tr_b16 v[28:29], v7 offset:43008
ds_read_b64_tr_b16 v[30:31], v7 offset:43520
s_waitcnt lgkmcnt(6)
v_mfma_f32_32x32x16_bf16 v[32:47], v[16:19], v[96:99], 0
ds_read_b64_tr_b16 v[16:17], v7 offset:36864
ds_read_b64_tr_b16 v[18:19], v7 offset:37376
s_waitcnt lgkmcnt(6)
v_mfma_f32_32x32x16_bf16 v[48:63], v[20:23], v[96:99], 0
ds_read_b64_tr_b16 v[20:21], v7 offset:45056
ds_read_b64_tr_b16 v[22:23], v7 offset:45568
s_waitcnt lgkmcnt(6)
v_mfma_f32_32x32x16_bf16 v[32:47], v[24:27], v[100:103], v[32:47]
ds_read_b64_tr_b16 v[24:25], v7 offset:38912
ds_read_b64_tr_b16 v[26:27], v7 offset:39424
s_waitcnt lgkmcnt(6)
v_mfma_f32_32x32x16_bf16 v[48:63], v[28:31], v[100:103], v[48:63]
s_barrier
ds_read_b64_tr_b16 v[28:29], v7 offset:47104
ds_read_b64_tr_b16 v[30:31], v7 offset:47616
s_waitcnt lgkmcnt(6)
v_mfma_f32_32x32x16_bf16 v[32:47], v[16:19], v[104:107], v[32:47]
ds_read_b64_tr_b16 v[16:17], v7 offset:49152
ds_read_b64_tr_b16 v[18:19], v7 offset:49664
s_waitcnt lgkmcnt(6)
v_mfma_f32_32x32x16_bf16 v[48:63], v[20:23], v[104:107], v[48:63]
ds_read_b64_tr_b16 v[20:21], v7 offset:57344
ds_read_b64_tr_b16 v[22:23], v7 offset:57856
s_waitcnt lgkmcnt(6)
v_mfma_f32_32x32x16_bf16 v[32:47], v[24:27], v[108:111], v[32:47]
ds_read_b64_tr_b16 v[24:25], v7 offset:51200
ds_read_b64_tr_b16 v[26:27], v7 offset:51712
s_waitcnt lgkmcnt(6)
v_mfma_f32_32x32x16_bf16 v[48:63], v[28:31], v[108:111], v[48:63]
ds_read_b64_tr_b16 v[28:29], v7 offset:59392
ds_read_b64_tr_b16 v[30:31], v7 offset:59904
s_waitcnt lgkmcnt(6)
v_mfma_f32_32x32x16_bf16 v[32:47], v[16:19], v[112:115], v[32:47]
ds_read_b64_tr_b16 v[16:17], v7 offset:53248
ds_read_b64_tr_b16 v[18:19], v7 offset:53760
s_waitcnt lgkmcnt(6)
v_mfma_f32_32x32x16_bf16 v[48:63], v[20:23], v[112:115], v[48:63]
ds_read_b64_tr_b16 v[20:21], v7 offset:61440
ds_read_b64_tr_b16 v[22:23], v7 offset:61952
s_waitcnt lgkmcnt(6)
v_mfma_f32_32x32x16_bf16 v[32:47], v[24:27], v[116:119], v[32:47]
ds_read_b64_tr_b16 v[24:25], v7 offset:55296
ds_read_b64_tr_b16 v[26:27], v7 offset:55808
s_waitcnt lgkmcnt(6)
v_mfma_f32_32x32x16_bf16 v[48:63], v[28:31], v[116:119], v[48:63]
ds_read_b64_tr_b16 v[28:29], v7 offset:63488
ds_read_b64_tr_b16 v[30:31], v7 offset:64000
s_waitcnt lgkmcnt(6)
v_mfma_f32_32x32x16_bf16 v[32:47], v[16:19], v[120:123], v[32:47]
ds_read_b64_tr_b16 v[16:17], v6 offset:0
ds_read_b64_tr_b16 v[18:19], v6 offset:512
s_waitcnt lgkmcnt(6)
v_mfma_f32_32x32x16_bf16 v[48:63], v[20:23], v[120:123], v[48:63]
ds_read_b64_tr_b16 v[20:21], v6 offset:8192
ds_read_b64_tr_b16 v[22:23], v6 offset:8704
s_waitcnt lgkmcnt(6)
v_mfma_f32_32x32x16_bf16 v[32:47], v[24:27], v[124:127], v[32:47]
ds_read_b64_tr_b16 v[24:25], v6 offset:2048
ds_read_b64_tr_b16 v[26:27], v6 offset:2560
s_waitcnt lgkmcnt(6)
v_mfma_f32_32x32x16_bf16 v[48:63], v[28:31], v[124:127], v[48:63]
ds_read_b64_tr_b16 v[28:29], v6 offset:10240
ds_read_b64_tr_b16 v[30:31], v6 offset:10752
s_waitcnt lgkmcnt(6)
v_mfma_f32_32x32x16_bf16 v[32:47], v[16:19], v[128:131], v[32:47]
ds_read_b64_tr_b16 v[16:17], v6 offset:4096
ds_read_b64_tr_b16 v[18:19], v6 offset:4608
s_waitcnt lgkmcnt(6)
v_mfma_f32_32x32x16_bf16 v[48:63], v[20:23], v[128:131], v[48:63]
ds_read_b64_tr_b16 v[20:21], v6 offset:12288
ds_read_b64_tr_b16 v[22:23], v6 offset:12800
s_waitcnt lgkmcnt(6)
v_mfma_f32_32x32x16_bf16 v[32:47], v[24:27], v[132:135], v[32:47]
ds_read_b64_tr_b16 v[24:25], v6 offset:6144
ds_read_b64_tr_b16 v[26:27], v6 offset:6656
s_waitcnt lgkmcnt(6)
v_mfma_f32_32x32x16_bf16 v[48:63], v[28:31], v[132:135], v[48:63]
s_barrier
ds_read_b64_tr_b16 v[28:29], v6 offset:14336
ds_read_b64_tr_b16 v[30:31], v6 offset:14848
s_waitcnt lgkmcnt(6)
v_mfma_f32_32x32x16_bf16 v[32:47], v[16:19], v[136:139], v[32:47]
ds_read_b64_tr_b16 v[16:17], v4 offset:16384
ds_read_b64_tr_b16 v[18:19], v4 offset:16896
s_waitcnt lgkmcnt(6)
v_mfma_f32_32x32x16_bf16 v[48:63], v[20:23], v[136:139], v[48:63]
ds_read_b64_tr_b16 v[20:21], v4 offset:24576
ds_read_b64_tr_b16 v[22:23], v4 offset:25088
s_waitcnt vmcnt(0)
buffer_store_dword v0, v3, s[24:27], s58 offen offset:0 sc1
s_waitcnt lgkmcnt(6)
v_mfma_f32_32x32x16_bf16 v[32:47], v[24:27], v[140:143], v[32:47]
ds_read_b64_tr_b16 v[24:25], v4 offset:18432
ds_read_b64_tr_b16 v[26:27], v4 offset:18944
s_waitcnt lgkmcnt(6)
v_mfma_f32_32x32x16_bf16 v[48:63], v[28:31], v[140:143], v[48:63]
ds_read_b64_tr_b16 v[28:29], v4 offset:26624
ds_read_b64_tr_b16 v[30:31], v4 offset:27136
s_waitcnt lgkmcnt(6)
v_mfma_f32_32x32x16_bf16 v[64:79], v[16:19], v[144:147], v[64:79]
ds_read_b64_tr_b16 v[16:17], v4 offset:20480
ds_read_b64_tr_b16 v[18:19], v4 offset:20992
s_waitcnt lgkmcnt(6)
v_mfma_f32_32x32x16_bf16 v[80:95], v[20:23], v[144:147], v[80:95]
ds_read_b64_tr_b16 v[20:21], v4 offset:28672
ds_read_b64_tr_b16 v[22:23], v4 offset:29184
s_waitcnt lgkmcnt(6)
v_mfma_f32_32x32x16_bf16 v[64:79], v[24:27], v[148:151], v[64:79]
ds_read_b64_tr_b16 v[24:25], v4 offset:22528
ds_read_b64_tr_b16 v[26:27], v4 offset:23040
s_waitcnt lgkmcnt(6)
v_mfma_f32_32x32x16_bf16 v[80:95], v[28:31], v[148:151], v[80:95]
ds_read_b64_tr_b16 v[28:29], v4 offset:30720
ds_read_b64_tr_b16 v[30:31], v4 offset:31232
s_waitcnt lgkmcnt(6)
v_mfma_f32_32x32x16_bf16 v[64:79], v[16:19], v[152:155], v[64:79]
ds_read_b64_tr_b16 v[16:17], v6 offset:16384
ds_read_b64_tr_b16 v[18:19], v6 offset:16896
s_waitcnt lgkmcnt(6)
v_mfma_f32_32x32x16_bf16 v[80:95], v[20:23], v[152:155], v[80:95]
ds_read_b64_tr_b16 v[20:21], v6 offset:24576
ds_read_b64_tr_b16 v[22:23], v6 offset:25088
s_waitcnt lgkmcnt(6)
v_mfma_f32_32x32x16_bf16 v[64:79], v[24:27], v[156:159], v[64:79]
ds_read_b64_tr_b16 v[24:25], v6 offset:18432
ds_read_b64_tr_b16 v[26:27], v6 offset:18944
s_waitcnt lgkmcnt(6)
v_mfma_f32_32x32x16_bf16 v[80:95], v[28:31], v[156:159], v[80:95]
ds_read_b64_tr_b16 v[28:29], v6 offset:26624
ds_read_b64_tr_b16 v[30:31], v6 offset:27136
s_waitcnt lgkmcnt(6)
v_mfma_f32_32x32x16_bf16 v[32:47], v[16:19], v[144:147], v[32:47]
ds_read_b64_tr_b16 v[16:17], v6 offset:20480
ds_read_b64_tr_b16 v[18:19], v6 offset:20992
s_waitcnt lgkmcnt(6)
v_mfma_f32_32x32x16_bf16 v[48:63], v[20:23], v[144:147], v[48:63]
ds_read_b64_tr_b16 v[20:21], v6 offset:28672
ds_read_b64_tr_b16 v[22:23], v6 offset:29184
s_waitcnt lgkmcnt(6)
v_mfma_f32_32x32x16_bf16 v[32:47], v[24:27], v[148:151], v[32:47]
ds_read_b64_tr_b16 v[24:25], v6 offset:22528
ds_read_b64_tr_b16 v[26:27], v6 offset:23040
s_waitcnt lgkmcnt(6)
v_mfma_f32_32x32x16_bf16 v[48:63], v[28:31], v[148:151], v[48:63]
s_barrier
ds_read_b64_tr_b16 v[28:29], v6 offset:30720
ds_read_b64_tr_b16 v[30:31], v6 offset:31232
s_waitcnt lgkmcnt(6)
v_mfma_f32_32x32x16_bf16 v[32:47], v[16:19], v[152:155], v[32:47]
ds_read_b64_tr_b16 v[16:17], v4 offset:32768
ds_read_b64_tr_b16 v[18:19], v4 offset:33280
s_waitcnt lgkmcnt(6)
v_mfma_f32_32x32x16_bf16 v[48:63], v[20:23], v[152:155], v[48:63]
ds_read_b64_tr_b16 v[20:21], v4 offset:40960
ds_read_b64_tr_b16 v[22:23], v4 offset:41472
s_waitcnt lgkmcnt(6)
v_mfma_f32_32x32x16_bf16 v[32:47], v[24:27], v[156:159], v[32:47]
ds_read_b64_tr_b16 v[24:25], v4 offset:34816
ds_read_b64_tr_b16 v[26:27], v4 offset:35328
s_waitcnt lgkmcnt(6)
v_mfma_f32_32x32x16_bf16 v[48:63], v[28:31], v[156:159], v[48:63]
ds_read_b64_tr_b16 v[28:29], v4 offset:43008
ds_read_b64_tr_b16 v[30:31], v4 offset:43520
s_waitcnt lgkmcnt(6)
v_mfma_f32_32x32x16_bf16 v[64:79], v[16:19], v[160:163], v[64:79]
ds_read_b64_tr_b16 v[16:17], v4 offset:36864
ds_read_b64_tr_b16 v[18:19], v4 offset:37376
s_waitcnt lgkmcnt(6)
v_mfma_f32_32x32x16_bf16 v[80:95], v[20:23], v[160:163], v[80:95]
ds_read_b64_tr_b16 v[20:21], v4 offset:45056
ds_read_b64_tr_b16 v[22:23], v4 offset:45568
s_waitcnt lgkmcnt(6)
v_mfma_f32_32x32x16_bf16 v[64:79], v[24:27], v[164:167], v[64:79]
ds_read_b64_tr_b16 v[24:25], v4 offset:38912
ds_read_b64_tr_b16 v[26:27], v4 offset:39424
s_waitcnt lgkmcnt(6)
v_mfma_f32_32x32x16_bf16 v[80:95], v[28:31], v[164:167], v[80:95]
ds_read_b64_tr_b16 v[28:29], v4 offset:47104
ds_read_b64_tr_b16 v[30:31], v4 offset:47616
s_waitcnt lgkmcnt(6)
v_mfma_f32_32x32x16_bf16 v[64:79], v[16:19], v[168:171], v[64:79]
ds_read_b64_tr_b16 v[16:17], v6 offset:32768
ds_read_b64_tr_b16 v[18:19], v6 offset:33280
s_waitcnt lgkmcnt(6)
v_mfma_f32_32x32x16_bf16 v[80:95], v[20:23], v[168:171], v[80:95]
ds_read_b64_tr_b16 v[20:21], v6 offset:40960
ds_read_b64_tr_b16 v[22:23], v6 offset:41472
s_waitcnt lgkmcnt(6)
v_mfma_f32_32x32x16_bf16 v[64:79], v[24:27], v[172:175], v[64:79]
ds_read_b64_tr_b16 v[24:25], v6 offset:34816
ds_read_b64_tr_b16 v[26:27], v6 offset:35328
s_waitcnt lgkmcnt(6)
v_mfma_f32_32x32x16_bf16 v[80:95], v[28:31], v[172:175], v[80:95]
ds_read_b64_tr_b16 v[28:29], v6 offset:43008
ds_read_b64_tr_b16 v[30:31], v6 offset:43520
s_waitcnt lgkmcnt(6)
v_mfma_f32_32x32x16_bf16 v[32:47], v[16:19], v[160:163], v[32:47]
ds_read_b64_tr_b16 v[16:17], v6 offset:36864
ds_read_b64_tr_b16 v[18:19], v6 offset:37376
s_waitcnt lgkmcnt(6)
v_mfma_f32_32x32x16_bf16 v[48:63], v[20:23], v[160:163], v[48:63]
ds_read_b64_tr_b16 v[20:21], v6 offset:45056
ds_read_b64_tr_b16 v[22:23], v6 offset:45568
s_waitcnt lgkmcnt(6)
v_mfma_f32_32x32x16_bf16 v[32:47], v[24:27], v[164:167], v[32:47]
ds_read_b64_tr_b16 v[24:25], v6 offset:38912
ds_read_b64_tr_b16 v[26:27], v6 offset:39424
s_waitcnt lgkmcnt(6)
v_mfma_f32_32x32x16_bf16 v[48:63], v[28:31], v[164:167], v[48:63]
s_barrier
ds_read_b64_tr_b16 v[28:29], v6 offset:47104
ds_read_b64_tr_b16 v[30:31], v6 offset:47616
s_waitcnt lgkmcnt(6)
v_mfma_f32_32x32x16_bf16 v[32:47], v[16:19], v[168:171], v[32:47]
ds_read_b64_tr_b16 v[16:17], v4 offset:49152
ds_read_b64_tr_b16 v[18:19], v4 offset:49664
s_waitcnt lgkmcnt(6)
v_mfma_f32_32x32x16_bf16 v[48:63], v[20:23], v[168:171], v[48:63]
ds_read_b64_tr_b16 v[20:21], v4 offset:57344
ds_read_b64_tr_b16 v[22:23], v4 offset:57856
s_waitcnt lgkmcnt(6)
v_mfma_f32_32x32x16_bf16 v[32:47], v[24:27], v[172:175], v[32:47]
ds_read_b64_tr_b16 v[24:25], v4 offset:51200
ds_read_b64_tr_b16 v[26:27], v4 offset:51712
s_waitcnt lgkmcnt(6)
v_mfma_f32_32x32x16_bf16 v[48:63], v[28:31], v[172:175], v[48:63]
ds_read_b64_tr_b16 v[28:29], v4 offset:59392
ds_read_b64_tr_b16 v[30:31], v4 offset:59904
s_waitcnt lgkmcnt(6)
v_mfma_f32_32x32x16_bf16 v[64:79], v[16:19], v[176:179], v[64:79]
ds_read_b64_tr_b16 v[16:17], v4 offset:53248
ds_read_b64_tr_b16 v[18:19], v4 offset:53760
s_waitcnt lgkmcnt(6)
v_mfma_f32_32x32x16_bf16 v[80:95], v[20:23], v[176:179], v[80:95]
ds_read_b64_tr_b16 v[20:21], v4 offset:61440
ds_read_b64_tr_b16 v[22:23], v4 offset:61952
s_waitcnt lgkmcnt(6)
v_mfma_f32_32x32x16_bf16 v[64:79], v[24:27], v[180:183], v[64:79]
ds_read_b64_tr_b16 v[24:25], v4 offset:55296
ds_read_b64_tr_b16 v[26:27], v4 offset:55808
s_waitcnt lgkmcnt(6)
v_mfma_f32_32x32x16_bf16 v[80:95], v[28:31], v[180:183], v[80:95]
ds_read_b64_tr_b16 v[28:29], v4 offset:63488
ds_read_b64_tr_b16 v[30:31], v4 offset:64000
s_waitcnt lgkmcnt(6)
v_mfma_f32_32x32x16_bf16 v[64:79], v[16:19], v[184:187], v[64:79]
ds_read_b64_tr_b16 v[16:17], v6 offset:49152
ds_read_b64_tr_b16 v[18:19], v6 offset:49664
s_waitcnt lgkmcnt(6)
v_mfma_f32_32x32x16_bf16 v[80:95], v[20:23], v[184:187], v[80:95]
ds_read_b64_tr_b16 v[20:21], v6 offset:57344
ds_read_b64_tr_b16 v[22:23], v6 offset:57856
s_waitcnt lgkmcnt(6)
v_mfma_f32_32x32x16_bf16 v[64:79], v[24:27], v[188:191], v[64:79]
ds_read_b64_tr_b16 v[24:25], v6 offset:51200
ds_read_b64_tr_b16 v[26:27], v6 offset:51712
s_waitcnt lgkmcnt(6)
v_mfma_f32_32x32x16_bf16 v[80:95], v[28:31], v[188:191], v[80:95]
ds_read_b64_tr_b16 v[28:29], v6 offset:59392
ds_read_b64_tr_b16 v[30:31], v6 offset:59904
s_waitcnt lgkmcnt(6)
v_mfma_f32_32x32x16_bf16 v[32:47], v[16:19], v[176:179], v[32:47]
ds_read_b64_tr_b16 v[16:17], v6 offset:53248
ds_read_b64_tr_b16 v[18:19], v6 offset:53760
s_waitcnt lgkmcnt(6)
v_mfma_f32_32x32x16_bf16 v[48:63], v[20:23], v[176:179], v[48:63]
ds_read_b64_tr_b16 v[20:21], v6 offset:61440
ds_read_b64_tr_b16 v[22:23], v6 offset:61952
s_waitcnt lgkmcnt(6)
v_mfma_f32_32x32x16_bf16 v[32:47], v[24:27], v[180:183], v[32:47]
ds_read_b64_tr_b16 v[24:25], v6 offset:55296
ds_read_b64_tr_b16 v[26:27], v6 offset:55808
s_waitcnt lgkmcnt(6)
v_mfma_f32_32x32x16_bf16 v[48:63], v[28:31], v[180:183], v[48:63]
s_barrier
ds_read_b64_tr_b16 v[28:29], v6 offset:63488
ds_read_b64_tr_b16 v[30:31], v6 offset:64000
s_waitcnt lgkmcnt(6)
v_mfma_f32_32x32x16_bf16 v[32:47], v[16:19], v[184:187], v[32:47]
ds_read_b64_tr_b16 v[16:17], v5 offset:0
ds_read_b64_tr_b16 v[18:19], v5 offset:512
s_waitcnt lgkmcnt(6)
v_mfma_f32_32x32x16_bf16 v[48:63], v[20:23], v[184:187], v[48:63]
ds_read_b64_tr_b16 v[20:21], v5 offset:8192
ds_read_b64_tr_b16 v[22:23], v5 offset:8704
s_waitcnt lgkmcnt(6)
v_mfma_f32_32x32x16_bf16 v[32:47], v[24:27], v[188:191], v[32:47]
ds_read_b64_tr_b16 v[24:25], v5 offset:2048
ds_read_b64_tr_b16 v[26:27], v5 offset:2560
s_waitcnt lgkmcnt(6)
v_mfma_f32_32x32x16_bf16 v[48:63], v[28:31], v[188:191], v[48:63]
ds_read_b64_tr_b16 v[28:29], v5 offset:10240
ds_read_b64_tr_b16 v[30:31], v5 offset:10752
s_waitcnt lgkmcnt(6)
v_mfma_f32_32x32x16_bf16 v[64:79], v[16:19], v[192:195], v[64:79]
ds_read_b64_tr_b16 v[16:17], v5 offset:4096
ds_read_b64_tr_b16 v[18:19], v5 offset:4608
s_waitcnt lgkmcnt(6)
v_mfma_f32_32x32x16_bf16 v[80:95], v[20:23], v[192:195], v[80:95]
ds_read_b64_tr_b16 v[20:21], v5 offset:12288
ds_read_b64_tr_b16 v[22:23], v5 offset:12800
s_waitcnt lgkmcnt(6)
v_mfma_f32_32x32x16_bf16 v[64:79], v[24:27], v[196:199], v[64:79]
ds_read_b64_tr_b16 v[24:25], v5 offset:6144
ds_read_b64_tr_b16 v[26:27], v5 offset:6656
s_waitcnt lgkmcnt(6)
v_mfma_f32_32x32x16_bf16 v[80:95], v[28:31], v[196:199], v[80:95]
ds_read_b64_tr_b16 v[28:29], v5 offset:14336
ds_read_b64_tr_b16 v[30:31], v5 offset:14848
s_waitcnt lgkmcnt(6)
v_mfma_f32_32x32x16_bf16 v[64:79], v[16:19], v[200:203], v[64:79]
ds_read_b64_tr_b16 v[16:17], v7 offset:0
ds_read_b64_tr_b16 v[18:19], v7 offset:512
s_waitcnt lgkmcnt(6)
v_mfma_f32_32x32x16_bf16 v[80:95], v[20:23], v[200:203], v[80:95]
ds_read_b64_tr_b16 v[20:21], v7 offset:8192
ds_read_b64_tr_b16 v[22:23], v7 offset:8704
s_waitcnt lgkmcnt(6)
v_mfma_f32_32x32x16_bf16 v[64:79], v[24:27], v[204:207], v[64:79]
ds_read_b64_tr_b16 v[24:25], v7 offset:2048
ds_read_b64_tr_b16 v[26:27], v7 offset:2560
s_waitcnt lgkmcnt(6)
v_mfma_f32_32x32x16_bf16 v[80:95], v[28:31], v[204:207], v[80:95]
ds_read_b64_tr_b16 v[28:29], v7 offset:10240
ds_read_b64_tr_b16 v[30:31], v7 offset:10752
s_waitcnt lgkmcnt(6)
v_mfma_f32_32x32x16_bf16 v[32:47], v[16:19], v[192:195], v[32:47]
ds_read_b64_tr_b16 v[16:17], v7 offset:4096
ds_read_b64_tr_b16 v[18:19], v7 offset:4608
s_waitcnt lgkmcnt(6)
v_mfma_f32_32x32x16_bf16 v[48:63], v[20:23], v[192:195], v[48:63]
ds_read_b64_tr_b16 v[20:21], v7 offset:12288
ds_read_b64_tr_b16 v[22:23], v7 offset:12800
s_waitcnt lgkmcnt(6)
v_mfma_f32_32x32x16_bf16 v[32:47], v[24:27], v[196:199], v[32:47]
ds_read_b64_tr_b16 v[24:25], v7 offset:6144
ds_read_b64_tr_b16 v[26:27], v7 offset:6656
s_waitcnt lgkmcnt(6)
v_mfma_f32_32x32x16_bf16 v[48:63], v[28:31], v[196:199], v[48:63]
ds_read_b64_tr_b16 v[28:29], v7 offset:14336
ds_read_b64_tr_b16 v[30:31], v7 offset:14848
s_waitcnt lgkmcnt(6)
v_mfma_f32_32x32x16_bf16 v[32:47], v[16:19], v[200:203], v[32:47]
ds_read_b64_tr_b16 v[16:17], v5 offset:16384
ds_read_b64_tr_b16 v[18:19], v5 offset:16896
s_waitcnt lgkmcnt(6)
v_mfma_f32_32x32x16_bf16 v[48:63], v[20:23], v[200:203], v[48:63]
ds_read_b64_tr_b16 v[20:21], v5 offset:24576
ds_read_b64_tr_b16 v[22:23], v5 offset:25088
s_waitcnt lgkmcnt(6)
v_mfma_f32_32x32x16_bf16 v[32:47], v[24:27], v[204:207], v[32:47]
ds_read_b64_tr_b16 v[24:25], v5 offset:18432
ds_read_b64_tr_b16 v[26:27], v5 offset:18944
s_waitcnt lgkmcnt(6)
v_mfma_f32_32x32x16_bf16 v[48:63], v[28:31], v[204:207], v[48:63]
ds_read_b64_tr_b16 v[28:29], v5 offset:26624
ds_read_b64_tr_b16 v[30:31], v5 offset:27136
ds_write_b32 v13, v14
s_waitcnt lgkmcnt(7)
v_mfma_f32_32x32x16_bf16 v[64:79], v[16:19], v[208:211], v[64:79]
ds_read_b64_tr_b16 v[16:17], v5 offset:20480
ds_read_b64_tr_b16 v[18:19], v5 offset:20992
s_waitcnt lgkmcnt(7)
v_mfma_f32_32x32x16_bf16 v[80:95], v[20:23], v[208:211], v[80:95]
ds_read_b64_tr_b16 v[20:21], v5 offset:28672
ds_read_b64_tr_b16 v[22:23], v5 offset:29184
s_waitcnt lgkmcnt(7)
v_mfma_f32_32x32x16_bf16 v[64:79], v[24:27], v[212:215], v[64:79]
ds_read_b64_tr_b16 v[24:25], v5 offset:22528
ds_read_b64_tr_b16 v[26:27], v5 offset:23040
s_waitcnt lgkmcnt(7)
v_mfma_f32_32x32x16_bf16 v[80:95], v[28:31], v[212:215], v[80:95]
ds_read_b64_tr_b16 v[28:29], v5 offset:30720
ds_read_b64_tr_b16 v[30:31], v5 offset:31232
s_waitcnt lgkmcnt(6)
v_mfma_f32_32x32x16_bf16 v[64:79], v[16:19], v[216:219], v[64:79]
ds_read_b64_tr_b16 v[16:17], v5 offset:32768
ds_read_b64_tr_b16 v[18:19], v5 offset:33280
s_waitcnt lgkmcnt(6)
v_mfma_f32_32x32x16_bf16 v[80:95], v[20:23], v[216:219], v[80:95]
ds_read_b64_tr_b16 v[20:21], v5 offset:40960
ds_read_b64_tr_b16 v[22:23], v5 offset:41472
s_waitcnt lgkmcnt(6)
v_mfma_f32_32x32x16_bf16 v[64:79], v[24:27], v[220:223], v[64:79]
ds_read_b64_tr_b16 v[24:25], v5 offset:34816
ds_read_b64_tr_b16 v[26:27], v5 offset:35328
s_waitcnt lgkmcnt(6)
v_mfma_f32_32x32x16_bf16 v[80:95], v[28:31], v[220:223], v[80:95]
ds_read_b64_tr_b16 v[28:29], v5 offset:43008
ds_read_b64_tr_b16 v[30:31], v5 offset:43520
s_waitcnt lgkmcnt(6)
v_mfma_f32_32x32x16_bf16 v[64:79], v[16:19], v[224:227], v[64:79]
ds_read_b64_tr_b16 v[16:17], v5 offset:36864
ds_read_b64_tr_b16 v[18:19], v5 offset:37376
s_waitcnt lgkmcnt(6)
v_mfma_f32_32x32x16_bf16 v[80:95], v[20:23], v[224:227], v[80:95]
ds_read_b64_tr_b16 v[20:21], v5 offset:45056
ds_read_b64_tr_b16 v[22:23], v5 offset:45568
s_waitcnt lgkmcnt(6)
v_mfma_f32_32x32x16_bf16 v[64:79], v[24:27], v[228:231], v[64:79]
ds_read_b64_tr_b16 v[24:25], v5 offset:38912
ds_read_b64_tr_b16 v[26:27], v5 offset:39424
s_waitcnt lgkmcnt(6)
v_mfma_f32_32x32x16_bf16 v[80:95], v[28:31], v[228:231], v[80:95]
ds_read_b64_tr_b16 v[28:29], v5 offset:47104
ds_read_b64_tr_b16 v[30:31], v5 offset:47616
s_waitcnt lgkmcnt(6)
v_mfma_f32_32x32x16_bf16 v[64:79], v[16:19], v[232:235], v[64:79]
ds_read_b64_tr_b16 v[16:17], v5 offset:49152
ds_read_b64_tr_b16 v[18:19], v5 offset:49664
s_waitcnt lgkmcnt(6)
v_mfma_f32_32x32x16_bf16 v[80:95], v[20:23], v[232:235], v[80:95]
ds_read_b64_tr_b16 v[20:21], v5 offset:57344
ds_read_b64_tr_b16 v[22:23], v5 offset:57856
s_waitcnt lgkmcnt(6)
v_mfma_f32_32x32x16_bf16 v[64:79], v[24:27], v[236:239], v[64:79]
ds_read_b64_tr_b16 v[24:25], v5 offset:51200
ds_read_b64_tr_b16 v[26:27], v5 offset:51712
s_waitcnt lgkmcnt(6)
v_mfma_f32_32x32x16_bf16 v[80:95], v[28:31], v[236:239], v[80:95]
ds_read_b64_tr_b16 v[28:29], v5 offset:59392
ds_read_b64_tr_b16 v[30:31], v5 offset:59904
s_waitcnt lgkmcnt(6)
v_mfma_f32_32x32x16_bf16 v[64:79], v[16:19], v[240:243], v[64:79]
ds_read_b64_tr_b16 v[16:17], v5 offset:53248
ds_read_b64_tr_b16 v[18:19], v5 offset:53760
s_waitcnt lgkmcnt(6)
v_mfma_f32_32x32x16_bf16 v[80:95], v[20:23], v[240:243], v[80:95]
ds_read_b64_tr_b16 v[20:21], v5 offset:61440
ds_read_b64_tr_b16 v[22:23], v5 offset:61952
s_waitcnt lgkmcnt(6)
v_mfma_f32_32x32x16_bf16 v[64:79], v[24:27], v[244:247], v[64:79]
ds_read_b64_tr_b16 v[24:25], v5 offset:55296
ds_read_b64_tr_b16 v[26:27], v5 offset:55808
s_waitcnt lgkmcnt(6)
v_mfma_f32_32x32x16_bf16 v[80:95], v[28:31], v[244:247], v[80:95]
ds_read_b64_tr_b16 v[28:29], v5 offset:63488
ds_read_b64_tr_b16 v[30:31], v5 offset:64000
s_waitcnt lgkmcnt(6)
v_mfma_f32_32x32x16_bf16 v[64:79], v[16:19], v[248:251], v[64:79]
ds_read_b64_tr_b16 v[16:17], v7 offset:16384
ds_read_b64_tr_b16 v[18:19], v7 offset:16896
s_waitcnt lgkmcnt(6)
v_mfma_f32_32x32x16_bf16 v[80:95], v[20:23], v[248:251], v[80:95]
ds_read_b64_tr_b16 v[20:21], v7 offset:24576
ds_read_b64_tr_b16 v[22:23], v7 offset:25088
s_waitcnt lgkmcnt(6)
v_mfma_f32_32x32x16_bf16 v[64:79], v[24:27], v[252:255], v[64:79]
ds_read_b64_tr_b16 v[24:25], v7 offset:18432
ds_read_b64_tr_b16 v[26:27], v7 offset:18944
s_waitcnt lgkmcnt(6)
v_mfma_f32_32x32x16_bf16 v[80:95], v[28:31], v[252:255], v[80:95]
ds_read_b64_tr_b16 v[28:29], v7 offset:26624
ds_read_b64_tr_b16 v[30:31], v7 offset:27136
s_waitcnt lgkmcnt(6)
v_mfma_f32_32x32x16_bf16 v[32:47], v[16:19], v[208:211], v[32:47]
ds_read_b64_tr_b16 v[16:17], v7 offset:20480
ds_read_b64_tr_b16 v[18:19], v7 offset:20992
s_waitcnt lgkmcnt(6)
v_mfma_f32_32x32x16_bf16 v[48:63], v[20:23], v[208:211], v[48:63]
ds_read_b64_tr_b16 v[20:21], v7 offset:28672
ds_read_b64_tr_b16 v[22:23], v7 offset:29184
s_waitcnt lgkmcnt(6)
v_mfma_f32_32x32x16_bf16 v[32:47], v[24:27], v[212:215], v[32:47]
ds_read_b64_tr_b16 v[24:25], v7 offset:22528
ds_read_b64_tr_b16 v[26:27], v7 offset:23040
s_waitcnt lgkmcnt(6)
v_mfma_f32_32x32x16_bf16 v[48:63], v[28:31], v[212:215], v[48:63]
ds_read_b64_tr_b16 v[28:29], v7 offset:30720
ds_read_b64_tr_b16 v[30:31], v7 offset:31232
v_max_f32 v64, 0, v64
v_mul_f32 v64, v64, v80
v_max_f32 v65, 0, v65
s_waitcnt lgkmcnt(6)
v_mfma_f32_32x32x16_bf16 v[32:47], v[16:19], v[216:219], v[32:47]
ds_read_b64_tr_b16 v[16:17], v7 offset:32768
ds_read_b64_tr_b16 v[18:19], v7 offset:33280
v_mul_f32 v65, v65, v81
v_max_f32 v66, 0, v66
v_mul_f32 v66, v66, v82
s_waitcnt lgkmcnt(6)
v_mfma_f32_32x32x16_bf16 v[48:63], v[20:23], v[216:219], v[48:63]
ds_read_b64_tr_b16 v[20:21], v7 offset:40960
ds_read_b64_tr_b16 v[22:23], v7 offset:41472
v_max_f32 v67, 0, v67
v_mul_f32 v67, v67, v83
v_max_f32 v68, 0, v68
s_waitcnt lgkmcnt(6)
v_mfma_f32_32x32x16_bf16 v[32:47], v[24:27], v[220:223], v[32:47]
ds_read_b64_tr_b16 v[24:25], v7 offset:34816
ds_read_b64_tr_b16 v[26:27], v7 offset:35328
v_mul_f32 v68, v68, v84
v_max_f32 v69, 0, v69
v_mul_f32 v69, v69, v85
s_waitcnt lgkmcnt(6)
v_mfma_f32_32x32x16_bf16 v[48:63], v[28:31], v[220:223], v[48:63]
ds_read_b64_tr_b16 v[28:29], v7 offset:43008
ds_read_b64_tr_b16 v[30:31], v7 offset:43520
v_max_f32 v70, 0, v70
v_mul_f32 v70, v70, v86
v_max_f32 v71, 0, v71
s_waitcnt lgkmcnt(6)
v_mfma_f32_32x32x16_bf16 v[32:47], v[16:19], v[224:227], v[32:47]
ds_read_b64_tr_b16 v[16:17], v7 offset:36864
ds_read_b64_tr_b16 v[18:19], v7 offset:37376
v_mul_f32 v71, v71, v87
v_cvt_pk_bf16_f32 v64, v64, v65
v_cvt_pk_bf16_f32 v65, v66, v67
s_waitcnt lgkmcnt(6)
v_mfma_f32_32x32x16_bf16 v[48:63], v[20:23], v[224:227], v[48:63]
ds_read_b64_tr_b16 v[20:21], v7 offset:45056
ds_read_b64_tr_b16 v[22:23], v7 offset:45568
v_cvt_pk_bf16_f32 v66, v68, v69
v_cvt_pk_bf16_f32 v67, v70, v71
buffer_store_dwordx4 v[64:67], v12, s[24:27], s71 offen offset:0 sc1
s_waitcnt lgkmcnt(6)
v_mfma_f32_32x32x16_bf16 v[32:47], v[24:27], v[228:231], v[32:47]
ds_read_b64_tr_b16 v[24:25], v7 offset:38912
ds_read_b64_tr_b16 v[26:27], v7 offset:39424
v_max_f32 v72, 0, v72
v_mul_f32 v72, v72, v88
v_max_f32 v73, 0, v73
s_waitcnt lgkmcnt(6)
v_mfma_f32_32x32x16_bf16 v[48:63], v[28:31], v[228:231], v[48:63]
ds_read_b64_tr_b16 v[28:29], v7 offset:47104
ds_read_b64_tr_b16 v[30:31], v7 offset:47616
v_mul_f32 v73, v73, v89
v_max_f32 v74, 0, v74
v_mul_f32 v74, v74, v90
s_waitcnt lgkmcnt(6)
v_mfma_f32_32x32x16_bf16 v[32:47], v[16:19], v[232:235], v[32:47]
ds_read_b64_tr_b16 v[16:17], v7 offset:49152
ds_read_b64_tr_b16 v[18:19], v7 offset:49664
v_max_f32 v75, 0, v75
v_mul_f32 v75, v75, v91
v_max_f32 v76, 0, v76
s_waitcnt lgkmcnt(6)
v_mfma_f32_32x32x16_bf16 v[48:63], v[20:23], v[232:235], v[48:63]
ds_read_b64_tr_b16 v[20:21], v7 offset:57344
ds_read_b64_tr_b16 v[22:23], v7 offset:57856
v_mul_f32 v76, v76, v92
v_max_f32 v77, 0, v77
v_mul_f32 v77, v77, v93
s_waitcnt lgkmcnt(6)
v_mfma_f32_32x32x16_bf16 v[32:47], v[24:27], v[236:239], v[32:47]
ds_read_b64_tr_b16 v[24:25], v7 offset:51200
ds_read_b64_tr_b16 v[26:27], v7 offset:51712
v_max_f32 v78, 0, v78
v_mul_f32 v78, v78, v94
v_max_f32 v79, 0, v79
s_waitcnt lgkmcnt(6)
v_mfma_f32_32x32x16_bf16 v[48:63], v[28:31], v[236:239], v[48:63]
ds_read_b64_tr_b16 v[28:29], v7 offset:59392
ds_read_b64_tr_b16 v[30:31], v7 offset:59904
v_mul_f32 v79, v79, v95
v_cvt_pk_bf16_f32 v72, v72, v73
v_cvt_pk_bf16_f32 v73, v74, v75
s_waitcnt lgkmcnt(6)
v_mfma_f32_32x32x16_bf16 v[32:47], v[16:19], v[240:243], v[32:47]
ds_read_b64_tr_b16 v[16:17], v7 offset:53248
ds_read_b64_tr_b16 v[18:19], v7 offset:53760
v_cvt_pk_bf16_f32 v74, v76, v77
v_cvt_pk_bf16_f32 v75, v78, v79
buffer_store_dwordx4 v[72:75], v12, s[24:27], s71 offen offset:1024 sc1
s_waitcnt lgkmcnt(6)
v_mfma_f32_32x32x16_bf16 v[48:63], v[20:23], v[240:243], v[48:63]
ds_read_b64_tr_b16 v[20:21], v7 offset:61440
ds_read_b64_tr_b16 v[22:23], v7 offset:61952
s_waitcnt lgkmcnt(6)
v_mfma_f32_32x32x16_bf16 v[32:47], v[24:27], v[244:247], v[32:47]
ds_read_b64_tr_b16 v[24:25], v7 offset:55296
ds_read_b64_tr_b16 v[26:27], v7 offset:55808
s_waitcnt lgkmcnt(6)
v_mfma_f32_32x32x16_bf16 v[48:63], v[28:31], v[244:247], v[48:63]
ds_read_b64_tr_b16 v[28:29], v7 offset:63488
ds_read_b64_tr_b16 v[30:31], v7 offset:64000
s_waitcnt lgkmcnt(6)
v_mfma_f32_32x32x16_bf16 v[32:47], v[16:19], v[248:251], v[32:47]
s_waitcnt lgkmcnt(4)
v_mfma_f32_32x32x16_bf16 v[48:63], v[20:23], v[248:251], v[48:63]
s_waitcnt lgkmcnt(2)
v_mfma_f32_32x32x16_bf16 v[32:47], v[24:27], v[252:255], v[32:47]
s_waitcnt lgkmcnt(0)
v_mfma_f32_32x32x16_bf16 v[48:63], v[28:31], v[252:255], v[48:63]
s_nop 7
s_nop 3
v_max_f32 v32, 0, v32
v_mul_f32 v32, v32, v48
v_max_f32 v33, 0, v33
v_mul_f32 v33, v33, v49
v_max_f32 v34, 0, v34
v_mul_f32 v34, v34, v50
v_max_f32 v35, 0, v35
v_mul_f32 v35, v35, v51
v_max_f32 v36, 0, v36
v_mul_f32 v36, v36, v52
v_max_f32 v37, 0, v37
v_mul_f32 v37, v37, v53
v_max_f32 v38, 0, v38
v_mul_f32 v38, v38, v54
v_max_f32 v39, 0, v39
v_mul_f32 v39, v39, v55
v_cvt_pk_bf16_f32 v32, v32, v33
v_cvt_pk_bf16_f32 v33, v34, v35
v_cvt_pk_bf16_f32 v34, v36, v37
v_cvt_pk_bf16_f32 v35, v38, v39
buffer_store_dwordx4 v[32:35], v12, s[24:27], s71 offen offset:2048 sc1
v_max_f32 v40, 0, v40
v_mul_f32 v40, v40, v56
v_max_f32 v41, 0, v41
v_mul_f32 v41, v41, v57
v_max_f32 v42, 0, v42
v_mul_f32 v42, v42, v58
v_max_f32 v43, 0, v43
v_mul_f32 v43, v43, v59
v_max_f32 v44, 0, v44
v_mul_f32 v44, v44, v60
v_max_f32 v45, 0, v45
v_mul_f32 v45, v45, v61
v_max_f32 v46, 0, v46
v_mul_f32 v46, v46, v62
v_max_f32 v47, 0, v47
v_mul_f32 v47, v47, v63
v_cvt_pk_bf16_f32 v40, v40, v41
v_cvt_pk_bf16_f32 v41, v42, v43
v_cvt_pk_bf16_f32 v42, v44, v45
v_cvt_pk_bf16_f32 v43, v46, v47
buffer_store_dwordx4 v[40:43], v12, s[24:27], s71 offen offset:3072 sc1
s_branch F_att
F_cC:
s_add_u32 s44, s61, 4
s_lshl_b32 s45, s61, 1
s_sub_u32 s45, s45, 2
s_add_u32 s46, s45, 1
s_add_u32 s47, s61, 11
s_mov_b32 s48, 0
s_mov_b32 s49, 0
s_mov_b32 s53, 1051011932
s_lshl_b32 s63, s60, 2
s_add_u32 s63, s63, s3
v_lshrrev_b32 v13, 5, v2
v_lshlrev_b32 v13, 3, v13
v_bfe_u32 v14, v2, 2, 2
v_add_u32 v13, v13, v14
v_lshlrev_b32 v13, 7, v13
v_bfe_u32 v14, v2, 3, 1
v_lshl_add_u32 v13, v14, 6, v13
v_bfe_u32 v14, v2, 4, 1
v_lshl_add_u32 v13, v14, 5, v13
v_and_b32 v14, 3, v2
v_lshl_add_u32 v4, v14, 3, v13
v_add_u32 v5, 0x10000, v4
v_xor_b32 v6, 64, v4
v_xor_b32 v7, 64, v5
s_lshl_b32 s50, s49, 6
v_xor_b32 v8, s50, v4
v_xor_b32 v9, s50, v5
v_lshlrev_b32 v10, 3, v2
v_lshlrev_b32 v12, 4, v2
v_lshrrev_b32 v13, 5, v2
v_mul_u32_u24 v13, 10368, v13
v_and_b32 v14, 31, v2
v_lshl_add_u32 v11, v14, 4, v13
s_mov_b32 s52, 8388608
s_cmp_ge_u32 s44, 10
s_cselect_b32 s50, 12541952, s52
s_lshl_b32 s51, s44, 12
s_add_u32 s50, s50, s51
s_mul_i32 s51, s63, 40960
s_add_u32 s64, s50, s51
s_cmp_ge_u32 s44, 10
s_cselect_b32 s56, 1.0, s53
s_sub_u32 s50, s45, 20
s_lshl_b32 s50, s50, 10
s_mul_i32 s51, s63, 41472
s_add_u32 s50, s50, s51
s_add_u32 s66, s50, 16777216
s_add_u32 s67, s66, 20736
s_sub_u32 s50, s46, 20
s_lshl_b32 s50, s50, 10
s_mul_i32 s51, s63, 41472
s_add_u32 s50, s50, s51
s_add_u32 s68, s50, 16777216
s_add_u32 s69, s68, 20736
s_lshl_b32 s50, s47, 12
s_mul_i32 s51, s63, 110592
s_add_u32 s50, s50, s51
s_add_u32 s70, s50, 20971520
s_lshl_b32 s50, s48, 12
s_mul_i32 s51, s63, 110592
s_add_u32 s50, s50, s51
s_add_u32 s71, s50, 20971520
v_add_u32 v4, 32768, v4
v_add_u32 v5, 32768, v5
v_add_u32 v6, 32768, v6
v_add_u32 v7, 32768, v7
v_add_u32 v8, 32768, v8
v_add_u32 v9, 32768, v9
s_lshl_b32 s58, s63, 4
s_add_u32 s58, s58, s61
s_lshl_b32 s58, s58, 9
s_add_u32 s58, s58, 524288
s_lshl_b32 s40, s3, 2
s_add_u32 s40, s40, 16
v_mov_b32 v13, s40
v_mov_b32 v14, 1
s_lshl_b32 s43, s63, 9
s_add_u32 s43, s43, 0
v_lshrrev_b32 v16, 2, v2
v_lshlrev_b32 v16, 7, v16
v_and_b32 v17, 3, v2
v_lshl_add_u32 v16, v17, 2, v16
s_mov_b32 s1, 20000
s_mov_b32 exec_lo, 65535
s_mov_b32 exec_hi, 0
FXpC:
buffer_load_dword v17, v16, s[24:27], s43 offen offset:0 sc1
s_waitcnt vmcnt(0)
v_cmp_eq_u32 vcc, s0, v17
s_nop 0
s_cmp_eq_u64 vcc, exec
s_cbranch_scc1 FXpC_ok
s_sub_u32 s1, s1, 1
s_cmp_lg_u32 s1, 0
s_cbranch_scc1 FXpC
FXpC_ok:
s_mov_b64 exec, -1
s_mul_i32 s50, s63, 40960
s_add_u32 s50, s50, 4194304
buffer_load_dwordx4 v[96:99], v12, s[24:27], s50 offen offset:0 sc1
buffer_load_dwordx4 v[100:103], v12, s[24:27], s50 offen offset:1024 sc1
buffer_load_dwordx4 v[104:107], v12, s[24:27], s50 offen offset:2048 sc1
buffer_load_dwordx4 v[108:111], v12, s[24:27], s50 offen offset:3072 sc1
s_add_u32 s50, s50, 4096
buffer_load_dwordx4 v[112:115], v12, s[24:27], s50 offen offset:0 sc1
buffer_load_dwordx4 v[116:119], v12, s[24:27], s50 offen offset:1024 sc1
buffer_load_dwordx4 v[120:123], v12, s[24:27], s50 offen offset:2048 sc1
buffer_load_dwordx4 v[124:127], v12, s[24:27], s50 offen offset:3072 sc1
s_add_u32 s50, s50, 4096
buffer_load_dwordx4 v[128:131], v12, s[24:27], s50 offen offset:0 sc1
buffer_load_dwordx4 v[132:135], v12, s[24:27], s50 offen offset:1024 sc1
buffer_load_dwordx4 v[136:139], v12, s[24:27], s50 offen offset:2048 sc1
buffer_load_dwordx4 v[140:143], v12, s[24:27], s50 offen offset:3072 sc1
s_add_u32 s50, s50, 4096
buffer_load_dwordx4 v[144:147], v12, s[24:27], s50 offen offset:0 sc1
buffer_load_dwordx4 v[148:151], v12, s[24:27], s50 offen offset:1024 sc1
buffer_load_dwordx4 v[152:155], v12, s[24:27], s50 offen offset:2048 sc1
buffer_load_dwordx4 v[156:159], v12, s[24:27], s50 offen offset:3072 sc1
s_barrier
ds_read_b64_tr_b16 v[16:17], v5 offset:49152
ds_read_b64_tr_b16 v[18:19], v5 offset:49664
ds_read_b64_tr_b16 v[20:21], v7 offset:49152
ds_read_b64_tr_b16 v[22:23], v7 offset:49664
ds_read_b64_tr_b16 v[24:25], v4 offset:0
ds_read_b64_tr_b16 v[26:27], v4 offset:512
ds_read_b64_tr_b16 v[28:29], v6 offset:0
ds_read_b64_tr_b16 v[30:31], v6 offset:512
s_waitcnt vmcnt(15) lgkmcnt(6)
v_mfma_f32_32x32x16_bf16 v[32:47], v[96:99], v[16:19], 0
ds_read_b64_tr_b16 v[16:17], v5 offset:51200
ds_read_b64_tr_b16 v[18:19], v5 offset:51712
s_waitcnt lgkmcnt(6)
v_mfma_f32_32x32x16_bf16 v[48:63], v[96:99], v[20:23], 0
ds_read_b64_tr_b16 v[20:21], v7 offset:51200
ds_read_b64_tr_b16 v[22:23], v7 offset:51712
s_waitcnt lgkmcnt(6)
v_mfma_f32_32x32x16_bf16 v[64:79], v[96:99], v[24:27], 0
ds_read_b64_tr_b16 v[24:25], v4 offset:2048
ds_read_b64_tr_b16 v[26:27], v4 offset:2560
s_waitcnt lgkmcnt(6)
v_mfma_f32_32x32x16_bf16 v[80:95], v[96:99], v[28:31], 0
ds_read_b64_tr_b16 v[28:29], v6 offset:2048
ds_read_b64_tr_b16 v[30:31], v6 offset:2560
s_add_u32 s50, s50, 4096
buffer_load_dwordx4 v[160:163], v12, s[24:27], s50 offen offset:0 sc1
s_waitcnt vmcnt(15) lgkmcnt(6)
v_mfma_f32_32x32x16_bf16 v[32:47], v[100:103], v[16:19], v[32:47]
ds_read_b64_tr_b16 v[16:17], v5 offset:53248
ds_read_b64_tr_b16 v[18:19], v5 offset:53760
s_waitcnt lgkmcnt(6)
v_mfma_f32_32x32x16_bf16 v[48:63], v[100:103], v[20:23], v[48:63]
ds_read_b64_tr_b16 v[20:21], v7 offset:53248
ds_read_b64_tr_b16 v[22:23], v7 offset:53760
s_waitcnt lgkmcnt(6)
v_mfma_f32_32x32x16_bf16 v[64:79], v[100:103], v[24:27], v[64:79]
ds_read_b64_tr_b16 v[24:25], v4 offset:4096
ds_read_b64_tr_b16 v[26:27], v4 offset:4608
s_waitcnt lgkmcnt(6)
v_mfma_f32_32x32x16_bf16 v[80:95], v[100:103], v[28:31], v[80:95]
ds_read_b64_tr_b16 v[28:29], v6 offset:4096
ds_read_b64_tr_b16 v[30:31], v6 offset:4608
buffer_load_dwordx4 v[164:167], v12, s[24:27], s50 offen offset:1024 sc1
s_waitcnt vmcnt(15) lgkmcnt(6)
v_mfma_f32_32x32x16_bf16 v[32:47], v[104:107], v[16:19], v[32:47]
ds_read_b64_tr_b16 v[16:17], v5 offset:55296
ds_read_b64_tr_b16 v[18:19], v5 offset:55808
s_waitcnt lgkmcnt(6)
v_mfma_f32_32x32x16_bf16 v[48:63], v[104:107], v[20:23], v[48:63]
ds_read_b64_tr_b16 v[20:21], v7 offset:55296
ds_read_b64_tr_b16 v[22:23], v7 offset:55808
s_waitcnt lgkmcnt(6)
v_mfma_f32_32x32x16_bf16 v[64:79], v[104:107], v[24:27], v[64:79]
ds_read_b64_tr_b16 v[24:25], v4 offset:6144
ds_read_b64_tr_b16 v[26:27], v4 offset:6656
s_waitcnt lgkmcnt(6)
v_mfma_f32_32x32x16_bf16 v[80:95], v[104:107], v[28:31], v[80:95]
s_barrier
ds_read_b64_tr_b16 v[28:29], v6 offset:6144
ds_read_b64_tr_b16 v[30:31], v6 offset:6656
buffer_load_dwordx4 v[168:171], v12, s[24:27], s50 offen offset:2048 sc1
s_waitcnt vmcnt(15) lgkmcnt(6)
v_mfma_f32_32x32x16_bf16 v[32:47], v[108:111], v[16:19], v[32:47]
ds_read_b64_tr_b16 v[16:17], v5 offset:57344
ds_read_b64_tr_b16 v[18:19], v5 offset:57856
s_waitcnt lgkmcnt(6)
v_mfma_f32_32x32x16_bf16 v[48:63], v[108:111], v[20:23], v[48:63]
ds_read_b64_tr_b16 v[20:21], v7 offset:57344
ds_read_b64_tr_b16 v[22:23], v7 offset:57856
s_waitcnt lgkmcnt(6)
v_mfma_f32_32x32x16_bf16 v[64:79], v[108:111], v[24:27], v[64:79]
ds_read_b64_tr_b16 v[24:25], v4 offset:8192
ds_read_b64_tr_b16 v[26:27], v4 offset:8704
s_waitcnt lgkmcnt(6)
v_mfma_f32_32x32x16_bf16 v[80:95], v[108:111], v[28:31], v[80:95]
ds_read_b64_tr_b16 v[28:29], v6 offset:8192
ds_read_b64_tr_b16 v[30:31], v6 offset:8704
buffer_load_dwordx4 v[172:175], v12, s[24:27], s50 offen offset:3072 sc1
s_waitcnt vmcnt(15) lgkmcnt(6)
v_mfma_f32_32x32x16_bf16 v[32:47], v[112:115], v[16:19], v[32:47]
ds_read_b64_tr_b16 v[16:17], v5 offset:59392
ds_read_b64_tr_b16 v[18:19], v5 offset:59904
s_waitcnt lgkmcnt(6)
v_mfma_f32_32x32x16_bf16 v[48:63], v[112:115], v[20:23], v[48:63]
ds_read_b64_tr_b16 v[20:21], v7 offset:59392
ds_read_b64_tr_b16 v[22:23], v7 offset:59904
s_waitcnt lgkmcnt(6)
v_mfma_f32_32x32x16_bf16 v[64:79], v[112:115], v[24:27], v[64:79]
ds_read_b64_tr_b16 v[24:25], v4 offset:10240
ds_read_b64_tr_b16 v[26:27], v4 offset:10752
s_waitcnt lgkmcnt(6)
v_mfma_f32_32x32x16_bf16 v[80:95], v[112:115], v[28:31], v[80:95]
ds_read_b64_tr_b16 v[28:29], v6 offset:10240
ds_read_b64_tr_b16 v[30:31], v6 offset:10752
s_add_u32 s50, s50, 4096
buffer_load_dwordx4 v[176:179], v12, s[24:27], s50 offen offset:0 sc1
s_waitcnt vmcnt(15) lgkmcnt(6)
v_mfma_f32_32x32x16_bf16 v[32:47], v[116:119], v[16:19], v[32:47]
ds_read_b64_tr_b16 v[16:17], v5 offset:61440
ds_read_b64_tr_b16 v[18:19], v5 offset:61952
s_waitcnt lgkmcnt(6)
v_mfma_f32_32x32x16_bf16 v[48:63], v[116:119], v[20:23], v[48:63]
ds_read_b64_tr_b16 v[20:21], v7 offset:61440
ds_read_b64_tr_b16 v[22:23], v7 offset:61952
s_waitcnt lgkmcnt(6)
v_mfma_f32_32x32x16_bf16 v[64:79], v[116:119], v[24:27], v[64:79]
ds_read_b64_tr_b16 v[24:25], v4 offset:12288
ds_read_b64_tr_b16 v[26:27], v4 offset:12800
s_waitcnt lgkmcnt(6)
v_mfma_f32_32x32x16_bf16 v[80:95], v[116:119], v[28:31], v[80:95]
ds_read_b64_tr_b16 v[28:29], v6 offset:12288
ds_read_b64_tr_b16 v[30:31], v6 offset:12800
buffer_load_dwordx4 v[180:183], v12, s[24:27], s50 offen offset:1024 sc1
s_waitcnt vmcnt(15) lgkmcnt(6)
v_mfma_f32_32x32x16_bf16 v[32:47], v[120:123], v[16:19], v[32:47]
ds_read_b64_tr_b16 v[16:17], v5 offset:63488
ds_read_b64_tr_b16 v[18:19], v5 offset:64000
s_waitcnt lgkmcnt(6)
v_mfma_f32_32x32x16_bf16 v[48:63], v[120:123], v[20:23], v[48:63]
ds_read_b64_tr_b16 v[20:21], v7 offset:63488
ds_read_b64_tr_b16 v[22:23], v7 offset:64000
s_waitcnt lgkmcnt(6)
v_mfma_f32_32x32x16_bf16 v[64:79], v[120:123], v[24:27], v[64:79]
ds_read_b64_tr_b16 v[24:25], v4 offset:14336
ds_read_b64_tr_b16 v[26:27], v4 offset:14848
s_waitcnt lgkmcnt(6)
v_mfma_f32_32x32x16_bf16 v[80:95], v[120:123], v[28:31], v[80:95]
s_barrier
ds_read_b64_tr_b16 v[28:29], v6 offset:14336
ds_read_b64_tr_b16 v[30:31], v6 offset:14848
buffer_load_dwordx4 v[184:187], v12, s[24:27], s50 offen offset:2048 sc1
s_waitcnt vmcnt(15) lgkmcnt(6)
v_mfma_f32_32x32x16_bf16 v[32:47], v[124:127], v[16:19], v[32:47]
ds_read_b64_tr_b16 v[16:17], v4 offset:16384
ds_read_b64_tr_b16 v[18:19], v4 offset:16896
s_waitcnt lgkmcnt(6)
v_mfma_f32_32x32x16_bf16 v[48:63], v[124:127], v[20:23], v[48:63]
ds_read_b64_tr_b16 v[20:21], v6 offset:16384
ds_read_b64_tr_b16 v[22:23], v6 offset:16896
s_waitcnt lgkmcnt(6)
v_mfma_f32_32x32x16_bf16 v[64:79], v[124:127], v[24:27], v[64:79]
ds_read_b64_tr_b16 v[24:25], v4 offset:32768
ds_read_b64_tr_b16 v[26:27], v4 offset:33280
s_waitcnt lgkmcnt(6)
v_mfma_f32_32x32x16_bf16 v[80:95], v[124:127], v[28:31], v[80:95]
ds_read_b64_tr_b16 v[28:29], v6 offset:32768
ds_read_b64_tr_b16 v[30:31], v6 offset:33280
buffer_load_dwordx4 v[188:191], v12, s[24:27], s50 offen offset:3072 sc1
s_waitcnt vmcnt(15) lgkmcnt(6)
v_mfma_f32_32x32x16_bf16 v[32:47], v[128:131], v[16:19], v[32:47]
ds_read_b64_tr_b16 v[16:17], v4 offset:18432
ds_read_b64_tr_b16 v[18:19], v4 offset:18944
s_waitcnt lgkmcnt(6)
v_mfma_f32_32x32x16_bf16 v[48:63], v[128:131], v[20:23], v[48:63]
ds_read_b64_tr_b16 v[20:21], v6 offset:18432
ds_read_b64_tr_b16 v[22:23], v6 offset:18944
s_waitcnt lgkmcnt(6)
v_mfma_f32_32x32x16_bf16 v[64:79], v[128:131], v[24:27], v[64:79]
ds_read_b64_tr_b16 v[24:25], v4 offset:34816
ds_read_b64_tr_b16 v[26:27], v4 offset:35328
s_waitcnt lgkmcnt(6)
v_mfma_f32_32x32x16_bf16 v[80:95], v[128:131], v[28:31], v[80:95]
ds_read_b64_tr_b16 v[28:29], v6 offset:34816
ds_read_b64_tr_b16 v[30:31], v6 offset:35328
s_add_u32 s50, s50, 4096
buffer_load_dwordx4 v[192:195], v12, s[24:27], s50 offen offset:0 sc1
s_waitcnt vmcnt(15) lgkmcnt(6)
v_mfma_f32_32x32x16_bf16 v[32:47], v[132:135], v[16:19], v[32:47]
ds_read_b64_tr_b16 v[16:17], v4 offset:20480
ds_read_b64_tr_b16 v[18:19], v4 offset:20992
s_waitcnt lgkmcnt(6)
v_mfma_f32_32x32x16_bf16 v[48:63], v[132:135], v[20:23], v[48:63]
ds_read_b64_tr_b16 v[20:21], v6 offset:20480
ds_read_b64_tr_b16 v[22:23], v6 offset:20992
s_waitcnt lgkmcnt(6)
v_mfma_f32_32x32x16_bf16 v[64:79], v[132:135], v[24:27], v[64:79]
ds_read_b64_tr_b16 v[24:25], v4 offset:36864
ds_read_b64_tr_b16 v[26:27], v4 offset:37376
s_waitcnt lgkmcnt(6)
v_mfma_f32_32x32x16_bf16 v[80:95], v[132:135], v[28:31], v[80:95]
ds_read_b64_tr_b16 v[28:29], v6 offset:36864
ds_read_b64_tr_b16 v[30:31], v6 offset:37376
buffer_load_dwordx4 v[196:199], v12, s[24:27], s50 offen offset:1024 sc1
s_waitcnt vmcnt(15) lgkmcnt(6)
v_mfma_f32_32x32x16_bf16 v[32:47], v[136:139], v[16:19], v[32:47]
ds_read_b64_tr_b16 v[16:17], v4 offset:22528
ds_read_b64_tr_b16 v[18:19], v4 offset:23040
s_waitcnt lgkmcnt(6)
v_mfma_f32_32x32x16_bf16 v[48:63], v[136:139], v[20:23], v[48:63]
ds_read_b64_tr_b16 v[20:21], v6 offset:22528
ds_read_b64_tr_b16 v[22:23], v6 offset:23040
s_waitcnt lgkmcnt(6)
v_mfma_f32_32x32x16_bf16 v[64:79], v[136:139], v[24:27], v[64:79]
ds_read_b64_tr_b16 v[24:25], v4 offset:38912
ds_read_b64_tr_b16 v[26:27], v4 offset:39424
s_waitcnt lgkmcnt(6)
v_mfma_f32_32x32x16_bf16 v[80:95], v[136:139], v[28:31], v[80:95]
s_barrier
ds_read_b64_tr_b16 v[28:29], v6 offset:38912
ds_read_b64_tr_b16 v[30:31], v6 offset:39424
buffer_load_dwordx4 v[200:203], v12, s[24:27], s50 offen offset:2048 sc1
s_waitcnt vmcnt(15) lgkmcnt(6)
v_mfma_f32_32x32x16_bf16 v[32:47], v[140:143], v[16:19], v[32:47]
ds_read_b64_tr_b16 v[16:17], v4 offset:24576
ds_read_b64_tr_b16 v[18:19], v4 offset:25088
s_waitcnt lgkmcnt(6)
v_mfma_f32_32x32x16_bf16 v[48:63], v[140:143], v[20:23], v[48:63]
ds_read_b64_tr_b16 v[20:21], v6 offset:24576
ds_read_b64_tr_b16 v[22:23], v6 offset:25088
s_waitcnt lgkmcnt(6)
v_mfma_f32_32x32x16_bf16 v[64:79], v[140:143], v[24:27], v[64:79]
ds_read_b64_tr_b16 v[24:25], v4 offset:40960
ds_read_b64_tr_b16 v[26:27], v4 offset:41472
s_waitcnt lgkmcnt(6)
v_mfma_f32_32x32x16_bf16 v[80:95], v[140:143], v[28:31], v[80:95]
ds_read_b64_tr_b16 v[28:29], v6 offset:40960
ds_read_b64_tr_b16 v[30:31], v6 offset:41472
buffer_load_dwordx4 v[204:207], v12, s[24:27], s50 offen offset:3072 sc1
s_waitcnt vmcnt(15) lgkmcnt(6)
v_mfma_f32_32x32x16_bf16 v[32:47], v[144:147], v[16:19], v[32:47]
ds_read_b64_tr_b16 v[16:17], v4 offset:26624
ds_read_b64_tr_b16 v[18:19], v4 offset:27136
s_waitcnt lgkmcnt(6)
v_mfma_f32_32x32x16_bf16 v[48:63], v[144:147], v[20:23], v[48:63]
ds_read_b64_tr_b16 v[20:21], v6 offset:26624
ds_read_b64_tr_b16 v[22:23], v6 offset:27136
s_waitcnt lgkmcnt(6)
v_mfma_f32_32x32x16_bf16 v[64:79], v[144:147], v[24:27], v[64:79]
ds_read_b64_tr_b16 v[24:25], v4 offset:43008
ds_read_b64_tr_b16 v[26:27], v4 offset:43520
s_waitcnt lgkmcnt(6)
v_mfma_f32_32x32x16_bf16 v[80:95], v[144:147], v[28:31], v[80:95]
ds_read_b64_tr_b16 v[28:29], v6 offset:43008
ds_read_b64_tr_b16 v[30:31], v6 offset:43520
s_add_u32 s50, s50, 4096
buffer_load_dwordx4 v[208:211], v12, s[24:27], s50 offen offset:0 sc1
s_waitcnt vmcnt(15) lgkmcnt(6)
v_mfma_f32_32x32x16_bf16 v[32:47], v[148:151], v[16:19], v[32:47]
ds_read_b64_tr_b16 v[16:17], v4 offset:28672
ds_read_b64_tr_b16 v[18:19], v4 offset:29184
s_waitcnt lgkmcnt(6)
v_mfma_f32_32x32x16_bf16 v[48:63], v[148:151], v[20:23], v[48:63]
ds_read_b64_tr_b16 v[20:21], v6 offset:28672
ds_read_b64_tr_b16 v[22:23], v6 offset:29184
s_waitcnt lgkmcnt(6)
v_mfma_f32_32x32x16_bf16 v[64:79], v[148:151], v[24:27], v[64:79]
ds_read_b64_tr_b16 v[24:25], v4 offset:45056
ds_read_b64_tr_b16 v[26:27], v4 offset:45568
s_waitcnt lgkmcnt(6)
v_mfma_f32_32x32x16_bf16 v[80:95], v[148:151], v[28:31], v[80:95]
ds_read_b64_tr_b16 v[28:29], v6 offset:45056
ds_read_b64_tr_b16 v[30:31], v6 offset:45568
buffer_load_dwordx4 v[212:215], v12, s[24:27], s50 offen offset:1024 sc1
s_waitcnt vmcnt(15) lgkmcnt(6)
v_mfma_f32_32x32x16_bf16 v[32:47], v[152:155], v[16:19], v[32:47]
ds_read_b64_tr_b16 v[16:17], v4 offset:30720
ds_read_b64_tr_b16 v[18:19], v4 offset:31232
s_waitcnt lgkmcnt(6)
v_mfma_f32_32x32x16_bf16 v[48:63], v[152:155], v[20:23], v[48:63]
ds_read_b64_tr_b16 v[20:21], v6 offset:30720
ds_read_b64_tr_b16 v[22:23], v6 offset:31232
s_waitcnt lgkmcnt(6)
v_mfma_f32_32x32x16_bf16 v[64:79], v[152:155], v[24:27], v[64:79]
ds_read_b64_tr_b16 v[24:25], v4 offset:47104
ds_read_b64_tr_b16 v[26:27], v4 offset:47616
s_waitcnt lgkmcnt(6)
v_mfma_f32_32x32x16_bf16 v[80:95], v[152:155], v[28:31], v[80:95]
s_barrier
ds_read_b64_tr_b16 v[28:29], v6 offset:47104
ds_read_b64_tr_b16 v[30:31], v6 offset:47616
buffer_load_dwordx4 v[216:219], v12, s[24:27], s50 offen offset:2048 sc1
s_waitcnt vmcnt(15) lgkmcnt(6)
v_mfma_f32_32x32x16_bf16 v[32:47], v[156:159], v[16:19], v[32:47]
ds_read_b64_tr_b16 v[16:17], v4 offset:49152
ds_read_b64_tr_b16 v[18:19], v4 offset:49664
s_waitcnt lgkmcnt(6)
v_mfma_f32_32x32x16_bf16 v[48:63], v[156:159], v[20:23], v[48:63]
ds_read_b64_tr_b16 v[20:21], v6 offset:49152
ds_read_b64_tr_b16 v[22:23], v6 offset:49664
s_waitcnt lgkmcnt(6)
v_mfma_f32_32x32x16_bf16 v[64:79], v[156:159], v[24:27], v[64:79]
ds_read_b64_tr_b16 v[24:25], v5 offset:0
ds_read_b64_tr_b16 v[26:27], v5 offset:512
s_waitcnt lgkmcnt(6)
v_mfma_f32_32x32x16_bf16 v[80:95], v[156:159], v[28:31], v[80:95]
ds_read_b64_tr_b16 v[28:29], v7 offset:0
ds_read_b64_tr_b16 v[30:31], v7 offset:512
buffer_load_dwordx4 v[220:223], v12, s[24:27], s50 offen offset:3072 sc1
s_waitcnt vmcnt(15) lgkmcnt(6)
v_mfma_f32_32x32x16_bf16 v[32:47], v[160:163], v[16:19], v[32:47]
ds_read_b64_tr_b16 v[16:17], v4 offset:51200
ds_read_b64_tr_b16 v[18:19], v4 offset:51712
s_waitcnt lgkmcnt(6)
v_mfma_f32_32x32x16_bf16 v[48:63], v[160:163], v[20:23], v[48:63]
ds_read_b64_tr_b16 v[20:21], v6 offset:51200
ds_read_b64_tr_b16 v[22:23], v6 offset:51712
s_waitcnt lgkmcnt(6)
v_mfma_f32_32x32x16_bf16 v[64:79], v[160:163], v[24:27], v[64:79]
ds_read_b64_tr_b16 v[24:25], v5 offset:2048
ds_read_b64_tr_b16 v[26:27], v5 offset:2560
s_waitcnt lgkmcnt(6)
v_mfma_f32_32x32x16_bf16 v[80:95], v[160:163], v[28:31], v[80:95]
ds_read_b64_tr_b16 v[28:29], v7 offset:2048
ds_read_b64_tr_b16 v[30:31], v7 offset:2560
s_add_u32 s50, s50, 4096
buffer_load_dwordx4 v[224:227], v12, s[24:27], s50 offen offset:0 sc1
s_waitcnt vmcnt(15) lgkmcnt(6)
v_mfma_f32_32x32x16_bf16 v[32:47], v[164:167], v[16:19], v[32:47]
ds_read_b64_tr_b16 v[16:17], v4 offset:53248
ds_read_b64_tr_b16 v[18:19], v4 offset:53760
s_waitcnt lgkmcnt(6)
v_mfma_f32_32x32x16_bf16 v[48:63], v[164:167], v[20:23], v[48:63]
ds_read_b64_tr_b16 v[20:21], v6 offset:53248
ds_read_b64_tr_b16 v[22:23], v6 offset:53760
s_waitcnt lgkmcnt(6)
v_mfma_f32_32x32x16_bf16 v[64:79], v[164:167], v[24:27], v[64:79]
ds_read_b64_tr_b16 v[24:25], v5 offset:4096
ds_read_b64_tr_b16 v[26:27], v5 offset:4608
s_waitcnt lgkmcnt(6)
v_mfma_f32_32x32x16_bf16 v[80:95], v[164:167], v[28:31], v[80:95]
ds_read_b64_tr_b16 v[28:29], v7 offset:4096
ds_read_b64_tr_b16 v[30:31], v7 offset:4608
buffer_load_dwordx4 v[228:231], v12, s[24:27], s50 offen offset:1024 sc1
s_waitcnt vmcnt(15) lgkmcnt(6)
v_mfma_f32_32x32x16_bf16 v[32:47], v[168:171], v[16:19], v[32:47]
ds_read_b64_tr_b16 v[16:17], v4 offset:55296
ds_read_b64_tr_b16 v[18:19], v4 offset:55808
s_waitcnt lgkmcnt(6)
v_mfma_f32_32x32x16_bf16 v[48:63], v[168:171], v[20:23], v[48:63]
ds_read_b64_tr_b16 v[20:21], v6 offset:55296
ds_read_b64_tr_b16 v[22:23], v6 offset:55808
s_waitcnt lgkmcnt(6)
v_mfma_f32_32x32x16_bf16 v[64:79], v[168:171], v[24:27], v[64:79]
ds_read_b64_tr_b16 v[24:25], v5 offset:6144
ds_read_b64_tr_b16 v[26:27], v5 offset:6656
s_waitcnt lgkmcnt(6)
v_mfma_f32_32x32x16_bf16 v[80:95], v[168:171], v[28:31], v[80:95]
s_barrier
ds_read_b64_tr_b16 v[28:29], v7 offset:6144
ds_read_b64_tr_b16 v[30:31], v7 offset:6656
buffer_load_dwordx4 v[232:235], v12, s[24:27], s50 offen offset:2048 sc1
s_waitcnt vmcnt(15) lgkmcnt(6)
v_mfma_f32_32x32x16_bf16 v[32:47], v[172:175], v[16:19], v[32:47]
ds_read_b64_tr_b16 v[16:17], v4 offset:57344
ds_read_b64_tr_b16 v[18:19], v4 offset:57856
s_waitcnt lgkmcnt(6)
v_mfma_f32_32x32x16_bf16 v[48:63], v[172:175], v[20:23], v[48:63]
ds_read_b64_tr_b16 v[20:21], v6 offset:57344
ds_read_b64_tr_b16 v[22:23], v6 offset:57856
s_waitcnt lgkmcnt(6)
v_mfma_f32_32x32x16_bf16 v[64:79], v[172:175], v[24:27], v[64:79]
ds_read_b64_tr_b16 v[24:25], v5 offset:8192
ds_read_b64_tr_b16 v[26:27], v5 offset:8704
s_waitcnt lgkmcnt(6)
v_mfma_f32_32x32x16_bf16 v[80:95], v[172:175], v[28:31], v[80:95]
ds_read_b64_tr_b16 v[28:29], v7 offset:8192
ds_read_b64_tr_b16 v[30:31], v7 offset:8704
buffer_load_dwordx4 v[236:239], v12, s[24:27], s50 offen offset:3072 sc1
s_waitcnt vmcnt(15) lgkmcnt(6)
v_mfma_f32_32x32x16_bf16 v[32:47], v[176:179], v[16:19], v[32:47]
ds_read_b64_tr_b16 v[16:17], v4 offset:59392
ds_read_b64_tr_b16 v[18:19], v4 offset:59904
s_waitcnt lgkmcnt(6)
v_mfma_f32_32x32x16_bf16 v[48:63], v[176:179], v[20:23], v[48:63]
ds_read_b64_tr_b16 v[20:21], v6 offset:59392
ds_read_b64_tr_b16 v[22:23], v6 offset:59904
s_waitcnt lgkmcnt(6)
v_mfma_f32_32x32x16_bf16 v[64:79], v[176:179], v[24:27], v[64:79]
ds_read_b64_tr_b16 v[24:25], v5 offset:10240
ds_read_b64_tr_b16 v[26:27], v5 offset:10752
s_waitcnt lgkmcnt(6)
v_mfma_f32_32x32x16_bf16 v[80:95], v[176:179], v[28:31], v[80:95]
ds_read_b64_tr_b16 v[28:29], v7 offset:10240
ds_read_b64_tr_b16 v[30:31], v7 offset:10752
s_add_u32 s50, s50, 4096
buffer_load_dwordx4 v[240:243], v12, s[24:27], s50 offen offset:0 sc1
s_waitcnt vmcnt(15) lgkmcnt(6)
v_mfma_f32_32x32x16_bf16 v[32:47], v[180:183], v[16:19], v[32:47]
ds_read_b64_tr_b16 v[16:17], v4 offset:61440
ds_read_b64_tr_b16 v[18:19], v4 offset:61952
s_waitcnt lgkmcnt(6)
v_mfma_f32_32x32x16_bf16 v[48:63], v[180:183], v[20:23], v[48:63]
ds_read_b64_tr_b16 v[20:21], v6 offset:61440
ds_read_b64_tr_b16 v[22:23], v6 offset:61952
s_waitcnt lgkmcnt(6)
v_mfma_f32_32x32x16_bf16 v[64:79], v[180:183], v[24:27], v[64:79]
ds_read_b64_tr_b16 v[24:25], v5 offset:12288
ds_read_b64_tr_b16 v[26:27], v5 offset:12800
s_waitcnt lgkmcnt(6)
v_mfma_f32_32x32x16_bf16 v[80:95], v[180:183], v[28:31], v[80:95]
ds_read_b64_tr_b16 v[28:29], v7 offset:12288
ds_read_b64_tr_b16 v[30:31], v7 offset:12800
buffer_load_dwordx4 v[244:247], v12, s[24:27], s50 offen offset:1024 sc1
s_waitcnt vmcnt(15) lgkmcnt(6)
v_mfma_f32_32x32x16_bf16 v[32:47], v[184:187], v[16:19], v[32:47]
ds_read_b64_tr_b16 v[16:17], v4 offset:63488
ds_read_b64_tr_b16 v[18:19], v4 offset:64000
s_waitcnt lgkmcnt(6)
v_mfma_f32_32x32x16_bf16 v[48:63], v[184:187], v[20:23], v[48:63]
ds_read_b64_tr_b16 v[20:21], v6 offset:63488
ds_read_b64_tr_b16 v[22:23], v6 offset:64000
s_waitcnt lgkmcnt(6)
v_mfma_f32_32x32x16_bf16 v[64:79], v[184:187], v[24:27], v[64:79]
ds_read_b64_tr_b16 v[24:25], v5 offset:14336
ds_read_b64_tr_b16 v[26:27], v5 offset:14848
s_waitcnt lgkmcnt(6)
v_mfma_f32_32x32x16_bf16 v[80:95], v[184:187], v[28:31], v[80:95]
s_barrier
ds_read_b64_tr_b16 v[28:29], v7 offset:14336
ds_read_b64_tr_b16 v[30:31], v7 offset:14848
buffer_load_dwordx4 v[248:251], v12, s[24:27], s50 offen offset:2048 sc1
s_waitcnt vmcnt(15) lgkmcnt(6)
v_mfma_f32_32x32x16_bf16 v[32:47], v[188:191], v[16:19], v[32:47]
ds_read_b64_tr_b16 v[16:17], v5 offset:16384
ds_read_b64_tr_b16 v[18:19], v5 offset:16896
s_waitcnt lgkmcnt(6)
v_mfma_f32_32x32x16_bf16 v[48:63], v[188:191], v[20:23], v[48:63]
ds_read_b64_tr_b16 v[20:21], v7 offset:16384
ds_read_b64_tr_b16 v[22:23], v7 offset:16896
s_waitcnt lgkmcnt(6)
v_mfma_f32_32x32x16_bf16 v[64:79], v[188:191], v[24:27], v[64:79]
ds_read_b64_tr_b16 v[24:25], v5 offset:32768
ds_read_b64_tr_b16 v[26:27], v5 offset:33280
s_waitcnt lgkmcnt(6)
v_mfma_f32_32x32x16_bf16 v[80:95], v[188:191], v[28:31], v[80:95]
ds_read_b64_tr_b16 v[28:29], v7 offset:32768
ds_read_b64_tr_b16 v[30:31], v7 offset:33280
buffer_load_dwordx4 v[252:255], v12, s[24:27], s50 offen offset:3072 sc1
s_waitcnt vmcnt(15) lgkmcnt(6)
v_mfma_f32_32x32x16_bf16 v[32:47], v[192:195], v[16:19], v[32:47]
ds_read_b64_tr_b16 v[16:17], v5 offset:18432
ds_read_b64_tr_b16 v[18:19], v5 offset:18944
s_waitcnt lgkmcnt(6)
v_mfma_f32_32x32x16_bf16 v[48:63], v[192:195], v[20:23], v[48:63]
ds_read_b64_tr_b16 v[20:21], v7 offset:18432
ds_read_b64_tr_b16 v[22:23], v7 offset:18944
s_waitcnt lgkmcnt(6)
v_mfma_f32_32x32x16_bf16 v[64:79], v[192:195], v[24:27], v[64:79]
ds_read_b64_tr_b16 v[24:25], v5 offset:34816
ds_read_b64_tr_b16 v[26:27], v5 offset:35328
s_waitcnt lgkmcnt(6)
v_mfma_f32_32x32x16_bf16 v[80:95], v[192:195], v[28:31], v[80:95]
ds_read_b64_tr_b16 v[28:29], v7 offset:34816
ds_read_b64_tr_b16 v[30:31], v7 offset:35328
s_waitcnt vmcnt(14) lgkmcnt(6)
v_mfma_f32_32x32x16_bf16 v[32:47], v[196:199], v[16:19], v[32:47]
ds_read_b64_tr_b16 v[16:17], v5 offset:20480
ds_read_b64_tr_b16 v[18:19], v5 offset:20992
s_waitcnt lgkmcnt(6)
v_mfma_f32_32x32x16_bf16 v[48:63], v[196:199], v[20:23], v[48:63]
ds_read_b64_tr_b16 v[20:21], v7 offset:20480
ds_read_b64_tr_b16 v[22:23], v7 offset:20992
s_waitcnt lgkmcnt(6)
v_mfma_f32_32x32x16_bf16 v[64:79], v[196:199], v[24:27], v[64:79]
ds_read_b64_tr_b16 v[24:25], v5 offset:36864
ds_read_b64_tr_b16 v[26:27], v5 offset:37376
s_waitcnt lgkmcnt(6)
v_mfma_f32_32x32x16_bf16 v[80:95], v[196:199], v[28:31], v[80:95]
ds_read_b64_tr_b16 v[28:29], v7 offset:36864
ds_read_b64_tr_b16 v[30:31], v7 offset:37376
s_waitcnt vmcnt(13) lgkmcnt(6)
v_mfma_f32_32x32x16_bf16 v[32:47], v[200:203], v[16:19], v[32:47]
ds_read_b64_tr_b16 v[16:17], v5 offset:22528
ds_read_b64_tr_b16 v[18:19], v5 offset:23040
s_waitcnt lgkmcnt(6)
v_mfma_f32_32x32x16_bf16 v[48:63], v[200:203], v[20:23], v[48:63]
ds_read_b64_tr_b16 v[20:21], v7 offset:22528
ds_read_b64_tr_b16 v[22:23], v7 offset:23040
s_waitcnt lgkmcnt(6)
v_mfma_f32_32x32x16_bf16 v[64:79], v[200:203], v[24:27], v[64:79]
ds_read_b64_tr_b16 v[24:25], v5 offset:38912
ds_read_b64_tr_b16 v[26:27], v5 offset:39424
s_waitcnt lgkmcnt(6)
v_mfma_f32_32x32x16_bf16 v[80:95], v[200:203], v[28:31], v[80:95]
s_barrier
ds_read_b64_tr_b16 v[28:29], v7 offset:38912
ds_read_b64_tr_b16 v[30:31], v7 offset:39424
s_waitcnt vmcnt(12) lgkmcnt(6)
v_mfma_f32_32x32x16_bf16 v[32:47], v[204:207], v[16:19], v[32:47]
ds_read_b64_tr_b16 v[16:17], v5 offset:24576
ds_read_b64_tr_b16 v[18:19], v5 offset:25088
s_waitcnt lgkmcnt(6)
v_mfma_f32_32x32x16_bf16 v[48:63], v[204:207], v[20:23], v[48:63]
ds_read_b64_tr_b16 v[20:21], v7 offset:24576
ds_read_b64_tr_b16 v[22:23], v7 offset:25088
s_waitcnt lgkmcnt(6)
v_mfma_f32_32x32x16_bf16 v[64:79], v[204:207], v[24:27], v[64:79]
ds_read_b64_tr_b16 v[24:25], v5 offset:40960
ds_read_b64_tr_b16 v[26:27], v5 offset:41472
s_waitcnt lgkmcnt(6)
v_mfma_f32_32x32x16_bf16 v[80:95], v[204:207], v[28:31], v[80:95]
ds_read_b64_tr_b16 v[28:29], v7 offset:40960
ds_read_b64_tr_b16 v[30:31], v7 offset:41472
s_waitcnt vmcnt(11) lgkmcnt(6)
v_mfma_f32_32x32x16_bf16 v[32:47], v[208:211], v[16:19], v[32:47]
ds_read_b64_tr_b16 v[16:17], v5 offset:26624
ds_read_b64_tr_b16 v[18:19], v5 offset:27136
s_waitcnt lgkmcnt(6)
v_mfma_f32_32x32x16_bf16 v[48:63], v[208:211], v[20:23], v[48:63]
ds_read_b64_tr_b16 v[20:21], v7 offset:26624
ds_read_b64_tr_b16 v[22:23], v7 offset:27136
s_waitcnt lgkmcnt(6)
v_mfma_f32_32x32x16_bf16 v[64:79], v[208:211], v[24:27], v[64:79]
ds_read_b64_tr_b16 v[24:25], v5 offset:43008
ds_read_b64_tr_b16 v[26:27], v5 offset:43520
s_waitcnt lgkmcnt(6)
v_mfma_f32_32x32x16_bf16 v[80:95], v[208:211], v[28:31], v[80:95]
ds_read_b64_tr_b16 v[28:29], v7 offset:43008
ds_read_b64_tr_b16 v[30:31], v7 offset:43520
s_waitcnt vmcnt(10) lgkmcnt(6)
v_mfma_f32_32x32x16_bf16 v[32:47], v[212:215], v[16:19], v[32:47]
ds_read_b64_tr_b16 v[16:17], v5 offset:28672
ds_read_b64_tr_b16 v[18:19], v5 offset:29184
s_waitcnt lgkmcnt(6)
v_mfma_f32_32x32x16_bf16 v[48:63], v[212:215], v[20:23], v[48:63]
ds_read_b64_tr_b16 v[20:21], v7 offset:28672
ds_read_b64_tr_b16 v[22:23], v7 offset:29184
s_waitcnt lgkmcnt(6)
v_mfma_f32_32x32x16_bf16 v[64:79], v[212:215], v[24:27], v[64:79]
ds_read_b64_tr_b16 v[24:25], v5 offset:45056
ds_read_b64_tr_b16 v[26:27], v5 offset:45568
s_waitcnt lgkmcnt(6)
v_mfma_f32_32x32x16_bf16 v[80:95], v[212:215], v[28:31], v[80:95]
ds_read_b64_tr_b16 v[28:29], v7 offset:45056
ds_read_b64_tr_b16 v[30:31], v7 offset:45568
s_waitcnt vmcnt(9) lgkmcnt(6)
v_mfma_f32_32x32x16_bf16 v[32:47], v[216:219], v[16:19], v[32:47]
ds_read_b64_tr_b16 v[16:17], v5 offset:30720
ds_read_b64_tr_b16 v[18:19], v5 offset:31232
s_waitcnt lgkmcnt(6)
v_mfma_f32_32x32x16_bf16 v[48:63], v[216:219], v[20:23], v[48:63]
ds_read_b64_tr_b16 v[20:21], v7 offset:30720
ds_read_b64_tr_b16 v[22:23], v7 offset:31232
s_waitcnt lgkmcnt(6)
v_mfma_f32_32x32x16_bf16 v[64:79], v[216:219], v[24:27], v[64:79]
ds_read_b64_tr_b16 v[24:25], v5 offset:47104
ds_read_b64_tr_b16 v[26:27], v5 offset:47616
s_waitcnt lgkmcnt(6)
v_mfma_f32_32x32x16_bf16 v[80:95], v[216:219], v[28:31], v[80:95]
s_barrier
ds_read_b64_tr_b16 v[28:29], v7 offset:47104
ds_read_b64_tr_b16 v[30:31], v7 offset:47616
s_waitcnt vmcnt(8) lgkmcnt(6)
v_mfma_f32_32x32x16_bf16 v[32:47], v[220:223], v[16:19], v[32:47]
ds_read_b64_tr_b16 v[16:17], v5 offset:49152
ds_read_b64_tr_b16 v[18:19], v5 offset:49664
s_waitcnt lgkmcnt(6)
v_mfma_f32_32x32x16_bf16 v[48:63], v[220:223], v[20:23], v[48:63]
ds_read_b64_tr_b16 v[20:21], v7 offset:49152
ds_read_b64_tr_b16 v[22:23], v7 offset:49664
s_waitcnt lgkmcnt(6)
v_mfma_f32_32x32x16_bf16 v[64:79], v[220:223], v[24:27], v[64:79]
ds_read_b64_tr_b16 v[24:25], v5 offset:51200
ds_read_b64_tr_b16 v[26:27], v5 offset:51712
s_waitcnt lgkmcnt(6)
v_mfma_f32_32x32x16_bf16 v[80:95], v[220:223], v[28:31], v[80:95]
ds_read_b64_tr_b16 v[28:29], v7 offset:51200
ds_read_b64_tr_b16 v[30:31], v7 offset:51712
s_waitcnt vmcnt(7) lgkmcnt(6)
v_mfma_f32_32x32x16_bf16 v[32:47], v[224:227], v[16:19], v[32:47]
ds_read_b64_tr_b16 v[16:17], v5 offset:53248
ds_read_b64_tr_b16 v[18:19], v5 offset:53760
s_waitcnt lgkmcnt(6)
v_mfma_f32_32x32x16_bf16 v[48:63], v[224:227], v[20:23], v[48:63]
ds_read_b64_tr_b16 v[20:21], v7 offset:53248
ds_read_b64_tr_b16 v[22:23], v7 offset:53760
s_waitcnt vmcnt(6) lgkmcnt(6)
v_mfma_f32_32x32x16_bf16 v[32:47], v[228:231], v[24:27], v[32:47]
ds_read_b64_tr_b16 v[24:25], v5 offset:55296
ds_read_b64_tr_b16 v[26:27], v5 offset:55808
s_waitcnt lgkmcnt(6)
v_mfma_f32_32x32x16_bf16 v[48:63], v[228:231], v[28:31], v[48:63]
ds_read_b64_tr_b16 v[28:29], v7 offset:55296
ds_read_b64_tr_b16 v[30:31], v7 offset:55808
s_waitcnt vmcnt(5) lgkmcnt(6)
v_mfma_f32_32x32x16_bf16 v[32:47], v[232:235], v[16:19], v[32:47]
ds_read_b64_tr_b16 v[16:17], v5 offset:57344
ds_read_b64_tr_b16 v[18:19], v5 offset:57856
s_waitcnt lgkmcnt(6)
v_mfma_f32_32x32x16_bf16 v[48:63], v[232:235], v[20:23], v[48:63]
ds_read_b64_tr_b16 v[20:21], v7 offset:57344
ds_read_b64_tr_b16 v[22:23], v7 offset:57856
s_waitcnt vmcnt(4) lgkmcnt(6)
v_mfma_f32_32x32x16_bf16 v[32:47], v[236:239], v[24:27], v[32:47]
ds_read_b64_tr_b16 v[24:25], v5 offset:59392
ds_read_b64_tr_b16 v[26:27], v5 offset:59904
s_waitcnt lgkmcnt(6)
v_mfma_f32_32x32x16_bf16 v[48:63], v[236:239], v[28:31], v[48:63]
ds_read_b64_tr_b16 v[28:29], v7 offset:59392
ds_read_b64_tr_b16 v[30:31], v7 offset:59904
s_waitcnt vmcnt(3) lgkmcnt(6)
v_mfma_f32_32x32x16_bf16 v[32:47], v[240:243], v[16:19], v[32:47]
ds_read_b64_tr_b16 v[16:17], v5 offset:61440
ds_read_b64_tr_b16 v[18:19], v5 offset:61952
s_waitcnt lgkmcnt(6)
v_mfma_f32_32x32x16_bf16 v[48:63], v[240:243], v[20:23], v[48:63]
ds_read_b64_tr_b16 v[20:21], v7 offset:61440
ds_read_b64_tr_b16 v[22:23], v7 offset:61952
s_waitcnt vmcnt(2) lgkmcnt(6)
v_mfma_f32_32x32x16_bf16 v[32:47], v[244:247], v[24:27], v[32:47]
ds_read_b64_tr_b16 v[24:25], v5 offset:63488
ds_read_b64_tr_b16 v[26:27], v5 offset:64000
s_waitcnt lgkmcnt(6)
v_mfma_f32_32x32x16_bf16 v[48:63], v[244:247], v[28:31], v[48:63]
s_barrier
ds_read_b64_tr_b16 v[28:29], v7 offset:63488
ds_read_b64_tr_b16 v[30:31], v7 offset:64000
s_waitcnt vmcnt(1) lgkmcnt(6)
v_mfma_f32_32x32x16_bf16 v[32:47], v[248:251], v[16:19], v[32:47]
ds_read_b64_tr_b16 v[16:17], v4 offset:0
ds_read_b64_tr_b16 v[18:19], v4 offset:512
s_waitcnt lgkmcnt(6)
v_mfma_f32_32x32x16_bf16 v[48:63], v[248:251], v[20:23], v[48:63]
ds_read_b64_tr_b16 v[20:21], v6 offset:0
ds_read_b64_tr_b16 v[22:23], v6 offset:512
s_waitcnt vmcnt(0) lgkmcnt(6)
v_mfma_f32_32x32x16_bf16 v[32:47], v[252:255], v[24:27], v[32:47]
ds_read_b64_tr_b16 v[24:25], v4 offset:2048
ds_read_b64_tr_b16 v[26:27], v4 offset:2560
s_waitcnt lgkmcnt(6)
v_mfma_f32_32x32x16_bf16 v[48:63], v[252:255], v[28:31], v[48:63]
ds_read_b64_tr_b16 v[28:29], v6 offset:2048
ds_read_b64_tr_b16 v[30:31], v6 offset:2560
s_waitcnt lgkmcnt(6)
v_mfma_f32_32x32x16_bf16 v[64:79], v[224:227], v[16:19], v[64:79]
ds_read_b64_tr_b16 v[16:17], v4 offset:4096
ds_read_b64_tr_b16 v[18:19], v4 offset:4608
s_waitcnt lgkmcnt(6)
v_mfma_f32_32x32x16_bf16 v[80:95], v[224:227], v[20:23], v[80:95]
ds_read_b64_tr_b16 v[20:21], v6 offset:4096
ds_read_b64_tr_b16 v[22:23], v6 offset:4608
s_waitcnt lgkmcnt(6)
v_mfma_f32_32x32x16_bf16 v[64:79], v[228:231], v[24:27], v[64:79]
ds_read_b64_tr_b16 v[24:25], v4 offset:6144
ds_read_b64_tr_b16 v[26:27], v4 offset:6656
v_cvt_pk_bf16_f32 v32, v32, v33
v_cvt_pk_bf16_f32 v33, v34, v35
v_cvt_pk_bf16_f32 v34, v36, v37
s_waitcnt lgkmcnt(6)
v_mfma_f32_32x32x16_bf16 v[80:95], v[228:231], v[28:31], v[80:95]
ds_read_b64_tr_b16 v[28:29], v6 offset:6144
ds_read_b64_tr_b16 v[30:31], v6 offset:6656
v_cvt_pk_bf16_f32 v35, v38, v39
buffer_store_dwordx4 v[32:35], v11, s[24:27], s66 offen offset:0 sc1
v_cvt_pk_bf16_f32 v40, v40, v41
s_waitcnt lgkmcnt(6)
v_mfma_f32_32x32x16_bf16 v[64:79], v[232:235], v[16:19], v[64:79]
ds_read_b64_tr_b16 v[16:17], v4 offset:8192
ds_read_b64_tr_b16 v[18:19], v4 offset:8704
v_cvt_pk_bf16_f32 v41, v42, v43
v_cvt_pk_bf16_f32 v42, v44, v45
v_cvt_pk_bf16_f32 v43, v46, v47
s_waitcnt lgkmcnt(6)
v_mfma_f32_32x32x16_bf16 v[80:95], v[232:235], v[20:23], v[80:95]
ds_read_b64_tr_b16 v[20:21], v6 offset:8192
ds_read_b64_tr_b16 v[22:23], v6 offset:8704
buffer_store_dwordx4 v[40:43], v11, s[24:27], s67 offen offset:0 sc1
s_waitcnt lgkmcnt(6)
v_mfma_f32_32x32x16_bf16 v[64:79], v[236:239], v[24:27], v[64:79]
ds_read_b64_tr_b16 v[24:25], v4 offset:10240
ds_read_b64_tr_b16 v[26:27], v4 offset:10752
v_cvt_pk_bf16_f32 v48, v48, v49
v_cvt_pk_bf16_f32 v49, v50, v51
v_cvt_pk_bf16_f32 v50, v52, v53
s_waitcnt lgkmcnt(6)
v_mfma_f32_32x32x16_bf16 v[80:95], v[236:239], v[28:31], v[80:95]
ds_read_b64_tr_b16 v[28:29], v6 offset:10240
ds_read_b64_tr_b16 v[30:31], v6 offset:10752
v_cvt_pk_bf16_f32 v51, v54, v55
buffer_store_dwordx4 v[48:51], v11, s[24:27], s66 offen offset:512 sc1
v_cvt_pk_bf16_f32 v56, v56, v57
s_waitcnt lgkmcnt(6)
v_mfma_f32_32x32x16_bf16 v[64:79], v[240:243], v[16:19], v[64:79]
ds_read_b64_tr_b16 v[16:17], v4 offset:12288
ds_read_b64_tr_b16 v[18:19], v4 offset:12800
v_cvt_pk_bf16_f32 v57, v58, v59
v_cvt_pk_bf16_f32 v58, v60, v61
v_cvt_pk_bf16_f32 v59, v62, v63
s_waitcnt lgkmcnt(6)
v_mfma_f32_32x32x16_bf16 v[80:95], v[240:243], v[20:23], v[80:95]
ds_read_b64_tr_b16 v[20:21], v6 offset:12288
ds_read_b64_tr_b16 v[22:23], v6 offset:12800
buffer_store_dwordx4 v[56:59], v11, s[24:27], s67 offen offset:512 sc1
s_waitcnt lgkmcnt(6)
v_mfma_f32_32x32x16_bf16 v[64:79], v[244:247], v[24:27], v[64:79]
ds_read_b64_tr_b16 v[24:25], v4 offset:14336
ds_read_b64_tr_b16 v[26:27], v4 offset:14848
s_waitcnt lgkmcnt(6)
v_mfma_f32_32x32x16_bf16 v[80:95], v[244:247], v[28:31], v[80:95]
s_barrier
ds_read_b64_tr_b16 v[28:29], v6 offset:14336
ds_read_b64_tr_b16 v[30:31], v6 offset:14848
s_waitcnt lgkmcnt(6)
v_mfma_f32_32x32x16_bf16 v[64:79], v[248:251], v[16:19], v[64:79]
ds_read_b64_tr_b16 v[16:17], v4 offset:16384
ds_read_b64_tr_b16 v[18:19], v4 offset:16896
s_waitcnt lgkmcnt(6)
v_mfma_f32_32x32x16_bf16 v[80:95], v[248:251], v[20:23], v[80:95]
ds_read_b64_tr_b16 v[20:21], v6 offset:16384
ds_read_b64_tr_b16 v[22:23], v6 offset:16896
s_waitcnt lgkmcnt(6)
v_mfma_f32_32x32x16_bf16 v[64:79], v[252:255], v[24:27], v[64:79]
ds_read_b64_tr_b16 v[24:25], v4 offset:18432
ds_read_b64_tr_b16 v[26:27], v4 offset:18944
s_waitcnt lgkmcnt(6)
v_mfma_f32_32x32x16_bf16 v[80:95], v[252:255], v[28:31], v[80:95]
ds_read_b64_tr_b16 v[28:29], v6 offset:18432
ds_read_b64_tr_b16 v[30:31], v6 offset:18944
s_waitcnt lgkmcnt(6)
v_mfma_f32_32x32x16_bf16 v[32:47], v[16:19], v[96:99], 0
ds_read_b64_tr_b16 v[16:17], v4 offset:20480
ds_read_b64_tr_b16 v[18:19], v4 offset:20992
s_waitcnt lgkmcnt(6)
v_mfma_f32_32x32x16_bf16 v[48:63], v[20:23], v[96:99], 0
ds_read_b64_tr_b16 v[20:21], v6 offset:20480
ds_read_b64_tr_b16 v[22:23], v6 offset:20992
s_waitcnt lgkmcnt(6)
v_mfma_f32_32x32x16_bf16 v[32:47], v[24:27], v[100:103], v[32:47]
ds_read_b64_tr_b16 v[24:25], v4 offset:22528
ds_read_b64_tr_b16 v[26:27], v4 offset:23040
v_cvt_pk_bf16_f32 v64, v64, v65
v_cvt_pk_bf16_f32 v65, v66, v67
v_cvt_pk_bf16_f32 v66, v68, v69
s_waitcnt lgkmcnt(6)
v_mfma_f32_32x32x16_bf16 v[48:63], v[28:31], v[100:103], v[48:63]
ds_read_b64_tr_b16 v[28:29], v6 offset:22528
ds_read_b64_tr_b16 v[30:31], v6 offset:23040
v_cvt_pk_bf16_f32 v67, v70, v71
buffer_store_dwordx4 v[64:67], v11, s[24:27], s68 offen offset:0 sc1
v_cvt_pk_bf16_f32 v72, v72, v73
s_waitcnt lgkmcnt(6)
v_mfma_f32_32x32x16_bf16 v[32:47], v[16:19], v[104:107], v[32:47]
ds_read_b64_tr_b16 v[16:17], v4 offset:24576
ds_read_b64_tr_b16 v[18:19], v4 offset:25088
v_cvt_pk_bf16_f32 v73, v74, v75
v_cvt_pk_bf16_f32 v74, v76, v77
v_cvt_pk_bf16_f32 v75, v78, v79
s_waitcnt lgkmcnt(6)
v_mfma_f32_32x32x16_bf16 v[48:63], v[20:23], v[104:107], v[48:63]
ds_read_b64_tr_b16 v[20:21], v6 offset:24576
ds_read_b64_tr_b16 v[22:23], v6 offset:25088
buffer_store_dwordx4 v[72:75], v11, s[24:27], s69 offen offset:0 sc1
s_waitcnt lgkmcnt(6)
v_mfma_f32_32x32x16_bf16 v[32:47], v[24:27], v[108:111], v[32:47]
ds_read_b64_tr_b16 v[24:25], v4 offset:26624
ds_read_b64_tr_b16 v[26:27], v4 offset:27136
v_cvt_pk_bf16_f32 v80, v80, v81
v_cvt_pk_bf16_f32 v81, v82, v83
v_cvt_pk_bf16_f32 v82, v84, v85
s_waitcnt lgkmcnt(6)
v_mfma_f32_32x32x16_bf16 v[48:63], v[28:31], v[108:111], v[48:63]
ds_read_b64_tr_b16 v[28:29], v6 offset:26624
ds_read_b64_tr_b16 v[30:31], v6 offset:27136
v_cvt_pk_bf16_f32 v83, v86, v87
buffer_store_dwordx4 v[80:83], v11, s[24:27], s68 offen offset:512 sc1
v_cvt_pk_bf16_f32 v88, v88, v89
s_waitcnt lgkmcnt(6)
v_mfma_f32_32x32x16_bf16 v[32:47], v[16:19], v[112:115], v[32:47]
ds_read_b64_tr_b16 v[16:17], v4 offset:28672
ds_read_b64_tr_b16 v[18:19], v4 offset:29184
v_cvt_pk_bf16_f32 v89, v90, v91
v_cvt_pk_bf16_f32 v90, v92, v93
v_cvt_pk_bf16_f32 v91, v94, v95
s_waitcnt lgkmcnt(6)
v_mfma_f32_32x32x16_bf16 v[48:63], v[20:23], v[112:115], v[48:63]
ds_read_b64_tr_b16 v[20:21], v6 offset:28672
ds_read_b64_tr_b16 v[22:23], v6 offset:29184
buffer_store_dwordx4 v[88:91], v11, s[24:27], s69 offen offset:512 sc1
s_waitcnt lgkmcnt(6)
v_mfma_f32_32x32x16_bf16 v[32:47], v[24:27], v[116:119], v[32:47]
ds_read_b64_tr_b16 v[24:25], v4 offset:30720
ds_read_b64_tr_b16 v[26:27], v4 offset:31232
s_waitcnt lgkmcnt(6)
v_mfma_f32_32x32x16_bf16 v[48:63], v[28:31], v[116:119], v[48:63]
s_barrier
ds_read_b64_tr_b16 v[28:29], v6 offset:30720
ds_read_b64_tr_b16 v[30:31], v6 offset:31232
s_waitcnt lgkmcnt(6)
v_mfma_f32_32x32x16_bf16 v[32:47], v[16:19], v[120:123], v[32:47]
ds_read_b64_tr_b16 v[16:17], v4 offset:32768
ds_read_b64_tr_b16 v[18:19], v4 offset:33280
s_waitcnt lgkmcnt(6)
v_mfma_f32_32x32x16_bf16 v[48:63], v[20:23], v[120:123], v[48:63]
ds_read_b64_tr_b16 v[20:21], v6 offset:32768
ds_read_b64_tr_b16 v[22:23], v6 offset:33280
s_waitcnt lgkmcnt(6)
v_mfma_f32_32x32x16_bf16 v[32:47], v[24:27], v[124:127], v[32:47]
ds_read_b64_tr_b16 v[24:25], v4 offset:34816
ds_read_b64_tr_b16 v[26:27], v4 offset:35328
s_waitcnt lgkmcnt(6)
v_mfma_f32_32x32x16_bf16 v[48:63], v[28:31], v[124:127], v[48:63]
ds_read_b64_tr_b16 v[28:29], v6 offset:34816
ds_read_b64_tr_b16 v[30:31], v6 offset:35328
s_waitcnt lgkmcnt(6)
v_mfma_f32_32x32x16_bf16 v[32:47], v[16:19], v[128:131], v[32:47]
ds_read_b64_tr_b16 v[16:17], v4 offset:36864
ds_read_b64_tr_b16 v[18:19], v4 offset:37376
s_waitcnt lgkmcnt(6)
v_mfma_f32_32x32x16_bf16 v[48:63], v[20:23], v[128:131], v[48:63]
ds_read_b64_tr_b16 v[20:21], v6 offset:36864
ds_read_b64_tr_b16 v[22:23], v6 offset:37376
s_waitcnt lgkmcnt(6)
v_mfma_f32_32x32x16_bf16 v[32:47], v[24:27], v[132:135], v[32:47]
ds_read_b64_tr_b16 v[24:25], v4 offset:38912
ds_read_b64_tr_b16 v[26:27], v4 offset:39424
s_waitcnt lgkmcnt(6)
v_mfma_f32_32x32x16_bf16 v[48:63], v[28:31], v[132:135], v[48:63]
ds_read_b64_tr_b16 v[28:29], v6 offset:38912
ds_read_b64_tr_b16 v[30:31], v6 offset:39424
s_waitcnt lgkmcnt(6)
v_mfma_f32_32x32x16_bf16 v[32:47], v[16:19], v[136:139], v[32:47]
ds_read_b64_tr_b16 v[16:17], v4 offset:40960
ds_read_b64_tr_b16 v[18:19], v4 offset:41472
s_waitcnt lgkmcnt(6)
v_mfma_f32_32x32x16_bf16 v[48:63], v[20:23], v[136:139], v[48:63]
ds_read_b64_tr_b16 v[20:21], v6 offset:40960
ds_read_b64_tr_b16 v[22:23], v6 offset:41472
s_waitcnt lgkmcnt(6)
v_mfma_f32_32x32x16_bf16 v[32:47], v[24:27], v[140:143], v[32:47]
ds_read_b64_tr_b16 v[24:25], v4 offset:43008
ds_read_b64_tr_b16 v[26:27], v4 offset:43520
s_waitcnt lgkmcnt(6)
v_mfma_f32_32x32x16_bf16 v[48:63], v[28:31], v[140:143], v[48:63]
ds_read_b64_tr_b16 v[28:29], v6 offset:43008
ds_read_b64_tr_b16 v[30:31], v6 offset:43520
s_waitcnt lgkmcnt(6)
v_mfma_f32_32x32x16_bf16 v[32:47], v[16:19], v[144:147], v[32:47]
ds_read_b64_tr_b16 v[16:17], v4 offset:45056
ds_read_b64_tr_b16 v[18:19], v4 offset:45568
s_waitcnt lgkmcnt(6)
v_mfma_f32_32x32x16_bf16 v[48:63], v[20:23], v[144:147], v[48:63]
ds_read_b64_tr_b16 v[20:21], v6 offset:45056
ds_read_b64_tr_b16 v[22:23], v6 offset:45568
s_waitcnt lgkmcnt(6)
v_mfma_f32_32x32x16_bf16 v[32:47], v[24:27], v[148:151], v[32:47]
ds_read_b64_tr_b16 v[24:25], v4 offset:47104
ds_read_b64_tr_b16 v[26:27], v4 offset:47616
s_waitcnt lgkmcnt(6)
v_mfma_f32_32x32x16_bf16 v[48:63], v[28:31], v[148:151], v[48:63]
s_barrier
ds_read_b64_tr_b16 v[28:29], v6 offset:47104
ds_read_b64_tr_b16 v[30:31], v6 offset:47616
s_waitcnt lgkmcnt(6)
v_mfma_f32_32x32x16_bf16 v[32:47], v[16:19], v[152:155], v[32:47]
ds_read_b64_tr_b16 v[16:17], v4 offset:49152
ds_read_b64_tr_b16 v[18:19], v4 offset:49664
s_waitcnt lgkmcnt(6)
v_mfma_f32_32x32x16_bf16 v[48:63], v[20:23], v[152:155], v[48:63]
ds_read_b64_tr_b16 v[20:21], v6 offset:49152
ds_read_b64_tr_b16 v[22:23], v6 offset:49664
s_waitcnt lgkmcnt(6)
v_mfma_f32_32x32x16_bf16 v[32:47], v[24:27], v[156:159], v[32:47]
ds_read_b64_tr_b16 v[24:25], v4 offset:51200
ds_read_b64_tr_b16 v[26:27], v4 offset:51712
s_waitcnt lgkmcnt(6)
v_mfma_f32_32x32x16_bf16 v[48:63], v[28:31], v[156:159], v[48:63]
ds_read_b64_tr_b16 v[28:29], v6 offset:51200
ds_read_b64_tr_b16 v[30:31], v6 offset:51712
s_waitcnt lgkmcnt(6)
v_mfma_f32_32x32x16_bf16 v[32:47], v[16:19], v[160:163], v[32:47]
ds_read_b64_tr_b16 v[16:17], v4 offset:53248
ds_read_b64_tr_b16 v[18:19], v4 offset:53760
s_waitcnt lgkmcnt(6)
v_mfma_f32_32x32x16_bf16 v[48:63], v[20:23], v[160:163], v[48:63]
ds_read_b64_tr_b16 v[20:21], v6 offset:53248
ds_read_b64_tr_b16 v[22:23], v6 offset:53760
s_waitcnt lgkmcnt(6)
v_mfma_f32_32x32x16_bf16 v[32:47], v[24:27], v[164:167], v[32:47]
ds_read_b64_tr_b16 v[24:25], v4 offset:55296
ds_read_b64_tr_b16 v[26:27], v4 offset:55808
s_waitcnt lgkmcnt(6)
v_mfma_f32_32x32x16_bf16 v[48:63], v[28:31], v[164:167], v[48:63]
ds_read_b64_tr_b16 v[28:29], v6 offset:55296
ds_read_b64_tr_b16 v[30:31], v6 offset:55808
s_waitcnt lgkmcnt(6)
v_mfma_f32_32x32x16_bf16 v[32:47], v[16:19], v[168:171], v[32:47]
ds_read_b64_tr_b16 v[16:17], v4 offset:57344
ds_read_b64_tr_b16 v[18:19], v4 offset:57856
s_waitcnt lgkmcnt(6)
v_mfma_f32_32x32x16_bf16 v[48:63], v[20:23], v[168:171], v[48:63]
ds_read_b64_tr_b16 v[20:21], v6 offset:57344
ds_read_b64_tr_b16 v[22:23], v6 offset:57856
s_waitcnt lgkmcnt(6)
v_mfma_f32_32x32x16_bf16 v[32:47], v[24:27], v[172:175], v[32:47]
ds_read_b64_tr_b16 v[24:25], v4 offset:59392
ds_read_b64_tr_b16 v[26:27], v4 offset:59904
s_waitcnt lgkmcnt(6)
v_mfma_f32_32x32x16_bf16 v[48:63], v[28:31], v[172:175], v[48:63]
ds_read_b64_tr_b16 v[28:29], v6 offset:59392
ds_read_b64_tr_b16 v[30:31], v6 offset:59904
s_waitcnt lgkmcnt(6)
v_mfma_f32_32x32x16_bf16 v[32:47], v[16:19], v[176:179], v[32:47]
ds_read_b64_tr_b16 v[16:17], v4 offset:61440
ds_read_b64_tr_b16 v[18:19], v4 offset:61952
s_waitcnt lgkmcnt(6)
v_mfma_f32_32x32x16_bf16 v[48:63], v[20:23], v[176:179], v[48:63]
ds_read_b64_tr_b16 v[20:21], v6 offset:61440
ds_read_b64_tr_b16 v[22:23], v6 offset:61952
s_waitcnt lgkmcnt(6)
v_mfma_f32_32x32x16_bf16 v[32:47], v[24:27], v[180:183], v[32:47]
ds_read_b64_tr_b16 v[24:25], v4 offset:63488
ds_read_b64_tr_b16 v[26:27], v4 offset:64000
s_waitcnt lgkmcnt(6)
v_mfma_f32_32x32x16_bf16 v[48:63], v[28:31], v[180:183], v[48:63]
s_barrier
ds_read_b64_tr_b16 v[28:29], v6 offset:63488
ds_read_b64_tr_b16 v[30:31], v6 offset:64000
s_waitcnt lgkmcnt(6)
v_mfma_f32_32x32x16_bf16 v[32:47], v[16:19], v[184:187], v[32:47]
ds_read_b64_tr_b16 v[16:17], v5 offset:0
ds_read_b64_tr_b16 v[18:19], v5 offset:512
s_waitcnt lgkmcnt(6)
v_mfma_f32_32x32x16_bf16 v[48:63], v[20:23], v[184:187], v[48:63]
ds_read_b64_tr_b16 v[20:21], v7 offset:0
ds_read_b64_tr_b16 v[22:23], v7 offset:512
s_waitcnt lgkmcnt(6)
v_mfma_f32_32x32x16_bf16 v[32:47], v[24:27], v[188:191], v[32:47]
ds_read_b64_tr_b16 v[24:25], v5 offset:2048
ds_read_b64_tr_b16 v[26:27], v5 offset:2560
s_waitcnt lgkmcnt(6)
v_mfma_f32_32x32x16_bf16 v[48:63], v[28:31], v[188:191], v[48:63]
ds_read_b64_tr_b16 v[28:29], v7 offset:2048
ds_read_b64_tr_b16 v[30:31], v7 offset:2560
s_waitcnt lgkmcnt(6)
v_mfma_f32_32x32x16_bf16 v[32:47], v[16:19], v[192:195], v[32:47]
ds_read_b64_tr_b16 v[16:17], v5 offset:4096
ds_read_b64_tr_b16 v[18:19], v5 offset:4608
s_waitcnt lgkmcnt(6)
v_mfma_f32_32x32x16_bf16 v[48:63], v[20:23], v[192:195], v[48:63]
ds_read_b64_tr_b16 v[20:21], v7 offset:4096
ds_read_b64_tr_b16 v[22:23], v7 offset:4608
s_waitcnt lgkmcnt(6)
v_mfma_f32_32x32x16_bf16 v[32:47], v[24:27], v[196:199], v[32:47]
ds_read_b64_tr_b16 v[24:25], v5 offset:6144
ds_read_b64_tr_b16 v[26:27], v5 offset:6656
s_waitcnt lgkmcnt(6)
v_mfma_f32_32x32x16_bf16 v[48:63], v[28:31], v[196:199], v[48:63]
ds_read_b64_tr_b16 v[28:29], v7 offset:6144
ds_read_b64_tr_b16 v[30:31], v7 offset:6656
s_waitcnt lgkmcnt(6)
v_mfma_f32_32x32x16_bf16 v[32:47], v[16:19], v[200:203], v[32:47]
ds_read_b64_tr_b16 v[16:17], v5 offset:8192
ds_read_b64_tr_b16 v[18:19], v5 offset:8704
s_waitcnt lgkmcnt(6)
v_mfma_f32_32x32x16_bf16 v[48:63], v[20:23], v[200:203], v[48:63]
ds_read_b64_tr_b16 v[20:21], v7 offset:8192
ds_read_b64_tr_b16 v[22:23], v7 offset:8704
s_waitcnt lgkmcnt(6)
v_mfma_f32_32x32x16_bf16 v[32:47], v[24:27], v[204:207], v[32:47]
ds_read_b64_tr_b16 v[24:25], v5 offset:10240
ds_read_b64_tr_b16 v[26:27], v5 offset:10752
s_waitcnt lgkmcnt(6)
v_mfma_f32_32x32x16_bf16 v[48:63], v[28:31], v[204:207], v[48:63]
ds_read_b64_tr_b16 v[28:29], v7 offset:10240
ds_read_b64_tr_b16 v[30:31], v7 offset:10752
s_waitcnt lgkmcnt(6)
v_mfma_f32_32x32x16_bf16 v[32:47], v[16:19], v[208:211], v[32:47]
ds_read_b64_tr_b16 v[16:17], v5 offset:12288
ds_read_b64_tr_b16 v[18:19], v5 offset:12800
s_waitcnt lgkmcnt(6)
v_mfma_f32_32x32x16_bf16 v[48:63], v[20:23], v[208:211], v[48:63]
ds_read_b64_tr_b16 v[20:21], v7 offset:12288
ds_read_b64_tr_b16 v[22:23], v7 offset:12800
s_waitcnt vmcnt(0)
buffer_store_dword v0, v3, s[24:27], s58 offen offset:128 sc1
s_waitcnt lgkmcnt(6)
v_mfma_f32_32x32x16_bf16 v[32:47], v[24:27], v[212:215], v[32:47]
ds_read_b64_tr_b16 v[24:25], v5 offset:14336
ds_read_b64_tr_b16 v[26:27], v5 offset:14848
s_waitcnt lgkmcnt(6)
v_mfma_f32_32x32x16_bf16 v[48:63], v[28:31], v[212:215], v[48:63]
s_barrier
ds_read_b64_tr_b16 v[28:29], v7 offset:14336
ds_read_b64_tr_b16 v[30:31], v7 offset:14848
s_waitcnt lgkmcnt(6)
v_mfma_f32_32x32x16_bf16 v[32:47], v[16:19], v[216:219], v[32:47]
ds_read_b64_tr_b16 v[16:17], v5 offset:16384
ds_read_b64_tr_b16 v[18:19], v5 offset:16896
s_waitcnt lgkmcnt(6)
v_mfma_f32_32x32x16_bf16 v[48:63], v[20:23], v[216:219], v[48:63]
ds_read_b64_tr_b16 v[20:21], v7 offset:16384
ds_read_b64_tr_b16 v[22:23], v7 offset:16896
s_waitcnt lgkmcnt(6)
v_mfma_f32_32x32x16_bf16 v[32:47], v[24:27], v[220:223], v[32:47]
ds_read_b64_tr_b16 v[24:25], v5 offset:18432
ds_read_b64_tr_b16 v[26:27], v5 offset:18944
s_waitcnt lgkmcnt(6)
v_mfma_f32_32x32x16_bf16 v[48:63], v[28:31], v[220:223], v[48:63]
ds_read_b64_tr_b16 v[28:29], v7 offset:18432
ds_read_b64_tr_b16 v[30:31], v7 offset:18944
s_waitcnt lgkmcnt(6)
v_mfma_f32_32x32x16_bf16 v[32:47], v[16:19], v[224:227], v[32:47]
ds_read_b64_tr_b16 v[16:17], v5 offset:20480
ds_read_b64_tr_b16 v[18:19], v5 offset:20992
s_waitcnt lgkmcnt(6)
v_mfma_f32_32x32x16_bf16 v[48:63], v[20:23], v[224:227], v[48:63]
ds_read_b64_tr_b16 v[20:21], v7 offset:20480
ds_read_b64_tr_b16 v[22:23], v7 offset:20992
s_waitcnt lgkmcnt(6)
v_mfma_f32_32x32x16_bf16 v[32:47], v[24:27], v[228:231], v[32:47]
ds_read_b64_tr_b16 v[24:25], v5 offset:22528
ds_read_b64_tr_b16 v[26:27], v5 offset:23040
s_waitcnt lgkmcnt(6)
v_mfma_f32_32x32x16_bf16 v[48:63], v[28:31], v[228:231], v[48:63]
ds_read_b64_tr_b16 v[28:29], v7 offset:22528
ds_read_b64_tr_b16 v[30:31], v7 offset:23040
s_waitcnt lgkmcnt(6)
v_mfma_f32_32x32x16_bf16 v[32:47], v[16:19], v[232:235], v[32:47]
ds_read_b64_tr_b16 v[16:17], v5 offset:24576
ds_read_b64_tr_b16 v[18:19], v5 offset:25088
s_waitcnt lgkmcnt(6)
v_mfma_f32_32x32x16_bf16 v[48:63], v[20:23], v[232:235], v[48:63]
ds_read_b64_tr_b16 v[20:21], v7 offset:24576
ds_read_b64_tr_b16 v[22:23], v7 offset:25088
s_waitcnt lgkmcnt(6)
v_mfma_f32_32x32x16_bf16 v[32:47], v[24:27], v[236:239], v[32:47]
ds_read_b64_tr_b16 v[24:25], v5 offset:26624
ds_read_b64_tr_b16 v[26:27], v5 offset:27136
s_waitcnt lgkmcnt(6)
v_mfma_f32_32x32x16_bf16 v[48:63], v[28:31], v[236:239], v[48:63]
ds_read_b64_tr_b16 v[28:29], v7 offset:26624
ds_read_b64_tr_b16 v[30:31], v7 offset:27136
s_waitcnt lgkmcnt(6)
v_mfma_f32_32x32x16_bf16 v[32:47], v[16:19], v[240:243], v[32:47]
ds_read_b64_tr_b16 v[16:17], v5 offset:28672
ds_read_b64_tr_b16 v[18:19], v5 offset:29184
s_waitcnt lgkmcnt(6)
v_mfma_f32_32x32x16_bf16 v[48:63], v[20:23], v[240:243], v[48:63]
ds_read_b64_tr_b16 v[20:21], v7 offset:28672
ds_read_b64_tr_b16 v[22:23], v7 offset:29184
s_waitcnt lgkmcnt(6)
v_mfma_f32_32x32x16_bf16 v[32:47], v[24:27], v[244:247], v[32:47]
ds_read_b64_tr_b16 v[24:25], v5 offset:30720
ds_read_b64_tr_b16 v[26:27], v5 offset:31232
s_waitcnt lgkmcnt(6)
v_mfma_f32_32x32x16_bf16 v[48:63], v[28:31], v[244:247], v[48:63]
s_barrier
ds_read_b64_tr_b16 v[28:29], v7 offset:30720
ds_read_b64_tr_b16 v[30:31], v7 offset:31232
s_waitcnt lgkmcnt(6)
v_mfma_f32_32x32x16_bf16 v[32:47], v[16:19], v[248:251], v[32:47]
ds_read_b64_tr_b16 v[16:17], v5 offset:32768
ds_read_b64_tr_b16 v[18:19], v5 offset:33280
s_waitcnt lgkmcnt(6)
v_mfma_f32_32x32x16_bf16 v[48:63], v[20:23], v[248:251], v[48:63]
ds_read_b64_tr_b16 v[20:21], v5 offset:40960
ds_read_b64_tr_b16 v[22:23], v5 offset:41472
s_waitcnt lgkmcnt(6)
v_mfma_f32_32x32x16_bf16 v[32:47], v[24:27], v[252:255], v[32:47]
ds_read_b64_tr_b16 v[24:25], v5 offset:34816
ds_read_b64_tr_b16 v[26:27], v5 offset:35328
s_waitcnt lgkmcnt(6)
v_mfma_f32_32x32x16_bf16 v[48:63], v[28:31], v[252:255], v[48:63]
ds_read_b64_tr_b16 v[28:29], v5 offset:43008
ds_read_b64_tr_b16 v[30:31], v5 offset:43520
s_waitcnt lgkmcnt(6)
v_mfma_f32_32x32x16_bf16 v[64:79], v[16:19], v[96:99], 0
ds_read_b64_tr_b16 v[16:17], v5 offset:36864
ds_read_b64_tr_b16 v[18:19], v5 offset:37376
s_waitcnt lgkmcnt(6)
v_mfma_f32_32x32x16_bf16 v[80:95], v[20:23], v[96:99], 0
ds_read_b64_tr_b16 v[20:21], v5 offset:45056
ds_read_b64_tr_b16 v[22:23], v5 offset:45568
s_waitcnt lgkmcnt(6)
v_mfma_f32_32x32x16_bf16 v[64:79], v[24:27], v[100:103], v[64:79]
ds_read_b64_tr_b16 v[24:25], v5 offset:38912
ds_read_b64_tr_b16 v[26:27], v5 offset:39424
v_mul_f32 v32, s56, v32
v_mul_f32 v33, s56, v33
v_mul_f32 v34, s56, v34
s_waitcnt lgkmcnt(6)
v_mfma_f32_32x32x16_bf16 v[80:95], v[28:31], v[100:103], v[80:95]
ds_read_b64_tr_b16 v[28:29], v5 offset:47104
ds_read_b64_tr_b16 v[30:31], v5 offset:47616
v_mul_f32 v35, s56, v35
v_cvt_pk_bf16_f32 v32, v32, v33
v_cvt_pk_bf16_f32 v33, v34, v35
s_waitcnt lgkmcnt(6)
v_mfma_f32_32x32x16_bf16 v[64:79], v[16:19], v[104:107], v[64:79]
ds_read_b64_tr_b16 v[16:17], v5 offset:49152
ds_read_b64_tr_b16 v[18:19], v5 offset:49664
buffer_store_dwordx2 v[32:33], v10, s[24:27], s64 offen offset:0 sc1
v_mul_f32 v36, s56, v36
v_mul_f32 v37, s56, v37
s_waitcnt lgkmcnt(6)
v_mfma_f32_32x32x16_bf16 v[80:95], v[20:23], v[104:107], v[80:95]
ds_read_b64_tr_b16 v[20:21], v5 offset:57344
ds_read_b64_tr_b16 v[22:23], v5 offset:57856
v_mul_f32 v38, s56, v38
v_mul_f32 v39, s56, v39
v_cvt_pk_bf16_f32 v36, v36, v37
s_waitcnt lgkmcnt(6)
v_mfma_f32_32x32x16_bf16 v[64:79], v[24:27], v[108:111], v[64:79]
ds_read_b64_tr_b16 v[24:25], v5 offset:51200
ds_read_b64_tr_b16 v[26:27], v5 offset:51712
v_cvt_pk_bf16_f32 v37, v38, v39
buffer_store_dwordx2 v[36:37], v10, s[24:27], s64 offen offset:512 sc1
v_mul_f32 v40, s56, v40
s_waitcnt lgkmcnt(6)
v_mfma_f32_32x32x16_bf16 v[80:95], v[28:31], v[108:111], v[80:95]
ds_read_b64_tr_b16 v[28:29], v5 offset:59392
ds_read_b64_tr_b16 v[30:31], v5 offset:59904
v_mul_f32 v41, s56, v41
v_mul_f32 v42, s56, v42
v_mul_f32 v43, s56, v43
s_waitcnt lgkmcnt(6)
v_mfma_f32_32x32x16_bf16 v[64:79], v[16:19], v[112:115], v[64:79]
ds_read_b64_tr_b16 v[16:17], v5 offset:53248
ds_read_b64_tr_b16 v[18:19], v5 offset:53760
v_cvt_pk_bf16_f32 v40, v40, v41
v_cvt_pk_bf16_f32 v41, v42, v43
buffer_store_dwordx2 v[40:41], v10, s[24:27], s64 offen offset:1024 sc1
s_waitcnt lgkmcnt(6)
v_mfma_f32_32x32x16_bf16 v[80:95], v[20:23], v[112:115], v[80:95]
ds_read_b64_tr_b16 v[20:21], v5 offset:61440
ds_read_b64_tr_b16 v[22:23], v5 offset:61952
v_mul_f32 v44, s56, v44
v_mul_f32 v45, s56, v45
v_mul_f32 v46, s56, v46
s_waitcnt lgkmcnt(6)
v_mfma_f32_32x32x16_bf16 v[64:79], v[24:27], v[116:119], v[64:79]
ds_read_b64_tr_b16 v[24:25], v5 offset:55296
ds_read_b64_tr_b16 v[26:27], v5 offset:55808
v_mul_f32 v47, s56, v47
v_cvt_pk_bf16_f32 v44, v44, v45
v_cvt_pk_bf16_f32 v45, v46, v47
s_waitcnt lgkmcnt(6)
v_mfma_f32_32x32x16_bf16 v[80:95], v[28:31], v[116:119], v[80:95]
s_barrier
ds_read_b64_tr_b16 v[28:29], v5 offset:63488
ds_read_b64_tr_b16 v[30:31], v5 offset:64000
buffer_store_dwordx2 v[44:45], v10, s[24:27], s64 offen offset:1536 sc1
s_waitcnt lgkmcnt(6)
v_mfma_f32_32x32x16_bf16 v[64:79], v[16:19], v[120:123], v[64:79]
ds_read_b64_tr_b16 v[16:17], v4 offset:0
ds_read_b64_tr_b16 v[18:19], v4 offset:512
v_mul_f32 v48, s56, v48
v_mul_f32 v49, s56, v49
v_mul_f32 v50, s56, v50
s_waitcnt lgkmcnt(6)
v_mfma_f32_32x32x16_bf16 v[80:95], v[20:23], v[120:123], v[80:95]
ds_read_b64_tr_b16 v[20:21], v4 offset:8192
ds_read_b64_tr_b16 v[22:23], v4 offset:8704
v_mul_f32 v51, s56, v51
v_cvt_pk_bf16_f32 v48, v48, v49
v_cvt_pk_bf16_f32 v49, v50, v51
s_waitcnt lgkmcnt(6)
v_mfma_f32_32x32x16_bf16 v[64:79], v[24:27], v[124:127], v[64:79]
ds_read_b64_tr_b16 v[24:25], v4 offset:2048
ds_read_b64_tr_b16 v[26:27], v4 offset:2560
buffer_store_dwordx2 v[48:49], v10, s[24:27], s64 offen offset:2048 sc1
v_mul_f32 v52, s56, v52
v_mul_f32 v53, s56, v53
s_waitcnt lgkmcnt(6)
v_mfma_f32_32x32x16_bf16 v[80:95], v[28:31], v[124:127], v[80:95]
ds_read_b64_tr_b16 v[28:29], v4 offset:10240
ds_read_b64_tr_b16 v[30:31], v4 offset:10752
v_mul_f32 v54, s56, v54
v_mul_f32 v55, s56, v55
v_cvt_pk_bf16_f32 v52, v52, v53
s_waitcnt lgkmcnt(6)
v_mfma_f32_32x32x16_bf16 v[64:79], v[16:19], v[128:131], v[64:79]
ds_read_b64_tr_b16 v[16:17], v4 offset:4096
ds_read_b64_tr_b16 v[18:19], v4 offset:4608
v_cvt_pk_bf16_f32 v53, v54, v55
buffer_store_dwordx2 v[52:53], v10, s[24:27], s64 offen offset:2560 sc1
v_mul_f32 v56, s56, v56
s_waitcnt lgkmcnt(6)
v_mfma_f32_32x32x16_bf16 v[80:95], v[20:23], v[128:131], v[80:95]
ds_read_b64_tr_b16 v[20:21], v4 offset:12288
ds_read_b64_tr_b16 v[22:23], v4 offset:12800
v_mul_f32 v57, s56, v57
v_mul_f32 v58, s56, v58
v_mul_f32 v59, s56, v59
s_waitcnt lgkmcnt(6)
v_mfma_f32_32x32x16_bf16 v[64:79], v[24:27], v[132:135], v[64:79]
ds_read_b64_tr_b16 v[24:25], v4 offset:6144
ds_read_b64_tr_b16 v[26:27], v4 offset:6656
v_cvt_pk_bf16_f32 v56, v56, v57
v_cvt_pk_bf16_f32 v57, v58, v59
buffer_store_dwordx2 v[56:57], v10, s[24:27], s64 offen offset:3072 sc1
s_waitcnt lgkmcnt(6)
v_mfma_f32_32x32x16_bf16 v[80:95], v[28:31], v[132:135], v[80:95]
ds_read_b64_tr_b16 v[28:29], v4 offset:14336
ds_read_b64_tr_b16 v[30:31], v4 offset:14848
v_mul_f32 v60, s56, v60
v_mul_f32 v61, s56, v61
v_mul_f32 v62, s56, v62
s_waitcnt lgkmcnt(6)
v_mfma_f32_32x32x16_bf16 v[64:79], v[16:19], v[136:139], v[64:79]
ds_read_b64_tr_b16 v[16:17], v7 offset:32768
ds_read_b64_tr_b16 v[18:19], v7 offset:33280
v_mul_f32 v63, s56, v63
v_cvt_pk_bf16_f32 v60, v60, v61
v_cvt_pk_bf16_f32 v61, v62, v63
s_waitcnt lgkmcnt(6)
v_mfma_f32_32x32x16_bf16 v[80:95], v[20:23], v[136:139], v[80:95]
ds_read_b64_tr_b16 v[20:21], v7 offset:40960
ds_read_b64_tr_b16 v[22:23], v7 offset:41472
buffer_store_dwordx2 v[60:61], v10, s[24:27], s64 offen offset:3584 sc1
s_waitcnt lgkmcnt(6)
v_mfma_f32_32x32x16_bf16 v[64:79], v[24:27], v[140:143], v[64:79]
ds_read_b64_tr_b16 v[24:25], v7 offset:34816
ds_read_b64_tr_b16 v[26:27], v7 offset:35328
s_waitcnt lgkmcnt(6)
v_mfma_f32_32x32x16_bf16 v[80:95], v[28:31], v[140:143], v[80:95]
ds_read_b64_tr_b16 v[28:29], v7 offset:43008
ds_read_b64_tr_b16 v[30:31], v7 offset:43520
s_waitcnt lgkmcnt(6)
v_mfma_f32_32x32x16_bf16 v[32:47], v[16:19], v[96:99], 0
ds_read_b64_tr_b16 v[16:17], v7 offset:36864
ds_read_b64_tr_b16 v[18:19], v7 offset:37376
s_waitcnt lgkmcnt(6)
v_mfma_f32_32x32x16_bf16 v[48:63], v[20:23], v[96:99], 0
ds_read_b64_tr_b16 v[20:21], v7 offset:45056
ds_read_b64_tr_b16 v[22:23], v7 offset:45568
s_waitcnt lgkmcnt(6)
v_mfma_f32_32x32x16_bf16 v[32:47], v[24:27], v[100:103], v[32:47]
ds_read_b64_tr_b16 v[24:25], v7 offset:38912
ds_read_b64_tr_b16 v[26:27], v7 offset:39424
s_waitcnt lgkmcnt(6)
v_mfma_f32_32x32x16_bf16 v[48:63], v[28:31], v[100:103], v[48:63]
s_barrier
ds_read_b64_tr_b16 v[28:29], v7 offset:47104
ds_read_b64_tr_b16 v[30:31], v7 offset:47616
s_waitcnt lgkmcnt(6)
v_mfma_f32_32x32x16_bf16 v[32:47], v[16:19], v[104:107], v[32:47]
ds_read_b64_tr_b16 v[16:17], v7 offset:49152
ds_read_b64_tr_b16 v[18:19], v7 offset:49664
s_waitcnt lgkmcnt(6)
v_mfma_f32_32x32x16_bf16 v[48:63], v[20:23], v[104:107], v[48:63]
ds_read_b64_tr_b16 v[20:21], v7 offset:57344
ds_read_b64_tr_b16 v[22:23], v7 offset:57856
s_waitcnt lgkmcnt(6)
v_mfma_f32_32x32x16_bf16 v[32:47], v[24:27], v[108:111], v[32:47]
ds_read_b64_tr_b16 v[24:25], v7 offset:51200
ds_read_b64_tr_b16 v[26:27], v7 offset:51712
s_waitcnt lgkmcnt(6)
v_mfma_f32_32x32x16_bf16 v[48:63], v[28:31], v[108:111], v[48:63]
ds_read_b64_tr_b16 v[28:29], v7 offset:59392
ds_read_b64_tr_b16 v[30:31], v7 offset:59904
s_waitcnt lgkmcnt(6)
v_mfma_f32_32x32x16_bf16 v[32:47], v[16:19], v[112:115], v[32:47]
ds_read_b64_tr_b16 v[16:17], v7 offset:53248
ds_read_b64_tr_b16 v[18:19], v7 offset:53760
s_waitcnt lgkmcnt(6)
v_mfma_f32_32x32x16_bf16 v[48:63], v[20:23], v[112:115], v[48:63]
ds_read_b64_tr_b16 v[20:21], v7 offset:61440
ds_read_b64_tr_b16 v[22:23], v7 offset:61952
s_waitcnt lgkmcnt(6)
v_mfma_f32_32x32x16_bf16 v[32:47], v[24:27], v[116:119], v[32:47]
ds_read_b64_tr_b16 v[24:25], v7 offset:55296
ds_read_b64_tr_b16 v[26:27], v7 offset:55808
s_waitcnt lgkmcnt(6)
v_mfma_f32_32x32x16_bf16 v[48:63], v[28:31], v[116:119], v[48:63]
ds_read_b64_tr_b16 v[28:29], v7 offset:63488
ds_read_b64_tr_b16 v[30:31], v7 offset:64000
s_waitcnt lgkmcnt(6)
v_mfma_f32_32x32x16_bf16 v[32:47], v[16:19], v[120:123], v[32:47]
ds_read_b64_tr_b16 v[16:17], v6 offset:0
ds_read_b64_tr_b16 v[18:19], v6 offset:512
s_waitcnt lgkmcnt(6)
v_mfma_f32_32x32x16_bf16 v[48:63], v[20:23], v[120:123], v[48:63]
ds_read_b64_tr_b16 v[20:21], v6 offset:8192
ds_read_b64_tr_b16 v[22:23], v6 offset:8704
s_waitcnt lgkmcnt(6)
v_mfma_f32_32x32x16_bf16 v[32:47], v[24:27], v[124:127], v[32:47]
ds_read_b64_tr_b16 v[24:25], v6 offset:2048
ds_read_b64_tr_b16 v[26:27], v6 offset:2560
s_waitcnt lgkmcnt(6)
v_mfma_f32_32x32x16_bf16 v[48:63], v[28:31], v[124:127], v[48:63]
ds_read_b64_tr_b16 v[28:29], v6 offset:10240
ds_read_b64_tr_b16 v[30:31], v6 offset:10752
s_waitcnt lgkmcnt(6)
v_mfma_f32_32x32x16_bf16 v[32:47], v[16:19], v[128:131], v[32:47]
ds_read_b64_tr_b16 v[16:17], v6 offset:4096
ds_read_b64_tr_b16 v[18:19], v6 offset:4608
s_waitcnt lgkmcnt(6)
v_mfma_f32_32x32x16_bf16 v[48:63], v[20:23], v[128:131], v[48:63]
ds_read_b64_tr_b16 v[20:21], v6 offset:12288
ds_read_b64_tr_b16 v[22:23], v6 offset:12800
s_waitcnt lgkmcnt(6)
v_mfma_f32_32x32x16_bf16 v[32:47], v[24:27], v[132:135], v[32:47]
ds_read_b64_tr_b16 v[24:25], v6 offset:6144
ds_read_b64_tr_b16 v[26:27], v6 offset:6656
s_waitcnt lgkmcnt(6)
v_mfma_f32_32x32x16_bf16 v[48:63], v[28:31], v[132:135], v[48:63]
s_barrier
ds_read_b64_tr_b16 v[28:29], v6 offset:14336
ds_read_b64_tr_b16 v[30:31], v6 offset:14848
s_waitcnt lgkmcnt(6)
v_mfma_f32_32x32x16_bf16 v[32:47], v[16:19], v[136:139], v[32:47]
ds_read_b64_tr_b16 v[16:17], v4 offset:16384
ds_read_b64_tr_b16 v[18:19], v4 offset:16896
s_waitcnt lgkmcnt(6)
v_mfma_f32_32x32x16_bf16 v[48:63], v[20:23], v[136:139], v[48:63]
ds_read_b64_tr_b16 v[20:21], v4 offset:24576
ds_read_b64_tr_b16 v[22:23], v4 offset:25088
s_waitcnt vmcnt(0)
buffer_store_dword v0, v3, s[24:27], s58 offen offset:0 sc1
s_waitcnt lgkmcnt(6)
v_mfma_f32_32x32x16_bf16 v[32:47], v[24:27], v[140:143], v[32:47]
ds_read_b64_tr_b16 v[24:25], v4 offset:18432
ds_read_b64_tr_b16 v[26:27], v4 offset:18944
s_waitcnt lgkmcnt(6)
v_mfma_f32_32x32x16_bf16 v[48:63], v[28:31], v[140:143], v[48:63]
ds_read_b64_tr_b16 v[28:29], v4 offset:26624
ds_read_b64_tr_b16 v[30:31], v4 offset:27136
s_waitcnt lgkmcnt(6)
v_mfma_f32_32x32x16_bf16 v[64:79], v[16:19], v[144:147], v[64:79]
ds_read_b64_tr_b16 v[16:17], v4 offset:20480
ds_read_b64_tr_b16 v[18:19], v4 offset:20992
s_waitcnt lgkmcnt(6)
v_mfma_f32_32x32x16_bf16 v[80:95], v[20:23], v[144:147], v[80:95]
ds_read_b64_tr_b16 v[20:21], v4 offset:28672
ds_read_b64_tr_b16 v[22:23], v4 offset:29184
s_waitcnt lgkmcnt(6)
v_mfma_f32_32x32x16_bf16 v[64:79], v[24:27], v[148:151], v[64:79]
ds_read_b64_tr_b16 v[24:25], v4 offset:22528
ds_read_b64_tr_b16 v[26:27], v4 offset:23040
s_waitcnt lgkmcnt(6)
v_mfma_f32_32x32x16_bf16 v[80:95], v[28:31], v[148:151], v[80:95]
ds_read_b64_tr_b16 v[28:29], v4 offset:30720
ds_read_b64_tr_b16 v[30:31], v4 offset:31232
s_waitcnt lgkmcnt(6)
v_mfma_f32_32x32x16_bf16 v[64:79], v[16:19], v[152:155], v[64:79]
ds_read_b64_tr_b16 v[16:17], v6 offset:16384
ds_read_b64_tr_b16 v[18:19], v6 offset:16896
s_waitcnt lgkmcnt(6)
v_mfma_f32_32x32x16_bf16 v[80:95], v[20:23], v[152:155], v[80:95]
ds_read_b64_tr_b16 v[20:21], v6 offset:24576
ds_read_b64_tr_b16 v[22:23], v6 offset:25088
s_waitcnt lgkmcnt(6)
v_mfma_f32_32x32x16_bf16 v[64:79], v[24:27], v[156:159], v[64:79]
ds_read_b64_tr_b16 v[24:25], v6 offset:18432
ds_read_b64_tr_b16 v[26:27], v6 offset:18944
s_waitcnt lgkmcnt(6)
v_mfma_f32_32x32x16_bf16 v[80:95], v[28:31], v[156:159], v[80:95]
ds_read_b64_tr_b16 v[28:29], v6 offset:26624
ds_read_b64_tr_b16 v[30:31], v6 offset:27136
s_waitcnt lgkmcnt(6)
v_mfma_f32_32x32x16_bf16 v[32:47], v[16:19], v[144:147], v[32:47]
ds_read_b64_tr_b16 v[16:17], v6 offset:20480
ds_read_b64_tr_b16 v[18:19], v6 offset:20992
s_waitcnt lgkmcnt(6)
v_mfma_f32_32x32x16_bf16 v[48:63], v[20:23], v[144:147], v[48:63]
ds_read_b64_tr_b16 v[20:21], v6 offset:28672
ds_read_b64_tr_b16 v[22:23], v6 offset:29184
s_waitcnt lgkmcnt(6)
v_mfma_f32_32x32x16_bf16 v[32:47], v[24:27], v[148:151], v[32:47]
ds_read_b64_tr_b16 v[24:25], v6 offset:22528
ds_read_b64_tr_b16 v[26:27], v6 offset:23040
s_waitcnt lgkmcnt(6)
v_mfma_f32_32x32x16_bf16 v[48:63], v[28:31], v[148:151], v[48:63]
s_barrier
ds_read_b64_tr_b16 v[28:29], v6 offset:30720
ds_read_b64_tr_b16 v[30:31], v6 offset:31232
s_waitcnt lgkmcnt(6)
v_mfma_f32_32x32x16_bf16 v[32:47], v[16:19], v[152:155], v[32:47]
ds_read_b64_tr_b16 v[16:17], v4 offset:32768
ds_read_b64_tr_b16 v[18:19], v4 offset:33280
s_waitcnt lgkmcnt(6)
v_mfma_f32_32x32x16_bf16 v[48:63], v[20:23], v[152:155], v[48:63]
ds_read_b64_tr_b16 v[20:21], v4 offset:40960
ds_read_b64_tr_b16 v[22:23], v4 offset:41472
s_waitcnt lgkmcnt(6)
v_mfma_f32_32x32x16_bf16 v[32:47], v[24:27], v[156:159], v[32:47]
ds_read_b64_tr_b16 v[24:25], v4 offset:34816
ds_read_b64_tr_b16 v[26:27], v4 offset:35328
s_waitcnt lgkmcnt(6)
v_mfma_f32_32x32x16_bf16 v[48:63], v[28:31], v[156:159], v[48:63]
ds_read_b64_tr_b16 v[28:29], v4 offset:43008
ds_read_b64_tr_b16 v[30:31], v4 offset:43520
s_waitcnt lgkmcnt(6)
v_mfma_f32_32x32x16_bf16 v[64:79], v[16:19], v[160:163], v[64:79]
ds_read_b64_tr_b16 v[16:17], v4 offset:36864
ds_read_b64_tr_b16 v[18:19], v4 offset:37376
s_waitcnt lgkmcnt(6)
v_mfma_f32_32x32x16_bf16 v[80:95], v[20:23], v[160:163], v[80:95]
ds_read_b64_tr_b16 v[20:21], v4 offset:45056
ds_read_b64_tr_b16 v[22:23], v4 offset:45568
s_waitcnt lgkmcnt(6)
v_mfma_f32_32x32x16_bf16 v[64:79], v[24:27], v[164:167], v[64:79]
ds_read_b64_tr_b16 v[24:25], v4 offset:38912
ds_read_b64_tr_b16 v[26:27], v4 offset:39424
s_waitcnt lgkmcnt(6)
v_mfma_f32_32x32x16_bf16 v[80:95], v[28:31], v[164:167], v[80:95]
ds_read_b64_tr_b16 v[28:29], v4 offset:47104
ds_read_b64_tr_b16 v[30:31], v4 offset:47616
s_waitcnt lgkmcnt(6)
v_mfma_f32_32x32x16_bf16 v[64:79], v[16:19], v[168:171], v[64:79]
ds_read_b64_tr_b16 v[16:17], v6 offset:32768
ds_read_b64_tr_b16 v[18:19], v6 offset:33280
s_waitcnt lgkmcnt(6)
v_mfma_f32_32x32x16_bf16 v[80:95], v[20:23], v[168:171], v[80:95]
ds_read_b64_tr_b16 v[20:21], v6 offset:40960
ds_read_b64_tr_b16 v[22:23], v6 offset:41472
s_waitcnt lgkmcnt(6)
v_mfma_f32_32x32x16_bf16 v[64:79], v[24:27], v[172:175], v[64:79]
ds_read_b64_tr_b16 v[24:25], v6 offset:34816
ds_read_b64_tr_b16 v[26:27], v6 offset:35328
s_waitcnt lgkmcnt(6)
v_mfma_f32_32x32x16_bf16 v[80:95], v[28:31], v[172:175], v[80:95]
ds_read_b64_tr_b16 v[28:29], v6 offset:43008
ds_read_b64_tr_b16 v[30:31], v6 offset:43520
s_waitcnt lgkmcnt(6)
v_mfma_f32_32x32x16_bf16 v[32:47], v[16:19], v[160:163], v[32:47]
ds_read_b64_tr_b16 v[16:17], v6 offset:36864
ds_read_b64_tr_b16 v[18:19], v6 offset:37376
s_waitcnt lgkmcnt(6)
v_mfma_f32_32x32x16_bf16 v[48:63], v[20:23], v[160:163], v[48:63]
ds_read_b64_tr_b16 v[20:21], v6 offset:45056
ds_read_b64_tr_b16 v[22:23], v6 offset:45568
s_waitcnt lgkmcnt(6)
v_mfma_f32_32x32x16_bf16 v[32:47], v[24:27], v[164:167], v[32:47]
ds_read_b64_tr_b16 v[24:25], v6 offset:38912
ds_read_b64_tr_b16 v[26:27], v6 offset:39424
s_waitcnt lgkmcnt(6)
v_mfma_f32_32x32x16_bf16 v[48:63], v[28:31], v[164:167], v[48:63]
s_barrier
ds_read_b64_tr_b16 v[28:29], v6 offset:47104
ds_read_b64_tr_b16 v[30:31], v6 offset:47616
s_waitcnt lgkmcnt(6)
v_mfma_f32_32x32x16_bf16 v[32:47], v[16:19], v[168:171], v[32:47]
ds_read_b64_tr_b16 v[16:17], v4 offset:49152
ds_read_b64_tr_b16 v[18:19], v4 offset:49664
s_waitcnt lgkmcnt(6)
v_mfma_f32_32x32x16_bf16 v[48:63], v[20:23], v[168:171], v[48:63]
ds_read_b64_tr_b16 v[20:21], v4 offset:57344
ds_read_b64_tr_b16 v[22:23], v4 offset:57856
s_waitcnt lgkmcnt(6)
v_mfma_f32_32x32x16_bf16 v[32:47], v[24:27], v[172:175], v[32:47]
ds_read_b64_tr_b16 v[24:25], v4 offset:51200
ds_read_b64_tr_b16 v[26:27], v4 offset:51712
s_waitcnt lgkmcnt(6)
v_mfma_f32_32x32x16_bf16 v[48:63], v[28:31], v[172:175], v[48:63]
ds_read_b64_tr_b16 v[28:29], v4 offset:59392
ds_read_b64_tr_b16 v[30:31], v4 offset:59904
s_waitcnt lgkmcnt(6)
v_mfma_f32_32x32x16_bf16 v[64:79], v[16:19], v[176:179], v[64:79]
ds_read_b64_tr_b16 v[16:17], v4 offset:53248
ds_read_b64_tr_b16 v[18:19], v4 offset:53760
s_waitcnt lgkmcnt(6)
v_mfma_f32_32x32x16_bf16 v[80:95], v[20:23], v[176:179], v[80:95]
ds_read_b64_tr_b16 v[20:21], v4 offset:61440
ds_read_b64_tr_b16 v[22:23], v4 offset:61952
s_waitcnt lgkmcnt(6)
v_mfma_f32_32x32x16_bf16 v[64:79], v[24:27], v[180:183], v[64:79]
ds_read_b64_tr_b16 v[24:25], v4 offset:55296
ds_read_b64_tr_b16 v[26:27], v4 offset:55808
s_waitcnt lgkmcnt(6)
v_mfma_f32_32x32x16_bf16 v[80:95], v[28:31], v[180:183], v[80:95]
ds_read_b64_tr_b16 v[28:29], v4 offset:63488
ds_read_b64_tr_b16 v[30:31], v4 offset:64000
s_waitcnt lgkmcnt(6)
v_mfma_f32_32x32x16_bf16 v[64:79], v[16:19], v[184:187], v[64:79]
ds_read_b64_tr_b16 v[16:17], v6 offset:49152
ds_read_b64_tr_b16 v[18:19], v6 offset:49664
s_waitcnt lgkmcnt(6)
v_mfma_f32_32x32x16_bf16 v[80:95], v[20:23], v[184:187], v[80:95]
ds_read_b64_tr_b16 v[20:21], v6 offset:57344
ds_read_b64_tr_b16 v[22:23], v6 offset:57856
s_waitcnt lgkmcnt(6)
v_mfma_f32_32x32x16_bf16 v[64:79], v[24:27], v[188:191], v[64:79]
ds_read_b64_tr_b16 v[24:25], v6 offset:51200
ds_read_b64_tr_b16 v[26:27], v6 offset:51712
s_waitcnt lgkmcnt(6)
v_mfma_f32_32x32x16_bf16 v[80:95], v[28:31], v[188:191], v[80:95]
ds_read_b64_tr_b16 v[28:29], v6 offset:59392
ds_read_b64_tr_b16 v[30:31], v6 offset:59904
s_waitcnt lgkmcnt(6)
v_mfma_f32_32x32x16_bf16 v[32:47], v[16:19], v[176:179], v[32:47]
ds_read_b64_tr_b16 v[16:17], v6 offset:53248
ds_read_b64_tr_b16 v[18:19], v6 offset:53760
s_waitcnt lgkmcnt(6)
v_mfma_f32_32x32x16_bf16 v[48:63], v[20:23], v[176:179], v[48:63]
ds_read_b64_tr_b16 v[20:21], v6 offset:61440
ds_read_b64_tr_b16 v[22:23], v6 offset:61952
s_waitcnt lgkmcnt(6)
v_mfma_f32_32x32x16_bf16 v[32:47], v[24:27], v[180:183], v[32:47]
ds_read_b64_tr_b16 v[24:25], v6 offset:55296
ds_read_b64_tr_b16 v[26:27], v6 offset:55808
s_waitcnt lgkmcnt(6)
v_mfma_f32_32x32x16_bf16 v[48:63], v[28:31], v[180:183], v[48:63]
s_barrier
ds_read_b64_tr_b16 v[28:29], v6 offset:63488
ds_read_b64_tr_b16 v[30:31], v6 offset:64000
s_waitcnt lgkmcnt(6)
v_mfma_f32_32x32x16_bf16 v[32:47], v[16:19], v[184:187], v[32:47]
ds_read_b64_tr_b16 v[16:17], v5 offset:0
ds_read_b64_tr_b16 v[18:19], v5 offset:512
s_waitcnt lgkmcnt(6)
v_mfma_f32_32x32x16_bf16 v[48:63], v[20:23], v[184:187], v[48:63]
ds_read_b64_tr_b16 v[20:21], v5 offset:8192
ds_read_b64_tr_b16 v[22:23], v5 offset:8704
s_waitcnt lgkmcnt(6)
v_mfma_f32_32x32x16_bf16 v[32:47], v[24:27], v[188:191], v[32:47]
ds_read_b64_tr_b16 v[24:25], v5 offset:2048
ds_read_b64_tr_b16 v[26:27], v5 offset:2560
s_waitcnt lgkmcnt(6)
v_mfma_f32_32x32x16_bf16 v[48:63], v[28:31], v[188:191], v[48:63]
ds_read_b64_tr_b16 v[28:29], v5 offset:10240
ds_read_b64_tr_b16 v[30:31], v5 offset:10752
s_waitcnt lgkmcnt(6)
v_mfma_f32_32x32x16_bf16 v[64:79], v[16:19], v[192:195], v[64:79]
ds_read_b64_tr_b16 v[16:17], v5 offset:4096
ds_read_b64_tr_b16 v[18:19], v5 offset:4608
s_waitcnt lgkmcnt(6)
v_mfma_f32_32x32x16_bf16 v[80:95], v[20:23], v[192:195], v[80:95]
ds_read_b64_tr_b16 v[20:21], v5 offset:12288
ds_read_b64_tr_b16 v[22:23], v5 offset:12800
s_waitcnt lgkmcnt(6)
v_mfma_f32_32x32x16_bf16 v[64:79], v[24:27], v[196:199], v[64:79]
ds_read_b64_tr_b16 v[24:25], v5 offset:6144
ds_read_b64_tr_b16 v[26:27], v5 offset:6656
s_waitcnt lgkmcnt(6)
v_mfma_f32_32x32x16_bf16 v[80:95], v[28:31], v[196:199], v[80:95]
ds_read_b64_tr_b16 v[28:29], v5 offset:14336
ds_read_b64_tr_b16 v[30:31], v5 offset:14848
s_waitcnt lgkmcnt(6)
v_mfma_f32_32x32x16_bf16 v[64:79], v[16:19], v[200:203], v[64:79]
ds_read_b64_tr_b16 v[16:17], v7 offset:0
ds_read_b64_tr_b16 v[18:19], v7 offset:512
s_waitcnt lgkmcnt(6)
v_mfma_f32_32x32x16_bf16 v[80:95], v[20:23], v[200:203], v[80:95]
ds_read_b64_tr_b16 v[20:21], v7 offset:8192
ds_read_b64_tr_b16 v[22:23], v7 offset:8704
s_waitcnt lgkmcnt(6)
v_mfma_f32_32x32x16_bf16 v[64:79], v[24:27], v[204:207], v[64:79]
ds_read_b64_tr_b16 v[24:25], v7 offset:2048
ds_read_b64_tr_b16 v[26:27], v7 offset:2560
s_waitcnt lgkmcnt(6)
v_mfma_f32_32x32x16_bf16 v[80:95], v[28:31], v[204:207], v[80:95]
ds_read_b64_tr_b16 v[28:29], v7 offset:10240
ds_read_b64_tr_b16 v[30:31], v7 offset:10752
s_waitcnt lgkmcnt(6)
v_mfma_f32_32x32x16_bf16 v[32:47], v[16:19], v[192:195], v[32:47]
ds_read_b64_tr_b16 v[16:17], v7 offset:4096
ds_read_b64_tr_b16 v[18:19], v7 offset:4608
s_waitcnt lgkmcnt(6)
v_mfma_f32_32x32x16_bf16 v[48:63], v[20:23], v[192:195], v[48:63]
ds_read_b64_tr_b16 v[20:21], v7 offset:12288
ds_read_b64_tr_b16 v[22:23], v7 offset:12800
s_waitcnt lgkmcnt(6)
v_mfma_f32_32x32x16_bf16 v[32:47], v[24:27], v[196:199], v[32:47]
ds_read_b64_tr_b16 v[24:25], v7 offset:6144
ds_read_b64_tr_b16 v[26:27], v7 offset:6656
s_waitcnt lgkmcnt(6)
v_mfma_f32_32x32x16_bf16 v[48:63], v[28:31], v[196:199], v[48:63]
ds_read_b64_tr_b16 v[28:29], v7 offset:14336
ds_read_b64_tr_b16 v[30:31], v7 offset:14848
s_waitcnt lgkmcnt(6)
v_mfma_f32_32x32x16_bf16 v[32:47], v[16:19], v[200:203], v[32:47]
ds_read_b64_tr_b16 v[16:17], v5 offset:16384
ds_read_b64_tr_b16 v[18:19], v5 offset:16896
s_waitcnt lgkmcnt(6)
v_mfma_f32_32x32x16_bf16 v[48:63], v[20:23], v[200:203], v[48:63]
ds_read_b64_tr_b16 v[20:21], v5 offset:24576
ds_read_b64_tr_b16 v[22:23], v5 offset:25088
s_waitcnt lgkmcnt(6)
v_mfma_f32_32x32x16_bf16 v[32:47], v[24:27], v[204:207], v[32:47]
ds_read_b64_tr_b16 v[24:25], v5 offset:18432
ds_read_b64_tr_b16 v[26:27], v5 offset:18944
s_waitcnt lgkmcnt(6)
v_mfma_f32_32x32x16_bf16 v[48:63], v[28:31], v[204:207], v[48:63]
ds_read_b64_tr_b16 v[28:29], v5 offset:26624
ds_read_b64_tr_b16 v[30:31], v5 offset:27136
ds_write_b32 v13, v14
s_waitcnt lgkmcnt(7)
v_mfma_f32_32x32x16_bf16 v[64:79], v[16:19], v[208:211], v[64:79]
ds_read_b64_tr_b16 v[16:17], v5 offset:20480
ds_read_b64_tr_b16 v[18:19], v5 offset:20992
s_waitcnt lgkmcnt(7)
v_mfma_f32_32x32x16_bf16 v[80:95], v[20:23], v[208:211], v[80:95]
ds_read_b64_tr_b16 v[20:21], v5 offset:28672
ds_read_b64_tr_b16 v[22:23], v5 offset:29184
s_waitcnt lgkmcnt(7)
v_mfma_f32_32x32x16_bf16 v[64:79], v[24:27], v[212:215], v[64:79]
ds_read_b64_tr_b16 v[24:25], v5 offset:22528
ds_read_b64_tr_b16 v[26:27], v5 offset:23040
s_waitcnt lgkmcnt(7)
v_mfma_f32_32x32x16_bf16 v[80:95], v[28:31], v[212:215], v[80:95]
ds_read_b64_tr_b16 v[28:29], v5 offset:30720
ds_read_b64_tr_b16 v[30:31], v5 offset:31232
s_waitcnt lgkmcnt(6)
v_mfma_f32_32x32x16_bf16 v[64:79], v[16:19], v[216:219], v[64:79]
ds_read_b64_tr_b16 v[16:17], v5 offset:32768
ds_read_b64_tr_b16 v[18:19], v5 offset:33280
s_waitcnt lgkmcnt(6)
v_mfma_f32_32x32x16_bf16 v[80:95], v[20:23], v[216:219], v[80:95]
ds_read_b64_tr_b16 v[20:21], v5 offset:40960
ds_read_b64_tr_b16 v[22:23], v5 offset:41472
s_waitcnt lgkmcnt(6)
v_mfma_f32_32x32x16_bf16 v[64:79], v[24:27], v[220:223], v[64:79]
ds_read_b64_tr_b16 v[24:25], v5 offset:34816
ds_read_b64_tr_b16 v[26:27], v5 offset:35328
s_waitcnt lgkmcnt(6)
v_mfma_f32_32x32x16_bf16 v[80:95], v[28:31], v[220:223], v[80:95]
ds_read_b64_tr_b16 v[28:29], v5 offset:43008
ds_read_b64_tr_b16 v[30:31], v5 offset:43520
s_waitcnt lgkmcnt(6)
v_mfma_f32_32x32x16_bf16 v[64:79], v[16:19], v[224:227], v[64:79]
ds_read_b64_tr_b16 v[16:17], v5 offset:36864
ds_read_b64_tr_b16 v[18:19], v5 offset:37376
s_waitcnt lgkmcnt(6)
v_mfma_f32_32x32x16_bf16 v[80:95], v[20:23], v[224:227], v[80:95]
ds_read_b64_tr_b16 v[20:21], v5 offset:45056
ds_read_b64_tr_b16 v[22:23], v5 offset:45568
s_waitcnt lgkmcnt(6)
v_mfma_f32_32x32x16_bf16 v[64:79], v[24:27], v[228:231], v[64:79]
ds_read_b64_tr_b16 v[24:25], v5 offset:38912
ds_read_b64_tr_b16 v[26:27], v5 offset:39424
s_waitcnt lgkmcnt(6)
v_mfma_f32_32x32x16_bf16 v[80:95], v[28:31], v[228:231], v[80:95]
ds_read_b64_tr_b16 v[28:29], v5 offset:47104
ds_read_b64_tr_b16 v[30:31], v5 offset:47616
s_waitcnt lgkmcnt(6)
v_mfma_f32_32x32x16_bf16 v[64:79], v[16:19], v[232:235], v[64:79]
ds_read_b64_tr_b16 v[16:17], v5 offset:49152
ds_read_b64_tr_b16 v[18:19], v5 offset:49664
s_waitcnt lgkmcnt(6)
v_mfma_f32_32x32x16_bf16 v[80:95], v[20:23], v[232:235], v[80:95]
ds_read_b64_tr_b16 v[20:21], v5 offset:57344
ds_read_b64_tr_b16 v[22:23], v5 offset:57856
s_waitcnt lgkmcnt(6)
v_mfma_f32_32x32x16_bf16 v[64:79], v[24:27], v[236:239], v[64:79]
ds_read_b64_tr_b16 v[24:25], v5 offset:51200
ds_read_b64_tr_b16 v[26:27], v5 offset:51712
s_waitcnt lgkmcnt(6)
v_mfma_f32_32x32x16_bf16 v[80:95], v[28:31], v[236:239], v[80:95]
ds_read_b64_tr_b16 v[28:29], v5 offset:59392
ds_read_b64_tr_b16 v[30:31], v5 offset:59904
s_waitcnt lgkmcnt(6)
v_mfma_f32_32x32x16_bf16 v[64:79], v[16:19], v[240:243], v[64:79]
ds_read_b64_tr_b16 v[16:17], v5 offset:53248
ds_read_b64_tr_b16 v[18:19], v5 offset:53760
s_waitcnt lgkmcnt(6)
v_mfma_f32_32x32x16_bf16 v[80:95], v[20:23], v[240:243], v[80:95]
ds_read_b64_tr_b16 v[20:21], v5 offset:61440
ds_read_b64_tr_b16 v[22:23], v5 offset:61952
s_waitcnt lgkmcnt(6)
v_mfma_f32_32x32x16_bf16 v[64:79], v[24:27], v[244:247], v[64:79]
ds_read_b64_tr_b16 v[24:25], v5 offset:55296
ds_read_b64_tr_b16 v[26:27], v5 offset:55808
s_waitcnt lgkmcnt(6)
v_mfma_f32_32x32x16_bf16 v[80:95], v[28:31], v[244:247], v[80:95]
ds_read_b64_tr_b16 v[28:29], v5 offset:63488
ds_read_b64_tr_b16 v[30:31], v5 offset:64000
s_waitcnt lgkmcnt(6)
v_mfma_f32_32x32x16_bf16 v[64:79], v[16:19], v[248:251], v[64:79]
ds_read_b64_tr_b16 v[16:17], v7 offset:16384
ds_read_b64_tr_b16 v[18:19], v7 offset:16896
s_waitcnt lgkmcnt(6)
v_mfma_f32_32x32x16_bf16 v[80:95], v[20:23], v[248:251], v[80:95]
ds_read_b64_tr_b16 v[20:21], v7 offset:24576
ds_read_b64_tr_b16 v[22:23], v7 offset:25088
s_waitcnt lgkmcnt(6)
v_mfma_f32_32x32x16_bf16 v[64:79], v[24:27], v[252:255], v[64:79]
ds_read_b64_tr_b16 v[24:25], v7 offset:18432
ds_read_b64_tr_b16 v[26:27], v7 offset:18944
s_waitcnt lgkmcnt(6)
v_mfma_f32_32x32x16_bf16 v[80:95], v[28:31], v[252:255], v[80:95]
ds_read_b64_tr_b16 v[28:29], v7 offset:26624
ds_read_b64_tr_b16 v[30:31], v7 offset:27136
s_waitcnt lgkmcnt(6)
v_mfma_f32_32x32x16_bf16 v[32:47], v[16:19], v[208:211], v[32:47]
ds_read_b64_tr_b16 v[16:17], v7 offset:20480
ds_read_b64_tr_b16 v[18:19], v7 offset:20992
s_waitcnt lgkmcnt(6)
v_mfma_f32_32x32x16_bf16 v[48:63], v[20:23], v[208:211], v[48:63]
ds_read_b64_tr_b16 v[20:21], v7 offset:28672
ds_read_b64_tr_b16 v[22:23], v7 offset:29184
s_waitcnt lgkmcnt(6)
v_mfma_f32_32x32x16_bf16 v[32:47], v[24:27], v[212:215], v[32:47]
ds_read_b64_tr_b16 v[24:25], v7 offset:22528
ds_read_b64_tr_b16 v[26:27], v7 offset:23040
s_waitcnt lgkmcnt(6)
v_mfma_f32_32x32x16_bf16 v[48:63], v[28:31], v[212:215], v[48:63]
ds_read_b64_tr_b16 v[28:29], v7 offset:30720
ds_read_b64_tr_b16 v[30:31], v7 offset:31232
v_max_f32 v64, 0, v64
v_mul_f32 v64, v64, v80
v_max_f32 v65, 0, v65
s_waitcnt lgkmcnt(6)
v_mfma_f32_32x32x16_bf16 v[32:47], v[16:19], v[216:219], v[32:47]
ds_read_b64_tr_b16 v[16:17], v7 offset:32768
ds_read_b64_tr_b16 v[18:19], v7 offset:33280
v_mul_f32 v65, v65, v81
v_max_f32 v66, 0, v66
v_mul_f32 v66, v66, v82
s_waitcnt lgkmcnt(6)
v_mfma_f32_32x32x16_bf16 v[48:63], v[20:23], v[216:219], v[48:63]
ds_read_b64_tr_b16 v[20:21], v7 offset:40960
ds_read_b64_tr_b16 v[22:23], v7 offset:41472
v_max_f32 v67, 0, v67
v_mul_f32 v67, v67, v83
v_max_f32 v68, 0, v68
s_waitcnt lgkmcnt(6)
v_mfma_f32_32x32x16_bf16 v[32:47], v[24:27], v[220:223], v[32:47]
ds_read_b64_tr_b16 v[24:25], v7 offset:34816
ds_read_b64_tr_b16 v[26:27], v7 offset:35328
v_mul_f32 v68, v68, v84
v_max_f32 v69, 0, v69
v_mul_f32 v69, v69, v85
s_waitcnt lgkmcnt(6)
v_mfma_f32_32x32x16_bf16 v[48:63], v[28:31], v[220:223], v[48:63]
ds_read_b64_tr_b16 v[28:29], v7 offset:43008
ds_read_b64_tr_b16 v[30:31], v7 offset:43520
v_max_f32 v70, 0, v70
v_mul_f32 v70, v70, v86
v_max_f32 v71, 0, v71
s_waitcnt lgkmcnt(6)
v_mfma_f32_32x32x16_bf16 v[32:47], v[16:19], v[224:227], v[32:47]
ds_read_b64_tr_b16 v[16:17], v7 offset:36864
ds_read_b64_tr_b16 v[18:19], v7 offset:37376
v_mul_f32 v71, v71, v87
v_cvt_pk_bf16_f32 v64, v64, v65
v_cvt_pk_bf16_f32 v65, v66, v67
s_waitcnt lgkmcnt(6)
v_mfma_f32_32x32x16_bf16 v[48:63], v[20:23], v[224:227], v[48:63]
ds_read_b64_tr_b16 v[20:21], v7 offset:45056
ds_read_b64_tr_b16 v[22:23], v7 offset:45568
v_cvt_pk_bf16_f32 v66, v68, v69
v_cvt_pk_bf16_f32 v67, v70, v71
buffer_store_dwordx4 v[64:67], v12, s[24:27], s70 offen offset:0 sc1
s_waitcnt lgkmcnt(6)
v_mfma_f32_32x32x16_bf16 v[32:47], v[24:27], v[228:231], v[32:47]
ds_read_b64_tr_b16 v[24:25], v7 offset:38912
ds_read_b64_tr_b16 v[26:27], v7 offset:39424
v_max_f32 v72, 0, v72
v_mul_f32 v72, v72, v88
v_max_f32 v73, 0, v73
s_waitcnt lgkmcnt(6)
v_mfma_f32_32x32x16_bf16 v[48:63], v[28:31], v[228:231], v[48:63]
ds_read_b64_tr_b16 v[28:29], v7 offset:47104
ds_read_b64_tr_b16 v[30:31], v7 offset:47616
v_mul_f32 v73, v73, v89
v_max_f32 v74, 0, v74
v_mul_f32 v74, v74, v90
s_waitcnt lgkmcnt(6)
v_mfma_f32_32x32x16_bf16 v[32:47], v[16:19], v[232:235], v[32:47]
ds_read_b64_tr_b16 v[16:17], v7 offset:49152
ds_read_b64_tr_b16 v[18:19], v7 offset:49664
v_max_f32 v75, 0, v75
v_mul_f32 v75, v75, v91
v_max_f32 v76, 0, v76
s_waitcnt lgkmcnt(6)
v_mfma_f32_32x32x16_bf16 v[48:63], v[20:23], v[232:235], v[48:63]
ds_read_b64_tr_b16 v[20:21], v7 offset:57344
ds_read_b64_tr_b16 v[22:23], v7 offset:57856
v_mul_f32 v76, v76, v92
v_max_f32 v77, 0, v77
v_mul_f32 v77, v77, v93
s_waitcnt lgkmcnt(6)
v_mfma_f32_32x32x16_bf16 v[32:47], v[24:27], v[236:239], v[32:47]
ds_read_b64_tr_b16 v[24:25], v7 offset:51200
ds_read_b64_tr_b16 v[26:27], v7 offset:51712
v_max_f32 v78, 0, v78
v_mul_f32 v78, v78, v94
v_max_f32 v79, 0, v79
s_waitcnt lgkmcnt(6)
v_mfma_f32_32x32x16_bf16 v[48:63], v[28:31], v[236:239], v[48:63]
ds_read_b64_tr_b16 v[28:29], v7 offset:59392
ds_read_b64_tr_b16 v[30:31], v7 offset:59904
v_mul_f32 v79, v79, v95
v_cvt_pk_bf16_f32 v72, v72, v73
v_cvt_pk_bf16_f32 v73, v74, v75
s_waitcnt lgkmcnt(6)
v_mfma_f32_32x32x16_bf16 v[32:47], v[16:19], v[240:243], v[32:47]
ds_read_b64_tr_b16 v[16:17], v7 offset:53248
ds_read_b64_tr_b16 v[18:19], v7 offset:53760
v_cvt_pk_bf16_f32 v74, v76, v77
v_cvt_pk_bf16_f32 v75, v78, v79
buffer_store_dwordx4 v[72:75], v12, s[24:27], s70 offen offset:1024 sc1
s_waitcnt lgkmcnt(6)
v_mfma_f32_32x32x16_bf16 v[48:63], v[20:23], v[240:243], v[48:63]
ds_read_b64_tr_b16 v[20:21], v7 offset:61440
ds_read_b64_tr_b16 v[22:23], v7 offset:61952
s_waitcnt lgkmcnt(6)
v_mfma_f32_32x32x16_bf16 v[32:47], v[24:27], v[244:247], v[32:47]
ds_read_b64_tr_b16 v[24:25], v7 offset:55296
ds_read_b64_tr_b16 v[26:27], v7 offset:55808
s_waitcnt lgkmcnt(6)
v_mfma_f32_32x32x16_bf16 v[48:63], v[28:31], v[244:247], v[48:63]
ds_read_b64_tr_b16 v[28:29], v7 offset:63488
ds_read_b64_tr_b16 v[30:31], v7 offset:64000
s_waitcnt lgkmcnt(6)
v_mfma_f32_32x32x16_bf16 v[32:47], v[16:19], v[248:251], v[32:47]
s_waitcnt lgkmcnt(4)
v_mfma_f32_32x32x16_bf16 v[48:63], v[20:23], v[248:251], v[48:63]
s_waitcnt lgkmcnt(2)
v_mfma_f32_32x32x16_bf16 v[32:47], v[24:27], v[252:255], v[32:47]
s_waitcnt lgkmcnt(0)
v_mfma_f32_32x32x16_bf16 v[48:63], v[28:31], v[252:255], v[48:63]
s_nop 7
s_nop 3
v_max_f32 v32, 0, v32
v_mul_f32 v32, v32, v48
v_max_f32 v33, 0, v33
v_mul_f32 v33, v33, v49
v_max_f32 v34, 0, v34
v_mul_f32 v34, v34, v50
v_max_f32 v35, 0, v35
v_mul_f32 v35, v35, v51
v_max_f32 v36, 0, v36
v_mul_f32 v36, v36, v52
v_max_f32 v37, 0, v37
v_mul_f32 v37, v37, v53
v_max_f32 v38, 0, v38
v_mul_f32 v38, v38, v54
v_max_f32 v39, 0, v39
v_mul_f32 v39, v39, v55
v_cvt_pk_bf16_f32 v32, v32, v33
v_cvt_pk_bf16_f32 v33, v34, v35
v_cvt_pk_bf16_f32 v34, v36, v37
v_cvt_pk_bf16_f32 v35, v38, v39
buffer_store_dwordx4 v[32:35], v12, s[24:27], s70 offen offset:2048 sc1
v_max_f32 v40, 0, v40
v_mul_f32 v40, v40, v56
v_max_f32 v41, 0, v41
v_mul_f32 v41, v41, v57
v_max_f32 v42, 0, v42
v_mul_f32 v42, v42, v58
v_max_f32 v43, 0, v43
v_mul_f32 v43, v43, v59
v_max_f32 v44, 0, v44
v_mul_f32 v44, v44, v60
v_max_f32 v45, 0, v45
v_mul_f32 v45, v45, v61
v_max_f32 v46, 0, v46
v_mul_f32 v46, v46, v62
v_max_f32 v47, 0, v47
v_mul_f32 v47, v47, v63
v_cvt_pk_bf16_f32 v40, v40, v41
v_cvt_pk_bf16_f32 v41, v42, v43
v_cvt_pk_bf16_f32 v42, v44, v45
v_cvt_pk_bf16_f32 v43, v46, v47
buffer_store_dwordx4 v[40:43], v12, s[24:27], s70 offen offset:3072 sc1
s_branch F_att
F_att:
s_and_b32 s61, s2, 7
s_lshr_b32 s60, s2, 3
s_mov_b32 s62, 0
s_mov_b32 s63, s3
v_lshrrev_b32 v247, 5, v2
v_and_b32 v248, 31, v2
s_and_b32 s64, s63, 1
s_lshr_b32 s65, s63, 1
s_cmp_eq_u32 s64, 0
s_cselect_b64 s[68:69], -1, 0
s_cselect_b32 s66, -1, 0
s_cselect_b32 s67, 0, -1
s_mul_i32 s40, s65, 5
s_mul_i32 s41, s64, 3
s_add_u32 s41, s41, s40
s_add_u32 s40, s40, 2
s_mul_i32 s42, s62, 5120
s_lshl_b32 s41, s41, 9
s_add_u32 s41, s41, s42
s_lshl_b32 s40, s40, 9
s_add_u32 s40, s40, s42
v_lshlrev_b32 v240, 3, v2
v_add_u32 v241, s40, v240
v_add_u32 v240, s41, v240
v_subrev_u32 v242, 4, v248
v_cmp_gt_u32 vcc, 16, v248
s_nop 1
v_cndmask_b32 v242, v242, v248, vcc
v_cndmask_b32 v242, v242, v248, s[68:69]
v_cmp_le_u32 s[42:43], 20, v248
v_cmp_le_u32 s[44:45], 16, v248
v_cmp_le_u32 s[46:47], 24, v248
s_andn2_b64 s[44:45], s[44:45], s[42:43]
s_or_b64 s[44:45], s[44:45], s[46:47]
s_cmp_eq_u32 s64, 0
s_cselect_b64 s[42:43], s[42:43], s[44:45]
s_mul_i32 s44, s63, 20
v_add_u32 v242, s44, v242
v_lshlrev_b32 v242, 4, v242
v_mul_u32_u24 v243, 1280, v247
v_add_u32 v242, v242, v243
s_mul_i32 s44, s62, 5120
s_add_u32 s44, s44, 61952
v_add_u32 v242, s44, v242
v_mov_b32 v243, 113152
v_cndmask_b32 v242, v242, v243, s[42:43]
v_mov_b32 v243, 2560
v_cndmask_b32 v243, v243, 0, s[42:43]
v_lshlrev_b32 v247, 2, v247
v_sub_u32 v247, v248, v247
v_cmp_gt_i32 s[70:71], 0, v247
v_cmp_gt_i32 s[72:73], 1, v247
v_cmp_gt_i32 s[74:75], 2, v247
v_cmp_gt_i32 s[76:77], 3, v247
v_cmp_gt_i32 s[78:79], 8, v247
v_cmp_gt_i32 s[80:81], 9, v247
v_cmp_gt_i32 s[82:83], 10, v247
v_cmp_gt_i32 s[84:85], 11, v247
v_cmp_gt_i32 s[86:87], 16, v247
v_cmp_gt_i32 s[88:89], 17, v247
v_cmp_gt_i32 s[90:91], 18, v247
v_cmp_gt_i32 s[92:93], 19, v247
v_cmp_gt_i32 s[94:95], 24, v247
v_cmp_gt_i32 s[96:97], 25, v247
v_cmp_gt_i32 s[98:99], 26, v247
v_cmp_gt_i32 s[100:101], 27, v247
v_mov_b32 v248, 0xffff0000
v_mov_b32 v244, 0xff800000
v_cndmask_b32 v232, 0, v248, s[72:73]
v_cndmask_b32 v233, 0, v248, s[76:77]
v_cndmask_b32 v234, 0, v248, s[80:81]
v_cndmask_b32 v235, 0, v248, s[84:85]
v_cndmask_b32 v236, 0, v248, s[88:89]
v_cndmask_b32 v237, 0, v248, s[92:93]
v_cndmask_b32 v238, 0, v248, s[96:97]
v_cndmask_b32 v239, 0, v248, s[100:101]
v_cndmask_b32 v232, v232, -1, s[70:71]
v_cndmask_b32 v233, v233, -1, s[74:75]
v_cndmask_b32 v234, v234, -1, s[78:79]
v_cndmask_b32 v235, v235, -1, s[82:83]
v_cndmask_b32 v236, v236, -1, s[86:87]
v_cndmask_b32 v237, v237, -1, s[90:91]
v_cndmask_b32 v238, v238, -1, s[94:95]
v_cndmask_b32 v239, v239, -1, s[98:99]
v_lshlrev_b32 v249, 4, v2
s_lshl_b32 s44, s65, 3
v_add_u32 v250, s44, v249
s_waitcnt vmcnt(0)
buffer_store_dword v0, v3, s[24:27], s58 offen offset:384 sc1
s_barrier
s_lshl_b32 s40, s60, 3
s_add_u32 s40, s40, s61
s_lshl_b32 s40, s40, 2
s_add_u32 s40, s40, s3
s_lshl_b32 s40, s40, 7
s_add_u32 s58, s40, 131072
s_mov_b32 s59, 0
F_task:
ds_read2st64_b64 v[208:211], v240 offset0:1 offset1:2
ds_read_b64 v[212:213], v241 offset:512
ds_read2st64_b64 v[8:11], v240 offset0:21 offset1:22
ds_read2st64_b64 v[44:47], v241 offset0:21 offset1:31
ds_read2st64_b64 v[12:15], v240 offset0:31 offset1:32
ds_read2st64_b64 v[16:19], v240 offset0:41 offset1:42
ds_read2st64_b64 v[48:51], v241 offset0:41 offset1:51
ds_read2st64_b64 v[20:23], v240 offset0:51 offset1:52
ds_read2st64_b64 v[24:27], v240 offset0:61 offset1:62
ds_read2st64_b64 v[52:55], v241 offset0:61 offset1:71
ds_read2st64_b64 v[28:31], v240 offset0:71 offset1:72
ds_read2st64_b64 v[32:35], v240 offset0:81 offset1:82
ds_read2st64_b64 v[56:59], v241 offset0:81 offset1:91
s_waitcnt lgkmcnt(11)
v_cndmask_b32 v212, 0, v212, s[66:67]
v_cndmask_b32 v213, 0, v213, s[66:67]
ds_read2st64_b64 v[36:39], v240 offset0:91 offset1:92
ds_read2st64_b64 v[40:43], v240 offset0:101 offset1:102
ds_read_b64 v[60:61], v241 offset:51712
s_waitcnt lgkmcnt(12)
v_mfma_f32_32x32x16_bf16 v[64:79], v[8:11], v[208:211], 0
v_mfma_f32_32x32x8_bf16 v[64:79], v[44:45], v[212:213], v[64:79]
s_waitcnt lgkmcnt(0)
v_mfma_f32_32x32x16_bf16 v[192:207], v[40:43], v[208:211], 0
v_mfma_f32_32x32x8_bf16 v[192:207], v[60:61], v[212:213], v[192:207]
s_waitcnt lgkmcnt(11)
v_mfma_f32_32x32x16_bf16 v[80:95], v[12:15], v[208:211], 0
v_mfma_f32_32x32x8_bf16 v[80:95], v[46:47], v[212:213], v[80:95]
s_waitcnt lgkmcnt(9)
v_mfma_f32_32x32x16_bf16 v[96:111], v[16:19], v[208:211], 0
v_mfma_f32_32x32x8_bf16 v[96:111], v[48:49], v[212:213], v[96:111]
s_waitcnt lgkmcnt(8)
v_mfma_f32_32x32x16_bf16 v[112:127], v[20:23], v[208:211], 0
v_mfma_f32_32x32x8_bf16 v[112:127], v[50:51], v[212:213], v[112:127]
s_waitcnt lgkmcnt(6)
v_mfma_f32_32x32x16_bf16 v[128:143], v[24:27], v[208:211], 0
v_mfma_f32_32x32x8_bf16 v[128:143], v[52:53], v[212:213], v[128:143]
s_waitcnt lgkmcnt(5)
v_mfma_f32_32x32x16_bf16 v[144:159], v[28:31], v[208:211], 0
v_mfma_f32_32x32x8_bf16 v[144:159], v[54:55], v[212:213], v[144:159]
s_waitcnt lgkmcnt(3)
v_mfma_f32_32x32x16_bf16 v[160:175], v[32:35], v[208:211], 0
v_mfma_f32_32x32x8_bf16 v[160:175], v[56:57], v[212:213], v[160:175]
s_waitcnt lgkmcnt(2)
v_mfma_f32_32x32x16_bf16 v[176:191], v[36:39], v[208:211], 0
v_mfma_f32_32x32x8_bf16 v[176:191], v[58:59], v[212:213], v[176:191]
s_nop 7
s_nop 3
s_lshl_b32 s40, s60, 1
s_add_u32 s40, s40, s62
s_cmp_ge_u32 s40, 8
s_cbranch_scc1 AT_noneg
s_add_u32 s41, s40, 0
s_cmp_ge_u32 s41, 8
s_cbranch_scc1 AT_noneg
v_mov_b32 v64, v244
v_mov_b32 v65, v244
v_mov_b32 v66, v244
v_mov_b32 v67, v244
v_mov_b32 v68, v244
v_mov_b32 v69, v244
v_mov_b32 v70, v244
v_mov_b32 v71, v244
v_mov_b32 v72, v244
v_mov_b32 v73, v244
v_mov_b32 v74, v244
v_mov_b32 v75, v244
v_mov_b32 v76, v244
v_mov_b32 v77, v244
v_mov_b32 v78, v244
v_mov_b32 v79, v244
s_add_u32 s41, s40, 1
s_cmp_ge_u32 s41, 8
s_cbranch_scc1 AT_noneg
v_mov_b32 v80, v244
v_mov_b32 v81, v244
v_mov_b32 v82, v244
v_mov_b32 v83, v244
v_mov_b32 v84, v244
v_mov_b32 v85, v244
v_mov_b32 v86, v244
v_mov_b32 v87, v244
v_mov_b32 v88, v244
v_mov_b32 v89, v244
v_mov_b32 v90, v244
v_mov_b32 v91, v244
v_mov_b32 v92, v244
v_mov_b32 v93, v244
v_mov_b32 v94, v244
v_mov_b32 v95, v244
s_add_u32 s41, s40, 2
s_cmp_ge_u32 s41, 8
s_cbranch_scc1 AT_noneg
v_mov_b32 v96, v244
v_mov_b32 v97, v244
v_mov_b32 v98, v244
v_mov_b32 v99, v244
v_mov_b32 v100, v244
v_mov_b32 v101, v244
v_mov_b32 v102, v244
v_mov_b32 v103, v244
v_mov_b32 v104, v244
v_mov_b32 v105, v244
v_mov_b32 v106, v244
v_mov_b32 v107, v244
v_mov_b32 v108, v244
v_mov_b32 v109, v244
v_mov_b32 v110, v244
v_mov_b32 v111, v244
s_add_u32 s41, s40, 3
s_cmp_ge_u32 s41, 8
s_cbranch_scc1 AT_noneg
v_mov_b32 v112, v244
v_mov_b32 v113, v244
v_mov_b32 v114, v244
v_mov_b32 v115, v244
v_mov_b32 v116, v244
v_mov_b32 v117, v244
v_mov_b32 v118, v244
v_mov_b32 v119, v244
v_mov_b32 v120, v244
v_mov_b32 v121, v244
v_mov_b32 v122, v244
v_mov_b32 v123, v244
v_mov_b32 v124, v244
v_mov_b32 v125, v244
v_mov_b32 v126, v244
v_mov_b32 v127, v244
s_add_u32 s41, s40, 4
s_cmp_ge_u32 s41, 8
s_cbranch_scc1 AT_noneg
v_mov_b32 v128, v244
v_mov_b32 v129, v244
v_mov_b32 v130, v244
v_mov_b32 v131, v244
v_mov_b32 v132, v244
v_mov_b32 v133, v244
v_mov_b32 v134, v244
v_mov_b32 v135, v244
v_mov_b32 v136, v244
v_mov_b32 v137, v244
v_mov_b32 v138, v244
v_mov_b32 v139, v244
v_mov_b32 v140, v244
v_mov_b32 v141, v244
v_mov_b32 v142, v244
v_mov_b32 v143, v244
s_add_u32 s41, s40, 5
s_cmp_ge_u32 s41, 8
s_cbranch_scc1 AT_noneg
v_mov_b32 v144, v244
v_mov_b32 v145, v244
v_mov_b32 v146, v244
v_mov_b32 v147, v244
v_mov_b32 v148, v244
v_mov_b32 v149, v244
v_mov_b32 v150, v244
v_mov_b32 v151, v244
v_mov_b32 v152, v244
v_mov_b32 v153, v244
v_mov_b32 v154, v244
v_mov_b32 v155, v244
v_mov_b32 v156, v244
v_mov_b32 v157, v244
v_mov_b32 v158, v244
v_mov_b32 v159, v244
s_add_u32 s41, s40, 6
s_cmp_ge_u32 s41, 8
s_cbranch_scc1 AT_noneg
v_mov_b32 v160, v244
v_mov_b32 v161, v244
v_mov_b32 v162, v244
v_mov_b32 v163, v244
v_mov_b32 v164, v244
v_mov_b32 v165, v244
v_mov_b32 v166, v244
v_mov_b32 v167, v244
v_mov_b32 v168, v244
v_mov_b32 v169, v244
v_mov_b32 v170, v244
v_mov_b32 v171, v244
v_mov_b32 v172, v244
v_mov_b32 v173, v244
v_mov_b32 v174, v244
v_mov_b32 v175, v244
s_add_u32 s41, s40, 7
s_cmp_ge_u32 s41, 8
s_cbranch_scc1 AT_noneg
v_mov_b32 v176, v244
v_mov_b32 v177, v244
v_mov_b32 v178, v244
v_mov_b32 v179, v244
v_mov_b32 v180, v244
v_mov_b32 v181, v244
v_mov_b32 v182, v244
v_mov_b32 v183, v244
v_mov_b32 v184, v244
v_mov_b32 v185, v244
v_mov_b32 v186, v244
v_mov_b32 v187, v244
v_mov_b32 v188, v244
v_mov_b32 v189, v244
v_mov_b32 v190, v244
v_mov_b32 v191, v244
AT_noneg:
s_cmp_lg_u32 s59, 0
s_cbranch_scc1 AT_nb
AT_nb:
v_cndmask_b32 v64, v192, v64, s[70:71]
v_cndmask_b32 v65, v193, v65, s[72:73]
v_cndmask_b32 v66, v194, v66, s[74:75]
v_cndmask_b32 v67, v195, v67, s[76:77]
v_cndmask_b32 v68, v196, v68, s[78:79]
v_cndmask_b32 v69, v197, v69, s[80:81]
v_cndmask_b32 v70, v198, v70, s[82:83]
v_cndmask_b32 v71, v199, v71, s[84:85]
v_cndmask_b32 v72, v200, v72, s[86:87]
v_cndmask_b32 v73, v201, v73, s[88:89]
v_cndmask_b32 v74, v202, v74, s[90:91]
v_cndmask_b32 v75, v203, v75, s[92:93]
v_cndmask_b32 v76, v204, v76, s[94:95]
v_cndmask_b32 v77, v205, v77, s[96:97]
v_cndmask_b32 v78, v206, v78, s[98:99]
v_cndmask_b32 v79, v207, v79, s[100:101]
v_add_u32 v247, v242, v243
v_add_u32 v247, v247, v243
ds_read_b128 v[8:11], v247
v_add_u32 v247, v247, v243
ds_read_b128 v[12:15], v247
v_add_u32 v247, v247, v243
ds_read_b128 v[16:19], v247
v_add_u32 v247, v247, v243
ds_read_b128 v[20:23], v247
v_add_u32 v247, v247, v243
ds_read_b128 v[24:27], v247
v_add_u32 v247, v247, v243
ds_read_b128 v[28:31], v247
v_add_u32 v247, v247, v243
ds_read_b128 v[32:35], v247
v_add_u32 v247, v247, v243
ds_read_b128 v[36:39], v247
v_add_u32 v247, v247, v243
ds_read_b128 v[40:43], v247
v_add_u32 v247, v247, v243
ds_read_b128 v[44:47], v247
v_add_u32 v247, v247, v243
ds_read_b128 v[48:51], v247
v_add_u32 v247, v247, v243
ds_read_b128 v[52:55], v247
v_max_f32 v245, v64, v65
v_max_f32 v246, v80, v81
v_max3_f32 v245, v245, v66, v67
v_max3_f32 v246, v246, v82, v83
v_max3_f32 v245, v245, v68, v69
v_max3_f32 v246, v246, v84, v85
v_max3_f32 v245, v245, v70, v71
v_max3_f32 v246, v246, v86, v87
v_max3_f32 v245, v245, v72, v73
v_max3_f32 v246, v246, v88, v89
v_max3_f32 v245, v245, v74, v75
v_max3_f32 v246, v246, v90, v91
v_max3_f32 v245, v245, v76, v77
v_max3_f32 v246, v246, v92, v93
v_max3_f32 v245, v245, v78, v79
v_max3_f32 v246, v246, v94, v95
v_max3_f32 v245, v245, v96, v97
v_max3_f32 v246, v246, v112, v113
v_max3_f32 v245, v245, v98, v99
v_max3_f32 v246, v246, v114, v115
v_max3_f32 v245, v245, v100, v101
v_max3_f32 v246, v246, v116, v117
v_max3_f32 v245, v245, v102, v103
v_max3_f32 v246, v246, v118, v119
v_max3_f32 v245, v245, v104, v105
v_max3_f32 v246, v246, v120, v121
v_max3_f32 v245, v245, v106, v107
v_max3_f32 v246, v246, v122, v123
v_max3_f32 v245, v245, v108, v109
v_max3_f32 v246, v246, v124, v125
v_max3_f32 v245, v245, v110, v111
v_max3_f32 v246, v246, v126, v127
v_max3_f32 v245, v245, v128, v129
v_max3_f32 v246, v246, v144, v145
v_max3_f32 v245, v245, v130, v131
v_max3_f32 v246, v246, v146, v147
v_max3_f32 v245, v245, v132, v133
v_max3_f32 v246, v246, v148, v149
v_max3_f32 v245, v245, v134, v135
v_max3_f32 v246, v246, v150, v151
v_max3_f32 v245, v245, v136, v137
v_max3_f32 v246, v246, v152, v153
v_max3_f32 v245, v245, v138, v139
v_max3_f32 v246, v246, v154, v155
v_max3_f32 v245, v245, v140, v141
v_max3_f32 v246, v246, v156, v157
v_max3_f32 v245, v245, v142, v143
v_max3_f32 v246, v246, v158, v159
v_max3_f32 v245, v245, v160, v161
v_max3_f32 v246, v246, v176, v177
v_max3_f32 v245, v245, v162, v163
v_max3_f32 v246, v246, v178, v179
v_max3_f32 v245, v245, v164, v165
v_max3_f32 v246, v246, v180, v181
v_max3_f32 v245, v245, v166, v167
v_max3_f32 v246, v246, v182, v183
v_max3_f32 v245, v245, v168, v169
v_max3_f32 v246, v246, v184, v185
v_max3_f32 v245, v245, v170, v171
v_max3_f32 v246, v246, v186, v187
v_max3_f32 v245, v245, v172, v173
v_max3_f32 v246, v246, v188, v189
v_max3_f32 v245, v245, v174, v175
v_max3_f32 v246, v246, v190, v191
v_max_f32 v245, v245, v246
s_nop 0
v_mov_b32 v246, v245
s_nop 1
v_permlane32_swap_b32 v245, v246
s_nop 0
v_max_f32 v245, v245, v246
v_mov_b32 v246, 1106247680
v_cmp_nle_f32 vcc, |v245|, v246
s_nop 4
s_cbranch_vccz AT_nosub
v_sub_f32 v64, v64, v245
v_sub_f32 v65, v65, v245
v_sub_f32 v66, v66, v245
v_sub_f32 v67, v67, v245
v_sub_f32 v68, v68, v245
v_sub_f32 v69, v69, v245
v_sub_f32 v70, v70, v245
v_sub_f32 v71, v71, v245
v_sub_f32 v72, v72, v245
v_sub_f32 v73, v73, v245
v_sub_f32 v74, v74, v245
v_sub_f32 v75, v75, v245
v_sub_f32 v76, v76, v245
v_sub_f32 v77, v77, v245
v_sub_f32 v78, v78, v245
v_sub_f32 v79, v79, v245
v_sub_f32 v80, v80, v245
v_sub_f32 v81, v81, v245
v_sub_f32 v82, v82, v245
v_sub_f32 v83, v83, v245
v_sub_f32 v84, v84, v245
v_sub_f32 v85, v85, v245
v_sub_f32 v86, v86, v245
v_sub_f32 v87, v87, v245
v_sub_f32 v88, v88, v245
v_sub_f32 v89, v89, v245
v_sub_f32 v90, v90, v245
v_sub_f32 v91, v91, v245
v_sub_f32 v92, v92, v245
v_sub_f32 v93, v93, v245
v_sub_f32 v94, v94, v245
v_sub_f32 v95, v95, v245
v_sub_f32 v96, v96, v245
v_sub_f32 v97, v97, v245
v_sub_f32 v98, v98, v245
v_sub_f32 v99, v99, v245
v_sub_f32 v100, v100, v245
v_sub_f32 v101, v101, v245
v_sub_f32 v102, v102, v245
v_sub_f32 v103, v103, v245
v_sub_f32 v104, v104, v245
v_sub_f32 v105, v105, v245
v_sub_f32 v106, v106, v245
v_sub_f32 v107, v107, v245
v_sub_f32 v108, v108, v245
v_sub_f32 v109, v109, v245
v_sub_f32 v110, v110, v245
v_sub_f32 v111, v111, v245
v_sub_f32 v112, v112, v245
v_sub_f32 v113, v113, v245
v_sub_f32 v114, v114, v245
v_sub_f32 v115, v115, v245
v_sub_f32 v116, v116, v245
v_sub_f32 v117, v117, v245
v_sub_f32 v118, v118, v245
v_sub_f32 v119, v119, v245
v_sub_f32 v120, v120, v245
v_sub_f32 v121, v121, v245
v_sub_f32 v122, v122, v245
v_sub_f32 v123, v123, v245
v_sub_f32 v124, v124, v245
v_sub_f32 v125, v125, v245
v_sub_f32 v126, v126, v245
v_sub_f32 v127, v127, v245
v_sub_f32 v128, v128, v245
v_sub_f32 v129, v129, v245
v_sub_f32 v130, v130, v245
v_sub_f32 v131, v131, v245
v_sub_f32 v132, v132, v245
v_sub_f32 v133, v133, v245
v_sub_f32 v134, v134, v245
v_sub_f32 v135, v135, v245
v_sub_f32 v136, v136, v245
v_sub_f32 v137, v137, v245
v_sub_f32 v138, v138, v245
v_sub_f32 v139, v139, v245
v_sub_f32 v140, v140, v245
v_sub_f32 v141, v141, v245
v_sub_f32 v142, v142, v245
v_sub_f32 v143, v143, v245
v_sub_f32 v144, v144, v245
v_sub_f32 v145, v145, v245
v_sub_f32 v146, v146, v245
v_sub_f32 v147, v147, v245
v_sub_f32 v148, v148, v245
v_sub_f32 v149, v149, v245
v_sub_f32 v150, v150, v245
v_sub_f32 v151, v151, v245
v_sub_f32 v152, v152, v245
v_sub_f32 v153, v153, v245
v_sub_f32 v154, v154, v245
v_sub_f32 v155, v155, v245
v_sub_f32 v156, v156, v245
v_sub_f32 v157, v157, v245
v_sub_f32 v158, v158, v245
v_sub_f32 v159, v159, v245
v_sub_f32 v160, v160, v245
v_sub_f32 v161, v161, v245
v_sub_f32 v162, v162, v245
v_sub_f32 v163, v163, v245
v_sub_f32 v164, v164, v245
v_sub_f32 v165, v165, v245
v_sub_f32 v166, v166, v245
v_sub_f32 v167, v167, v245
v_sub_f32 v168, v168, v245
v_sub_f32 v169, v169, v245
v_sub_f32 v170, v170, v245
v_sub_f32 v171, v171, v245
v_sub_f32 v172, v172, v245
v_sub_f32 v173, v173, v245
v_sub_f32 v174, v174, v245
v_sub_f32 v175, v175, v245
v_sub_f32 v176, v176, v245
v_sub_f32 v177, v177, v245
v_sub_f32 v178, v178, v245
v_sub_f32 v179, v179, v245
v_sub_f32 v180, v180, v245
v_sub_f32 v181, v181, v245
v_sub_f32 v182, v182, v245
v_sub_f32 v183, v183, v245
v_sub_f32 v184, v184, v245
v_sub_f32 v185, v185, v245
v_sub_f32 v186, v186, v245
v_sub_f32 v187, v187, v245
v_sub_f32 v188, v188, v245
v_sub_f32 v189, v189, v245
v_sub_f32 v190, v190, v245
v_sub_f32 v191, v191, v245
AT_nosub:
v_exp_f32 v80, v80
v_exp_f32 v81, v81
v_exp_f32 v82, v82
v_exp_f32 v83, v83
v_exp_f32 v84, v84
v_exp_f32 v85, v85
v_exp_f32 v86, v86
v_exp_f32 v87, v87
s_nop 0
v_cvt_pk_bf16_f32 v80, v80, v81
v_cvt_pk_bf16_f32 v81, v82, v83
v_cvt_pk_bf16_f32 v82, v84, v85
v_cvt_pk_bf16_f32 v83, v86, v87
v_exp_f32 v88, v88
v_exp_f32 v89, v89
v_exp_f32 v90, v90
s_waitcnt lgkmcnt(11)
v_mfma_f32_32x32x16_bf16 v[216:231], v[8:11], v[80:83], 0
v_add_u32 v247, v247, v243
ds_read_b128 v[56:59], v247
v_exp_f32 v91, v91
v_exp_f32 v92, v92
v_exp_f32 v93, v93
v_exp_f32 v94, v94
v_exp_f32 v95, v95
s_nop 0
v_cvt_pk_bf16_f32 v84, v88, v89
v_cvt_pk_bf16_f32 v85, v90, v91
v_cvt_pk_bf16_f32 v86, v92, v93
v_cvt_pk_bf16_f32 v87, v94, v95
v_exp_f32 v96, v96
v_exp_f32 v97, v97
v_exp_f32 v98, v98
s_waitcnt lgkmcnt(11)
v_mfma_f32_32x32x16_bf16 v[216:231], v[12:15], v[84:87], v[216:231]
v_add_u32 v247, v247, v243
ds_read_b128 v[60:63], v247
v_exp_f32 v99, v99
v_exp_f32 v100, v100
v_exp_f32 v101, v101
v_exp_f32 v102, v102
v_exp_f32 v103, v103
s_nop 0
v_cvt_pk_bf16_f32 v96, v96, v97
v_cvt_pk_bf16_f32 v97, v98, v99
v_cvt_pk_bf16_f32 v98, v100, v101
v_cvt_pk_bf16_f32 v99, v102, v103
v_exp_f32 v104, v104
v_exp_f32 v105, v105
v_exp_f32 v106, v106
s_waitcnt lgkmcnt(11)
v_mfma_f32_32x32x16_bf16 v[216:231], v[16:19], v[96:99], v[216:231]
v_mov_b32 v247, v242
ds_read_b128 v[192:195], v247
v_exp_f32 v107, v107
v_exp_f32 v108, v108
v_exp_f32 v109, v109
v_exp_f32 v110, v110
v_exp_f32 v111, v111
s_nop 0
v_cvt_pk_bf16_f32 v100, v104, v105
v_cvt_pk_bf16_f32 v101, v106, v107
v_cvt_pk_bf16_f32 v102, v108, v109
v_cvt_pk_bf16_f32 v103, v110, v111
s_cmp_eq_u32 s59, 0
s_cbranch_scc1 AT_no1
s_waitcnt vmcnt(0)
buffer_store_dword v0, v3, s[24:27], s58 offen offset:64 sc1
AT_no1:
v_exp_f32 v112, v112
v_exp_f32 v113, v113
v_exp_f32 v114, v114
s_waitcnt lgkmcnt(11)
v_mfma_f32_32x32x16_bf16 v[216:231], v[20:23], v[100:103], v[216:231]
v_add_u32 v247, v247, v243
ds_read_b128 v[196:199], v247
v_exp_f32 v115, v115
v_exp_f32 v116, v116
v_exp_f32 v117, v117
v_exp_f32 v118, v118
v_exp_f32 v119, v119
s_nop 0
v_cvt_pk_bf16_f32 v112, v112, v113
v_cvt_pk_bf16_f32 v113, v114, v115
v_cvt_pk_bf16_f32 v114, v116, v117
v_cvt_pk_bf16_f32 v115, v118, v119
v_exp_f32 v120, v120
v_exp_f32 v121, v121
v_exp_f32 v122, v122
s_waitcnt lgkmcnt(11)
v_mfma_f32_32x32x16_bf16 v[216:231], v[24:27], v[112:115], v[216:231]
v_lshl_add_u32 v247, v243, 4, v242
ds_read_b128 v[200:203], v247
v_exp_f32 v123, v123
v_exp_f32 v124, v124
v_exp_f32 v125, v125
v_exp_f32 v126, v126
v_exp_f32 v127, v127
s_nop 0
v_cvt_pk_bf16_f32 v116, v120, v121
v_cvt_pk_bf16_f32 v117, v122, v123
v_cvt_pk_bf16_f32 v118, v124, v125
v_cvt_pk_bf16_f32 v119, v126, v127
v_exp_f32 v128, v128
v_exp_f32 v129, v129
v_exp_f32 v130, v130
s_waitcnt lgkmcnt(11)
v_mfma_f32_32x32x16_bf16 v[216:231], v[28:31], v[116:119], v[216:231]
v_add_u32 v247, v247, v243
ds_read_b128 v[204:207], v247
v_exp_f32 v131, v131
v_exp_f32 v132, v132
v_exp_f32 v133, v133
v_exp_f32 v134, v134
v_exp_f32 v135, v135
s_nop 0
v_cvt_pk_bf16_f32 v128, v128, v129
v_cvt_pk_bf16_f32 v129, v130, v131
v_cvt_pk_bf16_f32 v130, v132, v133
v_cvt_pk_bf16_f32 v131, v134, v135
v_exp_f32 v136, v136
v_exp_f32 v137, v137
v_exp_f32 v138, v138
s_waitcnt lgkmcnt(11)
v_mfma_f32_32x32x16_bf16 v[216:231], v[32:35], v[128:131], v[216:231]
v_exp_f32 v139, v139
v_exp_f32 v140, v140
v_exp_f32 v141, v141
v_exp_f32 v142, v142
v_exp_f32 v143, v143
s_nop 0
v_cvt_pk_bf16_f32 v132, v136, v137
v_cvt_pk_bf16_f32 v133, v138, v139
v_cvt_pk_bf16_f32 v134, v140, v141
v_cvt_pk_bf16_f32 v135, v142, v143
v_exp_f32 v144, v144
v_exp_f32 v145, v145
v_exp_f32 v146, v146
s_waitcnt lgkmcnt(10)
v_mfma_f32_32x32x16_bf16 v[216:231], v[36:39], v[132:135], v[216:231]
v_exp_f32 v147, v147
v_exp_f32 v148, v148
v_exp_f32 v149, v149
v_exp_f32 v150, v150
v_exp_f32 v151, v151
s_nop 0
v_cvt_pk_bf16_f32 v144, v144, v145
v_cvt_pk_bf16_f32 v145, v146, v147
v_cvt_pk_bf16_f32 v146, v148, v149
v_cvt_pk_bf16_f32 v147, v150, v151
v_exp_f32 v152, v152
v_exp_f32 v153, v153
v_exp_f32 v154, v154
s_waitcnt lgkmcnt(9)
v_mfma_f32_32x32x16_bf16 v[216:231], v[40:43], v[144:147], v[216:231]
v_exp_f32 v155, v155
v_exp_f32 v156, v156
v_exp_f32 v157, v157
v_exp_f32 v158, v158
v_exp_f32 v159, v159
s_nop 0
v_cvt_pk_bf16_f32 v148, v152, v153
v_cvt_pk_bf16_f32 v149, v154, v155
v_cvt_pk_bf16_f32 v150, v156, v157
v_cvt_pk_bf16_f32 v151, v158, v159
v_exp_f32 v160, v160
v_exp_f32 v161, v161
v_exp_f32 v162, v162
s_waitcnt lgkmcnt(8)
v_mfma_f32_32x32x16_bf16 v[216:231], v[44:47], v[148:151], v[216:231]
v_exp_f32 v163, v163
v_exp_f32 v164, v164
v_exp_f32 v165, v165
v_exp_f32 v166, v166
v_exp_f32 v167, v167
s_nop 0
v_cvt_pk_bf16_f32 v160, v160, v161
v_cvt_pk_bf16_f32 v161, v162, v163
v_cvt_pk_bf16_f32 v162, v164, v165
v_cvt_pk_bf16_f32 v163, v166, v167
v_exp_f32 v168, v168
v_exp_f32 v169, v169
v_exp_f32 v170, v170
s_waitcnt lgkmcnt(7)
v_mfma_f32_32x32x16_bf16 v[216:231], v[48:51], v[160:163], v[216:231]
v_exp_f32 v171, v171
v_exp_f32 v172, v172
v_exp_f32 v173, v173
v_exp_f32 v174, v174
v_exp_f32 v175, v175
s_nop 0
v_cvt_pk_bf16_f32 v164, v168, v169
v_cvt_pk_bf16_f32 v165, v170, v171
v_cvt_pk_bf16_f32 v166, v172, v173
v_cvt_pk_bf16_f32 v167, v174, v175
v_exp_f32 v176, v176
v_exp_f32 v177, v177
v_exp_f32 v178, v178
s_waitcnt lgkmcnt(6)
v_mfma_f32_32x32x16_bf16 v[216:231], v[52:55], v[164:167], v[216:231]
v_exp_f32 v179, v179
v_exp_f32 v180, v180
v_exp_f32 v181, v181
v_exp_f32 v182, v182
v_exp_f32 v183, v183
s_nop 0
v_cvt_pk_bf16_f32 v176, v176, v177
v_cvt_pk_bf16_f32 v177, v178, v179
v_cvt_pk_bf16_f32 v178, v180, v181
v_cvt_pk_bf16_f32 v179, v182, v183
v_exp_f32 v184, v184
v_exp_f32 v185, v185
v_exp_f32 v186, v186
s_waitcnt lgkmcnt(5)
v_mfma_f32_32x32x16_bf16 v[216:231], v[56:59], v[176:179], v[216:231]
v_exp_f32 v187, v187
v_exp_f32 v188, v188
v_exp_f32 v189, v189
v_exp_f32 v190, v190
v_exp_f32 v191, v191
s_nop 0
v_cvt_pk_bf16_f32 v180, v184, v185
v_cvt_pk_bf16_f32 v181, v186, v187
v_cvt_pk_bf16_f32 v182, v188, v189
v_cvt_pk_bf16_f32 v183, v190, v191
v_exp_f32 v64, v64
v_exp_f32 v65, v65
v_exp_f32 v66, v66
s_waitcnt lgkmcnt(4)
v_mfma_f32_32x32x16_bf16 v[216:231], v[60:63], v[180:183], v[216:231]
v_exp_f32 v67, v67
v_exp_f32 v68, v68
v_exp_f32 v69, v69
v_exp_f32 v70, v70
v_exp_f32 v71, v71
s_nop 0
v_cvt_pk_bf16_f32 v64, v64, v65
v_cvt_pk_bf16_f32 v65, v66, v67
v_cvt_pk_bf16_f32 v66, v68, v69
v_cvt_pk_bf16_f32 v67, v70, v71
v_exp_f32 v72, v72
v_exp_f32 v73, v73
v_exp_f32 v74, v74
v_exp_f32 v75, v75
v_exp_f32 v76, v76
v_exp_f32 v77, v77
v_exp_f32 v78, v78
v_exp_f32 v79, v79
s_nop 0
v_cvt_pk_bf16_f32 v68, v72, v73
v_cvt_pk_bf16_f32 v69, v74, v75
v_cvt_pk_bf16_f32 v70, v76, v77
v_cvt_pk_bf16_f32 v71, v78, v79
v_and_b32 v72, v64, v232
v_and_b32 v73, v65, v233
v_and_b32 v74, v66, v234
v_and_b32 v75, v67, v235
v_and_b32 v76, v68, v236
v_and_b32 v77, v69, v237
v_and_b32 v78, v70, v238
v_and_b32 v79, v71, v239
v_bfi_b32 v64, v232, 0, v64
v_bfi_b32 v65, v233, 0, v65
v_bfi_b32 v66, v234, 0, v66
v_bfi_b32 v67, v235, 0, v67
v_bfi_b32 v68, v236, 0, v68
v_bfi_b32 v69, v237, 0, v69
v_bfi_b32 v70, v238, 0, v70
v_bfi_b32 v71, v239, 0, v71
s_waitcnt lgkmcnt(0)
v_mfma_f32_32x32x16_bf16 v[216:231], v[192:195], v[72:75], v[216:231]
v_mfma_f32_32x32x16_bf16 v[216:231], v[196:199], v[76:79], v[216:231]
v_mfma_f32_32x32x16_bf16 v[216:231], v[200:203], v[64:67], v[216:231]
v_mfma_f32_32x32x16_bf16 v[216:231], v[204:207], v[68:71], v[216:231]
s_lshl_b32 s40, s60, 1
s_add_u32 s40, s40, s62
s_mul_i32 s40, s40, 40960
s_mul_i32 s41, s61, 5120
s_add_u32 s40, s40, s41
s_add_u32 s40, s40, 29360128
s_lshl_b32 s41, s63, 10
s_add_u32 s41, s41, s40
s_add_u32 s40, s40, 4096
s_nop 3
s_nop 0
v_mov_b32 v247, v224
v_mov_b32 v248, v224
s_nop 1
v_permlane32_swap_b32 v247, v248
s_nop 0
v_cndmask_b32 v247, v247, v248, s[68:69]
v_rcp_f32 v247, v247
s_nop 0
v_mul_f32 v216, v216, v247
v_mul_f32 v217, v217, v247
v_mul_f32 v218, v218, v247
v_mul_f32 v219, v219, v247
v_mul_f32 v220, v220, v247
v_mul_f32 v221, v221, v247
v_mul_f32 v222, v222, v247
v_mul_f32 v223, v223, v247
v_mul_f32 v224, v224, v247
v_mul_f32 v225, v225, v247
v_mul_f32 v226, v226, v247
v_mul_f32 v227, v227, v247
v_cvt_pk_bf16_f32 v216, v216, v217
v_cvt_pk_bf16_f32 v217, v218, v219
v_cvt_pk_bf16_f32 v218, v220, v221
v_cvt_pk_bf16_f32 v219, v222, v223
v_cvt_pk_bf16_f32 v220, v224, v225
v_cvt_pk_bf16_f32 v221, v226, v227
buffer_store_dwordx4 v[216:219], v249, s[24:27], s41 offen sc1
s_mov_b64 s[42:43], exec
s_mov_b64 exec, s[66:67]
buffer_store_dwordx2 v[220:221], v250, s[24:27], s40 offen sc1
s_mov_b64 exec, s[42:43]
s_cmp_lg_u32 s59, 0
s_cbranch_scc1 F_att_done
s_mov_b32 s59, 1
s_mov_b32 s62, 1
v_add_u32 v240, 5120, v240
v_add_u32 v241, 5120, v241
v_lshl_add_u32 v242, v243, 1, v242
s_branch F_task
F_att_done:
s_lshl_b32 s40, s3, 2
s_add_u32 s40, s40, 32
v_mov_b32 v4, s40
v_mov_b32 v5, 1
ds_write_b32 v4, v5
s_lshl_b32 s40, s60, 3
s_add_u32 s40, s40, s61
s_lshl_b32 s40, s40, 2
s_add_u32 s40, s40, s3
s_lshl_b32 s40, s40, 7
s_add_u32 s58, s40, 131072
s_and_b32 s40, s2, 7
s_lshr_b32 s41, s2, 3
s_and_b32 s42, s40, 1
s_lshl_b32 s42, s42, 2
s_and_b32 s43, s41, 3
s_add_u32 s61, s42, s43
s_lshr_b32 s42, s40, 1
s_lshl_b32 s42, s42, 3
s_lshr_b32 s43, s41, 2
s_add_u32 s60, s42, s43
s_mul_i32 s62, s61, 378880
s_add_u32 s62, s62, 33554432
s_lshl_b32 s40, s60, 1
s_mul_i32 s63, s40, 110592
s_add_u32 s63, s63, 20971520
s_mul_i32 s64, s40, 40960
s_add_u32 s64, s64, 29249536
v_lshlrev_b32 v4, 4, v2
v_add_u32 v5, 4096, v4
v_lshrrev_b32 v9, 4, v2
v_and_b32 v10, 15, v2
v_lshlrev_b32 v6, 9, v9
v_lshl_add_u32 v6, v10, 4, v6
v_mul_u32_u24 v7, 1280, v10
v_lshl_add_u32 v8, v9, 3, v7
v_add_u32 v8, 128, v8
v_lshl_add_u32 v7, v9, 4, v7
s_lshl_b32 s40, s60, 2
s_and_b32 s41, s3, 3
s_add_u32 s40, s40, s41
s_mul_i32 s40, s40, 20480
s_mul_i32 s41, s61, 160
s_add_u32 s69, s40, s41
s_mov_b32 s28, s4
s_and_b32 s29, s5, 0xffff
s_mov_b32 s30, 2621440
s_mov_b32 s31, 0x20000
s_mov_b32 s32, s18
s_and_b32 s33, s19, 0xffff
s_mov_b32 s34, 2621440
s_mov_b32 s35, 0x20000
buffer_load_dwordx4 v[240:243], v7, s[28:31], s69 offen
buffer_load_dwordx2 v[244:245], v8, s[28:31], s69 offen
s_add_u32 s70, s69, 40960
s_sub_u32 s41, s69, 40960
s_cmp_lt_u32 s3, 2
s_cselect_b32 s70, s70, s41
buffer_load_dwordx4 v[246:249], v7, s[28:31], s70 offen offset:64
s_waitcnt vmcnt(3)
buffer_store_dword v0, v3, s[24:27], s58 offen offset:0 sc1
v_lshlrev_b32 v9, 4, v2
v_add_u32 v11, 40960, v9
v_mov_b32 v20, 48
s_mov_b32 s1, 160000
T3_wh:
ds_read_b128 v[16:19], v20
s_waitcnt lgkmcnt(0)
v_min_u32 v16, v16, v17
v_min3_u32 v16, v16, v18, v19
s_nop 0
v_readfirstlane_b32 s40, v16
s_cmp_lg_u32 s40, 0
s_cbranch_scc1 T3_wh_ok
s_sub_u32 s1, s1, 1
s_cmp_lg_u32 s1, 0
s_cbranch_scc1 T3_wh
T3_wh_ok:
s_waitcnt vmcnt(0)
s_cmp_lg_u32 s3, 0
s_cbranch_scc1 T3_n0
ds_read_b128 v[16:19], v9 offset:512
ds_read_b128 v[20:23], v9 offset:1536
ds_read_b128 v[24:27], v9 offset:4608
ds_read_b128 v[28:31], v9 offset:20992
ds_read_b128 v[32:35], v9 offset:22016
ds_read_b128 v[36:39], v9 offset:25088
ds_read_b128 v[40:43], v11 offset:512
ds_read_b128 v[44:47], v11 offset:1536
ds_read_b128 v[48:51], v11 offset:4608
ds_read_b128 v[52:55], v11 offset:20992
ds_read_b128 v[56:59], v11 offset:22016
ds_read_b128 v[60:63], v11 offset:25088
v_lshlrev_b32 v80, 16, v240
v_and_b32 v81, 0xffff0000, v240
v_lshlrev_b32 v82, 16, v241
v_and_b32 v83, 0xffff0000, v241
v_lshlrev_b32 v84, 16, v242
v_and_b32 v85, 0xffff0000, v242
v_lshlrev_b32 v86, 16, v243
v_and_b32 v87, 0xffff0000, v243
v_lshlrev_b32 v88, 16, v244
v_and_b32 v89, 0xffff0000, v244
v_lshlrev_b32 v90, 16, v245
v_and_b32 v91, 0xffff0000, v245
s_waitcnt lgkmcnt(9)
v_add_f32 v80, v80, v16
v_add_f32 v81, v81, v17
v_add_f32 v82, v82, v18
v_add_f32 v83, v83, v19
v_add_f32 v84, v84, v20
v_add_f32 v85, v85, v21
v_add_f32 v86, v86, v22
v_add_f32 v87, v87, v23
v_add_f32 v88, v88, v24
v_add_f32 v89, v89, v25
v_add_f32 v90, v90, v26
v_add_f32 v91, v91, v27
s_waitcnt lgkmcnt(6)
v_add_f32 v80, v80, v28
v_add_f32 v81, v81, v29
v_add_f32 v82, v82, v30
v_add_f32 v83, v83, v31
v_add_f32 v84, v84, v32
v_add_f32 v85, v85, v33
v_add_f32 v86, v86, v34
v_add_f32 v87, v87, v35
v_add_f32 v88, v88, v36
v_add_f32 v89, v89, v37
v_add_f32 v90, v90, v38
v_add_f32 v91, v91, v39
s_waitcnt lgkmcnt(3)
v_add_f32 v80, v80, v40
v_add_f32 v81, v81, v41
v_add_f32 v82, v82, v42
v_add_f32 v83, v83, v43
v_add_f32 v84, v84, v44
v_add_f32 v85, v85, v45
v_add_f32 v86, v86, v46
v_add_f32 v87, v87, v47
v_add_f32 v88, v88, v48
v_add_f32 v89, v89, v49
v_add_f32 v90, v90, v50
v_add_f32 v91, v91, v51
s_waitcnt lgkmcnt(0)
v_add_f32 v80, v80, v52
v_add_f32 v81, v81, v53
v_add_f32 v82, v82, v54
v_add_f32 v83, v83, v55
v_add_f32 v84, v84, v56
v_add_f32 v85, v85, v57
v_add_f32 v86, v86, v58
v_add_f32 v87, v87, v59
v_add_f32 v88, v88, v60
v_add_f32 v89, v89, v61
v_add_f32 v90, v90, v62
v_add_f32 v91, v91, v63
v_cvt_pk_bf16_f32 v96, v80, v81
v_cvt_pk_bf16_f32 v97, v82, v83
v_cvt_pk_bf16_f32 v98, v84, v85
v_cvt_pk_bf16_f32 v99, v86, v87
v_cvt_pk_bf16_f32 v100, v88, v89
v_cvt_pk_bf16_f32 v101, v90, v91
buffer_store_dwordx4 v[96:99], v7, s[32:35], s69 offen
buffer_store_dwordx2 v[100:101], v8, s[32:35], s69 offen
s_barrier
ds_read_b128 v[16:19], v9 offset:12800
ds_read_b128 v[20:23], v9 offset:13824
ds_read_b128 v[24:27], v9 offset:33280
ds_read_b128 v[28:31], v9 offset:34304
ds_read_b128 v[32:35], v11 offset:12800
ds_read_b128 v[36:39], v11 offset:13824
ds_read_b128 v[40:43], v11 offset:33280
ds_read_b128 v[44:47], v11 offset:34304
v_lshlrev_b32 v80, 16, v246
v_and_b32 v81, 0xffff0000, v246
v_lshlrev_b32 v82, 16, v247
v_and_b32 v83, 0xffff0000, v247
v_lshlrev_b32 v84, 16, v248
v_and_b32 v85, 0xffff0000, v248
v_lshlrev_b32 v86, 16, v249
v_and_b32 v87, 0xffff0000, v249
s_waitcnt lgkmcnt(6)
v_add_f32 v80, v80, v16
v_add_f32 v81, v81, v17
v_add_f32 v82, v82, v18
v_add_f32 v83, v83, v19
v_add_f32 v84, v84, v20
v_add_f32 v85, v85, v21
v_add_f32 v86, v86, v22
v_add_f32 v87, v87, v23
s_waitcnt lgkmcnt(4)
v_add_f32 v80, v80, v24
v_add_f32 v81, v81, v25
v_add_f32 v82, v82, v26
v_add_f32 v83, v83, v27
v_add_f32 v84, v84, v28
v_add_f32 v85, v85, v29
v_add_f32 v86, v86, v30
v_add_f32 v87, v87, v31
s_waitcnt lgkmcnt(2)
v_add_f32 v80, v80, v32
v_add_f32 v81, v81, v33
v_add_f32 v82, v82, v34
v_add_f32 v83, v83, v35
v_add_f32 v84, v84, v36
v_add_f32 v85, v85, v37
v_add_f32 v86, v86, v38
v_add_f32 v87, v87, v39
s_waitcnt lgkmcnt(0)
v_add_f32 v80, v80, v40
v_add_f32 v81, v81, v41
v_add_f32 v82, v82, v42
v_add_f32 v83, v83, v43
v_add_f32 v84, v84, v44
v_add_f32 v85, v85, v45
v_add_f32 v86, v86, v46
v_add_f32 v87, v87, v47
v_cvt_pk_bf16_f32 v96, v80, v81
v_cvt_pk_bf16_f32 v97, v82, v83
v_cvt_pk_bf16_f32 v98, v84, v85
v_cvt_pk_bf16_f32 v99, v86, v87
buffer_store_dwordx4 v[96:99], v7, s[32:35], s70 offen offset:64
s_branch F_fin
T3_n0:
s_cmp_lg_u32 s3, 1
s_cbranch_scc1 T3_n1
ds_read_b128 v[16:19], v9 offset:5632
ds_read_b128 v[20:23], v9 offset:6656
ds_read_b128 v[24:27], v9 offset:9728
ds_read_b128 v[28:31], v9 offset:26112
ds_read_b128 v[32:35], v9 offset:27136
ds_read_b128 v[36:39], v9 offset:30208
ds_read_b128 v[40:43], v11 offset:5632
ds_read_b128 v[44:47], v11 offset:6656
ds_read_b128 v[48:51], v11 offset:9728
ds_read_b128 v[52:55], v11 offset:26112
ds_read_b128 v[56:59], v11 offset:27136
ds_read_b128 v[60:63], v11 offset:30208
v_lshlrev_b32 v80, 16, v240
v_and_b32 v81, 0xffff0000, v240
v_lshlrev_b32 v82, 16, v241
v_and_b32 v83, 0xffff0000, v241
v_lshlrev_b32 v84, 16, v242
v_and_b32 v85, 0xffff0000, v242
v_lshlrev_b32 v86, 16, v243
v_and_b32 v87, 0xffff0000, v243
v_lshlrev_b32 v88, 16, v244
v_and_b32 v89, 0xffff0000, v244
v_lshlrev_b32 v90, 16, v245
v_and_b32 v91, 0xffff0000, v245
s_waitcnt lgkmcnt(9)
v_add_f32 v80, v80, v16
v_add_f32 v81, v81, v17
v_add_f32 v82, v82, v18
v_add_f32 v83, v83, v19
v_add_f32 v84, v84, v20
v_add_f32 v85, v85, v21
v_add_f32 v86, v86, v22
v_add_f32 v87, v87, v23
v_add_f32 v88, v88, v24
v_add_f32 v89, v89, v25
v_add_f32 v90, v90, v26
v_add_f32 v91, v91, v27
s_waitcnt lgkmcnt(6)
v_add_f32 v80, v80, v28
v_add_f32 v81, v81, v29
v_add_f32 v82, v82, v30
v_add_f32 v83, v83, v31
v_add_f32 v84, v84, v32
v_add_f32 v85, v85, v33
v_add_f32 v86, v86, v34
v_add_f32 v87, v87, v35
v_add_f32 v88, v88, v36
v_add_f32 v89, v89, v37
v_add_f32 v90, v90, v38
v_add_f32 v91, v91, v39
s_waitcnt lgkmcnt(3)
v_add_f32 v80, v80, v40
v_add_f32 v81, v81, v41
v_add_f32 v82, v82, v42
v_add_f32 v83, v83, v43
v_add_f32 v84, v84, v44
v_add_f32 v85, v85, v45
v_add_f32 v86, v86, v46
v_add_f32 v87, v87, v47
v_add_f32 v88, v88, v48
v_add_f32 v89, v89, v49
v_add_f32 v90, v90, v50
v_add_f32 v91, v91, v51
s_waitcnt lgkmcnt(0)
v_add_f32 v80, v80, v52
v_add_f32 v81, v81, v53
v_add_f32 v82, v82, v54
v_add_f32 v83, v83, v55
v_add_f32 v84, v84, v56
v_add_f32 v85, v85, v57
v_add_f32 v86, v86, v58
v_add_f32 v87, v87, v59
v_add_f32 v88, v88, v60
v_add_f32 v89, v89, v61
v_add_f32 v90, v90, v62
v_add_f32 v91, v91, v63
v_cvt_pk_bf16_f32 v96, v80, v81
v_cvt_pk_bf16_f32 v97, v82, v83
v_cvt_pk_bf16_f32 v98, v84, v85
v_cvt_pk_bf16_f32 v99, v86, v87
v_cvt_pk_bf16_f32 v100, v88, v89
v_cvt_pk_bf16_f32 v101, v90, v91
buffer_store_dwordx4 v[96:99], v7, s[32:35], s69 offen
buffer_store_dwordx2 v[100:101], v8, s[32:35], s69 offen
s_barrier
ds_read_b128 v[16:19], v9 offset:17920
ds_read_b128 v[20:23], v9 offset:18944
ds_read_b128 v[24:27], v9 offset:38400
ds_read_b128 v[28:31], v9 offset:39424
ds_read_b128 v[32:35], v11 offset:17920
ds_read_b128 v[36:39], v11 offset:18944
ds_read_b128 v[40:43], v11 offset:38400
ds_read_b128 v[44:47], v11 offset:39424
v_lshlrev_b32 v80, 16, v246
v_and_b32 v81, 0xffff0000, v246
v_lshlrev_b32 v82, 16, v247
v_and_b32 v83, 0xffff0000, v247
v_lshlrev_b32 v84, 16, v248
v_and_b32 v85, 0xffff0000, v248
v_lshlrev_b32 v86, 16, v249
v_and_b32 v87, 0xffff0000, v249
s_waitcnt lgkmcnt(6)
v_add_f32 v80, v80, v16
v_add_f32 v81, v81, v17
v_add_f32 v82, v82, v18
v_add_f32 v83, v83, v19
v_add_f32 v84, v84, v20
v_add_f32 v85, v85, v21
v_add_f32 v86, v86, v22
v_add_f32 v87, v87, v23
s_waitcnt lgkmcnt(4)
v_add_f32 v80, v80, v24
v_add_f32 v81, v81, v25
v_add_f32 v82, v82, v26
v_add_f32 v83, v83, v27
v_add_f32 v84, v84, v28
v_add_f32 v85, v85, v29
v_add_f32 v86, v86, v30
v_add_f32 v87, v87, v31
s_waitcnt lgkmcnt(2)
v_add_f32 v80, v80, v32
v_add_f32 v81, v81, v33
v_add_f32 v82, v82, v34
v_add_f32 v83, v83, v35
v_add_f32 v84, v84, v36
v_add_f32 v85, v85, v37
v_add_f32 v86, v86, v38
v_add_f32 v87, v87, v39
s_waitcnt lgkmcnt(0)
v_add_f32 v80, v80, v40
v_add_f32 v81, v81, v41
v_add_f32 v82, v82, v42
v_add_f32 v83, v83, v43
v_add_f32 v84, v84, v44
v_add_f32 v85, v85, v45
v_add_f32 v86, v86, v46
v_add_f32 v87, v87, v47
v_cvt_pk_bf16_f32 v96, v80, v81
v_cvt_pk_bf16_f32 v97, v82, v83
v_cvt_pk_bf16_f32 v98, v84, v85
v_cvt_pk_bf16_f32 v99, v86, v87
buffer_store_dwordx4 v[96:99], v7, s[32:35], s70 offen offset:64
s_branch F_fin
T3_n1:
s_cmp_lg_u32 s3, 2
s_cbranch_scc1 T3_n2
ds_read_b128 v[16:19], v9 offset:2560
ds_read_b128 v[20:23], v9 offset:3584
ds_read_b128 v[24:27], v9 offset:23040
ds_read_b128 v[28:31], v9 offset:24064
ds_read_b128 v[32:35], v11 offset:2560
ds_read_b128 v[36:39], v11 offset:3584
ds_read_b128 v[40:43], v11 offset:23040
ds_read_b128 v[44:47], v11 offset:24064
v_lshlrev_b32 v80, 16, v246
v_and_b32 v81, 0xffff0000, v246
v_lshlrev_b32 v82, 16, v247
v_and_b32 v83, 0xffff0000, v247
v_lshlrev_b32 v84, 16, v248
v_and_b32 v85, 0xffff0000, v248
v_lshlrev_b32 v86, 16, v249
v_and_b32 v87, 0xffff0000, v249
s_waitcnt lgkmcnt(6)
v_add_f32 v80, v80, v16
v_add_f32 v81, v81, v17
v_add_f32 v82, v82, v18
v_add_f32 v83, v83, v19
v_add_f32 v84, v84, v20
v_add_f32 v85, v85, v21
v_add_f32 v86, v86, v22
v_add_f32 v87, v87, v23
s_waitcnt lgkmcnt(4)
v_add_f32 v80, v80, v24
v_add_f32 v81, v81, v25
v_add_f32 v82, v82, v26
v_add_f32 v83, v83, v27
v_add_f32 v84, v84, v28
v_add_f32 v85, v85, v29
v_add_f32 v86, v86, v30
v_add_f32 v87, v87, v31
s_waitcnt lgkmcnt(2)
v_add_f32 v80, v80, v32
v_add_f32 v81, v81, v33
v_add_f32 v82, v82, v34
v_add_f32 v83, v83, v35
v_add_f32 v84, v84, v36
v_add_f32 v85, v85, v37
v_add_f32 v86, v86, v38
v_add_f32 v87, v87, v39
s_waitcnt lgkmcnt(0)
v_add_f32 v80, v80, v40
v_add_f32 v81, v81, v41
v_add_f32 v82, v82, v42
v_add_f32 v83, v83, v43
v_add_f32 v84, v84, v44
v_add_f32 v85, v85, v45
v_add_f32 v86, v86, v46
v_add_f32 v87, v87, v47
v_cvt_pk_bf16_f32 v96, v80, v81
v_cvt_pk_bf16_f32 v97, v82, v83
v_cvt_pk_bf16_f32 v98, v84, v85
v_cvt_pk_bf16_f32 v99, v86, v87
buffer_store_dwordx4 v[96:99], v7, s[32:35], s70 offen offset:64
s_barrier
ds_read_b128 v[16:19], v9 offset:10752
ds_read_b128 v[20:23], v9 offset:11776
ds_read_b128 v[24:27], v9 offset:14848
ds_read_b128 v[28:31], v9 offset:31232
ds_read_b128 v[32:35], v9 offset:32256
ds_read_b128 v[36:39], v9 offset:35328
ds_read_b128 v[40:43], v11 offset:10752
ds_read_b128 v[44:47], v11 offset:11776
ds_read_b128 v[48:51], v11 offset:14848
ds_read_b128 v[52:55], v11 offset:31232
ds_read_b128 v[56:59], v11 offset:32256
ds_read_b128 v[60:63], v11 offset:35328
v_lshlrev_b32 v80, 16, v240
v_and_b32 v81, 0xffff0000, v240
v_lshlrev_b32 v82, 16, v241
v_and_b32 v83, 0xffff0000, v241
v_lshlrev_b32 v84, 16, v242
v_and_b32 v85, 0xffff0000, v242
v_lshlrev_b32 v86, 16, v243
v_and_b32 v87, 0xffff0000, v243
v_lshlrev_b32 v88, 16, v244
v_and_b32 v89, 0xffff0000, v244
v_lshlrev_b32 v90, 16, v245
v_and_b32 v91, 0xffff0000, v245
s_waitcnt lgkmcnt(9)
v_add_f32 v80, v80, v16
v_add_f32 v81, v81, v17
v_add_f32 v82, v82, v18
v_add_f32 v83, v83, v19
v_add_f32 v84, v84, v20
v_add_f32 v85, v85, v21
v_add_f32 v86, v86, v22
v_add_f32 v87, v87, v23
v_add_f32 v88, v88, v24
v_add_f32 v89, v89, v25
v_add_f32 v90, v90, v26
v_add_f32 v91, v91, v27
s_waitcnt lgkmcnt(6)
v_add_f32 v80, v80, v28
v_add_f32 v81, v81, v29
v_add_f32 v82, v82, v30
v_add_f32 v83, v83, v31
v_add_f32 v84, v84, v32
v_add_f32 v85, v85, v33
v_add_f32 v86, v86, v34
v_add_f32 v87, v87, v35
v_add_f32 v88, v88, v36
v_add_f32 v89, v89, v37
v_add_f32 v90, v90, v38
v_add_f32 v91, v91, v39
s_waitcnt lgkmcnt(3)
v_add_f32 v80, v80, v40
v_add_f32 v81, v81, v41
v_add_f32 v82, v82, v42
v_add_f32 v83, v83, v43
v_add_f32 v84, v84, v44
v_add_f32 v85, v85, v45
v_add_f32 v86, v86, v46
v_add_f32 v87, v87, v47
v_add_f32 v88, v88, v48
v_add_f32 v89, v89, v49
v_add_f32 v90, v90, v50
v_add_f32 v91, v91, v51
s_waitcnt lgkmcnt(0)
v_add_f32 v80, v80, v52
v_add_f32 v81, v81, v53
v_add_f32 v82, v82, v54
v_add_f32 v83, v83, v55
v_add_f32 v84, v84, v56
v_add_f32 v85, v85, v57
v_add_f32 v86, v86, v58
v_add_f32 v87, v87, v59
v_add_f32 v88, v88, v60
v_add_f32 v89, v89, v61
v_add_f32 v90, v90, v62
v_add_f32 v91, v91, v63
v_cvt_pk_bf16_f32 v96, v80, v81
v_cvt_pk_bf16_f32 v97, v82, v83
v_cvt_pk_bf16_f32 v98, v84, v85
v_cvt_pk_bf16_f32 v99, v86, v87
v_cvt_pk_bf16_f32 v100, v88, v89
v_cvt_pk_bf16_f32 v101, v90, v91
buffer_store_dwordx4 v[96:99], v7, s[32:35], s69 offen
buffer_store_dwordx2 v[100:101], v8, s[32:35], s69 offen
s_branch F_fin
T3_n2:
ds_read_b128 v[16:19], v9 offset:7680
ds_read_b128 v[20:23], v9 offset:8704
ds_read_b128 v[24:27], v9 offset:28160
ds_read_b128 v[28:31], v9 offset:29184
ds_read_b128 v[32:35], v11 offset:7680
ds_read_b128 v[36:39], v11 offset:8704
ds_read_b128 v[40:43], v11 offset:28160
ds_read_b128 v[44:47], v11 offset:29184
v_lshlrev_b32 v80, 16, v246
v_and_b32 v81, 0xffff0000, v246
v_lshlrev_b32 v82, 16, v247
v_and_b32 v83, 0xffff0000, v247
v_lshlrev_b32 v84, 16, v248
v_and_b32 v85, 0xffff0000, v248
v_lshlrev_b32 v86, 16, v249
v_and_b32 v87, 0xffff0000, v249
s_waitcnt lgkmcnt(6)
v_add_f32 v80, v80, v16
v_add_f32 v81, v81, v17
v_add_f32 v82, v82, v18
v_add_f32 v83, v83, v19
v_add_f32 v84, v84, v20
v_add_f32 v85, v85, v21
v_add_f32 v86, v86, v22
v_add_f32 v87, v87, v23
s_waitcnt lgkmcnt(4)
v_add_f32 v80, v80, v24
v_add_f32 v81, v81, v25
v_add_f32 v82, v82, v26
v_add_f32 v83, v83, v27
v_add_f32 v84, v84, v28
v_add_f32 v85, v85, v29
v_add_f32 v86, v86, v30
v_add_f32 v87, v87, v31
s_waitcnt lgkmcnt(2)
v_add_f32 v80, v80, v32
v_add_f32 v81, v81, v33
v_add_f32 v82, v82, v34
v_add_f32 v83, v83, v35
v_add_f32 v84, v84, v36
v_add_f32 v85, v85, v37
v_add_f32 v86, v86, v38
v_add_f32 v87, v87, v39
s_waitcnt lgkmcnt(0)
v_add_f32 v80, v80, v40
v_add_f32 v81, v81, v41
v_add_f32 v82, v82, v42
v_add_f32 v83, v83, v43
v_add_f32 v84, v84, v44
v_add_f32 v85, v85, v45
v_add_f32 v86, v86, v46
v_add_f32 v87, v87, v47
v_cvt_pk_bf16_f32 v96, v80, v81
v_cvt_pk_bf16_f32 v97, v82, v83
v_cvt_pk_bf16_f32 v98, v84, v85
v_cvt_pk_bf16_f32 v99, v86, v87
buffer_store_dwordx4 v[96:99], v7, s[32:35], s70 offen offset:64
s_barrier
ds_read_b128 v[16:19], v9 offset:15872
ds_read_b128 v[20:23], v9 offset:16896
ds_read_b128 v[24:27], v9 offset:19968
ds_read_b128 v[28:31], v9 offset:36352
ds_read_b128 v[32:35], v9 offset:37376
ds_read_b128 v[36:39], v9 offset:40448
ds_read_b128 v[40:43], v11 offset:15872
ds_read_b128 v[44:47], v11 offset:16896
ds_read_b128 v[48:51], v11 offset:19968
ds_read_b128 v[52:55], v11 offset:36352
ds_read_b128 v[56:59], v11 offset:37376
ds_read_b128 v[60:63], v11 offset:40448
v_lshlrev_b32 v80, 16, v240
v_and_b32 v81, 0xffff0000, v240
v_lshlrev_b32 v82, 16, v241
v_and_b32 v83, 0xffff0000, v241
v_lshlrev_b32 v84, 16, v242
v_and_b32 v85, 0xffff0000, v242
v_lshlrev_b32 v86, 16, v243
v_and_b32 v87, 0xffff0000, v243
v_lshlrev_b32 v88, 16, v244
v_and_b32 v89, 0xffff0000, v244
v_lshlrev_b32 v90, 16, v245
v_and_b32 v91, 0xffff0000, v245
s_waitcnt lgkmcnt(9)
v_add_f32 v80, v80, v16
v_add_f32 v81, v81, v17
v_add_f32 v82, v82, v18
v_add_f32 v83, v83, v19
v_add_f32 v84, v84, v20
v_add_f32 v85, v85, v21
v_add_f32 v86, v86, v22
v_add_f32 v87, v87, v23
v_add_f32 v88, v88, v24
v_add_f32 v89, v89, v25
v_add_f32 v90, v90, v26
v_add_f32 v91, v91, v27
s_waitcnt lgkmcnt(6)
v_add_f32 v80, v80, v28
v_add_f32 v81, v81, v29
v_add_f32 v82, v82, v30
v_add_f32 v83, v83, v31
v_add_f32 v84, v84, v32
v_add_f32 v85, v85, v33
v_add_f32 v86, v86, v34
v_add_f32 v87, v87, v35
v_add_f32 v88, v88, v36
v_add_f32 v89, v89, v37
v_add_f32 v90, v90, v38
v_add_f32 v91, v91, v39
s_waitcnt lgkmcnt(3)
v_add_f32 v80, v80, v40
v_add_f32 v81, v81, v41
v_add_f32 v82, v82, v42
v_add_f32 v83, v83, v43
v_add_f32 v84, v84, v44
v_add_f32 v85, v85, v45
v_add_f32 v86, v86, v46
v_add_f32 v87, v87, v47
v_add_f32 v88, v88, v48
v_add_f32 v89, v89, v49
v_add_f32 v90, v90, v50
v_add_f32 v91, v91, v51
s_waitcnt lgkmcnt(0)
v_add_f32 v80, v80, v52
v_add_f32 v81, v81, v53
v_add_f32 v82, v82, v54
v_add_f32 v83, v83, v55
v_add_f32 v84, v84, v56
v_add_f32 v85, v85, v57
v_add_f32 v86, v86, v58
v_add_f32 v87, v87, v59
v_add_f32 v88, v88, v60
v_add_f32 v89, v89, v61
v_add_f32 v90, v90, v62
v_add_f32 v91, v91, v63
v_cvt_pk_bf16_f32 v96, v80, v81
v_cvt_pk_bf16_f32 v97, v82, v83
v_cvt_pk_bf16_f32 v98, v84, v85
v_cvt_pk_bf16_f32 v99, v86, v87
v_cvt_pk_bf16_f32 v100, v88, v89
v_cvt_pk_bf16_f32 v101, v90, v91
buffer_store_dwordx4 v[96:99], v7, s[32:35], s69 offen
buffer_store_dwordx2 v[100:101], v8, s[32:35], s69 offen
s_branch F_fin
F_ldr0:
s_cmp_ge_u32 s61, 11
s_cbranch_scc1 F_lC
s_cmp_ge_u32 s61, 8
s_cbranch_scc1 F_lB
F_lA:
s_mov_b32 s44, s61
s_and_b32 s45, s61, 3
s_add_u32 s45, s45, 8
s_mov_b32 s46, 0
s_lshl_b32 s47, s61, 1
s_add_u32 s48, s47, 1
s_lshr_b32 s49, s61, 2
s_sub_u32 s40, s3, 4
s_lshl_b32 s77, s40, 12
s_mov_b32 s28, s6
s_and_b32 s29, s7, 0xffff
s_mov_b32 s30, 2457600
s_mov_b32 s31, 0x20000
s_cmp_ge_u32 s40, 2
s_cbranch_scc1 LD_up_A
s_mov_b32 s32, s12
s_and_b32 s33, s13, 0xffff
s_mov_b32 s34, 2211840
s_mov_b32 s35, 0x20000
s_branch LD_sr_A
LD_up_A:
s_mov_b32 s32, s14
s_and_b32 s33, s15, 0xffff
s_mov_b32 s34, 2211840
s_mov_b32 s35, 0x20000
LD_sr_A:
v_lshrrev_b32 v20, 3, v2
v_and_b32 v21, 7, v2
v_bfe_u32 v22, v2, 4, 1
v_lshlrev_b32 v22, 2, v22
v_xor_b32 v21, v21, v22
v_lshlrev_b32 v21, 4, v21
v_mul_u32_u24 v4, 3840, v20
v_add_u32 v4, v4, v21
v_mul_u32_u24 v5, 3456, v20
v_add_u32 v5, v5, v21
s_mul_i32 s50, s40, 122880
s_lshl_b32 s51, s44, 7
s_add_u32 s72, s51, s50
s_lshl_b32 s51, s45, 7
s_add_u32 s73, s51, s50
s_lshl_b32 s51, s46, 7
s_add_u32 s74, s51, s50
s_and_b32 s50, s40, 1
s_mul_i32 s50, s50, 110592
s_lshl_b32 s51, s47, 7
s_add_u32 s75, s51, s50
s_lshl_b32 s51, s48, 7
s_add_u32 s76, s51, s50
s_mov_b32 s80, s16
s_and_b32 s81, s17, 0xffff
s_mov_b32 s82, 2211840
s_mov_b32 s83, 0x20000
s_mov_b32 s84, s8
s_and_b32 s85, s9, 0xffff
s_mov_b32 s86, 819200
s_mov_b32 s87, 0x20000
s_lshr_b32 s40, s2, 3
s_and_b32 s40, s40, 7
s_mul_i32 s40, s40, 80
s_sub_u32 s41, s3, 4
s_mul_i32 s42, s41, 20
s_add_u32 s42, s42, s40
v_add_u32 v23, s42, v2
v_mul_u32_u24 v23, 3840, v23
v_mov_b32 v25, 0x80000000
v_cmp_gt_u32 vcc, 20, v2
s_nop 1
v_cndmask_b32 v23, v25, v23, vcc
s_and_b32 s42, s41, 1
s_mul_i32 s42, s42, 40
s_add_u32 s42, s42, s40
v_add_u32 v24, s42, v2
v_mul_u32_u24 v24, 3456, v24
v_cmp_gt_u32 vcc, 40, v2
s_nop 1
v_cndmask_b32 v24, v25, v24, vcc
s_lshl_b32 s42, s47, 7
buffer_load_dword v27, v24, s[32:35], s42 offen
s_mov_b32 s88, -1
s_sub_u32 s50, s3, 4
s_lshr_b32 s42, s2, 3
s_lshl_b32 s53, s50, 5
s_add_u32 s53, s53, s42
s_cmp_ge_u32 s53, 74
s_cbranch_scc1 W2_1_skip
s_and_b32 s41, s2, 7
s_mul_i32 s54, s41, 378880
s_mul_i32 s55, s53, 5120
s_add_u32 s54, s54, s55
s_add_u32 s88, s54, 33554432
s_mul_i32 s43, s41, 160
s_mul_i32 s51, s50, 5120
s_add_u32 s51, s51, 12288
v_add_u32 v40, 0, v2
v_mul_u32_u24 v32, 205, v40
v_lshrrev_b32 v32, 11, v32
v_mul_u32_u24 v46, 10, v32
v_sub_u32 v40, v40, v46
v_lshlrev_b32 v40, 4, v40
v_add_u32 v41, 64, v2
v_mul_u32_u24 v33, 205, v41
v_lshrrev_b32 v33, 11, v33
v_mul_u32_u24 v46, 10, v33
v_sub_u32 v41, v41, v46
v_lshlrev_b32 v41, 4, v41
v_add_u32 v42, 128, v2
v_mul_u32_u24 v34, 205, v42
v_lshrrev_b32 v34, 11, v34
v_mul_u32_u24 v46, 10, v34
v_sub_u32 v42, v42, v46
v_lshlrev_b32 v42, 4, v42
v_add_u32 v43, 192, v2
v_mul_u32_u24 v35, 205, v43
v_lshrrev_b32 v35, 11, v35
v_mul_u32_u24 v46, 10, v35
v_sub_u32 v43, v43, v46
v_lshlrev_b32 v43, 4, v43
v_add_u32 v44, 256, v2
v_mul_u32_u24 v36, 205, v44
v_lshrrev_b32 v36, 11, v36
v_mul_u32_u24 v46, 10, v36
v_sub_u32 v44, v44, v46
v_lshlrev_b32 v44, 4, v44
s_cmp_ge_u32 s53, 54
s_cbranch_scc1 W2_1_o
s_mul_i32 s55, s53, 40960
s_add_u32 s55, s55, s43
v_mul_u32_u24 v46, 1280, v32
v_add_u32 v40, v40, v46
s_add_u32 m0, s51, 0
s_nop 0
buffer_load_dwordx4 v40, s[80:83], s55 offen lds
v_mul_u32_u24 v46, 1280, v33
v_add_u32 v41, v41, v46
s_add_u32 m0, s51, 1024
s_nop 0
buffer_load_dwordx4 v41, s[80:83], s55 offen lds
v_mul_u32_u24 v46, 1280, v34
v_add_u32 v42, v42, v46
s_add_u32 m0, s51, 2048
s_nop 0
buffer_load_dwordx4 v42, s[80:83], s55 offen lds
v_mul_u32_u24 v46, 1280, v35
v_add_u32 v43, v43, v46
s_add_u32 m0, s51, 3072
s_nop 0
buffer_load_dwordx4 v43, s[80:83], s55 offen lds
v_mul_u32_u24 v46, 1280, v36
v_add_u32 v44, v44, v46
s_add_u32 m0, s51, 4096
s_nop 0
buffer_load_dwordx4 v44, s[80:83], s55 offen lds
s_branch W2_1_skip
W2_1_o:
s_sub_u32 s55, s53, 54
s_lshl_b32 s55, s55, 1
s_add_u32 s55, s55, 0
s_mul_i32 s56, s55, 52
s_lshr_b32 s56, s56, 8
s_mul_i32 s57, s56, 5
s_sub_u32 s57, s55, s57
s_lshl_b32 s56, s56, 2
s_add_u32 s55, s56, s57
s_mul_i32 s55, s55, 20
s_mul_i32 s56, s56, 20
s_add_u32 s56, s56, 16
s_cmp_eq_u32 s57, 4
s_cselect_b32 s58, s56, s55
s_cselect_b32 s59, 1, 0
s_sub_u32 s55, s53, 54
s_lshl_b32 s55, s55, 1
s_add_u32 s55, s55, 1
s_mul_i32 s56, s55, 52
s_lshr_b32 s56, s56, 8
s_mul_i32 s57, s56, 5
s_sub_u32 s57, s55, s57
s_lshl_b32 s56, s56, 2
s_add_u32 s55, s56, s57
s_mul_i32 s55, s55, 20
s_mul_i32 s56, s56, 20
s_add_u32 s56, s56, 16
s_cmp_eq_u32 s57, 4
s_cselect_b32 s60, s56, s55
s_cselect_b32 s61, 1, 0
v_mov_b32 v47, s58
v_mov_b32 v48, s60
v_mov_b32 v49, s59
v_mov_b32 v50, s61
v_and_b32 v51, 15, v32
v_lshrrev_b32 v52, 2, v51
v_mul_u32_u24 v52, 20, v52
v_and_b32 v53, 3, v51
v_add_u32 v52, v52, v53
v_cmp_le_u32 vcc, 16, v32
s_nop 1
v_cndmask_b32 v53, v47, v48, vcc
v_cndmask_b32 v54, v49, v50, vcc
v_cmp_eq_u32 vcc, 1, v54
s_nop 1
v_cndmask_b32 v51, v51, v52, vcc
v_add_u32 v51, v51, v53
v_mul_u32_u24 v51, 1280, v51
v_add_u32 v40, v40, v51
s_add_u32 m0, s51, 0
s_nop 0
buffer_load_dwordx4 v40, s[84:87], s43 offen lds
v_and_b32 v51, 15, v33
v_lshrrev_b32 v52, 2, v51
v_mul_u32_u24 v52, 20, v52
v_and_b32 v53, 3, v51
v_add_u32 v52, v52, v53
v_cmp_le_u32 vcc, 16, v33
s_nop 1
v_cndmask_b32 v53, v47, v48, vcc
v_cndmask_b32 v54, v49, v50, vcc
v_cmp_eq_u32 vcc, 1, v54
s_nop 1
v_cndmask_b32 v51, v51, v52, vcc
v_add_u32 v51, v51, v53
v_mul_u32_u24 v51, 1280, v51
v_add_u32 v41, v41, v51
s_add_u32 m0, s51, 1024
s_nop 0
buffer_load_dwordx4 v41, s[84:87], s43 offen lds
v_and_b32 v51, 15, v34
v_lshrrev_b32 v52, 2, v51
v_mul_u32_u24 v52, 20, v52
v_and_b32 v53, 3, v51
v_add_u32 v52, v52, v53
v_cmp_le_u32 vcc, 16, v34
s_nop 1
v_cndmask_b32 v53, v47, v48, vcc
v_cndmask_b32 v54, v49, v50, vcc
v_cmp_eq_u32 vcc, 1, v54
s_nop 1
v_cndmask_b32 v51, v51, v52, vcc
v_add_u32 v51, v51, v53
v_mul_u32_u24 v51, 1280, v51
v_add_u32 v42, v42, v51
s_add_u32 m0, s51, 2048
s_nop 0
buffer_load_dwordx4 v42, s[84:87], s43 offen lds
v_and_b32 v51, 15, v35
v_lshrrev_b32 v52, 2, v51
v_mul_u32_u24 v52, 20, v52
v_and_b32 v53, 3, v51
v_add_u32 v52, v52, v53
v_cmp_le_u32 vcc, 16, v35
s_nop 1
v_cndmask_b32 v53, v47, v48, vcc
v_cndmask_b32 v54, v49, v50, vcc
v_cmp_eq_u32 vcc, 1, v54
s_nop 1
v_cndmask_b32 v51, v51, v52, vcc
v_add_u32 v51, v51, v53
v_mul_u32_u24 v51, 1280, v51
v_add_u32 v43, v43, v51
s_add_u32 m0, s51, 3072
s_nop 0
buffer_load_dwordx4 v43, s[84:87], s43 offen lds
v_and_b32 v51, 15, v36
v_lshrrev_b32 v52, 2, v51
v_mul_u32_u24 v52, 20, v52
v_and_b32 v53, 3, v51
v_add_u32 v52, v52, v53
v_cmp_le_u32 vcc, 16, v36
s_nop 1
v_cndmask_b32 v53, v47, v48, vcc
v_cndmask_b32 v54, v49, v50, vcc
v_cmp_eq_u32 vcc, 1, v54
s_nop 1
v_cndmask_b32 v51, v51, v52, vcc
v_add_u32 v51, v51, v53
v_mul_u32_u24 v51, 1280, v51
v_add_u32 v44, v44, v51
s_add_u32 m0, s51, 4096
s_nop 0
buffer_load_dwordx4 v44, s[84:87], s43 offen lds
W2_1_skip:
s_add_u32 m0, s77, 65536
s_add_u32 s78, s75, 0
buffer_load_dwordx4 v5, s[32:35], s78 offen lds
s_add_u32 m0, s77, 66560
s_add_u32 s78, s75, 27648
buffer_load_dwordx4 v5, s[32:35], s78 offen lds
s_add_u32 m0, s77, 67584
s_add_u32 s78, s75, 55296
buffer_load_dwordx4 v5, s[32:35], s78 offen lds
s_add_u32 m0, s77, 68608
s_add_u32 s78, s75, 82944
buffer_load_dwordx4 v5, s[32:35], s78 offen lds
s_add_u32 m0, s77, 81920
s_add_u32 s78, s75, 221184
buffer_load_dwordx4 v5, s[32:35], s78 offen lds
s_add_u32 m0, s77, 82944
s_add_u32 s78, s75, 248832
buffer_load_dwordx4 v5, s[32:35], s78 offen lds
s_add_u32 m0, s77, 83968
s_add_u32 s78, s75, 276480
buffer_load_dwordx4 v5, s[32:35], s78 offen lds
s_add_u32 m0, s77, 84992
s_add_u32 s78, s75, 304128
buffer_load_dwordx4 v5, s[32:35], s78 offen lds
s_barrier
s_barrier
s_add_u32 m0, s77, 98304
s_add_u32 s78, s75, 442368
buffer_load_dwordx4 v5, s[32:35], s78 offen lds
s_add_u32 m0, s77, 99328
s_add_u32 s78, s75, 470016
buffer_load_dwordx4 v5, s[32:35], s78 offen lds
s_add_u32 m0, s77, 100352
s_add_u32 s78, s75, 497664
buffer_load_dwordx4 v5, s[32:35], s78 offen lds
s_add_u32 m0, s77, 101376
s_add_u32 s78, s75, 525312
buffer_load_dwordx4 v5, s[32:35], s78 offen lds
s_add_u32 m0, s77, 114688
s_add_u32 s78, s75, 663552
buffer_load_dwordx4 v5, s[32:35], s78 offen lds
s_add_u32 m0, s77, 115712
s_add_u32 s78, s75, 691200
buffer_load_dwordx4 v5, s[32:35], s78 offen lds
s_add_u32 m0, s77, 116736
s_add_u32 s78, s75, 718848
buffer_load_dwordx4 v5, s[32:35], s78 offen lds
s_add_u32 m0, s77, 117760
s_add_u32 s78, s75, 746496
buffer_load_dwordx4 v5, s[32:35], s78 offen lds
s_add_u32 m0, s77, 131072
s_add_u32 s78, s75, 884736
buffer_load_dwordx4 v5, s[32:35], s78 offen lds
s_add_u32 m0, s77, 132096
s_add_u32 s78, s75, 912384
buffer_load_dwordx4 v5, s[32:35], s78 offen lds
s_add_u32 m0, s77, 133120
s_add_u32 s78, s75, 940032
buffer_load_dwordx4 v5, s[32:35], s78 offen lds
s_add_u32 m0, s77, 134144
s_add_u32 s78, s75, 967680
buffer_load_dwordx4 v5, s[32:35], s78 offen lds
s_add_u32 m0, s77, 147456
s_add_u32 s78, s75, 1105920
buffer_load_dwordx4 v5, s[32:35], s78 offen lds
s_add_u32 m0, s77, 148480
s_add_u32 s78, s75, 1133568
buffer_load_dwordx4 v5, s[32:35], s78 offen lds
s_add_u32 m0, s77, 149504
s_add_u32 s78, s75, 1161216
buffer_load_dwordx4 v5, s[32:35], s78 offen lds
s_add_u32 m0, s77, 150528
s_add_u32 s78, s75, 1188864
buffer_load_dwordx4 v5, s[32:35], s78 offen lds
s_add_u32 m0, s77, 32768
s_add_u32 s78, s75, 1327104
buffer_load_dwordx4 v5, s[32:35], s78 offen lds
s_add_u32 m0, s77, 33792
s_add_u32 s78, s75, 1354752
buffer_load_dwordx4 v5, s[32:35], s78 offen lds
s_add_u32 m0, s77, 34816
s_add_u32 s78, s75, 1382400
buffer_load_dwordx4 v5, s[32:35], s78 offen lds
s_add_u32 m0, s77, 35840
s_add_u32 s78, s75, 1410048
buffer_load_dwordx4 v5, s[32:35], s78 offen lds
s_add_u32 m0, s77, 49152
s_add_u32 s78, s75, 1548288
buffer_load_dwordx4 v5, s[32:35], s78 offen lds
s_add_u32 m0, s77, 50176
s_add_u32 s78, s75, 1575936
buffer_load_dwordx4 v5, s[32:35], s78 offen lds
s_add_u32 m0, s77, 51200
s_add_u32 s78, s75, 1603584
buffer_load_dwordx4 v5, s[32:35], s78 offen lds
s_add_u32 m0, s77, 52224
s_add_u32 s78, s75, 1631232
buffer_load_dwordx4 v5, s[32:35], s78 offen lds
s_waitcnt vmcnt(28)
s_barrier
v_cmp_eq_u32 vcc, 0, v2
v_mov_b32 v15, 0
v_mov_b32 v3, 0x80000000
ds_read_b32 v0, v15
v_cndmask_b32 v3, v3, 0, vcc
s_waitcnt lgkmcnt(0)
v_readfirstlane_b32 s0, v0
s_lshr_b32 s40, s2, 3
s_and_b32 s40, s40, 7
s_mul_i32 s40, s40, 80
s_sub_u32 s41, s3, 4
s_mul_i32 s42, s41, 20
s_add_u32 s42, s42, s40
v_add_u32 v23, s42, v2
v_mul_u32_u24 v23, 3840, v23
v_mov_b32 v25, 0x80000000
v_cmp_gt_u32 vcc, 20, v2
s_nop 1
v_cndmask_b32 v23, v25, v23, vcc
s_and_b32 s42, s41, 1
s_mul_i32 s42, s42, 40
s_add_u32 s42, s42, s40
v_add_u32 v24, s42, v2
v_mul_u32_u24 v24, 3456, v24
v_cmp_gt_u32 vcc, 40, v2
s_nop 1
v_cndmask_b32 v24, v25, v24, vcc
s_lshl_b32 s42, s44, 7
buffer_load_dword v26, v23, s[28:31], s42 offen
s_lshl_b32 s42, s45, 7
buffer_load_dword v26, v23, s[28:31], s42 offen
s_lshl_b32 s42, s48, 7
buffer_load_dword v27, v24, s[32:35], s42 offen
s_waitcnt vmcnt(27)
s_barrier
s_waitcnt vmcnt(23)
s_barrier
s_cmp_eq_u32 s88, -1
s_cbranch_scc1 W2F_2
v_lshrrev_b32 v32, 5, v2
v_lshlrev_b32 v32, 4, v32
v_bfe_u32 v33, v2, 4, 1
v_lshl_add_u32 v32, v33, 2, v32
v_bfe_u32 v33, v2, 2, 2
v_add_u32 v32, v32, v33
s_sub_u32 s50, s3, 4
s_mul_i32 s51, s50, 5120
s_add_u32 s51, s51, 12288
v_mul_u32_u24 v32, 160, v32
v_add_u32 v32, s51, v32
v_and_b32 v33, 3, v2
v_lshl_add_u32 v34, v33, 4, v32
v_lshl_add_u32 v35, v33, 3, v32
v_lshlrev_b32 v36, 4, v2
s_waitcnt vmcnt(63)
ds_read_b64_tr_b16 v[64:65], v34 offset:0
ds_read_b64_tr_b16 v[66:67], v34 offset:1280
ds_read_b64_tr_b16 v[68:69], v34 offset:8
ds_read_b64_tr_b16 v[70:71], v34 offset:1288
ds_read_b64_tr_b16 v[72:73], v34 offset:64
ds_read_b64_tr_b16 v[74:75], v34 offset:1344
ds_read_b64_tr_b16 v[76:77], v34 offset:72
ds_read_b64_tr_b16 v[78:79], v34 offset:1352
ds_read_b64_tr_b16 v[80:81], v35 offset:128
ds_read_b64_tr_b16 v[82:83], v35 offset:1408
s_add_u32 s52, s88, 4096
s_waitcnt lgkmcnt(8)
buffer_store_dwordx4 v[64:67], v36, s[24:27], s88 offen offset:0 sc1
s_waitcnt lgkmcnt(6)
buffer_store_dwordx4 v[68:71], v36, s[24:27], s88 offen offset:1024 sc1
s_waitcnt lgkmcnt(4)
buffer_store_dwordx4 v[72:75], v36, s[24:27], s88 offen offset:2048 sc1
s_waitcnt lgkmcnt(2)
buffer_store_dwordx4 v[76:79], v36, s[24:27], s88 offen offset:3072 sc1
s_waitcnt lgkmcnt(0)
buffer_store_dwordx4 v[80:83], v36, s[24:27], s52 offen offset:0 sc1
W2F_2:
s_add_u32 m0, s77, 65536
s_add_u32 s78, s75, 1769472
buffer_load_dwordx4 v5, s[32:35], s78 offen lds
s_add_u32 m0, s77, 66560
s_add_u32 s78, s75, 1797120
buffer_load_dwordx4 v5, s[32:35], s78 offen lds
s_add_u32 m0, s77, 67584
s_add_u32 s78, s75, 1824768
buffer_load_dwordx4 v5, s[32:35], s78 offen lds
s_add_u32 m0, s77, 68608
s_add_u32 s78, s75, 1852416
buffer_load_dwordx4 v5, s[32:35], s78 offen lds
s_waitcnt vmcnt(23)
s_barrier
s_add_u32 m0, s77, 81920
s_add_u32 s78, s75, 1990656
buffer_load_dwordx4 v5, s[32:35], s78 offen lds
s_add_u32 m0, s77, 82944
s_add_u32 s78, s75, 2018304
buffer_load_dwordx4 v5, s[32:35], s78 offen lds
s_add_u32 m0, s77, 83968
s_add_u32 s78, s75, 2045952
buffer_load_dwordx4 v5, s[32:35], s78 offen lds
s_add_u32 m0, s77, 84992
s_add_u32 s78, s75, 2073600
buffer_load_dwordx4 v5, s[32:35], s78 offen lds
s_waitcnt vmcnt(23)
s_barrier
s_add_u32 m0, s77, 98304
s_add_u32 s78, s72, 0
buffer_load_dwordx4 v4, s[28:31], s78 offen lds
s_add_u32 m0, s77, 99328
s_add_u32 s78, s72, 30720
buffer_load_dwordx4 v4, s[28:31], s78 offen lds
s_add_u32 m0, s77, 100352
s_add_u32 s78, s72, 61440
buffer_load_dwordx4 v4, s[28:31], s78 offen lds
s_add_u32 m0, s77, 101376
s_add_u32 s78, s72, 92160
buffer_load_dwordx4 v4, s[28:31], s78 offen lds
s_waitcnt vmcnt(23)
s_barrier
s_add_u32 m0, s77, 114688
s_add_u32 s78, s72, 491520
buffer_load_dwordx4 v4, s[28:31], s78 offen lds
s_add_u32 m0, s77, 115712
s_add_u32 s78, s72, 522240
buffer_load_dwordx4 v4, s[28:31], s78 offen lds
s_add_u32 m0, s77, 116736
s_add_u32 s78, s72, 552960
buffer_load_dwordx4 v4, s[28:31], s78 offen lds
s_add_u32 m0, s77, 117760
s_add_u32 s78, s72, 583680
buffer_load_dwordx4 v4, s[28:31], s78 offen lds
s_waitcnt vmcnt(23)
s_barrier
s_add_u32 m0, s77, 131072
s_add_u32 s78, s72, 983040
buffer_load_dwordx4 v4, s[28:31], s78 offen lds
s_add_u32 m0, s77, 132096
s_add_u32 s78, s72, 1013760
buffer_load_dwordx4 v4, s[28:31], s78 offen lds
s_add_u32 m0, s77, 133120
s_add_u32 s78, s72, 1044480
buffer_load_dwordx4 v4, s[28:31], s78 offen lds
s_add_u32 m0, s77, 134144
s_add_u32 s78, s72, 1075200
buffer_load_dwordx4 v4, s[28:31], s78 offen lds
s_waitcnt vmcnt(16)
s_barrier
s_cmp_lg_u32 s3, 4
s_cbranch_scc1 FW_3
s_lshl_b32 s40, s2, 7
s_add_u32 s40, s40, 65536
buffer_store_dword v0, v3, s[24:27], s40 offen offset:0 sc1
FW_3:
s_add_u32 m0, s77, 147456
s_add_u32 s78, s72, 1474560
buffer_load_dwordx4 v4, s[28:31], s78 offen lds
s_add_u32 m0, s77, 148480
s_add_u32 s78, s72, 1505280
buffer_load_dwordx4 v4, s[28:31], s78 offen lds
s_add_u32 m0, s77, 149504
s_add_u32 s78, s72, 1536000
buffer_load_dwordx4 v4, s[28:31], s78 offen lds
s_add_u32 m0, s77, 150528
s_add_u32 s78, s72, 1566720
buffer_load_dwordx4 v4, s[28:31], s78 offen lds
s_waitcnt vmcnt(16)
s_barrier
s_add_u32 m0, s77, 32768
s_add_u32 s78, s72, 1966080
buffer_load_dwordx4 v4, s[28:31], s78 offen lds
s_add_u32 m0, s77, 33792
s_add_u32 s78, s72, 1996800
buffer_load_dwordx4 v4, s[28:31], s78 offen lds
s_add_u32 m0, s77, 34816
s_add_u32 s78, s72, 2027520
buffer_load_dwordx4 v4, s[28:31], s78 offen lds
s_add_u32 m0, s77, 35840
s_add_u32 s78, s72, 2058240
buffer_load_dwordx4 v4, s[28:31], s78 offen lds
s_waitcnt vmcnt(20)
s_barrier
s_waitcnt vmcnt(16)
s_barrier
s_add_u32 m0, s77, 49152
s_add_u32 s78, s73, 0
buffer_load_dwordx4 v4, s[28:31], s78 offen lds
s_add_u32 m0, s77, 50176
s_add_u32 s78, s73, 30720
buffer_load_dwordx4 v4, s[28:31], s78 offen lds
s_add_u32 m0, s77, 51200
s_add_u32 s78, s73, 61440
buffer_load_dwordx4 v4, s[28:31], s78 offen lds
s_add_u32 m0, s77, 52224
s_add_u32 s78, s73, 92160
buffer_load_dwordx4 v4, s[28:31], s78 offen lds
s_add_u32 m0, s77, 65536
s_add_u32 s78, s73, 491520
buffer_load_dwordx4 v4, s[28:31], s78 offen lds
s_add_u32 m0, s77, 66560
s_add_u32 s78, s73, 522240
buffer_load_dwordx4 v4, s[28:31], s78 offen lds
s_add_u32 m0, s77, 67584
s_add_u32 s78, s73, 552960
buffer_load_dwordx4 v4, s[28:31], s78 offen lds
s_add_u32 m0, s77, 68608
s_add_u32 s78, s73, 583680
buffer_load_dwordx4 v4, s[28:31], s78 offen lds
s_waitcnt vmcnt(20)
s_barrier
s_add_u32 m0, s77, 81920
s_add_u32 s78, s73, 983040
buffer_load_dwordx4 v4, s[28:31], s78 offen lds
s_add_u32 m0, s77, 82944
s_add_u32 s78, s73, 1013760
buffer_load_dwordx4 v4, s[28:31], s78 offen lds
s_add_u32 m0, s77, 83968
s_add_u32 s78, s73, 1044480
buffer_load_dwordx4 v4, s[28:31], s78 offen lds
s_add_u32 m0, s77, 84992
s_add_u32 s78, s73, 1075200
buffer_load_dwordx4 v4, s[28:31], s78 offen lds
s_waitcnt vmcnt(20)
s_barrier
s_add_u32 m0, s77, 98304
s_add_u32 s78, s73, 1474560
buffer_load_dwordx4 v4, s[28:31], s78 offen lds
s_add_u32 m0, s77, 99328
s_add_u32 s78, s73, 1505280
buffer_load_dwordx4 v4, s[28:31], s78 offen lds
s_add_u32 m0, s77, 100352
s_add_u32 s78, s73, 1536000
buffer_load_dwordx4 v4, s[28:31], s78 offen lds
s_add_u32 m0, s77, 101376
s_add_u32 s78, s73, 1566720
buffer_load_dwordx4 v4, s[28:31], s78 offen lds
s_waitcnt vmcnt(20)
s_barrier
s_add_u32 m0, s77, 114688
s_add_u32 s78, s73, 1966080
buffer_load_dwordx4 v4, s[28:31], s78 offen lds
s_add_u32 m0, s77, 115712
s_add_u32 s78, s73, 1996800
buffer_load_dwordx4 v4, s[28:31], s78 offen lds
s_add_u32 m0, s77, 116736
s_add_u32 s78, s73, 2027520
buffer_load_dwordx4 v4, s[28:31], s78 offen lds
s_add_u32 m0, s77, 117760
s_add_u32 s78, s73, 2058240
buffer_load_dwordx4 v4, s[28:31], s78 offen lds
s_waitcnt vmcnt(20)
s_barrier
s_add_u32 m0, s77, 131072
s_add_u32 s78, s76, 0
buffer_load_dwordx4 v5, s[32:35], s78 offen lds
s_add_u32 m0, s77, 132096
s_add_u32 s78, s76, 27648
buffer_load_dwordx4 v5, s[32:35], s78 offen lds
s_add_u32 m0, s77, 133120
s_add_u32 s78, s76, 55296
buffer_load_dwordx4 v5, s[32:35], s78 offen lds
s_add_u32 m0, s77, 134144
s_add_u32 s78, s76, 82944
buffer_load_dwordx4 v5, s[32:35], s78 offen lds
s_waitcnt vmcnt(20)
s_barrier
s_add_u32 m0, s77, 147456
s_add_u32 s78, s76, 221184
buffer_load_dwordx4 v5, s[32:35], s78 offen lds
s_add_u32 m0, s77, 148480
s_add_u32 s78, s76, 248832
buffer_load_dwordx4 v5, s[32:35], s78 offen lds
s_add_u32 m0, s77, 149504
s_add_u32 s78, s76, 276480
buffer_load_dwordx4 v5, s[32:35], s78 offen lds
s_add_u32 m0, s77, 150528
s_add_u32 s78, s76, 304128
buffer_load_dwordx4 v5, s[32:35], s78 offen lds
s_waitcnt vmcnt(20)
s_barrier
s_add_u32 m0, s77, 32768
s_add_u32 s78, s76, 442368
buffer_load_dwordx4 v5, s[32:35], s78 offen lds
s_add_u32 m0, s77, 33792
s_add_u32 s78, s76, 470016
buffer_load_dwordx4 v5, s[32:35], s78 offen lds
s_add_u32 m0, s77, 34816
s_add_u32 s78, s76, 497664
buffer_load_dwordx4 v5, s[32:35], s78 offen lds
s_add_u32 m0, s77, 35840
s_add_u32 s78, s76, 525312
buffer_load_dwordx4 v5, s[32:35], s78 offen lds
s_waitcnt vmcnt(20)
s_barrier
s_add_u32 m0, s77, 49152
s_add_u32 s78, s76, 663552
buffer_load_dwordx4 v5, s[32:35], s78 offen lds
s_add_u32 m0, s77, 50176
s_add_u32 s78, s76, 691200
buffer_load_dwordx4 v5, s[32:35], s78 offen lds
s_add_u32 m0, s77, 51200
s_add_u32 s78, s76, 718848
buffer_load_dwordx4 v5, s[32:35], s78 offen lds
s_add_u32 m0, s77, 52224
s_add_u32 s78, s76, 746496
buffer_load_dwordx4 v5, s[32:35], s78 offen lds
s_waitcnt vmcnt(20)
s_barrier
s_add_u32 m0, s77, 65536
s_add_u32 s78, s76, 884736
buffer_load_dwordx4 v5, s[32:35], s78 offen lds
s_add_u32 m0, s77, 66560
s_add_u32 s78, s76, 912384
buffer_load_dwordx4 v5, s[32:35], s78 offen lds
s_add_u32 m0, s77, 67584
s_add_u32 s78, s76, 940032
buffer_load_dwordx4 v5, s[32:35], s78 offen lds
s_add_u32 m0, s77, 68608
s_add_u32 s78, s76, 967680
buffer_load_dwordx4 v5, s[32:35], s78 offen lds
s_waitcnt vmcnt(20)
s_barrier
s_add_u32 m0, s77, 81920
s_add_u32 s78, s76, 1105920
buffer_load_dwordx4 v5, s[32:35], s78 offen lds
s_add_u32 m0, s77, 82944
s_add_u32 s78, s76, 1133568
buffer_load_dwordx4 v5, s[32:35], s78 offen lds
s_add_u32 m0, s77, 83968
s_add_u32 s78, s76, 1161216
buffer_load_dwordx4 v5, s[32:35], s78 offen lds
s_add_u32 m0, s77, 84992
s_add_u32 s78, s76, 1188864
buffer_load_dwordx4 v5, s[32:35], s78 offen lds
s_waitcnt vmcnt(16)
s_barrier
s_add_u32 m0, s77, 98304
s_add_u32 s78, s76, 1327104
buffer_load_dwordx4 v5, s[32:35], s78 offen lds
s_add_u32 m0, s77, 99328
s_add_u32 s78, s76, 1354752
buffer_load_dwordx4 v5, s[32:35], s78 offen lds
s_add_u32 m0, s77, 100352
s_add_u32 s78, s76, 1382400
buffer_load_dwordx4 v5, s[32:35], s78 offen lds
s_add_u32 m0, s77, 101376
s_add_u32 s78, s76, 1410048
buffer_load_dwordx4 v5, s[32:35], s78 offen lds
s_waitcnt vmcnt(16)
s_barrier
s_add_u32 m0, s77, 114688
s_add_u32 s78, s76, 1548288
buffer_load_dwordx4 v5, s[32:35], s78 offen lds
s_add_u32 m0, s77, 115712
s_add_u32 s78, s76, 1575936
buffer_load_dwordx4 v5, s[32:35], s78 offen lds
s_add_u32 m0, s77, 116736
s_add_u32 s78, s76, 1603584
buffer_load_dwordx4 v5, s[32:35], s78 offen lds
s_add_u32 m0, s77, 117760
s_add_u32 s78, s76, 1631232
buffer_load_dwordx4 v5, s[32:35], s78 offen lds
s_waitcnt vmcnt(20)
s_barrier
s_waitcnt vmcnt(16)
s_barrier
s_add_u32 m0, s77, 131072
s_add_u32 s78, s76, 1769472
buffer_load_dwordx4 v5, s[32:35], s78 offen lds
s_add_u32 m0, s77, 132096
s_add_u32 s78, s76, 1797120
buffer_load_dwordx4 v5, s[32:35], s78 offen lds
s_add_u32 m0, s77, 133120
s_add_u32 s78, s76, 1824768
buffer_load_dwordx4 v5, s[32:35], s78 offen lds
s_add_u32 m0, s77, 134144
s_add_u32 s78, s76, 1852416
buffer_load_dwordx4 v5, s[32:35], s78 offen lds
s_add_u32 m0, s77, 147456
s_add_u32 s78, s76, 1990656
buffer_load_dwordx4 v5, s[32:35], s78 offen lds
s_add_u32 m0, s77, 148480
s_add_u32 s78, s76, 2018304
buffer_load_dwordx4 v5, s[32:35], s78 offen lds
s_add_u32 m0, s77, 149504
s_add_u32 s78, s76, 2045952
buffer_load_dwordx4 v5, s[32:35], s78 offen lds
s_add_u32 m0, s77, 150528
s_add_u32 s78, s76, 2073600
buffer_load_dwordx4 v5, s[32:35], s78 offen lds
s_waitcnt vmcnt(20)
s_barrier
s_and_b32 s61, s2, 7
s_lshr_b32 s60, s2, 3
v_add_u32 v8, 0, v2
v_mul_u32_u24 v13, 205, v8
v_lshrrev_b32 v13, 14, v13
v_mul_u32_u24 v14, 80, v13
v_sub_u32 v8, v8, v14
v_lshlrev_b32 v8, 4, v8
v_mul_u32_u24 v13, 10368, v13
v_add_u32 v8, v8, v13
v_add_u32 v8, 4096, v8
v_add_u32 v9, 64, v2
v_mul_u32_u24 v13, 205, v9
v_lshrrev_b32 v13, 14, v13
v_mul_u32_u24 v14, 80, v13
v_sub_u32 v9, v9, v14
v_lshlrev_b32 v9, 4, v9
v_mul_u32_u24 v13, 10368, v13
v_add_u32 v9, v9, v13
v_add_u32 v9, 3072, v9
v_add_u32 v10, 128, v2
v_mul_u32_u24 v13, 205, v10
v_lshrrev_b32 v13, 14, v13
v_mul_u32_u24 v14, 80, v13
v_sub_u32 v10, v10, v14
v_lshlrev_b32 v10, 4, v10
v_mul_u32_u24 v13, 10368, v13
v_add_u32 v10, v10, v13
v_add_u32 v10, 2048, v10
v_add_u32 v11, 192, v2
v_mul_u32_u24 v13, 205, v11
v_lshrrev_b32 v13, 14, v13
v_mul_u32_u24 v14, 80, v13
v_sub_u32 v11, v11, v14
v_lshlrev_b32 v11, 4, v11
v_mul_u32_u24 v13, 10368, v13
v_add_u32 v11, v11, v13
v_add_u32 v11, 1024, v11
v_add_u32 v12, 256, v2
v_mul_u32_u24 v13, 205, v12
v_lshrrev_b32 v13, 14, v13
v_mul_u32_u24 v14, 80, v13
v_sub_u32 v12, v12, v14
v_lshlrev_b32 v12, 4, v12
v_mul_u32_u24 v13, 10368, v13
v_add_u32 v12, v12, v13
v_add_u32 v12, 4096, v12
v_lshlrev_b32 v13, 4, v2
s_mov_b32 s41, 7561744
s_mov_b32 s42, 1602337
s_cmp_eq_u32 s61, 1
s_cselect_b32 s41, s42, s41
s_mov_b32 s42, 2267186
s_cmp_eq_u32 s61, 2
s_cselect_b32 s41, s42, s41
s_mov_b32 s42, 3385667
s_cmp_eq_u32 s61, 3
s_cselect_b32 s41, s42, s41
s_mov_b32 s42, 5622629
s_cmp_eq_u32 s61, 4
s_cselect_b32 s41, s42, s41
s_mov_b32 s42, 6741110
s_cmp_eq_u32 s61, 5
s_cselect_b32 s41, s42, s41
s_mov_b32 s42, 8311815
s_cmp_eq_u32 s61, 6
s_cselect_b32 s41, s42, s41
s_mov_b32 s42, 16666944
s_cmp_eq_u32 s61, 7
s_cselect_b32 s41, s42, s41
v_min_u32 v18, 59, v2
v_mul_u32_u24 v16, 43, v18
v_lshrrev_b32 v16, 8, v16
v_mul_u32_u24 v17, 6, v16
v_sub_u32 v17, v18, v17
v_lshlrev_b32 v17, 2, v17
v_lshrrev_b32 v17, v17, s41
v_and_b32 v17, 15, v17
s_lshl_b32 s42, s60, 1
s_sub_i32 s42, s42, 8
v_add_u32 v16, s42, v16
v_max_i32 v16, 0, v16
v_lshl_add_u32 v16, v16, 4, v17
v_lshlrev_b32 v16, 9, v16
v_add_u32 v84, 524288, v16
s_mul_i32 s41, s61, 80
s_add_u32 s43, s41, 79
s_lshr_b32 s41, s41, 7
s_lshr_b32 s43, s43, 7
s_add_u32 s41, s41, 11
s_add_u32 s43, s43, 11
v_min_u32 v18, 19, v2
v_and_b32 v17, 1, v18
v_cmp_eq_u32 vcc, 1, v17
v_mov_b32 v17, s41
v_mov_b32 v19, s43
v_cndmask_b32 v17, v17, v19, vcc
v_lshrrev_b32 v16, 1, v18
v_add_u32 v16, s42, v16
v_max_i32 v16, 0, v16
v_lshl_add_u32 v16, v16, 4, v17
v_lshlrev_b32 v16, 9, v16
v_add_u32 v85, 524416, v16
s_and_b32 s43, s2, 7
s_lshr_b32 s41, s2, 3
s_and_b32 s42, s43, 1
s_lshl_b32 s42, s42, 2
s_and_b32 s40, s41, 3
s_add_u32 s40, s42, s40
s_lshr_b32 s42, s43, 1
s_lshl_b32 s42, s42, 3
s_lshr_b32 s41, s41, 2
s_add_u32 s41, s42, s41
s_lshl_b32 s40, s40, 7
s_add_u32 s40, s40, 65536
v_and_b32 v16, 31, v2
v_lshlrev_b32 v16, 10, v16
v_add_u32 v86, s40, v16
s_lshl_b32 s41, s41, 14
s_add_u32 s41, s41, 524544
v_and_b32 v16, 15, v2
v_min_u32 v16, 10, v16
v_bfe_u32 v17, v2, 4, 1
v_lshl_add_u32 v16, v17, 4, v16
v_lshlrev_b32 v16, 9, v16
v_add_u32 v87, s41, v16
buffer_load_dword v88, v84, s[24:27], 0 offen sc1
buffer_load_dword v89, v85, s[24:27], 0 offen sc1
buffer_load_dword v90, v86, s[24:27], 0 offen sc1
buffer_load_dword v91, v87, s[24:27], 0 offen sc1
s_waitcnt vmcnt(20)
s_barrier
s_waitcnt vmcnt(4)
s_barrier
s_branch F_ltail
F_lB:
s_add_u32 s44, s61, 4
s_mov_b32 s45, 0
s_mov_b32 s46, 0
s_lshl_b32 s47, s61, 1
s_add_u32 s48, s47, 1
s_mov_b32 s49, 0
s_sub_u32 s40, s3, 4
s_lshl_b32 s77, s40, 12
s_mov_b32 s28, s6
s_and_b32 s29, s7, 0xffff
s_mov_b32 s30, 2457600
s_mov_b32 s31, 0x20000
s_cmp_ge_u32 s40, 2
s_cbranch_scc1 LD_up_B
s_mov_b32 s32, s12
s_and_b32 s33, s13, 0xffff
s_mov_b32 s34, 2211840
s_mov_b32 s35, 0x20000
s_branch LD_sr_B
LD_up_B:
s_mov_b32 s32, s14
s_and_b32 s33, s15, 0xffff
s_mov_b32 s34, 2211840
s_mov_b32 s35, 0x20000
LD_sr_B:
v_lshrrev_b32 v20, 3, v2
v_and_b32 v21, 7, v2
v_bfe_u32 v22, v2, 4, 1
v_lshlrev_b32 v22, 2, v22
v_xor_b32 v21, v21, v22
v_lshlrev_b32 v21, 4, v21
v_mul_u32_u24 v4, 3840, v20
v_add_u32 v4, v4, v21
v_mul_u32_u24 v5, 3456, v20
v_add_u32 v5, v5, v21
s_mul_i32 s50, s40, 122880
s_lshl_b32 s51, s44, 7
s_add_u32 s72, s51, s50
s_lshl_b32 s51, s45, 7
s_add_u32 s73, s51, s50
s_lshl_b32 s51, s46, 7
s_add_u32 s74, s51, s50
s_and_b32 s50, s40, 1
s_mul_i32 s50, s50, 110592
s_lshl_b32 s51, s47, 7
s_add_u32 s75, s51, s50
s_lshl_b32 s51, s48, 7
s_add_u32 s76, s51, s50
s_mov_b32 s80, s16
s_and_b32 s81, s17, 0xffff
s_mov_b32 s82, 2211840
s_mov_b32 s83, 0x20000
s_mov_b32 s84, s8
s_and_b32 s85, s9, 0xffff
s_mov_b32 s86, 819200
s_mov_b32 s87, 0x20000
s_lshr_b32 s40, s2, 3
s_and_b32 s40, s40, 7
s_mul_i32 s40, s40, 80
s_sub_u32 s41, s3, 4
s_mul_i32 s42, s41, 20
s_add_u32 s42, s42, s40
v_add_u32 v23, s42, v2
v_mul_u32_u24 v23, 3840, v23
v_mov_b32 v25, 0x80000000
v_cmp_gt_u32 vcc, 20, v2
s_nop 1
v_cndmask_b32 v23, v25, v23, vcc
s_and_b32 s42, s41, 1
s_mul_i32 s42, s42, 40
s_add_u32 s42, s42, s40
v_add_u32 v24, s42, v2
v_mul_u32_u24 v24, 3456, v24
v_cmp_gt_u32 vcc, 40, v2
s_nop 1
v_cndmask_b32 v24, v25, v24, vcc
s_lshl_b32 s42, s47, 7
buffer_load_dword v27, v24, s[32:35], s42 offen
s_mov_b32 s88, -1
s_sub_u32 s50, s3, 4
s_lshr_b32 s42, s2, 3
s_lshl_b32 s53, s50, 5
s_add_u32 s53, s53, s42
s_cmp_ge_u32 s53, 74
s_cbranch_scc1 W2_4_skip
s_and_b32 s41, s2, 7
s_mul_i32 s54, s41, 378880
s_mul_i32 s55, s53, 5120
s_add_u32 s54, s54, s55
s_add_u32 s88, s54, 33554432
s_mul_i32 s43, s41, 160
s_mul_i32 s51, s50, 5120
s_add_u32 s51, s51, 12288
v_add_u32 v40, 0, v2
v_mul_u32_u24 v32, 205, v40
v_lshrrev_b32 v32, 11, v32
v_mul_u32_u24 v46, 10, v32
v_sub_u32 v40, v40, v46
v_lshlrev_b32 v40, 4, v40
v_add_u32 v41, 64, v2
v_mul_u32_u24 v33, 205, v41
v_lshrrev_b32 v33, 11, v33
v_mul_u32_u24 v46, 10, v33
v_sub_u32 v41, v41, v46
v_lshlrev_b32 v41, 4, v41
v_add_u32 v42, 128, v2
v_mul_u32_u24 v34, 205, v42
v_lshrrev_b32 v34, 11, v34
v_mul_u32_u24 v46, 10, v34
v_sub_u32 v42, v42, v46
v_lshlrev_b32 v42, 4, v42
v_add_u32 v43, 192, v2
v_mul_u32_u24 v35, 205, v43
v_lshrrev_b32 v35, 11, v35
v_mul_u32_u24 v46, 10, v35
v_sub_u32 v43, v43, v46
v_lshlrev_b32 v43, 4, v43
v_add_u32 v44, 256, v2
v_mul_u32_u24 v36, 205, v44
v_lshrrev_b32 v36, 11, v36
v_mul_u32_u24 v46, 10, v36
v_sub_u32 v44, v44, v46
v_lshlrev_b32 v44, 4, v44
s_cmp_ge_u32 s53, 54
s_cbranch_scc1 W2_4_o
s_mul_i32 s55, s53, 40960
s_add_u32 s55, s55, s43
v_mul_u32_u24 v46, 1280, v32
v_add_u32 v40, v40, v46
s_add_u32 m0, s51, 0
s_nop 0
buffer_load_dwordx4 v40, s[80:83], s55 offen lds
v_mul_u32_u24 v46, 1280, v33
v_add_u32 v41, v41, v46
s_add_u32 m0, s51, 1024
s_nop 0
buffer_load_dwordx4 v41, s[80:83], s55 offen lds
v_mul_u32_u24 v46, 1280, v34
v_add_u32 v42, v42, v46
s_add_u32 m0, s51, 2048
s_nop 0
buffer_load_dwordx4 v42, s[80:83], s55 offen lds
v_mul_u32_u24 v46, 1280, v35
v_add_u32 v43, v43, v46
s_add_u32 m0, s51, 3072
s_nop 0
buffer_load_dwordx4 v43, s[80:83], s55 offen lds
v_mul_u32_u24 v46, 1280, v36
v_add_u32 v44, v44, v46
s_add_u32 m0, s51, 4096
s_nop 0
buffer_load_dwordx4 v44, s[80:83], s55 offen lds
s_branch W2_4_skip
W2_4_o:
s_sub_u32 s55, s53, 54
s_lshl_b32 s55, s55, 1
s_add_u32 s55, s55, 0
s_mul_i32 s56, s55, 52
s_lshr_b32 s56, s56, 8
s_mul_i32 s57, s56, 5
s_sub_u32 s57, s55, s57
s_lshl_b32 s56, s56, 2
s_add_u32 s55, s56, s57
s_mul_i32 s55, s55, 20
s_mul_i32 s56, s56, 20
s_add_u32 s56, s56, 16
s_cmp_eq_u32 s57, 4
s_cselect_b32 s58, s56, s55
s_cselect_b32 s59, 1, 0
s_sub_u32 s55, s53, 54
s_lshl_b32 s55, s55, 1
s_add_u32 s55, s55, 1
s_mul_i32 s56, s55, 52
s_lshr_b32 s56, s56, 8
s_mul_i32 s57, s56, 5
s_sub_u32 s57, s55, s57
s_lshl_b32 s56, s56, 2
s_add_u32 s55, s56, s57
s_mul_i32 s55, s55, 20
s_mul_i32 s56, s56, 20
s_add_u32 s56, s56, 16
s_cmp_eq_u32 s57, 4
s_cselect_b32 s60, s56, s55
s_cselect_b32 s61, 1, 0
v_mov_b32 v47, s58
v_mov_b32 v48, s60
v_mov_b32 v49, s59
v_mov_b32 v50, s61
v_and_b32 v51, 15, v32
v_lshrrev_b32 v52, 2, v51
v_mul_u32_u24 v52, 20, v52
v_and_b32 v53, 3, v51
v_add_u32 v52, v52, v53
v_cmp_le_u32 vcc, 16, v32
s_nop 1
v_cndmask_b32 v53, v47, v48, vcc
v_cndmask_b32 v54, v49, v50, vcc
v_cmp_eq_u32 vcc, 1, v54
s_nop 1
v_cndmask_b32 v51, v51, v52, vcc
v_add_u32 v51, v51, v53
v_mul_u32_u24 v51, 1280, v51
v_add_u32 v40, v40, v51
s_add_u32 m0, s51, 0
s_nop 0
buffer_load_dwordx4 v40, s[84:87], s43 offen lds
v_and_b32 v51, 15, v33
v_lshrrev_b32 v52, 2, v51
v_mul_u32_u24 v52, 20, v52
v_and_b32 v53, 3, v51
v_add_u32 v52, v52, v53
v_cmp_le_u32 vcc, 16, v33
s_nop 1
v_cndmask_b32 v53, v47, v48, vcc
v_cndmask_b32 v54, v49, v50, vcc
v_cmp_eq_u32 vcc, 1, v54
s_nop 1
v_cndmask_b32 v51, v51, v52, vcc
v_add_u32 v51, v51, v53
v_mul_u32_u24 v51, 1280, v51
v_add_u32 v41, v41, v51
s_add_u32 m0, s51, 1024
s_nop 0
buffer_load_dwordx4 v41, s[84:87], s43 offen lds
v_and_b32 v51, 15, v34
v_lshrrev_b32 v52, 2, v51
v_mul_u32_u24 v52, 20, v52
v_and_b32 v53, 3, v51
v_add_u32 v52, v52, v53
v_cmp_le_u32 vcc, 16, v34
s_nop 1
v_cndmask_b32 v53, v47, v48, vcc
v_cndmask_b32 v54, v49, v50, vcc
v_cmp_eq_u32 vcc, 1, v54
s_nop 1
v_cndmask_b32 v51, v51, v52, vcc
v_add_u32 v51, v51, v53
v_mul_u32_u24 v51, 1280, v51
v_add_u32 v42, v42, v51
s_add_u32 m0, s51, 2048
s_nop 0
buffer_load_dwordx4 v42, s[84:87], s43 offen lds
v_and_b32 v51, 15, v35
v_lshrrev_b32 v52, 2, v51
v_mul_u32_u24 v52, 20, v52
v_and_b32 v53, 3, v51
v_add_u32 v52, v52, v53
v_cmp_le_u32 vcc, 16, v35
s_nop 1
v_cndmask_b32 v53, v47, v48, vcc
v_cndmask_b32 v54, v49, v50, vcc
v_cmp_eq_u32 vcc, 1, v54
s_nop 1
v_cndmask_b32 v51, v51, v52, vcc
v_add_u32 v51, v51, v53
v_mul_u32_u24 v51, 1280, v51
v_add_u32 v43, v43, v51
s_add_u32 m0, s51, 3072
s_nop 0
buffer_load_dwordx4 v43, s[84:87], s43 offen lds
v_and_b32 v51, 15, v36
v_lshrrev_b32 v52, 2, v51
v_mul_u32_u24 v52, 20, v52
v_and_b32 v53, 3, v51
v_add_u32 v52, v52, v53
v_cmp_le_u32 vcc, 16, v36
s_nop 1
v_cndmask_b32 v53, v47, v48, vcc
v_cndmask_b32 v54, v49, v50, vcc
v_cmp_eq_u32 vcc, 1, v54
s_nop 1
v_cndmask_b32 v51, v51, v52, vcc
v_add_u32 v51, v51, v53
v_mul_u32_u24 v51, 1280, v51
v_add_u32 v44, v44, v51
s_add_u32 m0, s51, 4096
s_nop 0
buffer_load_dwordx4 v44, s[84:87], s43 offen lds
W2_4_skip:
s_add_u32 m0, s77, 147456
s_add_u32 s78, s75, 0
buffer_load_dwordx4 v5, s[32:35], s78 offen lds
s_add_u32 m0, s77, 148480
s_add_u32 s78, s75, 27648
buffer_load_dwordx4 v5, s[32:35], s78 offen lds
s_add_u32 m0, s77, 149504
s_add_u32 s78, s75, 55296
buffer_load_dwordx4 v5, s[32:35], s78 offen lds
s_add_u32 m0, s77, 150528
s_add_u32 s78, s75, 82944
buffer_load_dwordx4 v5, s[32:35], s78 offen lds
s_add_u32 m0, s77, 32768
s_add_u32 s78, s75, 221184
buffer_load_dwordx4 v5, s[32:35], s78 offen lds
s_add_u32 m0, s77, 33792
s_add_u32 s78, s75, 248832
buffer_load_dwordx4 v5, s[32:35], s78 offen lds
s_add_u32 m0, s77, 34816
s_add_u32 s78, s75, 276480
buffer_load_dwordx4 v5, s[32:35], s78 offen lds
s_add_u32 m0, s77, 35840
s_add_u32 s78, s75, 304128
buffer_load_dwordx4 v5, s[32:35], s78 offen lds
s_barrier
s_barrier
s_add_u32 m0, s77, 49152
s_add_u32 s78, s75, 442368
buffer_load_dwordx4 v5, s[32:35], s78 offen lds
s_add_u32 m0, s77, 50176
s_add_u32 s78, s75, 470016
buffer_load_dwordx4 v5, s[32:35], s78 offen lds
s_add_u32 m0, s77, 51200
s_add_u32 s78, s75, 497664
buffer_load_dwordx4 v5, s[32:35], s78 offen lds
s_add_u32 m0, s77, 52224
s_add_u32 s78, s75, 525312
buffer_load_dwordx4 v5, s[32:35], s78 offen lds
s_add_u32 m0, s77, 65536
s_add_u32 s78, s75, 663552
buffer_load_dwordx4 v5, s[32:35], s78 offen lds
s_add_u32 m0, s77, 66560
s_add_u32 s78, s75, 691200
buffer_load_dwordx4 v5, s[32:35], s78 offen lds
s_add_u32 m0, s77, 67584
s_add_u32 s78, s75, 718848
buffer_load_dwordx4 v5, s[32:35], s78 offen lds
s_add_u32 m0, s77, 68608
s_add_u32 s78, s75, 746496
buffer_load_dwordx4 v5, s[32:35], s78 offen lds
s_add_u32 m0, s77, 81920
s_add_u32 s78, s75, 884736
buffer_load_dwordx4 v5, s[32:35], s78 offen lds
s_add_u32 m0, s77, 82944
s_add_u32 s78, s75, 912384
buffer_load_dwordx4 v5, s[32:35], s78 offen lds
s_add_u32 m0, s77, 83968
s_add_u32 s78, s75, 940032
buffer_load_dwordx4 v5, s[32:35], s78 offen lds
s_add_u32 m0, s77, 84992
s_add_u32 s78, s75, 967680
buffer_load_dwordx4 v5, s[32:35], s78 offen lds
s_add_u32 m0, s77, 98304
s_add_u32 s78, s75, 1105920
buffer_load_dwordx4 v5, s[32:35], s78 offen lds
s_add_u32 m0, s77, 99328
s_add_u32 s78, s75, 1133568
buffer_load_dwordx4 v5, s[32:35], s78 offen lds
s_add_u32 m0, s77, 100352
s_add_u32 s78, s75, 1161216
buffer_load_dwordx4 v5, s[32:35], s78 offen lds
s_add_u32 m0, s77, 101376
s_add_u32 s78, s75, 1188864
buffer_load_dwordx4 v5, s[32:35], s78 offen lds
s_add_u32 m0, s77, 114688
s_add_u32 s78, s75, 1327104
buffer_load_dwordx4 v5, s[32:35], s78 offen lds
s_add_u32 m0, s77, 115712
s_add_u32 s78, s75, 1354752
buffer_load_dwordx4 v5, s[32:35], s78 offen lds
s_add_u32 m0, s77, 116736
s_add_u32 s78, s75, 1382400
buffer_load_dwordx4 v5, s[32:35], s78 offen lds
s_add_u32 m0, s77, 117760
s_add_u32 s78, s75, 1410048
buffer_load_dwordx4 v5, s[32:35], s78 offen lds
s_add_u32 m0, s77, 131072
s_add_u32 s78, s75, 1548288
buffer_load_dwordx4 v5, s[32:35], s78 offen lds
s_add_u32 m0, s77, 132096
s_add_u32 s78, s75, 1575936
buffer_load_dwordx4 v5, s[32:35], s78 offen lds
s_add_u32 m0, s77, 133120
s_add_u32 s78, s75, 1603584
buffer_load_dwordx4 v5, s[32:35], s78 offen lds
s_add_u32 m0, s77, 134144
s_add_u32 s78, s75, 1631232
buffer_load_dwordx4 v5, s[32:35], s78 offen lds
s_waitcnt vmcnt(28)
s_barrier
v_cmp_eq_u32 vcc, 0, v2
v_mov_b32 v15, 0
v_mov_b32 v3, 0x80000000
ds_read_b32 v0, v15
v_cndmask_b32 v3, v3, 0, vcc
s_waitcnt lgkmcnt(0)
v_readfirstlane_b32 s0, v0
s_lshr_b32 s40, s2, 3
s_and_b32 s40, s40, 7
s_mul_i32 s40, s40, 80
s_sub_u32 s41, s3, 4
s_mul_i32 s42, s41, 20
s_add_u32 s42, s42, s40
v_add_u32 v23, s42, v2
v_mul_u32_u24 v23, 3840, v23
v_mov_b32 v25, 0x80000000
v_cmp_gt_u32 vcc, 20, v2
s_nop 1
v_cndmask_b32 v23, v25, v23, vcc
s_and_b32 s42, s41, 1
s_mul_i32 s42, s42, 40
s_add_u32 s42, s42, s40
v_add_u32 v24, s42, v2
v_mul_u32_u24 v24, 3456, v24
v_cmp_gt_u32 vcc, 40, v2
s_nop 1
v_cndmask_b32 v24, v25, v24, vcc
s_lshl_b32 s42, s44, 7
buffer_load_dword v26, v23, s[28:31], s42 offen
s_lshl_b32 s42, s48, 7
buffer_load_dword v27, v24, s[32:35], s42 offen
s_waitcnt vmcnt(26)
s_barrier
s_waitcnt vmcnt(22)
s_barrier
s_cmp_eq_u32 s88, -1
s_cbranch_scc1 W2F_5
v_lshrrev_b32 v32, 5, v2
v_lshlrev_b32 v32, 4, v32
v_bfe_u32 v33, v2, 4, 1
v_lshl_add_u32 v32, v33, 2, v32
v_bfe_u32 v33, v2, 2, 2
v_add_u32 v32, v32, v33
s_sub_u32 s50, s3, 4
s_mul_i32 s51, s50, 5120
s_add_u32 s51, s51, 12288
v_mul_u32_u24 v32, 160, v32
v_add_u32 v32, s51, v32
v_and_b32 v33, 3, v2
v_lshl_add_u32 v34, v33, 4, v32
v_lshl_add_u32 v35, v33, 3, v32
v_lshlrev_b32 v36, 4, v2
s_waitcnt vmcnt(63)
ds_read_b64_tr_b16 v[64:65], v34 offset:0
ds_read_b64_tr_b16 v[66:67], v34 offset:1280
ds_read_b64_tr_b16 v[68:69], v34 offset:8
ds_read_b64_tr_b16 v[70:71], v34 offset:1288
ds_read_b64_tr_b16 v[72:73], v34 offset:64
ds_read_b64_tr_b16 v[74:75], v34 offset:1344
ds_read_b64_tr_b16 v[76:77], v34 offset:72
ds_read_b64_tr_b16 v[78:79], v34 offset:1352
ds_read_b64_tr_b16 v[80:81], v35 offset:128
ds_read_b64_tr_b16 v[82:83], v35 offset:1408
s_add_u32 s52, s88, 4096
s_waitcnt lgkmcnt(8)
buffer_store_dwordx4 v[64:67], v36, s[24:27], s88 offen offset:0 sc1
s_waitcnt lgkmcnt(6)
buffer_store_dwordx4 v[68:71], v36, s[24:27], s88 offen offset:1024 sc1
s_waitcnt lgkmcnt(4)
buffer_store_dwordx4 v[72:75], v36, s[24:27], s88 offen offset:2048 sc1
s_waitcnt lgkmcnt(2)
buffer_store_dwordx4 v[76:79], v36, s[24:27], s88 offen offset:3072 sc1
s_waitcnt lgkmcnt(0)
buffer_store_dwordx4 v[80:83], v36, s[24:27], s52 offen offset:0 sc1
W2F_5:
s_add_u32 m0, s77, 147456
s_add_u32 s78, s75, 1769472
buffer_load_dwordx4 v5, s[32:35], s78 offen lds
s_add_u32 m0, s77, 148480
s_add_u32 s78, s75, 1797120
buffer_load_dwordx4 v5, s[32:35], s78 offen lds
s_add_u32 m0, s77, 149504
s_add_u32 s78, s75, 1824768
buffer_load_dwordx4 v5, s[32:35], s78 offen lds
s_add_u32 m0, s77, 150528
s_add_u32 s78, s75, 1852416
buffer_load_dwordx4 v5, s[32:35], s78 offen lds
s_waitcnt vmcnt(22)
s_barrier
s_add_u32 m0, s77, 32768
s_add_u32 s78, s75, 1990656
buffer_load_dwordx4 v5, s[32:35], s78 offen lds
s_add_u32 m0, s77, 33792
s_add_u32 s78, s75, 2018304
buffer_load_dwordx4 v5, s[32:35], s78 offen lds
s_add_u32 m0, s77, 34816
s_add_u32 s78, s75, 2045952
buffer_load_dwordx4 v5, s[32:35], s78 offen lds
s_add_u32 m0, s77, 35840
s_add_u32 s78, s75, 2073600
buffer_load_dwordx4 v5, s[32:35], s78 offen lds
s_waitcnt vmcnt(22)
s_barrier
s_add_u32 m0, s77, 49152
s_add_u32 s78, s72, 0
buffer_load_dwordx4 v4, s[28:31], s78 offen lds
s_add_u32 m0, s77, 50176
s_add_u32 s78, s72, 30720
buffer_load_dwordx4 v4, s[28:31], s78 offen lds
s_add_u32 m0, s77, 51200
s_add_u32 s78, s72, 61440
buffer_load_dwordx4 v4, s[28:31], s78 offen lds
s_add_u32 m0, s77, 52224
s_add_u32 s78, s72, 92160
buffer_load_dwordx4 v4, s[28:31], s78 offen lds
s_waitcnt vmcnt(22)
s_barrier
s_add_u32 m0, s77, 65536
s_add_u32 s78, s72, 491520
buffer_load_dwordx4 v4, s[28:31], s78 offen lds
s_add_u32 m0, s77, 66560
s_add_u32 s78, s72, 522240
buffer_load_dwordx4 v4, s[28:31], s78 offen lds
s_add_u32 m0, s77, 67584
s_add_u32 s78, s72, 552960
buffer_load_dwordx4 v4, s[28:31], s78 offen lds
s_add_u32 m0, s77, 68608
s_add_u32 s78, s72, 583680
buffer_load_dwordx4 v4, s[28:31], s78 offen lds
s_waitcnt vmcnt(22)
s_barrier
s_add_u32 m0, s77, 81920
s_add_u32 s78, s72, 983040
buffer_load_dwordx4 v4, s[28:31], s78 offen lds
s_add_u32 m0, s77, 82944
s_add_u32 s78, s72, 1013760
buffer_load_dwordx4 v4, s[28:31], s78 offen lds
s_add_u32 m0, s77, 83968
s_add_u32 s78, s72, 1044480
buffer_load_dwordx4 v4, s[28:31], s78 offen lds
s_add_u32 m0, s77, 84992
s_add_u32 s78, s72, 1075200
buffer_load_dwordx4 v4, s[28:31], s78 offen lds
s_waitcnt vmcnt(16)
s_barrier
s_cmp_lg_u32 s3, 4
s_cbranch_scc1 FW_6
s_lshl_b32 s40, s2, 7
s_add_u32 s40, s40, 65536
buffer_store_dword v0, v3, s[24:27], s40 offen offset:0 sc1
FW_6:
s_add_u32 m0, s77, 98304
s_add_u32 s78, s72, 1474560
buffer_load_dwordx4 v4, s[28:31], s78 offen lds
s_add_u32 m0, s77, 99328
s_add_u32 s78, s72, 1505280
buffer_load_dwordx4 v4, s[28:31], s78 offen lds
s_add_u32 m0, s77, 100352
s_add_u32 s78, s72, 1536000
buffer_load_dwordx4 v4, s[28:31], s78 offen lds
s_add_u32 m0, s77, 101376
s_add_u32 s78, s72, 1566720
buffer_load_dwordx4 v4, s[28:31], s78 offen lds
s_waitcnt vmcnt(16)
s_barrier
s_add_u32 m0, s77, 114688
s_add_u32 s78, s72, 1966080
buffer_load_dwordx4 v4, s[28:31], s78 offen lds
s_add_u32 m0, s77, 115712
s_add_u32 s78, s72, 1996800
buffer_load_dwordx4 v4, s[28:31], s78 offen lds
s_add_u32 m0, s77, 116736
s_add_u32 s78, s72, 2027520
buffer_load_dwordx4 v4, s[28:31], s78 offen lds
s_add_u32 m0, s77, 117760
s_add_u32 s78, s72, 2058240
buffer_load_dwordx4 v4, s[28:31], s78 offen lds
s_waitcnt vmcnt(20)
s_barrier
s_waitcnt vmcnt(16)
s_barrier
s_add_u32 m0, s77, 131072
s_add_u32 s78, s76, 0
buffer_load_dwordx4 v5, s[32:35], s78 offen lds
s_add_u32 m0, s77, 132096
s_add_u32 s78, s76, 27648
buffer_load_dwordx4 v5, s[32:35], s78 offen lds
s_add_u32 m0, s77, 133120
s_add_u32 s78, s76, 55296
buffer_load_dwordx4 v5, s[32:35], s78 offen lds
s_add_u32 m0, s77, 134144
s_add_u32 s78, s76, 82944
buffer_load_dwordx4 v5, s[32:35], s78 offen lds
s_add_u32 m0, s77, 147456
s_add_u32 s78, s76, 221184
buffer_load_dwordx4 v5, s[32:35], s78 offen lds
s_add_u32 m0, s77, 148480
s_add_u32 s78, s76, 248832
buffer_load_dwordx4 v5, s[32:35], s78 offen lds
s_add_u32 m0, s77, 149504
s_add_u32 s78, s76, 276480
buffer_load_dwordx4 v5, s[32:35], s78 offen lds
s_add_u32 m0, s77, 150528
s_add_u32 s78, s76, 304128
buffer_load_dwordx4 v5, s[32:35], s78 offen lds
s_waitcnt vmcnt(20)
s_barrier
s_add_u32 m0, s77, 32768
s_add_u32 s78, s76, 442368
buffer_load_dwordx4 v5, s[32:35], s78 offen lds
s_add_u32 m0, s77, 33792
s_add_u32 s78, s76, 470016
buffer_load_dwordx4 v5, s[32:35], s78 offen lds
s_add_u32 m0, s77, 34816
s_add_u32 s78, s76, 497664
buffer_load_dwordx4 v5, s[32:35], s78 offen lds
s_add_u32 m0, s77, 35840
s_add_u32 s78, s76, 525312
buffer_load_dwordx4 v5, s[32:35], s78 offen lds
s_waitcnt vmcnt(20)
s_barrier
s_add_u32 m0, s77, 49152
s_add_u32 s78, s76, 663552
buffer_load_dwordx4 v5, s[32:35], s78 offen lds
s_add_u32 m0, s77, 50176
s_add_u32 s78, s76, 691200
buffer_load_dwordx4 v5, s[32:35], s78 offen lds
s_add_u32 m0, s77, 51200
s_add_u32 s78, s76, 718848
buffer_load_dwordx4 v5, s[32:35], s78 offen lds
s_add_u32 m0, s77, 52224
s_add_u32 s78, s76, 746496
buffer_load_dwordx4 v5, s[32:35], s78 offen lds
s_waitcnt vmcnt(20)
s_barrier
s_add_u32 m0, s77, 65536
s_add_u32 s78, s76, 884736
buffer_load_dwordx4 v5, s[32:35], s78 offen lds
s_add_u32 m0, s77, 66560
s_add_u32 s78, s76, 912384
buffer_load_dwordx4 v5, s[32:35], s78 offen lds
s_add_u32 m0, s77, 67584
s_add_u32 s78, s76, 940032
buffer_load_dwordx4 v5, s[32:35], s78 offen lds
s_add_u32 m0, s77, 68608
s_add_u32 s78, s76, 967680
buffer_load_dwordx4 v5, s[32:35], s78 offen lds
s_waitcnt vmcnt(20)
s_barrier
s_add_u32 m0, s77, 81920
s_add_u32 s78, s76, 1105920
buffer_load_dwordx4 v5, s[32:35], s78 offen lds
s_add_u32 m0, s77, 82944
s_add_u32 s78, s76, 1133568
buffer_load_dwordx4 v5, s[32:35], s78 offen lds
s_add_u32 m0, s77, 83968
s_add_u32 s78, s76, 1161216
buffer_load_dwordx4 v5, s[32:35], s78 offen lds
s_add_u32 m0, s77, 84992
s_add_u32 s78, s76, 1188864
buffer_load_dwordx4 v5, s[32:35], s78 offen lds
s_waitcnt vmcnt(16)
s_barrier
s_add_u32 m0, s77, 98304
s_add_u32 s78, s76, 1327104
buffer_load_dwordx4 v5, s[32:35], s78 offen lds
s_add_u32 m0, s77, 99328
s_add_u32 s78, s76, 1354752
buffer_load_dwordx4 v5, s[32:35], s78 offen lds
s_add_u32 m0, s77, 100352
s_add_u32 s78, s76, 1382400
buffer_load_dwordx4 v5, s[32:35], s78 offen lds
s_add_u32 m0, s77, 101376
s_add_u32 s78, s76, 1410048
buffer_load_dwordx4 v5, s[32:35], s78 offen lds
s_waitcnt vmcnt(16)
s_barrier
s_add_u32 m0, s77, 114688
s_add_u32 s78, s76, 1548288
buffer_load_dwordx4 v5, s[32:35], s78 offen lds
s_add_u32 m0, s77, 115712
s_add_u32 s78, s76, 1575936
buffer_load_dwordx4 v5, s[32:35], s78 offen lds
s_add_u32 m0, s77, 116736
s_add_u32 s78, s76, 1603584
buffer_load_dwordx4 v5, s[32:35], s78 offen lds
s_add_u32 m0, s77, 117760
s_add_u32 s78, s76, 1631232
buffer_load_dwordx4 v5, s[32:35], s78 offen lds
s_waitcnt vmcnt(20)
s_barrier
s_waitcnt vmcnt(16)
s_barrier
s_add_u32 m0, s77, 131072
s_add_u32 s78, s76, 1769472
buffer_load_dwordx4 v5, s[32:35], s78 offen lds
s_add_u32 m0, s77, 132096
s_add_u32 s78, s76, 1797120
buffer_load_dwordx4 v5, s[32:35], s78 offen lds
s_add_u32 m0, s77, 133120
s_add_u32 s78, s76, 1824768
buffer_load_dwordx4 v5, s[32:35], s78 offen lds
s_add_u32 m0, s77, 134144
s_add_u32 s78, s76, 1852416
buffer_load_dwordx4 v5, s[32:35], s78 offen lds
s_add_u32 m0, s77, 147456
s_add_u32 s78, s76, 1990656
buffer_load_dwordx4 v5, s[32:35], s78 offen lds
s_add_u32 m0, s77, 148480
s_add_u32 s78, s76, 2018304
buffer_load_dwordx4 v5, s[32:35], s78 offen lds
s_add_u32 m0, s77, 149504
s_add_u32 s78, s76, 2045952
buffer_load_dwordx4 v5, s[32:35], s78 offen lds
s_add_u32 m0, s77, 150528
s_add_u32 s78, s76, 2073600
buffer_load_dwordx4 v5, s[32:35], s78 offen lds
s_waitcnt vmcnt(20)
s_barrier
s_and_b32 s61, s2, 7
s_lshr_b32 s60, s2, 3
v_add_u32 v8, 0, v2
v_mul_u32_u24 v13, 205, v8
v_lshrrev_b32 v13, 14, v13
v_mul_u32_u24 v14, 80, v13
v_sub_u32 v8, v8, v14
v_lshlrev_b32 v8, 4, v8
v_mul_u32_u24 v13, 10368, v13
v_add_u32 v8, v8, v13
v_add_u32 v8, 4096, v8
v_add_u32 v9, 64, v2
v_mul_u32_u24 v13, 205, v9
v_lshrrev_b32 v13, 14, v13
v_mul_u32_u24 v14, 80, v13
v_sub_u32 v9, v9, v14
v_lshlrev_b32 v9, 4, v9
v_mul_u32_u24 v13, 10368, v13
v_add_u32 v9, v9, v13
v_add_u32 v9, 3072, v9
v_add_u32 v10, 128, v2
v_mul_u32_u24 v13, 205, v10
v_lshrrev_b32 v13, 14, v13
v_mul_u32_u24 v14, 80, v13
v_sub_u32 v10, v10, v14
v_lshlrev_b32 v10, 4, v10
v_mul_u32_u24 v13, 10368, v13
v_add_u32 v10, v10, v13
v_add_u32 v10, 2048, v10
v_add_u32 v11, 192, v2
v_mul_u32_u24 v13, 205, v11
v_lshrrev_b32 v13, 14, v13
v_mul_u32_u24 v14, 80, v13
v_sub_u32 v11, v11, v14
v_lshlrev_b32 v11, 4, v11
v_mul_u32_u24 v13, 10368, v13
v_add_u32 v11, v11, v13
v_add_u32 v11, 1024, v11
v_add_u32 v12, 256, v2
v_mul_u32_u24 v13, 205, v12
v_lshrrev_b32 v13, 14, v13
v_mul_u32_u24 v14, 80, v13
v_sub_u32 v12, v12, v14
v_lshlrev_b32 v12, 4, v12
v_mul_u32_u24 v13, 10368, v13
v_add_u32 v12, v12, v13
v_add_u32 v12, 4096, v12
v_lshlrev_b32 v13, 4, v2
s_mov_b32 s41, 7561744
s_mov_b32 s42, 1602337
s_cmp_eq_u32 s61, 1
s_cselect_b32 s41, s42, s41
s_mov_b32 s42, 2267186
s_cmp_eq_u32 s61, 2
s_cselect_b32 s41, s42, s41
s_mov_b32 s42, 3385667
s_cmp_eq_u32 s61, 3
s_cselect_b32 s41, s42, s41
s_mov_b32 s42, 5622629
s_cmp_eq_u32 s61, 4
s_cselect_b32 s41, s42, s41
s_mov_b32 s42, 6741110
s_cmp_eq_u32 s61, 5
s_cselect_b32 s41, s42, s41
s_mov_b32 s42, 8311815
s_cmp_eq_u32 s61, 6
s_cselect_b32 s41, s42, s41
s_mov_b32 s42, 16666944
s_cmp_eq_u32 s61, 7
s_cselect_b32 s41, s42, s41
v_min_u32 v18, 59, v2
v_mul_u32_u24 v16, 43, v18
v_lshrrev_b32 v16, 8, v16
v_mul_u32_u24 v17, 6, v16
v_sub_u32 v17, v18, v17
v_lshlrev_b32 v17, 2, v17
v_lshrrev_b32 v17, v17, s41
v_and_b32 v17, 15, v17
s_lshl_b32 s42, s60, 1
s_sub_i32 s42, s42, 8
v_add_u32 v16, s42, v16
v_max_i32 v16, 0, v16
v_lshl_add_u32 v16, v16, 4, v17
v_lshlrev_b32 v16, 9, v16
v_add_u32 v84, 524288, v16
s_mul_i32 s41, s61, 80
s_add_u32 s43, s41, 79
s_lshr_b32 s41, s41, 7
s_lshr_b32 s43, s43, 7
s_add_u32 s41, s41, 11
s_add_u32 s43, s43, 11
v_min_u32 v18, 19, v2
v_and_b32 v17, 1, v18
v_cmp_eq_u32 vcc, 1, v17
v_mov_b32 v17, s41
v_mov_b32 v19, s43
v_cndmask_b32 v17, v17, v19, vcc
v_lshrrev_b32 v16, 1, v18
v_add_u32 v16, s42, v16
v_max_i32 v16, 0, v16
v_lshl_add_u32 v16, v16, 4, v17
v_lshlrev_b32 v16, 9, v16
v_add_u32 v85, 524416, v16
s_and_b32 s43, s2, 7
s_lshr_b32 s41, s2, 3
s_and_b32 s42, s43, 1
s_lshl_b32 s42, s42, 2
s_and_b32 s40, s41, 3
s_add_u32 s40, s42, s40
s_lshr_b32 s42, s43, 1
s_lshl_b32 s42, s42, 3
s_lshr_b32 s41, s41, 2
s_add_u32 s41, s42, s41
s_lshl_b32 s40, s40, 7
s_add_u32 s40, s40, 65536
v_and_b32 v16, 31, v2
v_lshlrev_b32 v16, 10, v16
v_add_u32 v86, s40, v16
s_lshl_b32 s41, s41, 14
s_add_u32 s41, s41, 524544
v_and_b32 v16, 15, v2
v_min_u32 v16, 10, v16
v_bfe_u32 v17, v2, 4, 1
v_lshl_add_u32 v16, v17, 4, v16
v_lshlrev_b32 v16, 9, v16
v_add_u32 v87, s41, v16
buffer_load_dword v88, v84, s[24:27], 0 offen sc1
buffer_load_dword v89, v85, s[24:27], 0 offen sc1
buffer_load_dword v90, v86, s[24:27], 0 offen sc1
buffer_load_dword v91, v87, s[24:27], 0 offen sc1
s_waitcnt vmcnt(20)
s_barrier
s_waitcnt vmcnt(4)
s_barrier
s_branch F_ltail
F_lC:
s_add_u32 s44, s61, 4
s_lshl_b32 s45, s61, 1
s_sub_u32 s45, s45, 2
s_add_u32 s46, s45, 1
s_add_u32 s47, s61, 11
s_mov_b32 s48, 0
s_mov_b32 s49, 0
s_sub_u32 s40, s3, 4
s_lshl_b32 s77, s40, 12
s_mov_b32 s28, s6
s_and_b32 s29, s7, 0xffff
s_mov_b32 s30, 2457600
s_mov_b32 s31, 0x20000
s_cmp_ge_u32 s40, 2
s_cbranch_scc1 LD_up_C
s_mov_b32 s32, s12
s_and_b32 s33, s13, 0xffff
s_mov_b32 s34, 2211840
s_mov_b32 s35, 0x20000
s_branch LD_sr_C
LD_up_C:
s_mov_b32 s32, s14
s_and_b32 s33, s15, 0xffff
s_mov_b32 s34, 2211840
s_mov_b32 s35, 0x20000
LD_sr_C:
v_lshrrev_b32 v20, 3, v2
v_and_b32 v21, 7, v2
v_bfe_u32 v22, v2, 4, 1
v_lshlrev_b32 v22, 2, v22
v_xor_b32 v21, v21, v22
v_lshlrev_b32 v21, 4, v21
v_mul_u32_u24 v4, 3840, v20
v_add_u32 v4, v4, v21
v_mul_u32_u24 v5, 3456, v20
v_add_u32 v5, v5, v21
s_mul_i32 s50, s40, 122880
s_lshl_b32 s51, s44, 7
s_add_u32 s72, s51, s50
s_lshl_b32 s51, s45, 7
s_add_u32 s73, s51, s50
s_lshl_b32 s51, s46, 7
s_add_u32 s74, s51, s50
s_and_b32 s50, s40, 1
s_mul_i32 s50, s50, 110592
s_lshl_b32 s51, s47, 7
s_add_u32 s75, s51, s50
s_lshl_b32 s51, s48, 7
s_add_u32 s76, s51, s50
s_mov_b32 s80, s16
s_and_b32 s81, s17, 0xffff
s_mov_b32 s82, 2211840
s_mov_b32 s83, 0x20000
s_mov_b32 s84, s8
s_and_b32 s85, s9, 0xffff
s_mov_b32 s86, 819200
s_mov_b32 s87, 0x20000
s_lshr_b32 s40, s2, 3
s_and_b32 s40, s40, 7
s_mul_i32 s40, s40, 80
s_sub_u32 s41, s3, 4
s_mul_i32 s42, s41, 20
s_add_u32 s42, s42, s40
v_add_u32 v23, s42, v2
v_mul_u32_u24 v23, 3840, v23
v_mov_b32 v25, 0x80000000
v_cmp_gt_u32 vcc, 20, v2
s_nop 1
v_cndmask_b32 v23, v25, v23, vcc
s_and_b32 s42, s41, 1
s_mul_i32 s42, s42, 40
s_add_u32 s42, s42, s40
v_add_u32 v24, s42, v2
v_mul_u32_u24 v24, 3456, v24
v_cmp_gt_u32 vcc, 40, v2
s_nop 1
v_cndmask_b32 v24, v25, v24, vcc
s_lshl_b32 s42, s45, 7
buffer_load_dword v26, v23, s[28:31], s42 offen
s_lshl_b32 s42, s46, 7
buffer_load_dword v26, v23, s[28:31], s42 offen
s_mov_b32 s88, -1
s_sub_u32 s50, s3, 4
s_lshr_b32 s42, s2, 3
s_lshl_b32 s53, s50, 5
s_add_u32 s53, s53, s42
s_cmp_ge_u32 s53, 74
s_cbranch_scc1 W2_7_skip
s_and_b32 s41, s2, 7
s_mul_i32 s54, s41, 378880
s_mul_i32 s55, s53, 5120
s_add_u32 s54, s54, s55
s_add_u32 s88, s54, 33554432
s_mul_i32 s43, s41, 160
s_mul_i32 s51, s50, 5120
s_add_u32 s51, s51, 12288
v_add_u32 v40, 0, v2
v_mul_u32_u24 v32, 205, v40
v_lshrrev_b32 v32, 11, v32
v_mul_u32_u24 v46, 10, v32
v_sub_u32 v40, v40, v46
v_lshlrev_b32 v40, 4, v40
v_add_u32 v41, 64, v2
v_mul_u32_u24 v33, 205, v41
v_lshrrev_b32 v33, 11, v33
v_mul_u32_u24 v46, 10, v33
v_sub_u32 v41, v41, v46
v_lshlrev_b32 v41, 4, v41
v_add_u32 v42, 128, v2
v_mul_u32_u24 v34, 205, v42
v_lshrrev_b32 v34, 11, v34
v_mul_u32_u24 v46, 10, v34
v_sub_u32 v42, v42, v46
v_lshlrev_b32 v42, 4, v42
v_add_u32 v43, 192, v2
v_mul_u32_u24 v35, 205, v43
v_lshrrev_b32 v35, 11, v35
v_mul_u32_u24 v46, 10, v35
v_sub_u32 v43, v43, v46
v_lshlrev_b32 v43, 4, v43
v_add_u32 v44, 256, v2
v_mul_u32_u24 v36, 205, v44
v_lshrrev_b32 v36, 11, v36
v_mul_u32_u24 v46, 10, v36
v_sub_u32 v44, v44, v46
v_lshlrev_b32 v44, 4, v44
s_cmp_ge_u32 s53, 54
s_cbranch_scc1 W2_7_o
s_mul_i32 s55, s53, 40960
s_add_u32 s55, s55, s43
v_mul_u32_u24 v46, 1280, v32
v_add_u32 v40, v40, v46
s_add_u32 m0, s51, 0
s_nop 0
buffer_load_dwordx4 v40, s[80:83], s55 offen lds
v_mul_u32_u24 v46, 1280, v33
v_add_u32 v41, v41, v46
s_add_u32 m0, s51, 1024
s_nop 0
buffer_load_dwordx4 v41, s[80:83], s55 offen lds
v_mul_u32_u24 v46, 1280, v34
v_add_u32 v42, v42, v46
s_add_u32 m0, s51, 2048
s_nop 0
buffer_load_dwordx4 v42, s[80:83], s55 offen lds
v_mul_u32_u24 v46, 1280, v35
v_add_u32 v43, v43, v46
s_add_u32 m0, s51, 3072
s_nop 0
buffer_load_dwordx4 v43, s[80:83], s55 offen lds
v_mul_u32_u24 v46, 1280, v36
v_add_u32 v44, v44, v46
s_add_u32 m0, s51, 4096
s_nop 0
buffer_load_dwordx4 v44, s[80:83], s55 offen lds
s_branch W2_7_skip
W2_7_o:
s_sub_u32 s55, s53, 54
s_lshl_b32 s55, s55, 1
s_add_u32 s55, s55, 0
s_mul_i32 s56, s55, 52
s_lshr_b32 s56, s56, 8
s_mul_i32 s57, s56, 5
s_sub_u32 s57, s55, s57
s_lshl_b32 s56, s56, 2
s_add_u32 s55, s56, s57
s_mul_i32 s55, s55, 20
s_mul_i32 s56, s56, 20
s_add_u32 s56, s56, 16
s_cmp_eq_u32 s57, 4
s_cselect_b32 s58, s56, s55
s_cselect_b32 s59, 1, 0
s_sub_u32 s55, s53, 54
s_lshl_b32 s55, s55, 1
s_add_u32 s55, s55, 1
s_mul_i32 s56, s55, 52
s_lshr_b32 s56, s56, 8
s_mul_i32 s57, s56, 5
s_sub_u32 s57, s55, s57
s_lshl_b32 s56, s56, 2
s_add_u32 s55, s56, s57
s_mul_i32 s55, s55, 20
s_mul_i32 s56, s56, 20
s_add_u32 s56, s56, 16
s_cmp_eq_u32 s57, 4
s_cselect_b32 s60, s56, s55
s_cselect_b32 s61, 1, 0
v_mov_b32 v47, s58
v_mov_b32 v48, s60
v_mov_b32 v49, s59
v_mov_b32 v50, s61
v_and_b32 v51, 15, v32
v_lshrrev_b32 v52, 2, v51
v_mul_u32_u24 v52, 20, v52
v_and_b32 v53, 3, v51
v_add_u32 v52, v52, v53
v_cmp_le_u32 vcc, 16, v32
s_nop 1
v_cndmask_b32 v53, v47, v48, vcc
v_cndmask_b32 v54, v49, v50, vcc
v_cmp_eq_u32 vcc, 1, v54
s_nop 1
v_cndmask_b32 v51, v51, v52, vcc
v_add_u32 v51, v51, v53
v_mul_u32_u24 v51, 1280, v51
v_add_u32 v40, v40, v51
s_add_u32 m0, s51, 0
s_nop 0
buffer_load_dwordx4 v40, s[84:87], s43 offen lds
v_and_b32 v51, 15, v33
v_lshrrev_b32 v52, 2, v51
v_mul_u32_u24 v52, 20, v52
v_and_b32 v53, 3, v51
v_add_u32 v52, v52, v53
v_cmp_le_u32 vcc, 16, v33
s_nop 1
v_cndmask_b32 v53, v47, v48, vcc
v_cndmask_b32 v54, v49, v50, vcc
v_cmp_eq_u32 vcc, 1, v54
s_nop 1
v_cndmask_b32 v51, v51, v52, vcc
v_add_u32 v51, v51, v53
v_mul_u32_u24 v51, 1280, v51
v_add_u32 v41, v41, v51
s_add_u32 m0, s51, 1024
s_nop 0
buffer_load_dwordx4 v41, s[84:87], s43 offen lds
v_and_b32 v51, 15, v34
v_lshrrev_b32 v52, 2, v51
v_mul_u32_u24 v52, 20, v52
v_and_b32 v53, 3, v51
v_add_u32 v52, v52, v53
v_cmp_le_u32 vcc, 16, v34
s_nop 1
v_cndmask_b32 v53, v47, v48, vcc
v_cndmask_b32 v54, v49, v50, vcc
v_cmp_eq_u32 vcc, 1, v54
s_nop 1
v_cndmask_b32 v51, v51, v52, vcc
v_add_u32 v51, v51, v53
v_mul_u32_u24 v51, 1280, v51
v_add_u32 v42, v42, v51
s_add_u32 m0, s51, 2048
s_nop 0
buffer_load_dwordx4 v42, s[84:87], s43 offen lds
v_and_b32 v51, 15, v35
v_lshrrev_b32 v52, 2, v51
v_mul_u32_u24 v52, 20, v52
v_and_b32 v53, 3, v51
v_add_u32 v52, v52, v53
v_cmp_le_u32 vcc, 16, v35
s_nop 1
v_cndmask_b32 v53, v47, v48, vcc
v_cndmask_b32 v54, v49, v50, vcc
v_cmp_eq_u32 vcc, 1, v54
s_nop 1
v_cndmask_b32 v51, v51, v52, vcc
v_add_u32 v51, v51, v53
v_mul_u32_u24 v51, 1280, v51
v_add_u32 v43, v43, v51
s_add_u32 m0, s51, 3072
s_nop 0
buffer_load_dwordx4 v43, s[84:87], s43 offen lds
v_and_b32 v51, 15, v36
v_lshrrev_b32 v52, 2, v51
v_mul_u32_u24 v52, 20, v52
v_and_b32 v53, 3, v51
v_add_u32 v52, v52, v53
v_cmp_le_u32 vcc, 16, v36
s_nop 1
v_cndmask_b32 v53, v47, v48, vcc
v_cndmask_b32 v54, v49, v50, vcc
v_cmp_eq_u32 vcc, 1, v54
s_nop 1
v_cndmask_b32 v51, v51, v52, vcc
v_add_u32 v51, v51, v53
v_mul_u32_u24 v51, 1280, v51
v_add_u32 v44, v44, v51
s_add_u32 m0, s51, 4096
s_nop 0
buffer_load_dwordx4 v44, s[84:87], s43 offen lds
W2_7_skip:
s_add_u32 m0, s77, 147456
s_add_u32 s78, s73, 0
buffer_load_dwordx4 v4, s[28:31], s78 offen lds
s_add_u32 m0, s77, 148480
s_add_u32 s78, s73, 30720
buffer_load_dwordx4 v4, s[28:31], s78 offen lds
s_add_u32 m0, s77, 149504
s_add_u32 s78, s73, 61440
buffer_load_dwordx4 v4, s[28:31], s78 offen lds
s_add_u32 m0, s77, 150528
s_add_u32 s78, s73, 92160
buffer_load_dwordx4 v4, s[28:31], s78 offen lds
s_add_u32 m0, s77, 32768
s_add_u32 s78, s74, 0
buffer_load_dwordx4 v4, s[28:31], s78 offen lds
s_add_u32 m0, s77, 33792
s_add_u32 s78, s74, 30720
buffer_load_dwordx4 v4, s[28:31], s78 offen lds
s_add_u32 m0, s77, 34816
s_add_u32 s78, s74, 61440
buffer_load_dwordx4 v4, s[28:31], s78 offen lds
s_add_u32 m0, s77, 35840
s_add_u32 s78, s74, 92160
buffer_load_dwordx4 v4, s[28:31], s78 offen lds
s_barrier
s_barrier
s_add_u32 m0, s77, 49152
s_add_u32 s78, s73, 491520
buffer_load_dwordx4 v4, s[28:31], s78 offen lds
s_add_u32 m0, s77, 50176
s_add_u32 s78, s73, 522240
buffer_load_dwordx4 v4, s[28:31], s78 offen lds
s_add_u32 m0, s77, 51200
s_add_u32 s78, s73, 552960
buffer_load_dwordx4 v4, s[28:31], s78 offen lds
s_add_u32 m0, s77, 52224
s_add_u32 s78, s73, 583680
buffer_load_dwordx4 v4, s[28:31], s78 offen lds
s_add_u32 m0, s77, 65536
s_add_u32 s78, s74, 491520
buffer_load_dwordx4 v4, s[28:31], s78 offen lds
s_add_u32 m0, s77, 66560
s_add_u32 s78, s74, 522240
buffer_load_dwordx4 v4, s[28:31], s78 offen lds
s_add_u32 m0, s77, 67584
s_add_u32 s78, s74, 552960
buffer_load_dwordx4 v4, s[28:31], s78 offen lds
s_add_u32 m0, s77, 68608
s_add_u32 s78, s74, 583680
buffer_load_dwordx4 v4, s[28:31], s78 offen lds
s_add_u32 m0, s77, 81920
s_add_u32 s78, s73, 983040
buffer_load_dwordx4 v4, s[28:31], s78 offen lds
s_add_u32 m0, s77, 82944
s_add_u32 s78, s73, 1013760
buffer_load_dwordx4 v4, s[28:31], s78 offen lds
s_add_u32 m0, s77, 83968
s_add_u32 s78, s73, 1044480
buffer_load_dwordx4 v4, s[28:31], s78 offen lds
s_add_u32 m0, s77, 84992
s_add_u32 s78, s73, 1075200
buffer_load_dwordx4 v4, s[28:31], s78 offen lds
s_add_u32 m0, s77, 98304
s_add_u32 s78, s74, 983040
buffer_load_dwordx4 v4, s[28:31], s78 offen lds
s_add_u32 m0, s77, 99328
s_add_u32 s78, s74, 1013760
buffer_load_dwordx4 v4, s[28:31], s78 offen lds
s_add_u32 m0, s77, 100352
s_add_u32 s78, s74, 1044480
buffer_load_dwordx4 v4, s[28:31], s78 offen lds
s_add_u32 m0, s77, 101376
s_add_u32 s78, s74, 1075200
buffer_load_dwordx4 v4, s[28:31], s78 offen lds
s_add_u32 m0, s77, 114688
s_add_u32 s78, s73, 1474560
buffer_load_dwordx4 v4, s[28:31], s78 offen lds
s_add_u32 m0, s77, 115712
s_add_u32 s78, s73, 1505280
buffer_load_dwordx4 v4, s[28:31], s78 offen lds
s_add_u32 m0, s77, 116736
s_add_u32 s78, s73, 1536000
buffer_load_dwordx4 v4, s[28:31], s78 offen lds
s_add_u32 m0, s77, 117760
s_add_u32 s78, s73, 1566720
buffer_load_dwordx4 v4, s[28:31], s78 offen lds
s_add_u32 m0, s77, 131072
s_add_u32 s78, s74, 1474560
buffer_load_dwordx4 v4, s[28:31], s78 offen lds
s_add_u32 m0, s77, 132096
s_add_u32 s78, s74, 1505280
buffer_load_dwordx4 v4, s[28:31], s78 offen lds
s_add_u32 m0, s77, 133120
s_add_u32 s78, s74, 1536000
buffer_load_dwordx4 v4, s[28:31], s78 offen lds
s_add_u32 m0, s77, 134144
s_add_u32 s78, s74, 1566720
buffer_load_dwordx4 v4, s[28:31], s78 offen lds
s_waitcnt vmcnt(24)
s_barrier
v_cmp_eq_u32 vcc, 0, v2
v_mov_b32 v15, 0
v_mov_b32 v3, 0x80000000
ds_read_b32 v0, v15
v_cndmask_b32 v3, v3, 0, vcc
s_waitcnt lgkmcnt(0)
v_readfirstlane_b32 s0, v0
s_lshr_b32 s40, s2, 3
s_and_b32 s40, s40, 7
s_mul_i32 s40, s40, 80
s_sub_u32 s41, s3, 4
s_mul_i32 s42, s41, 20
s_add_u32 s42, s42, s40
v_add_u32 v23, s42, v2
v_mul_u32_u24 v23, 3840, v23
v_mov_b32 v25, 0x80000000
v_cmp_gt_u32 vcc, 20, v2
s_nop 1
v_cndmask_b32 v23, v25, v23, vcc
s_and_b32 s42, s41, 1
s_mul_i32 s42, s42, 40
s_add_u32 s42, s42, s40
v_add_u32 v24, s42, v2
v_mul_u32_u24 v24, 3456, v24
v_cmp_gt_u32 vcc, 40, v2
s_nop 1
v_cndmask_b32 v24, v25, v24, vcc
s_lshl_b32 s42, s44, 7
buffer_load_dword v26, v23, s[28:31], s42 offen
s_lshl_b32 s42, s47, 7
buffer_load_dword v27, v24, s[32:35], s42 offen
s_waitcnt vmcnt(26)
s_barrier
s_waitcnt vmcnt(18)
s_barrier
s_cmp_eq_u32 s88, -1
s_cbranch_scc1 W2F_8
v_lshrrev_b32 v32, 5, v2
v_lshlrev_b32 v32, 4, v32
v_bfe_u32 v33, v2, 4, 1
v_lshl_add_u32 v32, v33, 2, v32
v_bfe_u32 v33, v2, 2, 2
v_add_u32 v32, v32, v33
s_sub_u32 s50, s3, 4
s_mul_i32 s51, s50, 5120
s_add_u32 s51, s51, 12288
v_mul_u32_u24 v32, 160, v32
v_add_u32 v32, s51, v32
v_and_b32 v33, 3, v2
v_lshl_add_u32 v34, v33, 4, v32
v_lshl_add_u32 v35, v33, 3, v32
v_lshlrev_b32 v36, 4, v2
s_waitcnt vmcnt(63)
ds_read_b64_tr_b16 v[64:65], v34 offset:0
ds_read_b64_tr_b16 v[66:67], v34 offset:1280
ds_read_b64_tr_b16 v[68:69], v34 offset:8
ds_read_b64_tr_b16 v[70:71], v34 offset:1288
ds_read_b64_tr_b16 v[72:73], v34 offset:64
ds_read_b64_tr_b16 v[74:75], v34 offset:1344
ds_read_b64_tr_b16 v[76:77], v34 offset:72
ds_read_b64_tr_b16 v[78:79], v34 offset:1352
ds_read_b64_tr_b16 v[80:81], v35 offset:128
ds_read_b64_tr_b16 v[82:83], v35 offset:1408
s_add_u32 s52, s88, 4096
s_waitcnt lgkmcnt(8)
buffer_store_dwordx4 v[64:67], v36, s[24:27], s88 offen offset:0 sc1
s_waitcnt lgkmcnt(6)
buffer_store_dwordx4 v[68:71], v36, s[24:27], s88 offen offset:1024 sc1
s_waitcnt lgkmcnt(4)
buffer_store_dwordx4 v[72:75], v36, s[24:27], s88 offen offset:2048 sc1
s_waitcnt lgkmcnt(2)
buffer_store_dwordx4 v[76:79], v36, s[24:27], s88 offen offset:3072 sc1
s_waitcnt lgkmcnt(0)
buffer_store_dwordx4 v[80:83], v36, s[24:27], s52 offen offset:0 sc1
W2F_8:
s_waitcnt vmcnt(18)
s_barrier
s_add_u32 m0, s77, 147456
s_add_u32 s78, s73, 1966080
buffer_load_dwordx4 v4, s[28:31], s78 offen lds
s_add_u32 m0, s77, 148480
s_add_u32 s78, s73, 1996800
buffer_load_dwordx4 v4, s[28:31], s78 offen lds
s_add_u32 m0, s77, 149504
s_add_u32 s78, s73, 2027520
buffer_load_dwordx4 v4, s[28:31], s78 offen lds
s_add_u32 m0, s77, 150528
s_add_u32 s78, s73, 2058240
buffer_load_dwordx4 v4, s[28:31], s78 offen lds
s_add_u32 m0, s77, 32768
s_add_u32 s78, s74, 1966080
buffer_load_dwordx4 v4, s[28:31], s78 offen lds
s_add_u32 m0, s77, 33792
s_add_u32 s78, s74, 1996800
buffer_load_dwordx4 v4, s[28:31], s78 offen lds
s_add_u32 m0, s77, 34816
s_add_u32 s78, s74, 2027520
buffer_load_dwordx4 v4, s[28:31], s78 offen lds
s_add_u32 m0, s77, 35840
s_add_u32 s78, s74, 2058240
buffer_load_dwordx4 v4, s[28:31], s78 offen lds
s_waitcnt vmcnt(18)
s_barrier
s_waitcnt vmcnt(18)
s_barrier
s_add_u32 m0, s77, 49152
s_add_u32 s78, s72, 0
buffer_load_dwordx4 v4, s[28:31], s78 offen lds
s_add_u32 m0, s77, 50176
s_add_u32 s78, s72, 30720
buffer_load_dwordx4 v4, s[28:31], s78 offen lds
s_add_u32 m0, s77, 51200
s_add_u32 s78, s72, 61440
buffer_load_dwordx4 v4, s[28:31], s78 offen lds
s_add_u32 m0, s77, 52224
s_add_u32 s78, s72, 92160
buffer_load_dwordx4 v4, s[28:31], s78 offen lds
s_add_u32 m0, s77, 65536
s_add_u32 s78, s72, 491520
buffer_load_dwordx4 v4, s[28:31], s78 offen lds
s_add_u32 m0, s77, 66560
s_add_u32 s78, s72, 522240
buffer_load_dwordx4 v4, s[28:31], s78 offen lds
s_add_u32 m0, s77, 67584
s_add_u32 s78, s72, 552960
buffer_load_dwordx4 v4, s[28:31], s78 offen lds
s_add_u32 m0, s77, 68608
s_add_u32 s78, s72, 583680
buffer_load_dwordx4 v4, s[28:31], s78 offen lds
s_waitcnt vmcnt(18)
s_barrier
s_waitcnt vmcnt(18)
s_barrier
s_add_u32 m0, s77, 81920
s_add_u32 s78, s72, 983040
buffer_load_dwordx4 v4, s[28:31], s78 offen lds
s_add_u32 m0, s77, 82944
s_add_u32 s78, s72, 1013760
buffer_load_dwordx4 v4, s[28:31], s78 offen lds
s_add_u32 m0, s77, 83968
s_add_u32 s78, s72, 1044480
buffer_load_dwordx4 v4, s[28:31], s78 offen lds
s_add_u32 m0, s77, 84992
s_add_u32 s78, s72, 1075200
buffer_load_dwordx4 v4, s[28:31], s78 offen lds
s_add_u32 m0, s77, 98304
s_add_u32 s78, s72, 1474560
buffer_load_dwordx4 v4, s[28:31], s78 offen lds
s_add_u32 m0, s77, 99328
s_add_u32 s78, s72, 1505280
buffer_load_dwordx4 v4, s[28:31], s78 offen lds
s_add_u32 m0, s77, 100352
s_add_u32 s78, s72, 1536000
buffer_load_dwordx4 v4, s[28:31], s78 offen lds
s_add_u32 m0, s77, 101376
s_add_u32 s78, s72, 1566720
buffer_load_dwordx4 v4, s[28:31], s78 offen lds
s_waitcnt vmcnt(20)
s_barrier
s_cmp_lg_u32 s3, 4
s_cbranch_scc1 FW_9
s_lshl_b32 s40, s2, 7
s_add_u32 s40, s40, 65536
buffer_store_dword v0, v3, s[24:27], s40 offen offset:0 sc1
FW_9:
s_waitcnt vmcnt(16)
s_barrier
s_add_u32 m0, s77, 114688
s_add_u32 s78, s72, 1966080
buffer_load_dwordx4 v4, s[28:31], s78 offen lds
s_add_u32 m0, s77, 115712
s_add_u32 s78, s72, 1996800
buffer_load_dwordx4 v4, s[28:31], s78 offen lds
s_add_u32 m0, s77, 116736
s_add_u32 s78, s72, 2027520
buffer_load_dwordx4 v4, s[28:31], s78 offen lds
s_add_u32 m0, s77, 117760
s_add_u32 s78, s72, 2058240
buffer_load_dwordx4 v4, s[28:31], s78 offen lds
s_add_u32 m0, s77, 131072
s_add_u32 s78, s75, 0
buffer_load_dwordx4 v5, s[32:35], s78 offen lds
s_add_u32 m0, s77, 132096
s_add_u32 s78, s75, 27648
buffer_load_dwordx4 v5, s[32:35], s78 offen lds
s_add_u32 m0, s77, 133120
s_add_u32 s78, s75, 55296
buffer_load_dwordx4 v5, s[32:35], s78 offen lds
s_add_u32 m0, s77, 134144
s_add_u32 s78, s75, 82944
buffer_load_dwordx4 v5, s[32:35], s78 offen lds
s_waitcnt vmcnt(20)
s_barrier
s_add_u32 m0, s77, 147456
s_add_u32 s78, s75, 221184
buffer_load_dwordx4 v5, s[32:35], s78 offen lds
s_add_u32 m0, s77, 148480
s_add_u32 s78, s75, 248832
buffer_load_dwordx4 v5, s[32:35], s78 offen lds
s_add_u32 m0, s77, 149504
s_add_u32 s78, s75, 276480
buffer_load_dwordx4 v5, s[32:35], s78 offen lds
s_add_u32 m0, s77, 150528
s_add_u32 s78, s75, 304128
buffer_load_dwordx4 v5, s[32:35], s78 offen lds
s_waitcnt vmcnt(20)
s_barrier
s_add_u32 m0, s77, 32768
s_add_u32 s78, s75, 442368
buffer_load_dwordx4 v5, s[32:35], s78 offen lds
s_add_u32 m0, s77, 33792
s_add_u32 s78, s75, 470016
buffer_load_dwordx4 v5, s[32:35], s78 offen lds
s_add_u32 m0, s77, 34816
s_add_u32 s78, s75, 497664
buffer_load_dwordx4 v5, s[32:35], s78 offen lds
s_add_u32 m0, s77, 35840
s_add_u32 s78, s75, 525312
buffer_load_dwordx4 v5, s[32:35], s78 offen lds
s_waitcnt vmcnt(20)
s_barrier
s_add_u32 m0, s77, 49152
s_add_u32 s78, s75, 663552
buffer_load_dwordx4 v5, s[32:35], s78 offen lds
s_add_u32 m0, s77, 50176
s_add_u32 s78, s75, 691200
buffer_load_dwordx4 v5, s[32:35], s78 offen lds
s_add_u32 m0, s77, 51200
s_add_u32 s78, s75, 718848
buffer_load_dwordx4 v5, s[32:35], s78 offen lds
s_add_u32 m0, s77, 52224
s_add_u32 s78, s75, 746496
buffer_load_dwordx4 v5, s[32:35], s78 offen lds
s_waitcnt vmcnt(20)
s_barrier
s_add_u32 m0, s77, 65536
s_add_u32 s78, s75, 884736
buffer_load_dwordx4 v5, s[32:35], s78 offen lds
s_add_u32 m0, s77, 66560
s_add_u32 s78, s75, 912384
buffer_load_dwordx4 v5, s[32:35], s78 offen lds
s_add_u32 m0, s77, 67584
s_add_u32 s78, s75, 940032
buffer_load_dwordx4 v5, s[32:35], s78 offen lds
s_add_u32 m0, s77, 68608
s_add_u32 s78, s75, 967680
buffer_load_dwordx4 v5, s[32:35], s78 offen lds
s_waitcnt vmcnt(20)
s_barrier
s_add_u32 m0, s77, 81920
s_add_u32 s78, s75, 1105920
buffer_load_dwordx4 v5, s[32:35], s78 offen lds
s_add_u32 m0, s77, 82944
s_add_u32 s78, s75, 1133568
buffer_load_dwordx4 v5, s[32:35], s78 offen lds
s_add_u32 m0, s77, 83968
s_add_u32 s78, s75, 1161216
buffer_load_dwordx4 v5, s[32:35], s78 offen lds
s_add_u32 m0, s77, 84992
s_add_u32 s78, s75, 1188864
buffer_load_dwordx4 v5, s[32:35], s78 offen lds
s_waitcnt vmcnt(16)
s_barrier
s_add_u32 m0, s77, 98304
s_add_u32 s78, s75, 1327104
buffer_load_dwordx4 v5, s[32:35], s78 offen lds
s_add_u32 m0, s77, 99328
s_add_u32 s78, s75, 1354752
buffer_load_dwordx4 v5, s[32:35], s78 offen lds
s_add_u32 m0, s77, 100352
s_add_u32 s78, s75, 1382400
buffer_load_dwordx4 v5, s[32:35], s78 offen lds
s_add_u32 m0, s77, 101376
s_add_u32 s78, s75, 1410048
buffer_load_dwordx4 v5, s[32:35], s78 offen lds
s_waitcnt vmcnt(16)
s_barrier
s_add_u32 m0, s77, 114688
s_add_u32 s78, s75, 1548288
buffer_load_dwordx4 v5, s[32:35], s78 offen lds
s_add_u32 m0, s77, 115712
s_add_u32 s78, s75, 1575936
buffer_load_dwordx4 v5, s[32:35], s78 offen lds
s_add_u32 m0, s77, 116736
s_add_u32 s78, s75, 1603584
buffer_load_dwordx4 v5, s[32:35], s78 offen lds
s_add_u32 m0, s77, 117760
s_add_u32 s78, s75, 1631232
buffer_load_dwordx4 v5, s[32:35], s78 offen lds
s_waitcnt vmcnt(20)
s_barrier
s_waitcnt vmcnt(16)
s_barrier
s_add_u32 m0, s77, 131072
s_add_u32 s78, s75, 1769472
buffer_load_dwordx4 v5, s[32:35], s78 offen lds
s_add_u32 m0, s77, 132096
s_add_u32 s78, s75, 1797120
buffer_load_dwordx4 v5, s[32:35], s78 offen lds
s_add_u32 m0, s77, 133120
s_add_u32 s78, s75, 1824768
buffer_load_dwordx4 v5, s[32:35], s78 offen lds
s_add_u32 m0, s77, 134144
s_add_u32 s78, s75, 1852416
buffer_load_dwordx4 v5, s[32:35], s78 offen lds
s_add_u32 m0, s77, 147456
s_add_u32 s78, s75, 1990656
buffer_load_dwordx4 v5, s[32:35], s78 offen lds
s_add_u32 m0, s77, 148480
s_add_u32 s78, s75, 2018304
buffer_load_dwordx4 v5, s[32:35], s78 offen lds
s_add_u32 m0, s77, 149504
s_add_u32 s78, s75, 2045952
buffer_load_dwordx4 v5, s[32:35], s78 offen lds
s_add_u32 m0, s77, 150528
s_add_u32 s78, s75, 2073600
buffer_load_dwordx4 v5, s[32:35], s78 offen lds
s_waitcnt vmcnt(20)
s_barrier
s_and_b32 s61, s2, 7
s_lshr_b32 s60, s2, 3
v_add_u32 v8, 0, v2
v_mul_u32_u24 v13, 205, v8
v_lshrrev_b32 v13, 14, v13
v_mul_u32_u24 v14, 80, v13
v_sub_u32 v8, v8, v14
v_lshlrev_b32 v8, 4, v8
v_mul_u32_u24 v13, 10368, v13
v_add_u32 v8, v8, v13
v_add_u32 v8, 4096, v8
v_add_u32 v9, 64, v2
v_mul_u32_u24 v13, 205, v9
v_lshrrev_b32 v13, 14, v13
v_mul_u32_u24 v14, 80, v13
v_sub_u32 v9, v9, v14
v_lshlrev_b32 v9, 4, v9
v_mul_u32_u24 v13, 10368, v13
v_add_u32 v9, v9, v13
v_add_u32 v9, 3072, v9
v_add_u32 v10, 128, v2
v_mul_u32_u24 v13, 205, v10
v_lshrrev_b32 v13, 14, v13
v_mul_u32_u24 v14, 80, v13
v_sub_u32 v10, v10, v14
v_lshlrev_b32 v10, 4, v10
v_mul_u32_u24 v13, 10368, v13
v_add_u32 v10, v10, v13
v_add_u32 v10, 2048, v10
v_add_u32 v11, 192, v2
v_mul_u32_u24 v13, 205, v11
v_lshrrev_b32 v13, 14, v13
v_mul_u32_u24 v14, 80, v13
v_sub_u32 v11, v11, v14
v_lshlrev_b32 v11, 4, v11
v_mul_u32_u24 v13, 10368, v13
v_add_u32 v11, v11, v13
v_add_u32 v11, 1024, v11
v_add_u32 v12, 256, v2
v_mul_u32_u24 v13, 205, v12
v_lshrrev_b32 v13, 14, v13
v_mul_u32_u24 v14, 80, v13
v_sub_u32 v12, v12, v14
v_lshlrev_b32 v12, 4, v12
v_mul_u32_u24 v13, 10368, v13
v_add_u32 v12, v12, v13
v_add_u32 v12, 4096, v12
v_lshlrev_b32 v13, 4, v2
s_mov_b32 s41, 7561744
s_mov_b32 s42, 1602337
s_cmp_eq_u32 s61, 1
s_cselect_b32 s41, s42, s41
s_mov_b32 s42, 2267186
s_cmp_eq_u32 s61, 2
s_cselect_b32 s41, s42, s41
s_mov_b32 s42, 3385667
s_cmp_eq_u32 s61, 3
s_cselect_b32 s41, s42, s41
s_mov_b32 s42, 5622629
s_cmp_eq_u32 s61, 4
s_cselect_b32 s41, s42, s41
s_mov_b32 s42, 6741110
s_cmp_eq_u32 s61, 5
s_cselect_b32 s41, s42, s41
s_mov_b32 s42, 8311815
s_cmp_eq_u32 s61, 6
s_cselect_b32 s41, s42, s41
s_mov_b32 s42, 16666944
s_cmp_eq_u32 s61, 7
s_cselect_b32 s41, s42, s41
v_min_u32 v18, 59, v2
v_mul_u32_u24 v16, 43, v18
v_lshrrev_b32 v16, 8, v16
v_mul_u32_u24 v17, 6, v16
v_sub_u32 v17, v18, v17
v_lshlrev_b32 v17, 2, v17
v_lshrrev_b32 v17, v17, s41
v_and_b32 v17, 15, v17
s_lshl_b32 s42, s60, 1
s_sub_i32 s42, s42, 8
v_add_u32 v16, s42, v16
v_max_i32 v16, 0, v16
v_lshl_add_u32 v16, v16, 4, v17
v_lshlrev_b32 v16, 9, v16
v_add_u32 v84, 524288, v16
s_mul_i32 s41, s61, 80
s_add_u32 s43, s41, 79
s_lshr_b32 s41, s41, 7
s_lshr_b32 s43, s43, 7
s_add_u32 s41, s41, 11
s_add_u32 s43, s43, 11
v_min_u32 v18, 19, v2
v_and_b32 v17, 1, v18
v_cmp_eq_u32 vcc, 1, v17
v_mov_b32 v17, s41
v_mov_b32 v19, s43
v_cndmask_b32 v17, v17, v19, vcc
v_lshrrev_b32 v16, 1, v18
v_add_u32 v16, s42, v16
v_max_i32 v16, 0, v16
v_lshl_add_u32 v16, v16, 4, v17
v_lshlrev_b32 v16, 9, v16
v_add_u32 v85, 524416, v16
s_and_b32 s43, s2, 7
s_lshr_b32 s41, s2, 3
s_and_b32 s42, s43, 1
s_lshl_b32 s42, s42, 2
s_and_b32 s40, s41, 3
s_add_u32 s40, s42, s40
s_lshr_b32 s42, s43, 1
s_lshl_b32 s42, s42, 3
s_lshr_b32 s41, s41, 2
s_add_u32 s41, s42, s41
s_lshl_b32 s40, s40, 7
s_add_u32 s40, s40, 65536
v_and_b32 v16, 31, v2
v_lshlrev_b32 v16, 10, v16
v_add_u32 v86, s40, v16
s_lshl_b32 s41, s41, 14
s_add_u32 s41, s41, 524544
v_and_b32 v16, 15, v2
v_min_u32 v16, 10, v16
v_bfe_u32 v17, v2, 4, 1
v_lshl_add_u32 v16, v17, 4, v16
v_lshlrev_b32 v16, 9, v16
v_add_u32 v87, s41, v16
buffer_load_dword v88, v84, s[24:27], 0 offen sc1
buffer_load_dword v89, v85, s[24:27], 0 offen sc1
buffer_load_dword v90, v86, s[24:27], 0 offen sc1
buffer_load_dword v91, v87, s[24:27], 0 offen sc1
s_waitcnt vmcnt(20)
s_barrier
s_waitcnt vmcnt(4)
s_barrier
s_branch F_ltail
F_ltail:
s_sub_u32 s57, s3, 4
s_waitcnt vmcnt(0)
v_cmp_eq_u32 vcc, s0, v88
s_nop 0
s_cmp_eq_u64 vcc, -1
s_cbranch_scc1 PQK_pk
s_mov_b32 s41, 7561744
s_mov_b32 s42, 1602337
s_cmp_eq_u32 s61, 1
s_cselect_b32 s41, s42, s41
s_mov_b32 s42, 2267186
s_cmp_eq_u32 s61, 2
s_cselect_b32 s41, s42, s41
s_mov_b32 s42, 3385667
s_cmp_eq_u32 s61, 3
s_cselect_b32 s41, s42, s41
s_mov_b32 s42, 5622629
s_cmp_eq_u32 s61, 4
s_cselect_b32 s41, s42, s41
s_mov_b32 s42, 6741110
s_cmp_eq_u32 s61, 5
s_cselect_b32 s41, s42, s41
s_mov_b32 s42, 8311815
s_cmp_eq_u32 s61, 6
s_cselect_b32 s41, s42, s41
s_mov_b32 s42, 16666944
s_cmp_eq_u32 s61, 7
s_cselect_b32 s41, s42, s41
v_mul_u32_u24 v16, 43, v2
v_lshrrev_b32 v16, 8, v16
v_mul_u32_u24 v17, 6, v16
v_sub_u32 v17, v2, v17
v_lshlrev_b32 v17, 2, v17
v_lshrrev_b32 v17, v17, s41
v_and_b32 v17, 15, v17
s_lshl_b32 s42, s60, 1
s_sub_i32 s42, s42, 8
v_add_u32 v16, s42, v16
v_max_i32 v16, 0, v16
v_lshl_add_u32 v16, v16, 4, v17
v_lshlrev_b32 v16, 9, v16
s_mov_b32 s43, 524288
s_mov_b32 s1, 20000
s_mov_b32 exec_lo, -1
s_mov_b32 exec_hi, 268435455
PQK:
buffer_load_dword v18, v16, s[24:27], s43 offen offset:0 sc1
s_waitcnt vmcnt(0)
v_cmp_eq_u32 vcc, s0, v18
s_nop 0
s_cmp_eq_u64 vcc, exec
s_cbranch_scc1 PQK_ok
s_sub_u32 s1, s1, 1
s_cmp_lg_u32 s1, 0
s_cbranch_scc1 PQK
PQK_ok:
s_mov_b64 exec, -1
PQK_pk:
s_add_u32 s64, s57, 0
s_mul_i32 s67, s64, 5120
s_add_u32 s67, s67, 512
s_lshl_b32 s65, s60, 1
s_add_u32 s65, s65, s64
s_sub_i32 s66, s65, 10
s_max_i32 s66, s66, 0
s_cmp_lt_u32 s64, 2
s_cselect_b32 s65, s65, s66
s_mov_b32 s66, 12582912
s_cselect_b32 s66, 8388608, s66
s_mul_i32 s65, s65, 40960
s_add_u32 s65, s65, s66
s_mul_i32 s66, s61, 5120
s_add_u32 s65, s65, s66
s_mov_b32 m0, s67
s_nop 0
buffer_load_dwordx4 v13, s[24:27], s65 offen offset:0 sc1 lds
buffer_load_dwordx4 v13, s[24:27], s65 offen offset:1024 sc1 lds
buffer_load_dwordx4 v13, s[24:27], s65 offen offset:2048 sc1 lds
buffer_load_dwordx4 v13, s[24:27], s65 offen offset:3072 sc1 lds
s_add_u32 m0, s67, 4096
s_add_u32 s65, s65, 4096
buffer_load_dwordx4 v13, s[24:27], s65 offen sc1 lds
s_add_u32 s64, s57, 4
s_mul_i32 s67, s64, 5120
s_add_u32 s67, s67, 512
s_lshl_b32 s65, s60, 1
s_add_u32 s65, s65, s64
s_sub_i32 s66, s65, 10
s_max_i32 s66, s66, 0
s_mul_i32 s65, s66, 40960
s_add_u32 s65, s65, 12582912
s_mul_i32 s66, s61, 5120
s_add_u32 s65, s65, s66
s_mov_b32 m0, s67
s_nop 0
buffer_load_dwordx4 v13, s[24:27], s65 offen offset:0 sc1 lds
buffer_load_dwordx4 v13, s[24:27], s65 offen offset:1024 sc1 lds
buffer_load_dwordx4 v13, s[24:27], s65 offen offset:2048 sc1 lds
buffer_load_dwordx4 v13, s[24:27], s65 offen offset:3072 sc1 lds
s_add_u32 m0, s67, 4096
s_add_u32 s65, s65, 4096
buffer_load_dwordx4 v13, s[24:27], s65 offen sc1 lds
s_add_u32 s64, s57, 8
s_mul_i32 s67, s64, 5120
s_add_u32 s67, s67, 512
s_lshl_b32 s65, s60, 1
s_add_u32 s65, s65, s64
s_sub_i32 s66, s65, 10
s_max_i32 s66, s66, 0
s_mul_i32 s65, s66, 40960
s_add_u32 s65, s65, 12582912
s_mul_i32 s66, s61, 5120
s_add_u32 s65, s65, s66
s_mov_b32 m0, s67
s_nop 0
buffer_load_dwordx4 v13, s[24:27], s65 offen offset:0 sc1 lds
buffer_load_dwordx4 v13, s[24:27], s65 offen offset:1024 sc1 lds
buffer_load_dwordx4 v13, s[24:27], s65 offen offset:2048 sc1 lds
buffer_load_dwordx4 v13, s[24:27], s65 offen offset:3072 sc1 lds
s_add_u32 m0, s67, 4096
s_add_u32 s65, s65, 4096
buffer_load_dwordx4 v13, s[24:27], s65 offen sc1 lds
v_mov_b32 v24, 16
s_mov_b32 s1, 160000
PPR:
ds_read_b128 v[20:23], v24
s_waitcnt lgkmcnt(0)
v_min_u32 v20, v20, v21
v_min3_u32 v20, v20, v22, v23
s_nop 0
v_readfirstlane_b32 s40, v20
s_cmp_lg_u32 s40, 0
s_cbranch_scc1 PPR_ok
s_sub_u32 s1, s1, 1
s_cmp_lg_u32 s1, 0
s_cbranch_scc1 PPR
PPR_ok:
v_cmp_eq_u32 vcc, s0, v89
s_nop 0
s_cmp_eq_u64 vcc, -1
s_cbranch_scc1 PV_pk
s_mul_i32 s41, s61, 80
s_add_u32 s42, s41, 79
s_lshr_b32 s41, s41, 7
s_lshr_b32 s42, s42, 7
s_add_u32 s41, s41, 11
s_add_u32 s42, s42, 11
v_and_b32 v17, 1, v2
v_cmp_eq_u32 vcc, 1, v17
v_mov_b32 v17, s41
v_mov_b32 v18, s42
v_cndmask_b32 v17, v17, v18, vcc
v_lshrrev_b32 v16, 1, v2
s_lshl_b32 s42, s60, 1
s_sub_i32 s42, s42, 8
v_add_u32 v16, s42, v16
v_max_i32 v16, 0, v16
v_lshl_add_u32 v16, v16, 4, v17
v_lshlrev_b32 v16, 9, v16
s_mov_b32 s43, 524288
s_mov_b32 s1, 20000
s_mov_b32 exec_lo, 1048575
s_mov_b32 exec_hi, 0
PV:
buffer_load_dword v18, v16, s[24:27], s43 offen offset:128 sc1
s_waitcnt vmcnt(0)
v_cmp_eq_u32 vcc, s0, v18
s_nop 0
s_cmp_eq_u64 vcc, exec
s_cbranch_scc1 PV_ok
s_sub_u32 s1, s1, 1
s_cmp_lg_u32 s1, 0
s_cbranch_scc1 PV
PV_ok:
s_mov_b64 exec, -1
PV_pk:
s_cmp_lg_u32 s3, 7
s_cbranch_scc1 F_l1
v_mov_b32 v20, 0x3f803f80
v_mov_b32 v21, 0x3f803f80
v_mov_b32 v22, 0x3f803f80
v_mov_b32 v23, 0x3f803f80
v_mov_b32 v24, 113152
ds_write_b128 v24, v[20:23]
F_l1:
s_add_u32 s64, s57, 0
s_mul_i32 s67, s64, 5120
s_add_u32 s67, s67, 61952
s_lshl_b32 s65, s60, 1
s_add_u32 s65, s65, s64
s_sub_i32 s65, s65, 8
s_max_i32 s65, s65, 0
s_mul_i32 s65, s65, 41472
s_mul_i32 s66, s61, 1280
s_add_u32 s65, s65, s66
s_add_u32 s65, s65, 16773120
s_mov_b32 m0, s67
s_nop 0
buffer_load_dwordx4 v8, s[24:27], s65 offen offset:0 sc1 lds
buffer_load_dwordx4 v9, s[24:27], s65 offen offset:1024 sc1 lds
buffer_load_dwordx4 v10, s[24:27], s65 offen offset:2048 sc1 lds
buffer_load_dwordx4 v11, s[24:27], s65 offen offset:3072 sc1 lds
s_add_u32 m0, s67, 4096
s_nop 0
buffer_load_dwordx4 v12, s[24:27], s65 offen sc1 lds
s_add_u32 s64, s57, 4
s_mul_i32 s67, s64, 5120
s_add_u32 s67, s67, 61952
s_lshl_b32 s65, s60, 1
s_add_u32 s65, s65, s64
s_sub_i32 s65, s65, 8
s_max_i32 s65, s65, 0
s_mul_i32 s65, s65, 41472
s_mul_i32 s66, s61, 1280
s_add_u32 s65, s65, s66
s_add_u32 s65, s65, 16773120
s_mov_b32 m0, s67
s_nop 0
buffer_load_dwordx4 v8, s[24:27], s65 offen offset:0 sc1 lds
buffer_load_dwordx4 v9, s[24:27], s65 offen offset:1024 sc1 lds
buffer_load_dwordx4 v10, s[24:27], s65 offen offset:2048 sc1 lds
buffer_load_dwordx4 v11, s[24:27], s65 offen offset:3072 sc1 lds
s_add_u32 m0, s67, 4096
s_nop 0
buffer_load_dwordx4 v12, s[24:27], s65 offen sc1 lds
s_cmp_ge_u32 s57, 2
s_cbranch_scc1 F_l2
s_add_u32 s64, s57, 8
s_mul_i32 s67, s64, 5120
s_add_u32 s67, s67, 61952
s_lshl_b32 s65, s60, 1
s_add_u32 s65, s65, s64
s_sub_i32 s65, s65, 8
s_max_i32 s65, s65, 0
s_mul_i32 s65, s65, 41472
s_mul_i32 s66, s61, 1280
s_add_u32 s65, s65, s66
s_add_u32 s65, s65, 16773120
s_mov_b32 m0, s67
s_nop 0
buffer_load_dwordx4 v8, s[24:27], s65 offen offset:0 sc1 lds
buffer_load_dwordx4 v9, s[24:27], s65 offen offset:1024 sc1 lds
buffer_load_dwordx4 v10, s[24:27], s65 offen offset:2048 sc1 lds
buffer_load_dwordx4 v11, s[24:27], s65 offen offset:3072 sc1 lds
s_add_u32 m0, s67, 4096
s_nop 0
buffer_load_dwordx4 v12, s[24:27], s65 offen sc1 lds
F_l2:
s_and_b32 s40, s2, 7
s_lshr_b32 s41, s2, 3
s_and_b32 s42, s40, 1
s_lshl_b32 s42, s42, 2
s_and_b32 s43, s41, 3
s_add_u32 s61, s42, s43
s_lshr_b32 s42, s40, 1
s_lshl_b32 s42, s42, 3
s_lshr_b32 s43, s41, 2
s_add_u32 s60, s42, s43
s_mul_i32 s62, s61, 378880
s_add_u32 s62, s62, 33554432
s_lshl_b32 s40, s60, 1
s_mul_i32 s63, s40, 110592
s_add_u32 s63, s63, 20971520
s_mul_i32 s64, s40, 40960
s_add_u32 s64, s64, 29249536
v_lshlrev_b32 v4, 4, v2
v_add_u32 v5, 4096, v4
v_lshrrev_b32 v9, 4, v2
v_and_b32 v10, 15, v2
v_lshlrev_b32 v6, 9, v9
v_lshl_add_u32 v6, v10, 4, v6
v_mul_u32_u24 v7, 1280, v10
v_lshl_add_u32 v8, v9, 3, v7
v_add_u32 v8, 128, v8
v_lshl_add_u32 v7, v9, 4, v7
s_lshl_b32 s40, s60, 2
s_and_b32 s41, s3, 3
s_add_u32 s40, s40, s41
s_mul_i32 s40, s40, 20480
s_mul_i32 s41, s61, 160
s_add_u32 s69, s40, s41
v_cmp_eq_u32 vcc, s0, v90
s_nop 0
s_cmp_eq_u64 vcc, -1
s_cbranch_scc1 PW_pk
v_lshlrev_b32 v16, 10, v2
s_lshl_b32 s43, s61, 7
s_add_u32 s43, s43, 65536
s_mov_b32 s1, 20000
s_mov_b32 exec_lo, -1
s_mov_b32 exec_hi, 0
PW:
buffer_load_dword v18, v16, s[24:27], s43 offen offset:0 sc1
s_waitcnt vmcnt(0)
v_cmp_eq_u32 vcc, s0, v18
s_nop 0
s_cmp_eq_u64 vcc, exec
s_cbranch_scc1 PW_ok
s_sub_u32 s1, s1, 1
s_cmp_lg_u32 s1, 0
s_cbranch_scc1 PW
PW_ok:
s_mov_b64 exec, -1
PW_pk:
v_cmp_eq_u32 vcc, s0, v91
s_nop 0
s_cmp_eq_u64 vcc, -1
s_cbranch_scc1 PH_pk
s_lshl_b32 s43, s60, 14
s_add_u32 s43, s43, 524288
v_lshlrev_b32 v250, 9, v2
s_mov_b32 s1, 20000
s_mov_b32 exec_lo, 134154239
s_mov_b32 exec_hi, 0
PH:
buffer_load_dword v251, v250, s[24:27], s43 offen offset:256 sc1
s_waitcnt vmcnt(0)
v_cmp_eq_u32 vcc, s0, v251
s_nop 0
s_cmp_eq_u64 vcc, exec
s_cbranch_scc1 PH_ok
s_sub_u32 s1, s1, 1
s_cmp_lg_u32 s1, 0
s_cbranch_scc1 PH
PH_ok:
s_mov_b64 exec, -1
PH_pk:
s_lshr_b32 s40, s57, 1
s_lshl_b32 s40, s40, 2
s_and_b32 s41, s57, 1
s_add_u32 s56, s40, s41
s_add_u32 s42, s57, 40
s_cmp_lt_u32 s57, 2
s_cselect_b32 s55, s42, s57
s_add_u32 s40, s57, 2
s_lshr_b32 s40, s40, 1
s_lshl_b32 s40, s40, 2
s_add_u32 s54, s40, s41
s_add_u32 s54, s54, 2
s_add_u32 s65, s56, 0
s_mul_i32 s66, s65, 5120
s_lshl_b32 s67, s65, 11
s_add_u32 s66, s66, s62
s_add_u32 s67, s67, s63
s_add_u32 s68, s67, 110592
buffer_load_dwordx4 v[96:99], v4, s[24:27], s66 offen offset:0 sc1
buffer_load_dwordx4 v[100:103], v4, s[24:27], s66 offen offset:1024 sc1
buffer_load_dwordx4 v[104:107], v4, s[24:27], s66 offen offset:2048 sc1
buffer_load_dwordx4 v[108:111], v4, s[24:27], s66 offen offset:3072 sc1
buffer_load_dwordx4 v[112:115], v5, s[24:27], s66 offen offset:0 sc1
buffer_load_dwordx4 v[116:119], v6, s[24:27], s67 offen offset:0 sc1
buffer_load_dwordx4 v[120:123], v6, s[24:27], s67 offen offset:256 sc1
buffer_load_dwordx4 v[124:127], v6, s[24:27], s68 offen offset:0 sc1
buffer_load_dwordx4 v[128:131], v6, s[24:27], s68 offen offset:256 sc1
s_waitcnt vmcnt(9) lgkmcnt(0)
s_barrier
s_add_u32 s65, s56, 8
s_mul_i32 s66, s65, 5120
s_lshl_b32 s67, s65, 11
s_add_u32 s66, s66, s62
s_add_u32 s67, s67, s63
s_add_u32 s68, s67, 110592
buffer_load_dwordx4 v[132:135], v4, s[24:27], s66 offen offset:0 sc1
buffer_load_dwordx4 v[136:139], v4, s[24:27], s66 offen offset:1024 sc1
buffer_load_dwordx4 v[140:143], v4, s[24:27], s66 offen offset:2048 sc1
buffer_load_dwordx4 v[144:147], v4, s[24:27], s66 offen offset:3072 sc1
buffer_load_dwordx4 v[148:151], v5, s[24:27], s66 offen offset:0 sc1
buffer_load_dwordx4 v[152:155], v6, s[24:27], s67 offen offset:0 sc1
buffer_load_dwordx4 v[156:159], v6, s[24:27], s67 offen offset:256 sc1
buffer_load_dwordx4 v[160:163], v6, s[24:27], s68 offen offset:0 sc1
buffer_load_dwordx4 v[164:167], v6, s[24:27], s68 offen offset:256 sc1
s_add_u32 s65, s56, 16
s_mul_i32 s66, s65, 5120
s_lshl_b32 s67, s65, 11
s_add_u32 s66, s66, s62
s_add_u32 s67, s67, s63
s_add_u32 s68, s67, 110592
buffer_load_dwordx4 v[168:171], v4, s[24:27], s66 offen offset:0 sc1
buffer_load_dwordx4 v[172:175], v4, s[24:27], s66 offen offset:1024 sc1
buffer_load_dwordx4 v[176:179], v4, s[24:27], s66 offen offset:2048 sc1
buffer_load_dwordx4 v[180:183], v4, s[24:27], s66 offen offset:3072 sc1
buffer_load_dwordx4 v[184:187], v5, s[24:27], s66 offen offset:0 sc1
buffer_load_dwordx4 v[188:191], v6, s[24:27], s67 offen offset:0 sc1
buffer_load_dwordx4 v[192:195], v6, s[24:27], s67 offen offset:256 sc1
buffer_load_dwordx4 v[196:199], v6, s[24:27], s68 offen offset:0 sc1
buffer_load_dwordx4 v[200:203], v6, s[24:27], s68 offen offset:256 sc1
s_waitcnt vmcnt(18)
v_mfma_f32_16x16x32_bf16 v[16:19], v[96:99], v[116:119], 0
s_add_u32 s65, s56, 24
v_mfma_f32_16x16x32_bf16 v[36:39], v[96:99], v[120:123], 0
s_mul_i32 s66, s65, 5120
v_mfma_f32_16x16x32_bf16 v[56:59], v[96:99], v[124:127], 0
s_lshl_b32 s67, s65, 11
v_mfma_f32_16x16x32_bf16 v[76:79], v[96:99], v[128:131], 0
s_add_u32 s66, s66, s62
v_mfma_f32_16x16x32_bf16 v[20:23], v[100:103], v[116:119], 0
s_add_u32 s67, s67, s63
v_mfma_f32_16x16x32_bf16 v[40:43], v[100:103], v[120:123], 0
s_add_u32 s68, s67, 110592
v_mfma_f32_16x16x32_bf16 v[60:63], v[100:103], v[124:127], 0
buffer_load_dwordx4 v[204:207], v4, s[24:27], s66 offen offset:0 sc1
v_mfma_f32_16x16x32_bf16 v[80:83], v[100:103], v[128:131], 0
buffer_load_dwordx4 v[208:211], v4, s[24:27], s66 offen offset:1024 sc1
v_mfma_f32_16x16x32_bf16 v[24:27], v[104:107], v[116:119], 0
buffer_load_dwordx4 v[212:215], v4, s[24:27], s66 offen offset:2048 sc1
v_mfma_f32_16x16x32_bf16 v[44:47], v[104:107], v[120:123], 0
buffer_load_dwordx4 v[216:219], v4, s[24:27], s66 offen offset:3072 sc1
v_mfma_f32_16x16x32_bf16 v[64:67], v[104:107], v[124:127], 0
buffer_load_dwordx4 v[220:223], v5, s[24:27], s66 offen offset:0 sc1
v_mfma_f32_16x16x32_bf16 v[84:87], v[104:107], v[128:131], 0
buffer_load_dwordx4 v[224:227], v6, s[24:27], s67 offen offset:0 sc1
v_mfma_f32_16x16x32_bf16 v[28:31], v[108:111], v[116:119], 0
buffer_load_dwordx4 v[228:231], v6, s[24:27], s67 offen offset:256 sc1
v_mfma_f32_16x16x32_bf16 v[48:51], v[108:111], v[120:123], 0
buffer_load_dwordx4 v[232:235], v6, s[24:27], s68 offen offset:0 sc1
v_mfma_f32_16x16x32_bf16 v[68:71], v[108:111], v[124:127], 0
buffer_load_dwordx4 v[236:239], v6, s[24:27], s68 offen offset:256 sc1
v_mfma_f32_16x16x32_bf16 v[88:91], v[108:111], v[128:131], 0
v_mfma_f32_16x16x32_bf16 v[32:35], v[112:115], v[116:119], 0
v_mfma_f32_16x16x32_bf16 v[52:55], v[112:115], v[120:123], 0
v_mfma_f32_16x16x32_bf16 v[72:75], v[112:115], v[124:127], 0
v_mfma_f32_16x16x32_bf16 v[92:95], v[112:115], v[128:131], 0
s_waitcnt vmcnt(18)
v_mfma_f32_16x16x32_bf16 v[16:19], v[132:135], v[152:155], v[16:19]
s_add_u32 s65, s56, 32
v_mfma_f32_16x16x32_bf16 v[36:39], v[132:135], v[156:159], v[36:39]
s_mul_i32 s66, s65, 5120
v_mfma_f32_16x16x32_bf16 v[56:59], v[132:135], v[160:163], v[56:59]
s_lshl_b32 s67, s65, 11
v_mfma_f32_16x16x32_bf16 v[76:79], v[132:135], v[164:167], v[76:79]
s_add_u32 s66, s66, s62
v_mfma_f32_16x16x32_bf16 v[20:23], v[136:139], v[152:155], v[20:23]
s_add_u32 s67, s67, s63
v_mfma_f32_16x16x32_bf16 v[40:43], v[136:139], v[156:159], v[40:43]
s_add_u32 s68, s67, 110592
v_mfma_f32_16x16x32_bf16 v[60:63], v[136:139], v[160:163], v[60:63]
buffer_load_dwordx4 v[96:99], v4, s[24:27], s66 offen offset:0 sc1
v_mfma_f32_16x16x32_bf16 v[80:83], v[136:139], v[164:167], v[80:83]
buffer_load_dwordx4 v[100:103], v4, s[24:27], s66 offen offset:1024 sc1
v_mfma_f32_16x16x32_bf16 v[24:27], v[140:143], v[152:155], v[24:27]
buffer_load_dwordx4 v[104:107], v4, s[24:27], s66 offen offset:2048 sc1
v_mfma_f32_16x16x32_bf16 v[44:47], v[140:143], v[156:159], v[44:47]
buffer_load_dwordx4 v[108:111], v4, s[24:27], s66 offen offset:3072 sc1
v_mfma_f32_16x16x32_bf16 v[64:67], v[140:143], v[160:163], v[64:67]
buffer_load_dwordx4 v[112:115], v5, s[24:27], s66 offen offset:0 sc1
v_mfma_f32_16x16x32_bf16 v[84:87], v[140:143], v[164:167], v[84:87]
buffer_load_dwordx4 v[116:119], v6, s[24:27], s67 offen offset:0 sc1
v_mfma_f32_16x16x32_bf16 v[28:31], v[144:147], v[152:155], v[28:31]
buffer_load_dwordx4 v[120:123], v6, s[24:27], s67 offen offset:256 sc1
v_mfma_f32_16x16x32_bf16 v[48:51], v[144:147], v[156:159], v[48:51]
buffer_load_dwordx4 v[124:127], v6, s[24:27], s68 offen offset:0 sc1
v_mfma_f32_16x16x32_bf16 v[68:71], v[144:147], v[160:163], v[68:71]
buffer_load_dwordx4 v[128:131], v6, s[24:27], s68 offen offset:256 sc1
v_mfma_f32_16x16x32_bf16 v[88:91], v[144:147], v[164:167], v[88:91]
v_mfma_f32_16x16x32_bf16 v[32:35], v[148:151], v[152:155], v[32:35]
v_mfma_f32_16x16x32_bf16 v[52:55], v[148:151], v[156:159], v[52:55]
v_mfma_f32_16x16x32_bf16 v[72:75], v[148:151], v[160:163], v[72:75]
v_mfma_f32_16x16x32_bf16 v[92:95], v[148:151], v[164:167], v[92:95]
s_waitcnt vmcnt(18)
v_mfma_f32_16x16x32_bf16 v[16:19], v[168:171], v[188:191], v[16:19]
s_lshl_b32 s43, s60, 14
v_mfma_f32_16x16x32_bf16 v[36:39], v[168:171], v[192:195], v[36:39]
s_add_u32 s43, s43, 524288
v_mfma_f32_16x16x32_bf16 v[56:59], v[168:171], v[196:199], v[56:59]
v_and_b32 v250, 31, v2
v_mfma_f32_16x16x32_bf16 v[76:79], v[168:171], v[200:203], v[76:79]
v_lshlrev_b32 v250, 9, v250
v_mfma_f32_16x16x32_bf16 v[20:23], v[172:175], v[188:191], v[20:23]
buffer_load_dword v251, v250, s[24:27], s43 offen offset:384 sc1
v_mfma_f32_16x16x32_bf16 v[40:43], v[172:175], v[192:195], v[40:43]
s_mov_b32 s65, s55
v_mfma_f32_16x16x32_bf16 v[60:63], v[172:175], v[196:199], v[60:63]
s_mul_i32 s66, s65, 5120
v_mfma_f32_16x16x32_bf16 v[80:83], v[172:175], v[200:203], v[80:83]
s_lshl_b32 s67, s65, 11
v_mfma_f32_16x16x32_bf16 v[24:27], v[176:179], v[188:191], v[24:27]
s_add_u32 s66, s66, s62
v_mfma_f32_16x16x32_bf16 v[44:47], v[176:179], v[192:195], v[44:47]
s_add_u32 s67, s67, s63
v_mfma_f32_16x16x32_bf16 v[64:67], v[176:179], v[196:199], v[64:67]
s_add_u32 s68, s67, 110592
v_mfma_f32_16x16x32_bf16 v[84:87], v[176:179], v[200:203], v[84:87]
buffer_load_dwordx4 v[132:135], v4, s[24:27], s66 offen offset:0 sc1
v_mfma_f32_16x16x32_bf16 v[28:31], v[180:183], v[188:191], v[28:31]
buffer_load_dwordx4 v[136:139], v4, s[24:27], s66 offen offset:1024 sc1
v_mfma_f32_16x16x32_bf16 v[48:51], v[180:183], v[192:195], v[48:51]
buffer_load_dwordx4 v[140:143], v4, s[24:27], s66 offen offset:2048 sc1
v_mfma_f32_16x16x32_bf16 v[68:71], v[180:183], v[196:199], v[68:71]
buffer_load_dwordx4 v[144:147], v4, s[24:27], s66 offen offset:3072 sc1
v_mfma_f32_16x16x32_bf16 v[88:91], v[180:183], v[200:203], v[88:91]
buffer_load_dwordx4 v[148:151], v5, s[24:27], s66 offen offset:0 sc1
v_mfma_f32_16x16x32_bf16 v[32:35], v[184:187], v[188:191], v[32:35]
v_mfma_f32_16x16x32_bf16 v[52:55], v[184:187], v[192:195], v[52:55]
v_mfma_f32_16x16x32_bf16 v[72:75], v[184:187], v[196:199], v[72:75]
v_mfma_f32_16x16x32_bf16 v[92:95], v[184:187], v[200:203], v[92:95]
s_waitcnt vmcnt(15)
v_mfma_f32_16x16x32_bf16 v[16:19], v[204:207], v[224:227], v[16:19]
s_add_u32 s65, s54, 0
v_mfma_f32_16x16x32_bf16 v[36:39], v[204:207], v[228:231], v[36:39]
s_mul_i32 s66, s65, 5120
v_mfma_f32_16x16x32_bf16 v[56:59], v[204:207], v[232:235], v[56:59]
s_lshl_b32 s67, s65, 11
v_mfma_f32_16x16x32_bf16 v[76:79], v[204:207], v[236:239], v[76:79]
s_add_u32 s66, s66, s62
v_mfma_f32_16x16x32_bf16 v[20:23], v[208:211], v[224:227], v[20:23]
s_add_u32 s67, s67, s63
v_mfma_f32_16x16x32_bf16 v[40:43], v[208:211], v[228:231], v[40:43]
s_add_u32 s68, s67, 110592
v_mfma_f32_16x16x32_bf16 v[60:63], v[208:211], v[232:235], v[60:63]
buffer_load_dwordx4 v[168:171], v4, s[24:27], s66 offen offset:0 sc1
v_mfma_f32_16x16x32_bf16 v[80:83], v[208:211], v[236:239], v[80:83]
buffer_load_dwordx4 v[172:175], v4, s[24:27], s66 offen offset:1024 sc1
v_mfma_f32_16x16x32_bf16 v[24:27], v[212:215], v[224:227], v[24:27]
buffer_load_dwordx4 v[176:179], v4, s[24:27], s66 offen offset:2048 sc1
v_mfma_f32_16x16x32_bf16 v[44:47], v[212:215], v[228:231], v[44:47]
buffer_load_dwordx4 v[180:183], v4, s[24:27], s66 offen offset:3072 sc1
v_mfma_f32_16x16x32_bf16 v[64:67], v[212:215], v[232:235], v[64:67]
buffer_load_dwordx4 v[184:187], v5, s[24:27], s66 offen offset:0 sc1
v_mfma_f32_16x16x32_bf16 v[84:87], v[212:215], v[236:239], v[84:87]
v_mfma_f32_16x16x32_bf16 v[28:31], v[216:219], v[224:227], v[28:31]
v_mfma_f32_16x16x32_bf16 v[48:51], v[216:219], v[228:231], v[48:51]
v_mfma_f32_16x16x32_bf16 v[68:71], v[216:219], v[232:235], v[68:71]
v_mfma_f32_16x16x32_bf16 v[88:91], v[216:219], v[236:239], v[88:91]
v_mfma_f32_16x16x32_bf16 v[32:35], v[220:223], v[224:227], v[32:35]
v_mfma_f32_16x16x32_bf16 v[52:55], v[220:223], v[228:231], v[52:55]
v_mfma_f32_16x16x32_bf16 v[72:75], v[220:223], v[232:235], v[72:75]
v_mfma_f32_16x16x32_bf16 v[92:95], v[220:223], v[236:239], v[92:95]
s_waitcnt vmcnt(10)
v_cmp_eq_u32 vcc, s0, v251
s_nop 0
s_cmp_eq_u64 vcc, -1
s_cbranch_scc1 HS_10_h1k
s_lshl_b32 s43, s60, 14
s_add_u32 s43, s43, 524288
v_lshlrev_b32 v250, 9, v2
s_mov_b32 s1, 20000
s_mov_b32 exec_lo, -1
s_mov_b32 exec_hi, 0
HS_10_fh1:
buffer_load_dword v251, v250, s[24:27], s43 offen offset:384 sc1
s_waitcnt vmcnt(0)
v_cmp_eq_u32 vcc, s0, v251
s_nop 0
s_cmp_eq_u64 vcc, exec
s_cbranch_scc1 HS_10_fh1_ok
s_sub_u32 s1, s1, 1
s_cmp_lg_u32 s1, 0
s_cbranch_scc1 HS_10_fh1
HS_10_fh1_ok:
s_mov_b64 exec, -1
HS_10_h1k:
s_mov_b32 s65, s55
s_mul_i32 s66, s65, 5120
s_lshl_b32 s67, s65, 11
s_add_u32 s66, s66, s62
s_add_u32 s67, s67, s63
s_add_u32 s68, s67, 110592
buffer_load_dwordx4 v[152:155], v6, s[24:27], s67 offen offset:0 sc1
buffer_load_dwordx4 v[156:159], v6, s[24:27], s67 offen offset:256 sc1
buffer_load_dwordx4 v[160:163], v6, s[24:27], s68 offen offset:0 sc1
buffer_load_dwordx4 v[164:167], v6, s[24:27], s68 offen offset:256 sc1
s_add_u32 s65, s54, 0
s_mul_i32 s66, s65, 5120
s_lshl_b32 s67, s65, 11
s_add_u32 s66, s66, s62
s_add_u32 s67, s67, s63
s_add_u32 s68, s67, 110592
buffer_load_dwordx4 v[188:191], v6, s[24:27], s67 offen offset:0 sc1
buffer_load_dwordx4 v[192:195], v6, s[24:27], s67 offen offset:256 sc1
buffer_load_dwordx4 v[196:199], v6, s[24:27], s68 offen offset:0 sc1
buffer_load_dwordx4 v[200:203], v6, s[24:27], s68 offen offset:256 sc1
s_waitcnt vmcnt(19)
v_mfma_f32_16x16x32_bf16 v[16:19], v[96:99], v[116:119], v[16:19]
s_add_u32 s65, s54, 8
v_mfma_f32_16x16x32_bf16 v[36:39], v[96:99], v[120:123], v[36:39]
s_mul_i32 s66, s65, 5120
v_mfma_f32_16x16x32_bf16 v[56:59], v[96:99], v[124:127], v[56:59]
s_lshl_b32 s67, s65, 11
v_mfma_f32_16x16x32_bf16 v[76:79], v[96:99], v[128:131], v[76:79]
s_add_u32 s66, s66, s62
v_mfma_f32_16x16x32_bf16 v[20:23], v[100:103], v[116:119], v[20:23]
s_add_u32 s67, s67, s63
v_mfma_f32_16x16x32_bf16 v[40:43], v[100:103], v[120:123], v[40:43]
s_add_u32 s68, s67, 110592
v_mfma_f32_16x16x32_bf16 v[60:63], v[100:103], v[124:127], v[60:63]
buffer_load_dwordx4 v[204:207], v4, s[24:27], s66 offen offset:0 sc1
v_mfma_f32_16x16x32_bf16 v[80:83], v[100:103], v[128:131], v[80:83]
buffer_load_dwordx4 v[208:211], v4, s[24:27], s66 offen offset:1024 sc1
v_mfma_f32_16x16x32_bf16 v[24:27], v[104:107], v[116:119], v[24:27]
buffer_load_dwordx4 v[212:215], v4, s[24:27], s66 offen offset:2048 sc1
v_mfma_f32_16x16x32_bf16 v[44:47], v[104:107], v[120:123], v[44:47]
buffer_load_dwordx4 v[216:219], v4, s[24:27], s66 offen offset:3072 sc1
v_mfma_f32_16x16x32_bf16 v[64:67], v[104:107], v[124:127], v[64:67]
buffer_load_dwordx4 v[220:223], v5, s[24:27], s66 offen offset:0 sc1
v_mfma_f32_16x16x32_bf16 v[84:87], v[104:107], v[128:131], v[84:87]
buffer_load_dwordx4 v[224:227], v6, s[24:27], s67 offen offset:0 sc1
v_mfma_f32_16x16x32_bf16 v[28:31], v[108:111], v[116:119], v[28:31]
buffer_load_dwordx4 v[228:231], v6, s[24:27], s67 offen offset:256 sc1
v_mfma_f32_16x16x32_bf16 v[48:51], v[108:111], v[120:123], v[48:51]
buffer_load_dwordx4 v[232:235], v6, s[24:27], s68 offen offset:0 sc1
v_mfma_f32_16x16x32_bf16 v[68:71], v[108:111], v[124:127], v[68:71]
buffer_load_dwordx4 v[236:239], v6, s[24:27], s68 offen offset:256 sc1
v_mfma_f32_16x16x32_bf16 v[88:91], v[108:111], v[128:131], v[88:91]
v_mfma_f32_16x16x32_bf16 v[32:35], v[112:115], v[116:119], v[32:35]
v_mfma_f32_16x16x32_bf16 v[52:55], v[112:115], v[120:123], v[52:55]
v_mfma_f32_16x16x32_bf16 v[72:75], v[112:115], v[124:127], v[72:75]
v_mfma_f32_16x16x32_bf16 v[92:95], v[112:115], v[128:131], v[92:95]
s_waitcnt vmcnt(13)
v_mfma_f32_16x16x32_bf16 v[16:19], v[132:135], v[152:155], v[16:19]
s_add_u32 s65, s54, 16
v_mfma_f32_16x16x32_bf16 v[36:39], v[132:135], v[156:159], v[36:39]
s_mul_i32 s66, s65, 5120
v_mfma_f32_16x16x32_bf16 v[56:59], v[132:135], v[160:163], v[56:59]
s_lshl_b32 s67, s65, 11
v_mfma_f32_16x16x32_bf16 v[76:79], v[132:135], v[164:167], v[76:79]
s_add_u32 s66, s66, s62
v_mfma_f32_16x16x32_bf16 v[20:23], v[136:139], v[152:155], v[20:23]
s_add_u32 s67, s67, s63
v_mfma_f32_16x16x32_bf16 v[40:43], v[136:139], v[156:159], v[40:43]
s_add_u32 s68, s67, 110592
v_mfma_f32_16x16x32_bf16 v[60:63], v[136:139], v[160:163], v[60:63]
buffer_load_dwordx4 v[96:99], v4, s[24:27], s66 offen offset:0 sc1
v_mfma_f32_16x16x32_bf16 v[80:83], v[136:139], v[164:167], v[80:83]
buffer_load_dwordx4 v[100:103], v4, s[24:27], s66 offen offset:1024 sc1
v_mfma_f32_16x16x32_bf16 v[24:27], v[140:143], v[152:155], v[24:27]
buffer_load_dwordx4 v[104:107], v4, s[24:27], s66 offen offset:2048 sc1
v_mfma_f32_16x16x32_bf16 v[44:47], v[140:143], v[156:159], v[44:47]
buffer_load_dwordx4 v[108:111], v4, s[24:27], s66 offen offset:3072 sc1
v_mfma_f32_16x16x32_bf16 v[64:67], v[140:143], v[160:163], v[64:67]
buffer_load_dwordx4 v[112:115], v5, s[24:27], s66 offen offset:0 sc1
v_mfma_f32_16x16x32_bf16 v[84:87], v[140:143], v[164:167], v[84:87]
buffer_load_dwordx4 v[116:119], v6, s[24:27], s67 offen offset:0 sc1
v_mfma_f32_16x16x32_bf16 v[28:31], v[144:147], v[152:155], v[28:31]
buffer_load_dwordx4 v[120:123], v6, s[24:27], s67 offen offset:256 sc1
v_mfma_f32_16x16x32_bf16 v[48:51], v[144:147], v[156:159], v[48:51]
buffer_load_dwordx4 v[124:127], v6, s[24:27], s68 offen offset:0 sc1
v_mfma_f32_16x16x32_bf16 v[68:71], v[144:147], v[160:163], v[68:71]
buffer_load_dwordx4 v[128:131], v6, s[24:27], s68 offen offset:256 sc1
v_mfma_f32_16x16x32_bf16 v[88:91], v[144:147], v[164:167], v[88:91]
v_mfma_f32_16x16x32_bf16 v[32:35], v[148:151], v[152:155], v[32:35]
v_mfma_f32_16x16x32_bf16 v[52:55], v[148:151], v[156:159], v[52:55]
v_mfma_f32_16x16x32_bf16 v[72:75], v[148:151], v[160:163], v[72:75]
v_mfma_f32_16x16x32_bf16 v[92:95], v[148:151], v[164:167], v[92:95]
s_waitcnt vmcnt(18)
v_mfma_f32_16x16x32_bf16 v[16:19], v[168:171], v[188:191], v[16:19]
s_add_u32 s65, s54, 24
v_mfma_f32_16x16x32_bf16 v[36:39], v[168:171], v[192:195], v[36:39]
s_mul_i32 s66, s65, 5120
v_mfma_f32_16x16x32_bf16 v[56:59], v[168:171], v[196:199], v[56:59]
s_lshl_b32 s67, s65, 11
v_mfma_f32_16x16x32_bf16 v[76:79], v[168:171], v[200:203], v[76:79]
s_add_u32 s66, s66, s62
v_mfma_f32_16x16x32_bf16 v[20:23], v[172:175], v[188:191], v[20:23]
s_add_u32 s67, s67, s63
v_mfma_f32_16x16x32_bf16 v[40:43], v[172:175], v[192:195], v[40:43]
s_add_u32 s68, s67, 110592
v_mfma_f32_16x16x32_bf16 v[60:63], v[172:175], v[196:199], v[60:63]
buffer_load_dwordx4 v[132:135], v4, s[24:27], s66 offen offset:0 sc1
v_mfma_f32_16x16x32_bf16 v[80:83], v[172:175], v[200:203], v[80:83]
buffer_load_dwordx4 v[136:139], v4, s[24:27], s66 offen offset:1024 sc1
v_mfma_f32_16x16x32_bf16 v[24:27], v[176:179], v[188:191], v[24:27]
buffer_load_dwordx4 v[140:143], v4, s[24:27], s66 offen offset:2048 sc1
v_mfma_f32_16x16x32_bf16 v[44:47], v[176:179], v[192:195], v[44:47]
buffer_load_dwordx4 v[144:147], v4, s[24:27], s66 offen offset:3072 sc1
v_mfma_f32_16x16x32_bf16 v[64:67], v[176:179], v[196:199], v[64:67]
buffer_load_dwordx4 v[148:151], v5, s[24:27], s66 offen offset:0 sc1
v_mfma_f32_16x16x32_bf16 v[84:87], v[176:179], v[200:203], v[84:87]
buffer_load_dwordx4 v[152:155], v6, s[24:27], s67 offen offset:0 sc1
v_mfma_f32_16x16x32_bf16 v[28:31], v[180:183], v[188:191], v[28:31]
buffer_load_dwordx4 v[156:159], v6, s[24:27], s67 offen offset:256 sc1
v_mfma_f32_16x16x32_bf16 v[48:51], v[180:183], v[192:195], v[48:51]
buffer_load_dwordx4 v[160:163], v6, s[24:27], s68 offen offset:0 sc1
v_mfma_f32_16x16x32_bf16 v[68:71], v[180:183], v[196:199], v[68:71]
buffer_load_dwordx4 v[164:167], v6, s[24:27], s68 offen offset:256 sc1
v_mfma_f32_16x16x32_bf16 v[88:91], v[180:183], v[200:203], v[88:91]
v_mfma_f32_16x16x32_bf16 v[32:35], v[184:187], v[188:191], v[32:35]
v_mfma_f32_16x16x32_bf16 v[52:55], v[184:187], v[192:195], v[52:55]
v_mfma_f32_16x16x32_bf16 v[72:75], v[184:187], v[196:199], v[72:75]
v_mfma_f32_16x16x32_bf16 v[92:95], v[184:187], v[200:203], v[92:95]
s_waitcnt vmcnt(18)
v_mfma_f32_16x16x32_bf16 v[16:19], v[204:207], v[224:227], v[16:19]
s_add_u32 s65, s54, 32
v_mfma_f32_16x16x32_bf16 v[36:39], v[204:207], v[228:231], v[36:39]
s_mul_i32 s66, s65, 5120
v_mfma_f32_16x16x32_bf16 v[56:59], v[204:207], v[232:235], v[56:59]
s_lshl_b32 s67, s65, 11
v_mfma_f32_16x16x32_bf16 v[76:79], v[204:207], v[236:239], v[76:79]
s_add_u32 s66, s66, s62
v_mfma_f32_16x16x32_bf16 v[20:23], v[208:211], v[224:227], v[20:23]
s_add_u32 s67, s67, s63
v_mfma_f32_16x16x32_bf16 v[40:43], v[208:211], v[228:231], v[40:43]
s_add_u32 s68, s67, 110592
v_mfma_f32_16x16x32_bf16 v[60:63], v[208:211], v[232:235], v[60:63]
buffer_load_dwordx4 v[168:171], v4, s[24:27], s66 offen offset:0 sc1
v_mfma_f32_16x16x32_bf16 v[80:83], v[208:211], v[236:239], v[80:83]
buffer_load_dwordx4 v[172:175], v4, s[24:27], s66 offen offset:1024 sc1
v_mfma_f32_16x16x32_bf16 v[24:27], v[212:215], v[224:227], v[24:27]
buffer_load_dwordx4 v[176:179], v4, s[24:27], s66 offen offset:2048 sc1
v_mfma_f32_16x16x32_bf16 v[44:47], v[212:215], v[228:231], v[44:47]
buffer_load_dwordx4 v[180:183], v4, s[24:27], s66 offen offset:3072 sc1
v_mfma_f32_16x16x32_bf16 v[64:67], v[212:215], v[232:235], v[64:67]
buffer_load_dwordx4 v[184:187], v5, s[24:27], s66 offen offset:0 sc1
v_mfma_f32_16x16x32_bf16 v[84:87], v[212:215], v[236:239], v[84:87]
buffer_load_dwordx4 v[188:191], v6, s[24:27], s67 offen offset:0 sc1
v_mfma_f32_16x16x32_bf16 v[28:31], v[216:219], v[224:227], v[28:31]
buffer_load_dwordx4 v[192:195], v6, s[24:27], s67 offen offset:256 sc1
v_mfma_f32_16x16x32_bf16 v[48:51], v[216:219], v[228:231], v[48:51]
buffer_load_dwordx4 v[196:199], v6, s[24:27], s68 offen offset:0 sc1
v_mfma_f32_16x16x32_bf16 v[68:71], v[216:219], v[232:235], v[68:71]
buffer_load_dwordx4 v[200:203], v6, s[24:27], s68 offen offset:256 sc1
v_mfma_f32_16x16x32_bf16 v[88:91], v[216:219], v[236:239], v[88:91]
v_mfma_f32_16x16x32_bf16 v[32:35], v[220:223], v[224:227], v[32:35]
v_mfma_f32_16x16x32_bf16 v[52:55], v[220:223], v[228:231], v[52:55]
v_mfma_f32_16x16x32_bf16 v[72:75], v[220:223], v[232:235], v[72:75]
v_mfma_f32_16x16x32_bf16 v[92:95], v[220:223], v[236:239], v[92:95]
s_waitcnt vmcnt(18)
v_mfma_f32_16x16x32_bf16 v[16:19], v[96:99], v[116:119], v[16:19]
s_add_u32 s65, s57, 44
v_mfma_f32_16x16x32_bf16 v[36:39], v[96:99], v[120:123], v[36:39]
s_mul_i32 s66, s65, 5120
v_mfma_f32_16x16x32_bf16 v[56:59], v[96:99], v[124:127], v[56:59]
s_lshl_b32 s67, s65, 11
v_mfma_f32_16x16x32_bf16 v[76:79], v[96:99], v[128:131], v[76:79]
s_add_u32 s66, s66, s62
v_mfma_f32_16x16x32_bf16 v[20:23], v[100:103], v[116:119], v[20:23]
s_add_u32 s67, s67, s63
v_mfma_f32_16x16x32_bf16 v[40:43], v[100:103], v[120:123], v[40:43]
s_add_u32 s68, s67, 110592
v_mfma_f32_16x16x32_bf16 v[60:63], v[100:103], v[124:127], v[60:63]
buffer_load_dwordx4 v[204:207], v4, s[24:27], s66 offen offset:0 sc1
v_mfma_f32_16x16x32_bf16 v[80:83], v[100:103], v[128:131], v[80:83]
buffer_load_dwordx4 v[208:211], v4, s[24:27], s66 offen offset:1024 sc1
v_mfma_f32_16x16x32_bf16 v[24:27], v[104:107], v[116:119], v[24:27]
buffer_load_dwordx4 v[212:215], v4, s[24:27], s66 offen offset:2048 sc1
v_mfma_f32_16x16x32_bf16 v[44:47], v[104:107], v[120:123], v[44:47]
buffer_load_dwordx4 v[216:219], v4, s[24:27], s66 offen offset:3072 sc1
v_mfma_f32_16x16x32_bf16 v[64:67], v[104:107], v[124:127], v[64:67]
buffer_load_dwordx4 v[220:223], v5, s[24:27], s66 offen offset:0 sc1
v_mfma_f32_16x16x32_bf16 v[84:87], v[104:107], v[128:131], v[84:87]
buffer_load_dwordx4 v[224:227], v6, s[24:27], s67 offen offset:0 sc1
v_mfma_f32_16x16x32_bf16 v[28:31], v[108:111], v[116:119], v[28:31]
buffer_load_dwordx4 v[228:231], v6, s[24:27], s67 offen offset:256 sc1
v_mfma_f32_16x16x32_bf16 v[48:51], v[108:111], v[120:123], v[48:51]
buffer_load_dwordx4 v[232:235], v6, s[24:27], s68 offen offset:0 sc1
v_mfma_f32_16x16x32_bf16 v[68:71], v[108:111], v[124:127], v[68:71]
buffer_load_dwordx4 v[236:239], v6, s[24:27], s68 offen offset:256 sc1
v_mfma_f32_16x16x32_bf16 v[88:91], v[108:111], v[128:131], v[88:91]
v_mfma_f32_16x16x32_bf16 v[32:35], v[112:115], v[116:119], v[32:35]
v_mfma_f32_16x16x32_bf16 v[52:55], v[112:115], v[120:123], v[52:55]
v_mfma_f32_16x16x32_bf16 v[72:75], v[112:115], v[124:127], v[72:75]
v_mfma_f32_16x16x32_bf16 v[92:95], v[112:115], v[128:131], v[92:95]
s_waitcnt vmcnt(18)
v_mfma_f32_16x16x32_bf16 v[16:19], v[132:135], v[152:155], v[16:19]
s_add_u32 s65, s57, 48
v_mfma_f32_16x16x32_bf16 v[36:39], v[132:135], v[156:159], v[36:39]
s_mul_i32 s66, s65, 5120
v_mfma_f32_16x16x32_bf16 v[56:59], v[132:135], v[160:163], v[56:59]
s_lshl_b32 s67, s65, 11
v_mfma_f32_16x16x32_bf16 v[76:79], v[132:135], v[164:167], v[76:79]
s_add_u32 s66, s66, s62
v_mfma_f32_16x16x32_bf16 v[20:23], v[136:139], v[152:155], v[20:23]
s_add_u32 s67, s67, s63
v_mfma_f32_16x16x32_bf16 v[40:43], v[136:139], v[156:159], v[40:43]
s_add_u32 s68, s67, 110592
v_mfma_f32_16x16x32_bf16 v[60:63], v[136:139], v[160:163], v[60:63]
buffer_load_dwordx4 v[96:99], v4, s[24:27], s66 offen offset:0 sc1
v_mfma_f32_16x16x32_bf16 v[80:83], v[136:139], v[164:167], v[80:83]
buffer_load_dwordx4 v[100:103], v4, s[24:27], s66 offen offset:1024 sc1
v_mfma_f32_16x16x32_bf16 v[24:27], v[140:143], v[152:155], v[24:27]
buffer_load_dwordx4 v[104:107], v4, s[24:27], s66 offen offset:2048 sc1
v_mfma_f32_16x16x32_bf16 v[44:47], v[140:143], v[156:159], v[44:47]
buffer_load_dwordx4 v[108:111], v4, s[24:27], s66 offen offset:3072 sc1
v_mfma_f32_16x16x32_bf16 v[64:67], v[140:143], v[160:163], v[64:67]
buffer_load_dwordx4 v[112:115], v5, s[24:27], s66 offen offset:0 sc1
v_mfma_f32_16x16x32_bf16 v[84:87], v[140:143], v[164:167], v[84:87]
buffer_load_dwordx4 v[116:119], v6, s[24:27], s67 offen offset:0 sc1
v_mfma_f32_16x16x32_bf16 v[28:31], v[144:147], v[152:155], v[28:31]
buffer_load_dwordx4 v[120:123], v6, s[24:27], s67 offen offset:256 sc1
v_mfma_f32_16x16x32_bf16 v[48:51], v[144:147], v[156:159], v[48:51]
buffer_load_dwordx4 v[124:127], v6, s[24:27], s68 offen offset:0 sc1
v_mfma_f32_16x16x32_bf16 v[68:71], v[144:147], v[160:163], v[68:71]
buffer_load_dwordx4 v[128:131], v6, s[24:27], s68 offen offset:256 sc1
v_mfma_f32_16x16x32_bf16 v[88:91], v[144:147], v[164:167], v[88:91]
v_mfma_f32_16x16x32_bf16 v[32:35], v[148:151], v[152:155], v[32:35]
v_mfma_f32_16x16x32_bf16 v[52:55], v[148:151], v[156:159], v[52:55]
v_mfma_f32_16x16x32_bf16 v[72:75], v[148:151], v[160:163], v[72:75]
v_mfma_f32_16x16x32_bf16 v[92:95], v[148:151], v[164:167], v[92:95]
s_waitcnt vmcnt(18)
v_mfma_f32_16x16x32_bf16 v[16:19], v[168:171], v[188:191], v[16:19]
s_add_u32 s65, s57, 52
v_mfma_f32_16x16x32_bf16 v[36:39], v[168:171], v[192:195], v[36:39]
s_min_u32 s65, s65, 53
v_mfma_f32_16x16x32_bf16 v[56:59], v[168:171], v[196:199], v[56:59]
s_mul_i32 s66, s65, 5120
v_mfma_f32_16x16x32_bf16 v[76:79], v[168:171], v[200:203], v[76:79]
s_lshl_b32 s67, s65, 11
v_mfma_f32_16x16x32_bf16 v[20:23], v[172:175], v[188:191], v[20:23]
s_add_u32 s66, s66, s62
v_mfma_f32_16x16x32_bf16 v[40:43], v[172:175], v[192:195], v[40:43]
s_add_u32 s67, s67, s63
v_mfma_f32_16x16x32_bf16 v[60:63], v[172:175], v[196:199], v[60:63]
s_add_u32 s68, s67, 110592
v_mfma_f32_16x16x32_bf16 v[80:83], v[172:175], v[200:203], v[80:83]
buffer_load_dwordx4 v[132:135], v4, s[24:27], s66 offen offset:0 sc1
v_mfma_f32_16x16x32_bf16 v[24:27], v[176:179], v[188:191], v[24:27]
buffer_load_dwordx4 v[136:139], v4, s[24:27], s66 offen offset:1024 sc1
v_mfma_f32_16x16x32_bf16 v[44:47], v[176:179], v[192:195], v[44:47]
buffer_load_dwordx4 v[140:143], v4, s[24:27], s66 offen offset:2048 sc1
v_mfma_f32_16x16x32_bf16 v[64:67], v[176:179], v[196:199], v[64:67]
buffer_load_dwordx4 v[144:147], v4, s[24:27], s66 offen offset:3072 sc1
v_mfma_f32_16x16x32_bf16 v[84:87], v[176:179], v[200:203], v[84:87]
buffer_load_dwordx4 v[148:151], v5, s[24:27], s66 offen offset:0 sc1
v_mfma_f32_16x16x32_bf16 v[28:31], v[180:183], v[188:191], v[28:31]
buffer_load_dwordx4 v[152:155], v6, s[24:27], s67 offen offset:0 sc1
v_mfma_f32_16x16x32_bf16 v[48:51], v[180:183], v[192:195], v[48:51]
buffer_load_dwordx4 v[156:159], v6, s[24:27], s67 offen offset:256 sc1
v_mfma_f32_16x16x32_bf16 v[68:71], v[180:183], v[196:199], v[68:71]
buffer_load_dwordx4 v[160:163], v6, s[24:27], s68 offen offset:0 sc1
v_mfma_f32_16x16x32_bf16 v[88:91], v[180:183], v[200:203], v[88:91]
buffer_load_dwordx4 v[164:167], v6, s[24:27], s68 offen offset:256 sc1
v_mfma_f32_16x16x32_bf16 v[32:35], v[184:187], v[188:191], v[32:35]
v_mfma_f32_16x16x32_bf16 v[52:55], v[184:187], v[192:195], v[52:55]
v_mfma_f32_16x16x32_bf16 v[72:75], v[184:187], v[196:199], v[72:75]
v_mfma_f32_16x16x32_bf16 v[92:95], v[184:187], v[200:203], v[92:95]
s_waitcnt vmcnt(18)
v_mfma_f32_16x16x32_bf16 v[16:19], v[204:207], v[224:227], v[16:19]
s_add_u32 s65, s57, 54
v_mfma_f32_16x16x32_bf16 v[36:39], v[204:207], v[228:231], v[36:39]
s_mul_i32 s66, s65, 5120
v_mfma_f32_16x16x32_bf16 v[56:59], v[204:207], v[232:235], v[56:59]
s_lshl_b32 s67, s65, 11
v_mfma_f32_16x16x32_bf16 v[76:79], v[204:207], v[236:239], v[76:79]
s_add_u32 s66, s66, s62
v_mfma_f32_16x16x32_bf16 v[20:23], v[208:211], v[224:227], v[20:23]
s_add_u32 s67, s67, s64
v_mfma_f32_16x16x32_bf16 v[40:43], v[208:211], v[228:231], v[40:43]
s_add_u32 s68, s67, 40960
v_mfma_f32_16x16x32_bf16 v[60:63], v[208:211], v[232:235], v[60:63]
buffer_load_dwordx4 v[168:171], v4, s[24:27], s66 offen offset:0 sc1
v_mfma_f32_16x16x32_bf16 v[80:83], v[208:211], v[236:239], v[80:83]
buffer_load_dwordx4 v[172:175], v4, s[24:27], s66 offen offset:1024 sc1
v_mfma_f32_16x16x32_bf16 v[24:27], v[212:215], v[224:227], v[24:27]
buffer_load_dwordx4 v[176:179], v4, s[24:27], s66 offen offset:2048 sc1
v_mfma_f32_16x16x32_bf16 v[44:47], v[212:215], v[228:231], v[44:47]
buffer_load_dwordx4 v[180:183], v4, s[24:27], s66 offen offset:3072 sc1
v_mfma_f32_16x16x32_bf16 v[64:67], v[212:215], v[232:235], v[64:67]
buffer_load_dwordx4 v[184:187], v5, s[24:27], s66 offen offset:0 sc1
v_mfma_f32_16x16x32_bf16 v[84:87], v[212:215], v[236:239], v[84:87]
v_mfma_f32_16x16x32_bf16 v[28:31], v[216:219], v[224:227], v[28:31]
v_mfma_f32_16x16x32_bf16 v[48:51], v[216:219], v[228:231], v[48:51]
v_mfma_f32_16x16x32_bf16 v[68:71], v[216:219], v[232:235], v[68:71]
v_mfma_f32_16x16x32_bf16 v[88:91], v[216:219], v[236:239], v[88:91]
v_mfma_f32_16x16x32_bf16 v[32:35], v[220:223], v[224:227], v[32:35]
v_mfma_f32_16x16x32_bf16 v[52:55], v[220:223], v[228:231], v[52:55]
v_mfma_f32_16x16x32_bf16 v[72:75], v[220:223], v[232:235], v[72:75]
v_mfma_f32_16x16x32_bf16 v[92:95], v[220:223], v[236:239], v[92:95]
s_waitcnt vmcnt(14)
v_mfma_f32_16x16x32_bf16 v[16:19], v[96:99], v[116:119], v[16:19]
s_add_u32 s65, s57, 58
v_mfma_f32_16x16x32_bf16 v[36:39], v[96:99], v[120:123], v[36:39]
s_mul_i32 s66, s65, 5120
v_mfma_f32_16x16x32_bf16 v[56:59], v[96:99], v[124:127], v[56:59]
s_lshl_b32 s67, s65, 11
v_mfma_f32_16x16x32_bf16 v[76:79], v[96:99], v[128:131], v[76:79]
s_add_u32 s66, s66, s62
v_mfma_f32_16x16x32_bf16 v[20:23], v[100:103], v[116:119], v[20:23]
s_add_u32 s67, s67, s64
v_mfma_f32_16x16x32_bf16 v[40:43], v[100:103], v[120:123], v[40:43]
s_add_u32 s68, s67, 40960
v_mfma_f32_16x16x32_bf16 v[60:63], v[100:103], v[124:127], v[60:63]
buffer_load_dwordx4 v[204:207], v4, s[24:27], s66 offen offset:0 sc1
v_mfma_f32_16x16x32_bf16 v[80:83], v[100:103], v[128:131], v[80:83]
buffer_load_dwordx4 v[208:211], v4, s[24:27], s66 offen offset:1024 sc1
v_mfma_f32_16x16x32_bf16 v[24:27], v[104:107], v[116:119], v[24:27]
buffer_load_dwordx4 v[212:215], v4, s[24:27], s66 offen offset:2048 sc1
v_mfma_f32_16x16x32_bf16 v[44:47], v[104:107], v[120:123], v[44:47]
buffer_load_dwordx4 v[216:219], v4, s[24:27], s66 offen offset:3072 sc1
v_mfma_f32_16x16x32_bf16 v[64:67], v[104:107], v[124:127], v[64:67]
buffer_load_dwordx4 v[220:223], v5, s[24:27], s66 offen offset:0 sc1
v_mfma_f32_16x16x32_bf16 v[84:87], v[104:107], v[128:131], v[84:87]
v_mfma_f32_16x16x32_bf16 v[28:31], v[108:111], v[116:119], v[28:31]
v_mfma_f32_16x16x32_bf16 v[48:51], v[108:111], v[120:123], v[48:51]
v_mfma_f32_16x16x32_bf16 v[68:71], v[108:111], v[124:127], v[68:71]
v_mfma_f32_16x16x32_bf16 v[88:91], v[108:111], v[128:131], v[88:91]
v_mfma_f32_16x16x32_bf16 v[32:35], v[112:115], v[116:119], v[32:35]
v_mfma_f32_16x16x32_bf16 v[52:55], v[112:115], v[120:123], v[52:55]
v_mfma_f32_16x16x32_bf16 v[72:75], v[112:115], v[124:127], v[72:75]
v_mfma_f32_16x16x32_bf16 v[92:95], v[112:115], v[128:131], v[92:95]
s_lshl_b32 s43, s60, 12
s_add_u32 s43, s43, 131072
v_and_b32 v250, 31, v2
v_lshlrev_b32 v250, 7, v250
buffer_load_dword v251, v250, s[24:27], s43 offen offset:64 sc1
s_add_u32 s65, s57, 62
s_mul_i32 s66, s65, 5120
s_lshl_b32 s67, s65, 11
s_add_u32 s66, s66, s62
s_add_u32 s67, s67, s64
s_add_u32 s68, s67, 40960
buffer_load_dwordx4 v[96:99], v4, s[24:27], s66 offen offset:0 sc1
buffer_load_dwordx4 v[100:103], v4, s[24:27], s66 offen offset:1024 sc1
buffer_load_dwordx4 v[104:107], v4, s[24:27], s66 offen offset:2048 sc1
buffer_load_dwordx4 v[108:111], v4, s[24:27], s66 offen offset:3072 sc1
buffer_load_dwordx4 v[112:115], v5, s[24:27], s66 offen offset:0 sc1
s_cmp_ge_u32 s57, 2
s_cbranch_scc1 HS_10_skip
s_waitcnt vmcnt(16)
v_mfma_f32_16x16x32_bf16 v[16:19], v[132:135], v[152:155], v[16:19]
v_mfma_f32_16x16x32_bf16 v[36:39], v[132:135], v[156:159], v[36:39]
v_mfma_f32_16x16x32_bf16 v[56:59], v[132:135], v[160:163], v[56:59]
v_mfma_f32_16x16x32_bf16 v[76:79], v[132:135], v[164:167], v[76:79]
v_mfma_f32_16x16x32_bf16 v[20:23], v[136:139], v[152:155], v[20:23]
v_mfma_f32_16x16x32_bf16 v[40:43], v[136:139], v[156:159], v[40:43]
v_mfma_f32_16x16x32_bf16 v[60:63], v[136:139], v[160:163], v[60:63]
v_mfma_f32_16x16x32_bf16 v[80:83], v[136:139], v[164:167], v[80:83]
v_mfma_f32_16x16x32_bf16 v[24:27], v[140:143], v[152:155], v[24:27]
v_mfma_f32_16x16x32_bf16 v[44:47], v[140:143], v[156:159], v[44:47]
v_mfma_f32_16x16x32_bf16 v[64:67], v[140:143], v[160:163], v[64:67]
v_mfma_f32_16x16x32_bf16 v[84:87], v[140:143], v[164:167], v[84:87]
v_mfma_f32_16x16x32_bf16 v[28:31], v[144:147], v[152:155], v[28:31]
v_mfma_f32_16x16x32_bf16 v[48:51], v[144:147], v[156:159], v[48:51]
v_mfma_f32_16x16x32_bf16 v[68:71], v[144:147], v[160:163], v[68:71]
v_mfma_f32_16x16x32_bf16 v[88:91], v[144:147], v[164:167], v[88:91]
v_mfma_f32_16x16x32_bf16 v[32:35], v[148:151], v[152:155], v[32:35]
v_mfma_f32_16x16x32_bf16 v[52:55], v[148:151], v[156:159], v[52:55]
v_mfma_f32_16x16x32_bf16 v[72:75], v[148:151], v[160:163], v[72:75]
v_mfma_f32_16x16x32_bf16 v[92:95], v[148:151], v[164:167], v[92:95]
HS_10_skip:
s_waitcnt vmcnt(5)
v_cmp_eq_u32 vcc, s0, v251
s_nop 0
s_cmp_eq_u64 vcc, -1
s_cbranch_scc1 HS_10_o1k
s_lshl_b32 s43, s60, 12
s_add_u32 s43, s43, 131072
s_mov_b32 s1, 20000
s_mov_b32 exec_lo, -1
s_mov_b32 exec_hi, 0
HS_10_fo1:
buffer_load_dword v251, v250, s[24:27], s43 offen offset:64 sc1
s_waitcnt vmcnt(0)
v_cmp_eq_u32 vcc, s0, v251
s_nop 0
s_cmp_eq_u64 vcc, exec
s_cbranch_scc1 HS_10_fo1_ok
s_sub_u32 s1, s1, 1
s_cmp_lg_u32 s1, 0
s_cbranch_scc1 HS_10_fo1
HS_10_fo1_ok:
s_mov_b64 exec, -1
HS_10_o1k:
s_add_u32 s65, s57, 54
s_mul_i32 s66, s65, 5120
s_lshl_b32 s67, s65, 11
s_add_u32 s66, s66, s62
s_add_u32 s67, s67, s64
s_add_u32 s68, s67, 40960
buffer_load_dwordx4 v[188:191], v6, s[24:27], s67 offen offset:0 sc1
buffer_load_dwordx4 v[192:195], v6, s[24:27], s67 offen offset:256 sc1
s_add_u32 s65, s57, 58
s_mul_i32 s66, s65, 5120
s_lshl_b32 s67, s65, 11
s_add_u32 s66, s66, s62
s_add_u32 s67, s67, s64
s_add_u32 s68, s67, 40960
buffer_load_dwordx4 v[224:227], v6, s[24:27], s67 offen offset:0 sc1
buffer_load_dwordx4 v[228:231], v6, s[24:27], s67 offen offset:256 sc1
s_add_u32 s65, s57, 62
s_mul_i32 s66, s65, 5120
s_lshl_b32 s67, s65, 11
s_add_u32 s66, s66, s62
s_add_u32 s67, s67, s64
s_add_u32 s68, s67, 40960
buffer_load_dwordx4 v[116:119], v6, s[24:27], s67 offen offset:0 sc1
buffer_load_dwordx4 v[120:123], v6, s[24:27], s67 offen offset:256 sc1
s_add_u32 s65, s57, 66
s_mul_i32 s66, s65, 5120
s_lshl_b32 s67, s65, 11
s_add_u32 s66, s66, s62
s_add_u32 s67, s67, s64
s_add_u32 s68, s67, 40960
buffer_load_dwordx4 v[132:135], v4, s[24:27], s66 offen offset:0 sc1
buffer_load_dwordx4 v[136:139], v4, s[24:27], s66 offen offset:1024 sc1
buffer_load_dwordx4 v[140:143], v4, s[24:27], s66 offen offset:2048 sc1
buffer_load_dwordx4 v[144:147], v4, s[24:27], s66 offen offset:3072 sc1
buffer_load_dwordx4 v[148:151], v5, s[24:27], s66 offen offset:0 sc1
buffer_load_dwordx4 v[152:155], v6, s[24:27], s67 offen offset:0 sc1
buffer_load_dwordx4 v[156:159], v6, s[24:27], s67 offen offset:256 sc1
s_add_u32 s65, s57, 70
s_mul_i32 s66, s65, 5120
s_lshl_b32 s67, s65, 11
s_add_u32 s66, s66, s62
s_add_u32 s67, s67, s64
s_add_u32 s68, s67, 40960
buffer_load_dwordx4 v[124:127], v4, s[24:27], s66 offen offset:0 sc1
buffer_load_dwordx4 v[128:131], v4, s[24:27], s66 offen offset:1024 sc1
buffer_load_dwordx4 v[160:163], v4, s[24:27], s66 offen offset:2048 sc1
buffer_load_dwordx4 v[164:167], v4, s[24:27], s66 offen offset:3072 sc1
buffer_load_dwordx4 v[196:199], v5, s[24:27], s66 offen offset:0 sc1
buffer_load_dwordx4 v[200:203], v6, s[24:27], s67 offen offset:0 sc1
buffer_load_dwordx4 v[232:235], v6, s[24:27], s67 offen offset:256 sc1
s_lshl_b32 s43, s60, 12
s_add_u32 s43, s43, 131072
v_and_b32 v250, 31, v2
v_lshlrev_b32 v250, 7, v250
s_waitcnt vmcnt(18)
v_mfma_f32_16x16x32_bf16 v[16:19], v[168:171], v[188:191], v[16:19]
v_mfma_f32_16x16x32_bf16 v[36:39], v[168:171], v[192:195], v[36:39]
v_mfma_f32_16x16x32_bf16 v[20:23], v[172:175], v[188:191], v[20:23]
v_mfma_f32_16x16x32_bf16 v[40:43], v[172:175], v[192:195], v[40:43]
v_mfma_f32_16x16x32_bf16 v[24:27], v[176:179], v[188:191], v[24:27]
v_mfma_f32_16x16x32_bf16 v[44:47], v[176:179], v[192:195], v[44:47]
v_mfma_f32_16x16x32_bf16 v[28:31], v[180:183], v[188:191], v[28:31]
v_mfma_f32_16x16x32_bf16 v[48:51], v[180:183], v[192:195], v[48:51]
v_mfma_f32_16x16x32_bf16 v[32:35], v[184:187], v[188:191], v[32:35]
v_mfma_f32_16x16x32_bf16 v[52:55], v[184:187], v[192:195], v[52:55]
s_waitcnt vmcnt(16)
buffer_load_dword v251, v250, s[24:27], s43 offen sc1
v_mfma_f32_16x16x32_bf16 v[16:19], v[204:207], v[224:227], v[16:19]
v_mfma_f32_16x16x32_bf16 v[36:39], v[204:207], v[228:231], v[36:39]
v_mfma_f32_16x16x32_bf16 v[20:23], v[208:211], v[224:227], v[20:23]
v_mfma_f32_16x16x32_bf16 v[40:43], v[208:211], v[228:231], v[40:43]
v_mfma_f32_16x16x32_bf16 v[24:27], v[212:215], v[224:227], v[24:27]
v_mfma_f32_16x16x32_bf16 v[44:47], v[212:215], v[228:231], v[44:47]
v_mfma_f32_16x16x32_bf16 v[28:31], v[216:219], v[224:227], v[28:31]
v_mfma_f32_16x16x32_bf16 v[48:51], v[216:219], v[228:231], v[48:51]
v_mfma_f32_16x16x32_bf16 v[32:35], v[220:223], v[224:227], v[32:35]
v_mfma_f32_16x16x32_bf16 v[52:55], v[220:223], v[228:231], v[52:55]
s_waitcnt vmcnt(15)
v_mfma_f32_16x16x32_bf16 v[16:19], v[96:99], v[116:119], v[16:19]
v_mfma_f32_16x16x32_bf16 v[36:39], v[96:99], v[120:123], v[36:39]
v_mfma_f32_16x16x32_bf16 v[20:23], v[100:103], v[116:119], v[20:23]
v_mfma_f32_16x16x32_bf16 v[40:43], v[100:103], v[120:123], v[40:43]
v_mfma_f32_16x16x32_bf16 v[24:27], v[104:107], v[116:119], v[24:27]
v_mfma_f32_16x16x32_bf16 v[44:47], v[104:107], v[120:123], v[44:47]
v_mfma_f32_16x16x32_bf16 v[28:31], v[108:111], v[116:119], v[28:31]
v_mfma_f32_16x16x32_bf16 v[48:51], v[108:111], v[120:123], v[48:51]
v_mfma_f32_16x16x32_bf16 v[32:35], v[112:115], v[116:119], v[32:35]
v_mfma_f32_16x16x32_bf16 v[52:55], v[112:115], v[120:123], v[52:55]
s_waitcnt vmcnt(8)
v_mfma_f32_16x16x32_bf16 v[16:19], v[132:135], v[152:155], v[16:19]
v_mfma_f32_16x16x32_bf16 v[36:39], v[132:135], v[156:159], v[36:39]
v_mfma_f32_16x16x32_bf16 v[20:23], v[136:139], v[152:155], v[20:23]
v_mfma_f32_16x16x32_bf16 v[40:43], v[136:139], v[156:159], v[40:43]
v_mfma_f32_16x16x32_bf16 v[24:27], v[140:143], v[152:155], v[24:27]
v_mfma_f32_16x16x32_bf16 v[44:47], v[140:143], v[156:159], v[44:47]
v_mfma_f32_16x16x32_bf16 v[28:31], v[144:147], v[152:155], v[28:31]
v_mfma_f32_16x16x32_bf16 v[48:51], v[144:147], v[156:159], v[48:51]
v_mfma_f32_16x16x32_bf16 v[32:35], v[148:151], v[152:155], v[32:35]
v_mfma_f32_16x16x32_bf16 v[52:55], v[148:151], v[156:159], v[52:55]
s_waitcnt vmcnt(1)
v_mfma_f32_16x16x32_bf16 v[16:19], v[124:127], v[200:203], v[16:19]
v_mfma_f32_16x16x32_bf16 v[36:39], v[124:127], v[232:235], v[36:39]
v_mfma_f32_16x16x32_bf16 v[20:23], v[128:131], v[200:203], v[20:23]
v_mfma_f32_16x16x32_bf16 v[40:43], v[128:131], v[232:235], v[40:43]
v_mfma_f32_16x16x32_bf16 v[24:27], v[160:163], v[200:203], v[24:27]
v_mfma_f32_16x16x32_bf16 v[44:47], v[160:163], v[232:235], v[44:47]
v_mfma_f32_16x16x32_bf16 v[28:31], v[164:167], v[200:203], v[28:31]
v_mfma_f32_16x16x32_bf16 v[48:51], v[164:167], v[232:235], v[48:51]
v_mfma_f32_16x16x32_bf16 v[32:35], v[196:199], v[200:203], v[32:35]
v_mfma_f32_16x16x32_bf16 v[52:55], v[196:199], v[232:235], v[52:55]
v_lshlrev_b32 v9, 4, v2
v_mov_b32 v14, 32
s_mov_b32 s1, 160000
R3_wa:
ds_read_b128 v[10:13], v14
s_waitcnt lgkmcnt(0)
v_min_u32 v10, v10, v11
v_min3_u32 v10, v10, v12, v13
s_nop 0
v_readfirstlane_b32 s40, v10
s_cmp_lg_u32 s40, 0
s_cbranch_scc1 R3_wa_ok
s_sub_u32 s1, s1, 1
s_cmp_lg_u32 s1, 0
s_cbranch_scc1 R3_wa
R3_wa_ok:
s_sub_u32 s40, s3, 4
s_mul_i32 s41, s40, 20480
v_add_u32 v10, s41, v9
s_lshl_b32 s40, s40, 2
s_add_u32 s41, s40, 48
v_mov_b32 v11, s41
v_mov_b32 v12, 1
s_add_u32 s41, s40, 64
v_mov_b32 v13, s41
s_waitcnt vmcnt(0)
v_cmp_eq_u32 vcc, s0, v251
s_nop 0
s_cmp_eq_u64 vcc, -1
s_cbranch_scc1 HS_10_o2e
ds_write_b128 v10, v[16:19] offset:512
ds_write_b128 v10, v[20:23] offset:1536
ds_write_b128 v10, v[24:27] offset:2560
ds_write_b128 v10, v[28:31] offset:3584
ds_write_b128 v10, v[32:35] offset:4608
ds_write_b128 v10, v[36:39] offset:5632
ds_write_b128 v10, v[40:43] offset:6656
ds_write_b128 v10, v[44:47] offset:7680
ds_write_b128 v10, v[48:51] offset:8704
ds_write_b128 v10, v[52:55] offset:9728
s_waitcnt lgkmcnt(0)
ds_write_b32 v11, v12
s_mov_b32 s1, 20000
s_mov_b32 exec_lo, -1
s_mov_b32 exec_hi, 0
HS_10_fo2:
buffer_load_dword v251, v250, s[24:27], s43 offen offset:0 sc1
s_waitcnt vmcnt(0)
v_cmp_eq_u32 vcc, s0, v251
s_nop 0
s_cmp_eq_u64 vcc, exec
s_cbranch_scc1 HS_10_fo2_ok
s_sub_u32 s1, s1, 1
s_cmp_lg_u32 s1, 0
s_cbranch_scc1 HS_10_fo2
HS_10_fo2_ok:
s_mov_b64 exec, -1
s_add_u32 s65, s57, 54
s_mul_i32 s66, s65, 5120
s_lshl_b32 s67, s65, 11
s_add_u32 s66, s66, s62
s_add_u32 s67, s67, s64
s_add_u32 s68, s67, 40960
buffer_load_dwordx4 v[188:191], v6, s[24:27], s68 offen offset:0 sc1
buffer_load_dwordx4 v[192:195], v6, s[24:27], s68 offen offset:256 sc1
s_add_u32 s65, s57, 58
s_mul_i32 s66, s65, 5120
s_lshl_b32 s67, s65, 11
s_add_u32 s66, s66, s62
s_add_u32 s67, s67, s64
s_add_u32 s68, s67, 40960
buffer_load_dwordx4 v[224:227], v6, s[24:27], s68 offen offset:0 sc1
buffer_load_dwordx4 v[228:231], v6, s[24:27], s68 offen offset:256 sc1
s_add_u32 s65, s57, 62
s_mul_i32 s66, s65, 5120
s_lshl_b32 s67, s65, 11
s_add_u32 s66, s66, s62
s_add_u32 s67, s67, s64
s_add_u32 s68, s67, 40960
buffer_load_dwordx4 v[116:119], v6, s[24:27], s68 offen offset:0 sc1
buffer_load_dwordx4 v[120:123], v6, s[24:27], s68 offen offset:256 sc1
s_add_u32 s65, s57, 66
s_mul_i32 s66, s65, 5120
s_lshl_b32 s67, s65, 11
s_add_u32 s66, s66, s62
s_add_u32 s67, s67, s64
s_add_u32 s68, s67, 40960
buffer_load_dwordx4 v[152:155], v6, s[24:27], s68 offen offset:0 sc1
buffer_load_dwordx4 v[156:159], v6, s[24:27], s68 offen offset:256 sc1
s_add_u32 s65, s57, 70
s_mul_i32 s66, s65, 5120
s_lshl_b32 s67, s65, 11
s_add_u32 s66, s66, s62
s_add_u32 s67, s67, s64
s_add_u32 s68, s67, 40960
buffer_load_dwordx4 v[200:203], v6, s[24:27], s68 offen offset:0 sc1
buffer_load_dwordx4 v[232:235], v6, s[24:27], s68 offen offset:256 sc1
s_branch HS_10_o2j
HS_10_o2e:
s_add_u32 s65, s57, 54
s_mul_i32 s66, s65, 5120
s_lshl_b32 s67, s65, 11
s_add_u32 s66, s66, s62
s_add_u32 s67, s67, s64
s_add_u32 s68, s67, 40960
buffer_load_dwordx4 v[188:191], v6, s[24:27], s68 offen offset:0 sc1
buffer_load_dwordx4 v[192:195], v6, s[24:27], s68 offen offset:256 sc1
s_add_u32 s65, s57, 58
s_mul_i32 s66, s65, 5120
s_lshl_b32 s67, s65, 11
s_add_u32 s66, s66, s62
s_add_u32 s67, s67, s64
s_add_u32 s68, s67, 40960
buffer_load_dwordx4 v[224:227], v6, s[24:27], s68 offen offset:0 sc1
buffer_load_dwordx4 v[228:231], v6, s[24:27], s68 offen offset:256 sc1
s_add_u32 s65, s57, 62
s_mul_i32 s66, s65, 5120
s_lshl_b32 s67, s65, 11
s_add_u32 s66, s66, s62
s_add_u32 s67, s67, s64
s_add_u32 s68, s67, 40960
buffer_load_dwordx4 v[116:119], v6, s[24:27], s68 offen offset:0 sc1
buffer_load_dwordx4 v[120:123], v6, s[24:27], s68 offen offset:256 sc1
s_add_u32 s65, s57, 66
s_mul_i32 s66, s65, 5120
s_lshl_b32 s67, s65, 11
s_add_u32 s66, s66, s62
s_add_u32 s67, s67, s64
s_add_u32 s68, s67, 40960
buffer_load_dwordx4 v[152:155], v6, s[24:27], s68 offen offset:0 sc1
buffer_load_dwordx4 v[156:159], v6, s[24:27], s68 offen offset:256 sc1
s_add_u32 s65, s57, 70
s_mul_i32 s66, s65, 5120
s_lshl_b32 s67, s65, 11
s_add_u32 s66, s66, s62
s_add_u32 s67, s67, s64
s_add_u32 s68, s67, 40960
buffer_load_dwordx4 v[200:203], v6, s[24:27], s68 offen offset:0 sc1
buffer_load_dwordx4 v[232:235], v6, s[24:27], s68 offen offset:256 sc1
ds_write_b128 v10, v[16:19] offset:512
ds_write_b128 v10, v[20:23] offset:1536
ds_write_b128 v10, v[24:27] offset:2560
ds_write_b128 v10, v[28:31] offset:3584
ds_write_b128 v10, v[32:35] offset:4608
ds_write_b128 v10, v[36:39] offset:5632
ds_write_b128 v10, v[40:43] offset:6656
ds_write_b128 v10, v[44:47] offset:7680
ds_write_b128 v10, v[48:51] offset:8704
ds_write_b128 v10, v[52:55] offset:9728
s_waitcnt lgkmcnt(0)
ds_write_b32 v11, v12
HS_10_o2j:
s_waitcnt vmcnt(8)
v_mfma_f32_16x16x32_bf16 v[56:59], v[168:171], v[188:191], v[56:59]
v_mfma_f32_16x16x32_bf16 v[76:79], v[168:171], v[192:195], v[76:79]
v_mfma_f32_16x16x32_bf16 v[60:63], v[172:175], v[188:191], v[60:63]
v_mfma_f32_16x16x32_bf16 v[80:83], v[172:175], v[192:195], v[80:83]
v_mfma_f32_16x16x32_bf16 v[64:67], v[176:179], v[188:191], v[64:67]
v_mfma_f32_16x16x32_bf16 v[84:87], v[176:179], v[192:195], v[84:87]
v_mfma_f32_16x16x32_bf16 v[68:71], v[180:183], v[188:191], v[68:71]
v_mfma_f32_16x16x32_bf16 v[88:91], v[180:183], v[192:195], v[88:91]
v_mfma_f32_16x16x32_bf16 v[72:75], v[184:187], v[188:191], v[72:75]
v_mfma_f32_16x16x32_bf16 v[92:95], v[184:187], v[192:195], v[92:95]
s_waitcnt vmcnt(6)
v_mfma_f32_16x16x32_bf16 v[56:59], v[204:207], v[224:227], v[56:59]
v_mfma_f32_16x16x32_bf16 v[76:79], v[204:207], v[228:231], v[76:79]
v_mfma_f32_16x16x32_bf16 v[60:63], v[208:211], v[224:227], v[60:63]
v_mfma_f32_16x16x32_bf16 v[80:83], v[208:211], v[228:231], v[80:83]
v_mfma_f32_16x16x32_bf16 v[64:67], v[212:215], v[224:227], v[64:67]
v_mfma_f32_16x16x32_bf16 v[84:87], v[212:215], v[228:231], v[84:87]
v_mfma_f32_16x16x32_bf16 v[68:71], v[216:219], v[224:227], v[68:71]
v_mfma_f32_16x16x32_bf16 v[88:91], v[216:219], v[228:231], v[88:91]
v_mfma_f32_16x16x32_bf16 v[72:75], v[220:223], v[224:227], v[72:75]
v_mfma_f32_16x16x32_bf16 v[92:95], v[220:223], v[228:231], v[92:95]
s_waitcnt vmcnt(4)
v_mfma_f32_16x16x32_bf16 v[56:59], v[96:99], v[116:119], v[56:59]
v_mfma_f32_16x16x32_bf16 v[76:79], v[96:99], v[120:123], v[76:79]
v_mfma_f32_16x16x32_bf16 v[60:63], v[100:103], v[116:119], v[60:63]
v_mfma_f32_16x16x32_bf16 v[80:83], v[100:103], v[120:123], v[80:83]
v_mfma_f32_16x16x32_bf16 v[64:67], v[104:107], v[116:119], v[64:67]
v_mfma_f32_16x16x32_bf16 v[84:87], v[104:107], v[120:123], v[84:87]
v_mfma_f32_16x16x32_bf16 v[68:71], v[108:111], v[116:119], v[68:71]
v_mfma_f32_16x16x32_bf16 v[88:91], v[108:111], v[120:123], v[88:91]
v_mfma_f32_16x16x32_bf16 v[72:75], v[112:115], v[116:119], v[72:75]
v_mfma_f32_16x16x32_bf16 v[92:95], v[112:115], v[120:123], v[92:95]
s_waitcnt vmcnt(2)
v_mfma_f32_16x16x32_bf16 v[56:59], v[132:135], v[152:155], v[56:59]
v_mfma_f32_16x16x32_bf16 v[76:79], v[132:135], v[156:159], v[76:79]
v_mfma_f32_16x16x32_bf16 v[60:63], v[136:139], v[152:155], v[60:63]
v_mfma_f32_16x16x32_bf16 v[80:83], v[136:139], v[156:159], v[80:83]
v_mfma_f32_16x16x32_bf16 v[64:67], v[140:143], v[152:155], v[64:67]
v_mfma_f32_16x16x32_bf16 v[84:87], v[140:143], v[156:159], v[84:87]
v_mfma_f32_16x16x32_bf16 v[68:71], v[144:147], v[152:155], v[68:71]
v_mfma_f32_16x16x32_bf16 v[88:91], v[144:147], v[156:159], v[88:91]
v_mfma_f32_16x16x32_bf16 v[72:75], v[148:151], v[152:155], v[72:75]
v_mfma_f32_16x16x32_bf16 v[92:95], v[148:151], v[156:159], v[92:95]
s_waitcnt vmcnt(0)
v_mfma_f32_16x16x32_bf16 v[56:59], v[124:127], v[200:203], v[56:59]
v_mfma_f32_16x16x32_bf16 v[76:79], v[124:127], v[232:235], v[76:79]
v_mfma_f32_16x16x32_bf16 v[60:63], v[128:131], v[200:203], v[60:63]
v_mfma_f32_16x16x32_bf16 v[80:83], v[128:131], v[232:235], v[80:83]
v_mfma_f32_16x16x32_bf16 v[64:67], v[160:163], v[200:203], v[64:67]
v_mfma_f32_16x16x32_bf16 v[84:87], v[160:163], v[232:235], v[84:87]
v_mfma_f32_16x16x32_bf16 v[68:71], v[164:167], v[200:203], v[68:71]
v_mfma_f32_16x16x32_bf16 v[88:91], v[164:167], v[232:235], v[88:91]
v_mfma_f32_16x16x32_bf16 v[72:75], v[196:199], v[200:203], v[72:75]
v_mfma_f32_16x16x32_bf16 v[92:95], v[196:199], v[232:235], v[92:95]
s_nop 7
s_nop 1
ds_write_b128 v10, v[56:59] offset:10752
ds_write_b128 v10, v[76:79] offset:15872
ds_write_b128 v10, v[60:63] offset:11776
ds_write_b128 v10, v[80:83] offset:16896
ds_write_b128 v10, v[64:67] offset:12800
ds_write_b128 v10, v[84:87] offset:17920
ds_write_b128 v10, v[68:71] offset:13824
ds_write_b128 v10, v[88:91] offset:18944
ds_write_b128 v10, v[72:75] offset:14848
ds_write_b128 v10, v[92:95] offset:19968
s_waitcnt lgkmcnt(0)
s_barrier
s_branch F_fin
F_fin:
F_exit:
s_endpgm
.section .rodata,"a"
.p2align 6
.p2align 6
.amdhsa_kernel parallel_sum__sliding_block__glu_gated_reglu__prompt_kernel
  .amdhsa_next_free_vgpr 256
  .amdhsa_next_free_sgpr 102
  .amdhsa_accum_offset 256
  .amdhsa_group_segment_fixed_size 0
  .amdhsa_kernarg_size 80
  .amdhsa_user_sgpr_count 2
  .amdhsa_user_sgpr_kernarg_segment_ptr 1
  .amdhsa_system_sgpr_workgroup_id_x 1
  .amdhsa_float_denorm_mode_32 3
.end_amdhsa_kernel
```
